```python
import torch

def _softmax(x, axis=-1):
    return torch.softmax(x, dim=axis)
def _gelu(x):
    return torch.nn.functional.gelu(x, approximate="tanh")
def _silu(x):
    return torch.nn.functional.silu(x)
def _sigmoid(x):
    return torch.sigmoid(x)
def _layernorm(x, axis=-1, eps=1e-5):
    m = x.mean(dim=axis, keepdim=True)
    v = x.var(dim=axis, keepdim=True, unbiased=False)
    return (x - m) / torch.sqrt(v + eps)
def _scatter_add(tgt, idx, src, axis=0):
    return tgt.clone().index_add_(axis, idx, src)
def _segment_sum(src, seg, n):
    out = torch.zeros((n,) + src.shape[1:], dtype=src.dtype)
    return out.index_add_(0, seg, src)
def _pad(x, pw):
    flat = tuple(v for pair in reversed(pw) for v in pair)
    return torch.nn.functional.pad(x, flat)

kernel_name = 'recurrent_scan__mha_block_cached__glu_gated_bilinear__prompt'

def setup_inputs():

    _w = (lambda a: (lambda t: t.to(torch.bfloat16) if t.is_floating_point() else t)(torch.as_tensor(a)))
    def _A_setup():
        B, Sq, D = 1, 2048, 512
        H, Sk, Dh = 32, 2048, 128
        return {
            "x": _w((lambda *s: torch.randn(*s, dtype=torch.bfloat16) * 0.05)(B, Sq, D)),
            "k_cache": _w((lambda *s: torch.randn(*s, dtype=torch.bfloat16) * 1.6)(B, H, Sk, Dh)),
            "v_cache": _w((lambda *s: torch.randn(*s, dtype=torch.bfloat16) * 1.6)(B, H, Sk, Dh)),
            "wq": _w((lambda *s: torch.randn(*s, dtype=torch.bfloat16) * 1.6)(D, H * Dh) * (D ** -0.5)),
            "wo": _w((lambda *s: torch.randn(*s, dtype=torch.bfloat16) * 1.6)(H * Dh, D) * ((H * Dh) ** -0.5)),
        }
    _A_in = _A_setup()

    def _B_setup():
        B, S, D, F = 1, 2048, 512, 1792
        return {
            "x": _w((lambda *s: torch.randn(*s, dtype=torch.bfloat16) * 0.05)(B, S, D)),
            "w_gate": _w((lambda *s: torch.randn(*s, dtype=torch.bfloat16) * 0.2)(D, F) * (D ** -0.5)),
            "w_up": _w((lambda *s: torch.randn(*s, dtype=torch.bfloat16) * 0.2)(D, F) * (D ** -0.5)),
            "w_down": _w((lambda *s: torch.randn(*s, dtype=torch.bfloat16) * 0.2)(F, D) * (F ** -0.5)),
        }
    _B_in = _B_setup()

    return {
        "A_x": _A_in["x"],
        "A_k_cache": _A_in["k_cache"],
        "A_v_cache": _A_in["v_cache"],
        "A_wq": _A_in["wq"],
        "A_wo": _A_in["wo"],
        "B_x": _B_in["x"],
        "B_w_gate": _B_in["w_gate"],
        "B_w_up": _B_in["w_up"],
        "B_w_down": _B_in["w_down"],
    }

def reference(A_x, A_k_cache, A_v_cache, A_wq, A_wo, B_x, B_w_gate, B_w_up, B_w_down):
    def _A_ref(x, k_cache, v_cache, wq, wo):
        B, Sq, D = x.shape
        H, Dh = 32, 128
        q = (lambda x, *d: x.permute(*d))((x @ wq).reshape(B, Sq, H, Dh), 0, 2, 1, 3)
        scores = torch.einsum("bhqd,bhkd->bhqk", q, k_cache) * (Dh ** -0.5)
        p = _softmax(scores, axis=-1)
        o = torch.einsum("bhqk,bhkd->bhqd", p, v_cache)
        return (lambda x, *d: x.permute(*d))(o, 0, 2, 1, 3).reshape(B, Sq, H * Dh) @ wo

    def _B_ref(x, w_gate, w_up, w_down):
        g = torch.einsum("bsd,df->bsf", x, w_gate)
        u = torch.einsum("bsd,df->bsf", x, w_up)
        h = g * u
        return torch.einsum("bsf,fd->bsd", h, w_down)

    x = A_x
    xn = _layernorm(x, axis=-1)
    s = _A_ref(xn, A_k_cache, A_v_cache, A_wq, A_wo)
    g = _silu(_B_ref(xn, B_w_gate, B_w_up, B_w_down))
    return x + s * g
```

```asm
; @launch grid=(256,1,1) block=(256,1,1) lds=163840
.amdgcn_target "amdgcn-amd-amdhsa--gfx950"
.text
.globl recurrent_scan__mha_block_cached__glu_gated_bilinear__prompt_kernel
.p2align 8
.type recurrent_scan__mha_block_cached__glu_gated_bilinear__prompt_kernel,@function
recurrent_scan__mha_block_cached__glu_gated_bilinear__prompt_kernel:
    s_cmp_ge_u32 s2, 256
    s_cbranch_scc1 L_end
    s_load_dwordx16 s[64:79], s[0:1], 0
    s_load_dwordx8 s[80:87], s[0:1], 64
    v_lshrrev_b32 v4, 6, v0
    v_and_b32 v1, 63, v0
    v_readfirstlane_b32 s6, v4
    s_and_b32 s3, s2, 7
    s_bfe_u32 s7, s2, 0x20003
    s_lshl_b32 s3, s3, 2
    s_add_u32 s4, s3, s7
    s_lshr_b32 s5, s2, 5
    s_lshl_b32 s88, s6, 12
    s_and_b32 s3, s2, 1
    s_lshl_b32 s3, s3, 3
    s_add_u32 s89, s3, s5
    s_bfe_u32 s90, s2, 0x20003
    v_and_b32 v2, 15, v1
    v_lshrrev_b32 v3, 4, v1
    s_getpc_b64 s[100:101]
L_pc:
    s_lshr_b32 s3, s2, 3
    s_lshl_b32 s3, s3, 2
    s_add_u32 s3, s3, s6
    s_and_b32 s3, s3, 15
    s_lshl_b32 s3, s3, 13
    s_min_u32 s3, s3, L_codeend-L_pc-8192
    v_lshlrev_b32 v4, 7, v1
    v_add_u32 v4, s3, v4
    global_load_dword v26, v4, s[100:101]
    s_lshl_b32 s59, s6, 13
    s_lshl_b32 s3, s6, 3
    v_add_u32 v4, s3, v3
    v_lshlrev_b32 v5, 2, v3
    v_xor_b32 v5, v5, v2
    v_lshlrev_b32 v5, 4, v5
    v_lshl_add_u32 v22, v4, 13, v5
    v_lshrrev_b32 v4, 3, v1
    v_and_b32 v5, 3, v4
    v_lshrrev_b32 v6, 5, v1
    v_lshl_add_u32 v5, v6, 3, v5
    s_lshr_b32 s3, s6, 1
    s_lshl_b32 s3, s3, 4
    s_and_b32 s7, s6, 1
    s_lshl_b32 s7, s7, 2
    s_add_u32 s3, s3, s7
    v_add_u32 v5, s3, v5
    v_mul_u32_u24 v5, 3584, v5
    v_lshlrev_b32 v6, 1, v3
    v_and_b32 v7, 7, v1
    v_xor_b32 v6, v6, v7
    v_lshl_add_u32 v23, v6, 4, v5
    v_xor_b32 v6, v3, v7
    v_lshlrev_b32 v6, 4, v6
    v_lshl_add_u32 v24, v4, 10, v6
    v_xor_b32 v25, 64, v24
    s_and_b32 s3, s2, 0
    s_lshl_b32 s60, s3, 7
    s_lshl_b32 s61, s3, 19
    s_mul_i32 s62, s3, 229376
    s_mov_b32 s63, 0
    s_mov_b32 s54, 0
    s_lshl_b32 s92, s6, 11
    s_add_u32 s92, s92, 65536
    s_lshl_b32 s93, s6, 10
    s_add_u32 s93, s93, 73728
    s_lshl_b32 s3, s5, 18
    s_lshl_b32 s7, s6, 16
    s_add_u32 s3, s3, s7
    s_waitcnt lgkmcnt(0)
    s_add_u32 s20, s64, s3
    s_addc_u32 s21, s65, 0
    s_mov_b32 s22, 65536
    s_mov_b32 s23, 0x20000
    s_add_u32 m0, s59, 0
    s_add_u32 s56, s60, 0
    buffer_load_dwordx4 v24, s[20:23], s56 offen offset:0 lds
    s_add_u32 s57, s60, 7168
    buffer_load_dwordx4 v25, s[20:23], s57 offen offset:1024 lds
    s_add_u32 s56, s60, 14336
    buffer_load_dwordx4 v24, s[20:23], s56 offen offset:2048 lds
    s_add_u32 s57, s60, 21504
    buffer_load_dwordx4 v25, s[20:23], s57 offen offset:3072 lds
    s_add_u32 m0, s59, 4096
    s_add_u32 s56, s60, 32768
    buffer_load_dwordx4 v24, s[20:23], s56 offen offset:0 lds
    s_add_u32 s57, s60, 39936
    buffer_load_dwordx4 v25, s[20:23], s57 offen offset:1024 lds
    s_add_u32 s56, s60, 47104
    buffer_load_dwordx4 v24, s[20:23], s56 offen offset:2048 lds
    s_add_u32 s57, s60, 54272
    buffer_load_dwordx4 v25, s[20:23], s57 offen offset:3072 lds
    s_add_u32 s60, s60, 128
    s_and_b32 s60, s60, 1023
    s_lshl_b32 s3, s4, 8
    s_add_u32 s24, s70, s3
    s_addc_u32 s25, s71, 0
    s_mov_b32 s26, 4186368
    s_mov_b32 s27, 0x20000
    s_lshr_b32 s7, s4, 3
    s_sub_u32 s3, s4, s7
    s_lshl_b32 s3, s3, 7
    s_and_b32 s7, s4, 7
    s_cmp_lg_u32 s7, 7
    s_cselect_b32 s3, s3, 0
    s_cselect_b32 s7, 1831552, 0
    s_add_u32 s28, s76, s3
    s_addc_u32 s29, s77, 0
    s_mov_b32 s30, s7
    s_mov_b32 s31, 0x20000
    s_add_u32 s32, s78, s3
    s_addc_u32 s33, s79, 0
    s_mov_b32 s34, s7
    s_mov_b32 s35, 0x20000
    s_add_u32 m0, s92, 0
    s_add_u32 s56, s61, 0
    buffer_load_dwordx4 v22, s[24:27], s56 offen lds
    s_add_u32 s57, s61, 31744
    buffer_load_dwordx4 v22, s[24:27], s57 offen offset:1024 lds
    s_add_u32 m0, s93, 0
    s_add_u32 s56, s62, 0
    buffer_load_dwordx4 v23, s[28:31], s56 offen lds
    s_add_u32 m0, m0, 4096
    s_nop 0
    buffer_load_dwordx4 v23, s[32:35], s56 offen lds
    s_add_u32 m0, s92, 16384
    s_add_u32 s56, s61, 262144
    buffer_load_dwordx4 v22, s[24:27], s56 offen lds
    s_add_u32 s57, s61, 293888
    buffer_load_dwordx4 v22, s[24:27], s57 offen offset:1024 lds
    s_add_u32 m0, s93, 16384
    s_add_u32 s56, s62, 114688
    buffer_load_dwordx4 v23, s[28:31], s56 offen lds
    s_add_u32 m0, m0, 4096
    s_nop 0
    buffer_load_dwordx4 v23, s[32:35], s56 offen lds
    s_add_u32 s61, s61, 524288
    s_and_b32 s61, s61, 0x3fffff
    s_lshr_b32 s62, s61, 13
    s_mul_i32 s62, s62, 3584
    s_add_u32 s63, s63, 1
    s_cmp_eq_u32 s63, 3
    s_cselect_b32 s58, -2, 1
    s_cselect_b32 s63, 0, s63
    s_lshl_b32 s58, s58, 15
    s_add_u32 s92, s92, s58
    s_add_u32 s93, s93, s58
    s_mov_b64 exec, 0
    s_cmp_eq_u32 s6, 0
    s_cbranch_scc1 L_pad0
    s_cmp_eq_u32 s6, 1
    s_cbranch_scc1 L_pad1
    s_cmp_eq_u32 s6, 2
    s_cbranch_scc1 L_pad2
    s_branch L_pad3
.p2align 12
L_warmdone:
L_warmret:
    s_mov_b64 exec, -1
    s_add_u32 m0, s59, 32768
    s_add_u32 s56, s60, 0
    buffer_load_dwordx4 v24, s[20:23], s56 offen offset:0 lds
    v_mov_b32 v96, 0
    v_mov_b32 v97, 0
    v_mov_b32 v98, 0
    v_mov_b32 v99, 0
    s_lshl_b32 s3, s4, 19
    s_add_u32 s8, s66, s3
    s_addc_u32 s9, s67, 0
    s_mov_b32 s10, 524288
    s_mov_b32 s11, 0x20000
    s_add_u32 s12, s68, s3
    s_addc_u32 s13, s69, 0
    s_sub_u32 s12, s12, 18432
    s_subb_u32 s13, s13, 0
    s_mov_b32 s14, 542720
    s_mov_b32 s15, 0x20000
    s_mov_b32 s16, s86
    s_mov_b32 s17, s87
    s_mov_b32 s18, 268435456
    s_mov_b32 s19, 0x20000
    s_mov_b32 s44, s82
    s_mov_b32 s45, s83
    s_add_u32 s57, s60, 7168
    buffer_load_dwordx4 v25, s[20:23], s57 offen offset:1024 lds
    s_mov_b32 s46, 2097152
    s_mov_b32 s47, 0x20000
    s_mov_b32 s48, s84
    s_mov_b32 s49, s85
    s_mov_b32 s50, 256
    s_mov_b32 s51, 0x20000
    s_mov_b32 s96, s64
    s_mov_b32 s97, s65
    s_cmp_lt_u32 s2, 128
    s_cselect_b32 s72, s72, s80
    s_cselect_b32 s73, s73, s81
    s_and_b32 s3, s2, 127
    s_lshl_b32 s3, s3, 15
    s_cmp_lt_u32 s2, 184
    s_cselect_b32 s3, s3, 0
    s_cselect_b32 s7, 32768, 0
    s_cselect_b32 s74, 0x10000000, 0
    s_add_u32 s36, s72, s3
    s_addc_u32 s37, s73, 0
    s_mov_b32 s38, s7
    s_mov_b32 s39, 0x20000
    s_add_u32 s56, s60, 14336
    buffer_load_dwordx4 v24, s[20:23], s56 offen offset:2048 lds
    s_mov_b32 s40, s86
    s_mov_b32 s41, s87
    s_mov_b32 s42, s74
    s_mov_b32 s43, 0x20000
    v_bfe_u32 v4, v1, 2, 2
    v_and_b32 v5, 3, v1
    v_lshl_add_u32 v6, v3, 3, v4
    v_lshlrev_b32 v6, 8, v6
    v_lshl_add_u32 v6, v4, 6, v6
    v_lshl_add_u32 v6, v5, 4, v6
    v_add_u32 v6, 65536, v6
    v_xor_b32 v8, 0, v6
    v_xor_b32 v9, 64, v6
    v_xor_b32 v10, 128, v6
    v_xor_b32 v11, 192, v6
    v_bfe_u32 v6, v1, 2, 3
    v_lshrrev_b32 v7, 1, v6
    v_lshlrev_b32 v6, 7, v6
    v_lshl_add_u32 v6, v7, 5, v6
    v_lshl_add_u32 v6, v5, 3, v6
    v_lshrrev_b32 v7, 5, v1
    s_add_u32 s57, s60, 21504
    buffer_load_dwordx4 v25, s[20:23], s57 offen offset:3072 lds
    v_lshl_add_u32 v6, v7, 11, v6
    v_add_u32 v6, 73728, v6
    v_xor_b32 v12, 0, v6
    v_xor_b32 v13, 32, v6
    v_xor_b32 v14, 64, v6
    v_xor_b32 v15, 96, v6
    s_cmp_eq_u32 s6, 0
    s_cselect_b64 s[98:99], -1, 0
    s_cmp_lt_u32 s6, 2
    s_cselect_b64 s[100:101], -1, 0
    s_and_b32 s3, s6, 1
    s_lshl_b32 s3, s3, 12
    v_cndmask_b32 v4, v10, v8, s[98:99]
    v_add_u32 v5, s3, v12
    v_cndmask_b32 v16, v5, v4, s[100:101]
    v_cndmask_b32 v4, v10, v8, s[98:99]
    v_add_u32 v4, 8, v4
    v_add_u32 v5, s3, v13
    v_cndmask_b32 v17, v5, v4, s[100:101]
    v_cndmask_b32 v4, v11, v9, s[98:99]
    v_add_u32 v5, s3, v14
    s_add_u32 m0, s59, 36864
    s_add_u32 s56, s60, 32768
    buffer_load_dwordx4 v24, s[20:23], s56 offen offset:0 lds
    v_cndmask_b32 v18, v5, v4, s[100:101]
    v_cndmask_b32 v4, v11, v9, s[98:99]
    v_add_u32 v4, 8, v4
    v_add_u32 v5, s3, v15
    v_cndmask_b32 v19, v5, v4, s[100:101]
    v_lshrrev_b32 v4, 1, v2
    v_xor_b32 v4, v4, v3
    v_lshlrev_b32 v4, 4, v4
    v_lshl_add_u32 v4, v2, 7, v4
    v_add_u32 v20, s59, v4
    v_xor_b32 v21, 64, v20
    v_mov_b32 v4, 0x3f803f80
    v_and_b32 v5, 3, v1
    v_mov_b32 v6, 0xeeee
    v_and_b32 v7, 4, v1
    v_cmp_eq_u32 vcc, 0, v7
    v_mov_b32 v7, 0x4444
    v_cmp_eq_u32 s[98:99], 0, v5
    v_cndmask_b32 v27, v6, v7, vcc
    s_nop 0
    v_cndmask_b32 v6, 0, v4, s[98:99]
    s_add_u32 s57, s60, 39936
    buffer_load_dwordx4 v25, s[20:23], s57 offen offset:1024 lds
    v_cmp_eq_u32 s[98:99], 1, v5
    v_accvgpr_write_b32 a160, v6
    v_accvgpr_write_b32 a161, v6
    v_accvgpr_write_b32 a162, v6
    v_accvgpr_write_b32 a163, v6
    v_cndmask_b32 v6, 0, v4, s[98:99]
    v_cmp_eq_u32 s[98:99], 2, v5
    v_accvgpr_write_b32 a164, v6
    v_accvgpr_write_b32 a165, v6
    v_accvgpr_write_b32 a166, v6
    v_accvgpr_write_b32 a167, v6
    v_cndmask_b32 v6, 0, v4, s[98:99]
    v_cmp_eq_u32 s[98:99], 3, v5
    v_accvgpr_write_b32 a168, v6
    v_accvgpr_write_b32 a169, v6
    v_accvgpr_write_b32 a170, v6
    v_accvgpr_write_b32 a171, v6
    v_cndmask_b32 v6, 0, v4, s[98:99]
    v_accvgpr_write_b32 a172, v6
    v_accvgpr_write_b32 a173, v6
    v_accvgpr_write_b32 a174, v6
    s_add_u32 s56, s60, 47104
    buffer_load_dwordx4 v24, s[20:23], s56 offen offset:2048 lds
    v_accvgpr_write_b32 a175, v6
    s_lshl_b32 s3, s6, 3
    v_add_u32 v5, s3, v3
    v_and_b32 v7, 15, v5
    v_xor_b32 v7, v7, v2
    v_lshlrev_b32 v7, 4, v7
    v_lshl_add_u32 v28, v5, 8, v7
    v_xor_b32 v29, 64, v28
    v_lshlrev_b32 v7, 1, v3
    v_xor_b32 v7, v7, v2
    v_lshlrev_b32 v7, 4, v7
    v_lshl_add_u32 v30, v5, 8, v7
    v_xor_b32 v31, 128, v30
    s_mov_b32 s52, 4294959104
    v_mov_b32 v100, 0
    v_mov_b32 v101, 0
    v_mov_b32 v102, 0
    v_mov_b32 v103, 0
    v_mov_b32 v104, 0
    v_mfma_f32_32x32x16_bf16 a[0:15], v[96:99], v[96:99], 0
    v_mov_b32 v105, 0
    s_add_u32 s57, s60, 54272
    buffer_load_dwordx4 v25, s[20:23], s57 offen offset:3072 lds
    s_add_u32 s60, s60, 128
    s_and_b32 s60, s60, 1023
    v_mov_b32 v106, 0
    v_mov_b32 v107, 0
    v_mov_b32 v108, 0
    v_mov_b32 v109, 0
    v_mov_b32 v110, 0
    v_mov_b32 v111, 0
    v_mov_b32 v112, 0
    v_mov_b32 v113, 0
    v_mov_b32 v114, 0
    v_mov_b32 v115, 0
    v_mov_b32 v116, 0
    v_mov_b32 v117, 0
    v_mov_b32 v118, 0
    v_mov_b32 v119, 0
    v_mov_b32 v120, 0
    v_mfma_f32_32x32x16_bf16 a[16:31], v[96:99], v[96:99], 0
    v_mov_b32 v121, 0
    v_mov_b32 v122, 0
    v_mov_b32 v123, 0
    v_mov_b32 v124, 0
    v_mov_b32 v125, 0
    s_add_u32 m0, s92, 0
    s_add_u32 s56, s61, 0
    buffer_load_dwordx4 v22, s[24:27], s56 offen lds
    v_mov_b32 v126, 0
    v_mov_b32 v127, 0
    v_mov_b32 v128, 0
    v_mov_b32 v129, 0
    v_mov_b32 v130, 0
    v_mov_b32 v131, 0
    v_mov_b32 v132, 0
    v_mov_b32 v133, 0
    v_mov_b32 v134, 0
    v_mov_b32 v135, 0
    v_mov_b32 v136, 0
    v_mfma_f32_32x32x16_bf16 a[32:47], v[96:99], v[96:99], 0
    v_mov_b32 v137, 0
    v_mov_b32 v138, 0
    v_mov_b32 v139, 0
    v_mov_b32 v140, 0
    v_mov_b32 v141, 0
    v_mov_b32 v142, 0
    v_mov_b32 v143, 0
    v_mov_b32 v144, 0
    v_mov_b32 v145, 0
    s_add_u32 s57, s61, 31744
    buffer_load_dwordx4 v22, s[24:27], s57 offen offset:1024 lds
    v_mov_b32 v146, 0
    v_mov_b32 v147, 0
    v_mov_b32 v148, 0
    v_mov_b32 v149, 0
    v_mov_b32 v150, 0
    v_mov_b32 v151, 0
    v_mov_b32 v152, 0
    v_mfma_f32_32x32x16_bf16 a[48:63], v[96:99], v[96:99], 0
    v_mov_b32 v153, 0
    v_mov_b32 v154, 0
    v_mov_b32 v155, 0
    v_mov_b32 v156, 0
    v_mov_b32 v157, 0
    v_mov_b32 v158, 0
    v_mov_b32 v159, 0
    v_mov_b32 v160, 0
    v_mov_b32 v161, 0
    v_mov_b32 v162, 0
    v_mov_b32 v163, 0
    v_mov_b32 v164, 0
    v_mov_b32 v165, 0
    s_add_u32 m0, s93, 0
    s_add_u32 s56, s62, 0
    buffer_load_dwordx4 v23, s[28:31], s56 offen lds
    v_mov_b32 v166, 0
    v_mov_b32 v167, 0
    v_mov_b32 v168, 0
    v_mfma_f32_32x32x16_bf16 a[64:79], v[96:99], v[96:99], 0
    v_mov_b32 v169, 0
    v_mov_b32 v170, 0
    v_mov_b32 v171, 0
    v_mov_b32 v172, 0
    v_mov_b32 v173, 0
    v_mov_b32 v174, 0
    v_mov_b32 v175, 0
    v_mov_b32 v176, 0
    v_mov_b32 v177, 0
    v_mov_b32 v178, 0
    v_mov_b32 v179, 0
    v_mov_b32 v180, 0
    v_mov_b32 v181, 0
    v_mov_b32 v182, 0
    v_mov_b32 v183, 0
    v_mov_b32 v184, 0
    v_mfma_f32_32x32x16_bf16 a[80:95], v[96:99], v[96:99], 0
    s_add_u32 m0, m0, 4096
    s_nop 0
    buffer_load_dwordx4 v23, s[32:35], s56 offen lds
    v_mov_b32 v185, 0
    v_mov_b32 v186, 0
    v_mov_b32 v187, 0
    v_mov_b32 v188, 0
    v_mov_b32 v189, 0
    v_mov_b32 v190, 0
    v_mov_b32 v191, 0
    v_mov_b32 v192, 0
    v_mov_b32 v193, 0
    v_mov_b32 v194, 0
    v_mov_b32 v195, 0
    v_mov_b32 v196, 0
    v_mov_b32 v197, 0
    v_mov_b32 v198, 0
    v_mov_b32 v199, 0
    v_mov_b32 v200, 0
    v_mfma_f32_32x32x16_bf16 a[96:111], v[96:99], v[96:99], 0
    v_mov_b32 v201, 0
    v_mov_b32 v202, 0
    v_mov_b32 v203, 0
    v_mov_b32 v204, 0
    s_add_u32 m0, s92, 16384
    s_add_u32 s56, s61, 262144
    buffer_load_dwordx4 v22, s[24:27], s56 offen lds
    v_mov_b32 v205, 0
    v_mov_b32 v206, 0
    v_mov_b32 v207, 0
    v_mov_b32 v208, 0
    v_mov_b32 v209, 0
    v_mov_b32 v210, 0
    v_mov_b32 v211, 0
    v_mov_b32 v212, 0
    v_mov_b32 v213, 0
    v_mov_b32 v214, 0
    v_mov_b32 v215, 0
    v_mov_b32 v216, 0
    v_mfma_f32_32x32x16_bf16 a[112:127], v[96:99], v[96:99], 0
    v_mov_b32 v217, 0
    v_mov_b32 v218, 0
    v_mov_b32 v219, 0
    v_mov_b32 v220, 0
    v_mov_b32 v221, 0
    v_mov_b32 v222, 0
    v_mov_b32 v223, 0
    v_mov_b32 v224, 0
    s_add_u32 s57, s61, 293888
    buffer_load_dwordx4 v22, s[24:27], s57 offen offset:1024 lds
    v_mov_b32 v225, 0
    v_mov_b32 v226, 0
    v_mov_b32 v227, 0
    v_mov_b32 v228, 0
    v_mov_b32 v229, 0
    v_mov_b32 v230, 0
    v_mov_b32 v231, 0
    v_mov_b32 v232, 0
    v_mov_b32 v233, 0
    v_mov_b32 v234, 0
    v_mov_b32 v235, 0
    v_mov_b32 v236, 0
    v_mov_b32 v237, 0
    v_mov_b32 v238, 0
    v_mov_b32 v239, 0
    v_mov_b32 v240, 0
    v_mov_b32 v241, 0
    v_mov_b32 v242, 0
    v_mov_b32 v243, 0
    v_mov_b32 v244, 0
    v_mov_b32 v245, 0
    s_add_u32 m0, s93, 16384
    s_add_u32 s56, s62, 114688
    buffer_load_dwordx4 v23, s[28:31], s56 offen lds
    v_mov_b32 v246, 0
    v_mov_b32 v247, 0
    v_mov_b32 v248, 0
    v_mov_b32 v249, 0
    v_mov_b32 v250, 0
    v_mov_b32 v251, 0
    v_mov_b32 v252, 0
    v_mov_b32 v253, 0
    v_mov_b32 v254, 0
    v_mov_b32 v255, 0
    s_add_u32 m0, m0, 4096
    s_nop 0
    buffer_load_dwordx4 v23, s[32:35], s56 offen lds
    s_add_u32 s61, s61, 524288
    s_and_b32 s61, s61, 0x3fffff
    s_lshr_b32 s62, s61, 13
    s_mul_i32 s62, s62, 3584
    s_add_u32 s63, s63, 1
    s_cmp_eq_u32 s63, 3
    s_cselect_b32 s58, -2, 1
    s_cselect_b32 s63, 0, s63
    s_lshl_b32 s58, s58, 15
    s_add_u32 s92, s92, s58
    s_add_u32 s93, s93, s58
    s_lshl_b32 s3, s5, 2
    s_add_u32 s3, s3, s6
    s_lshl_b32 s3, s3, 2
    s_lshr_b32 s7, s4, 3
    s_add_u32 s3, s3, s7
    s_lshl_b32 s3, s3, 5
    s_and_b32 s7, s4, 7
    s_add_u32 s3, s3, s7
    s_lshl_b32 s3, s3, 2
    s_add_u32 s94, s3, 26214400
    v_mov_b32 v4, 0
    s_mov_b64 exec, 1
    buffer_store_dword v4, v4, s[16:19], s94 offen sc1
    s_lshl_b32 s3, s89, 2
    s_add_u32 s3, s3, s90
    s_lshl_b32 s3, s3, 2
    s_add_u32 s3, s3, s6
    s_lshl_b32 s3, s3, 3
    s_bfe_u32 s7, s2, 0x20001
    s_add_u32 s3, s3, s7
    s_lshl_b32 s3, s3, 7
    s_add_u32 s3, s3, 49283072
    buffer_store_dword v4, v4, s[16:19], s3 offen sc1
    buffer_store_dword v4, v4, s[16:19], s3 offen offset:512 sc1
    s_mov_b64 exec, -1
    s_waitcnt vmcnt(19)
    ds_read_b128 v[32:35], v20 offset:0
    ds_read_b128 v[36:39], v21 offset:0
    ds_read_b128 v[40:43], v20 offset:2048
    ds_read_b128 v[44:47], v21 offset:2048
    ds_read_b128 v[48:51], v20 offset:4096
    ds_read_b128 v[52:55], v21 offset:4096
    ds_read_b128 v[56:59], v20 offset:6144
    ds_read_b128 v[60:63], v21 offset:6144
    s_waitcnt lgkmcnt(0)
    s_barrier
    ds_read_b64_tr_b16 a[128:129], v16 offset:0
    ds_read_b64_tr_b16 a[130:131], v16 offset:1024
    ds_read_b64_tr_b16 a[132:133], v16 offset:16384
    ds_read_b64_tr_b16 a[134:135], v16 offset:17408
    ds_read_b64_tr_b16 a[136:137], v17 offset:0
    ds_read_b64_tr_b16 a[138:139], v17 offset:1024
    ds_read_b64_tr_b16 a[140:141], v17 offset:16384
    ds_read_b64_tr_b16 a[142:143], v17 offset:17408
    s_waitcnt lgkmcnt(4)
.p2align 3
    s_mov_b32 s55, 3
.p2align 3
L_a:
    v_smfmac_f32_16x16x64_bf16 v[224:227], a[160:163], v[32:39], v27
    s_add_u32 m0, s92, 0
    s_add_u32 s56, s61, 0
    buffer_load_dwordx4 v22, s[24:27], s56 offen lds
    v_smfmac_f32_16x16x64_bf16 v[224:227], a[164:167], v[40:47], v27
    s_waitcnt lgkmcnt(0)
    v_smfmac_f32_16x16x64_bf16 v[228:231], a[160:163], a[128:135], v27
    v_smfmac_f32_16x16x64_bf16 v[228:231], a[164:167], a[136:143], v27
    v_mfma_f32_4x4x4_16b_bf16 v[240:243], v[32:33], v[32:33], v[240:243]
    ds_read_b64_tr_b16 a[144:145], v18 offset:0
    v_mfma_f32_4x4x4_16b_bf16 v[244:247], v[40:41], v[40:41], v[244:247]
    ds_read_b64_tr_b16 a[146:147], v18 offset:1024
    v_mfma_f32_4x4x4_16b_bf16 v[248:251], v[48:49], v[48:49], v[248:251]
    ds_read_b64_tr_b16 a[148:149], v18 offset:16384
    v_mfma_f32_4x4x4_16b_bf16 v[252:255], v[56:57], v[56:57], v[252:255]
    ds_read_b64_tr_b16 a[150:151], v18 offset:17408
    v_mfma_f32_4x4x4_16b_bf16 v[240:243], v[34:35], v[34:35], v[240:243]
    ds_read_b64_tr_b16 a[152:153], v19 offset:0
    v_mfma_f32_4x4x4_16b_bf16 v[244:247], v[42:43], v[42:43], v[244:247]
    ds_read_b64_tr_b16 a[154:155], v19 offset:1024
    v_mfma_f32_4x4x4_16b_bf16 v[248:251], v[50:51], v[50:51], v[248:251]
    ds_read_b64_tr_b16 a[156:157], v19 offset:16384
    v_mfma_f32_4x4x4_16b_bf16 v[252:255], v[58:59], v[58:59], v[252:255]
    ds_read_b64_tr_b16 a[158:159], v19 offset:17408
    v_mfma_f32_4x4x4_16b_bf16 v[240:243], v[36:37], v[36:37], v[240:243]
    ds_read_b64_tr_b16 a[128:129], v8 offset:0
    v_mfma_f32_4x4x4_16b_bf16 v[244:247], v[44:45], v[44:45], v[244:247]
    ds_read_b64_tr_b16 a[130:131], v8 offset:1024
    v_mfma_f32_4x4x4_16b_bf16 v[248:251], v[52:53], v[52:53], v[248:251]
    ds_read_b64_tr_b16 a[132:133], v8 offset:16384
    v_mfma_f32_4x4x4_16b_bf16 v[252:255], v[60:61], v[60:61], v[252:255]
    ds_read_b64_tr_b16 a[134:135], v8 offset:17408
    v_mfma_f32_4x4x4_16b_bf16 v[240:243], v[38:39], v[38:39], v[240:243]
    ds_read_b64_tr_b16 a[136:137], v8 offset:8
    v_mfma_f32_4x4x4_16b_bf16 v[244:247], v[46:47], v[46:47], v[244:247]
    ds_read_b64_tr_b16 a[138:139], v8 offset:1032
    v_mfma_f32_4x4x4_16b_bf16 v[248:251], v[54:55], v[54:55], v[248:251]
    ds_read_b64_tr_b16 a[140:141], v8 offset:16392
    v_mfma_f32_4x4x4_16b_bf16 v[252:255], v[62:63], v[62:63], v[252:255]
    s_add_u32 s57, s61, 31744
    ds_read_b64_tr_b16 a[142:143], v8 offset:17416
    v_smfmac_f32_16x16x64_bf16 v[224:227], a[168:171], v[48:55], v27
    buffer_load_dwordx4 v22, s[24:27], s57 offen offset:1024 lds
    v_smfmac_f32_16x16x64_bf16 v[224:227], a[172:175], v[56:63], v27
    s_waitcnt lgkmcnt(8)
    v_smfmac_f32_16x16x64_bf16 v[228:231], a[168:171], a[144:151], v27
    v_smfmac_f32_16x16x64_bf16 v[228:231], a[172:175], a[152:159], v27
    s_waitcnt lgkmcnt(4)
    v_mfma_f32_16x16x32_bf16 v[96:99], a[128:131], v[32:35], v[96:99]
    ds_read_b64_tr_b16 a[144:145], v9 offset:0
    v_mfma_f32_16x16x32_bf16 v[96:99], a[132:135], v[36:39], v[96:99]
    ds_read_b64_tr_b16 a[146:147], v9 offset:1024
    v_mfma_f32_16x16x32_bf16 v[100:103], a[132:135], v[44:47], v[100:103]
    ds_read_b64_tr_b16 a[148:149], v9 offset:16384
    v_mfma_f32_16x16x32_bf16 v[100:103], a[128:131], v[40:43], v[100:103]
    ds_read_b64_tr_b16 a[150:151], v9 offset:17408
    v_mfma_f32_16x16x32_bf16 v[104:107], a[128:131], v[48:51], v[104:107]
    s_add_u32 m0, s93, 0
    s_add_u32 s56, s62, 0
    v_mfma_f32_16x16x32_bf16 v[104:107], a[132:135], v[52:55], v[104:107]
    buffer_load_dwordx4 v23, s[28:31], s56 offen lds
    v_mfma_f32_16x16x32_bf16 v[108:111], a[132:135], v[60:63], v[108:111]
    v_mfma_f32_16x16x32_bf16 v[108:111], a[128:131], v[56:59], v[108:111]
    s_waitcnt lgkmcnt(4)
    v_mfma_f32_16x16x32_bf16 v[124:127], a[136:139], v[56:59], v[124:127]
    ds_read_b64_tr_b16 a[152:153], v9 offset:8
    v_mfma_f32_16x16x32_bf16 v[124:127], a[140:143], v[60:63], v[124:127]
    ds_read_b64_tr_b16 a[154:155], v9 offset:1032
    v_mfma_f32_16x16x32_bf16 v[120:123], a[140:143], v[52:55], v[120:123]
    ds_read_b64_tr_b16 a[156:157], v9 offset:16392
    v_mfma_f32_16x16x32_bf16 v[120:123], a[136:139], v[48:51], v[120:123]
    ds_read_b64_tr_b16 a[158:159], v9 offset:17416
    v_mfma_f32_16x16x32_bf16 v[116:119], a[136:139], v[40:43], v[116:119]
    s_add_u32 m0, m0, 4096
    v_mfma_f32_16x16x32_bf16 v[116:119], a[140:143], v[44:47], v[116:119]
    buffer_load_dwordx4 v23, s[32:35], s56 offen lds
    v_mfma_f32_16x16x32_bf16 v[112:115], a[140:143], v[36:39], v[112:115]
    v_mfma_f32_16x16x32_bf16 v[112:115], a[136:139], v[32:35], v[112:115]
    s_waitcnt lgkmcnt(4)
    v_mfma_f32_16x16x32_bf16 v[128:131], a[144:147], v[32:35], v[128:131]
    ds_read_b64_tr_b16 a[128:129], v10 offset:0
    v_mfma_f32_16x16x32_bf16 v[128:131], a[148:151], v[36:39], v[128:131]
    ds_read_b64_tr_b16 a[130:131], v10 offset:1024
    v_mfma_f32_16x16x32_bf16 v[132:135], a[148:151], v[44:47], v[132:135]
    ds_read_b64_tr_b16 a[132:133], v10 offset:16384
    v_mfma_f32_16x16x32_bf16 v[132:135], a[144:147], v[40:43], v[132:135]
    ds_read_b64_tr_b16 a[134:135], v10 offset:17408
    v_mfma_f32_16x16x32_bf16 v[136:139], a[144:147], v[48:51], v[136:139]
    s_add_u32 m0, s92, 16384
    s_add_u32 s56, s61, 262144
    v_mfma_f32_16x16x32_bf16 v[136:139], a[148:151], v[52:55], v[136:139]
    buffer_load_dwordx4 v22, s[24:27], s56 offen lds
    v_mfma_f32_16x16x32_bf16 v[140:143], a[148:151], v[60:63], v[140:143]
    v_mfma_f32_16x16x32_bf16 v[140:143], a[144:147], v[56:59], v[140:143]
    s_waitcnt lgkmcnt(4)
    v_mfma_f32_16x16x32_bf16 v[156:159], a[152:155], v[56:59], v[156:159]
    ds_read_b64_tr_b16 a[136:137], v10 offset:8
    v_mfma_f32_16x16x32_bf16 v[156:159], a[156:159], v[60:63], v[156:159]
    ds_read_b64_tr_b16 a[138:139], v10 offset:1032
    v_mfma_f32_16x16x32_bf16 v[152:155], a[156:159], v[52:55], v[152:155]
    ds_read_b64_tr_b16 a[140:141], v10 offset:16392
    v_mfma_f32_16x16x32_bf16 v[152:155], a[152:155], v[48:51], v[152:155]
    ds_read_b64_tr_b16 a[142:143], v10 offset:17416
    v_mfma_f32_16x16x32_bf16 v[148:151], a[152:155], v[40:43], v[148:151]
    s_add_u32 s57, s61, 293888
    v_mfma_f32_16x16x32_bf16 v[148:151], a[156:159], v[44:47], v[148:151]
    buffer_load_dwordx4 v22, s[24:27], s57 offen offset:1024 lds
    v_mfma_f32_16x16x32_bf16 v[144:147], a[156:159], v[36:39], v[144:147]
    v_mfma_f32_16x16x32_bf16 v[144:147], a[152:155], v[32:35], v[144:147]
    s_waitcnt lgkmcnt(4)
    v_mfma_f32_16x16x32_bf16 v[160:163], a[128:131], v[32:35], v[160:163]
    ds_read_b64_tr_b16 a[144:145], v11 offset:0
    v_mfma_f32_16x16x32_bf16 v[160:163], a[132:135], v[36:39], v[160:163]
    ds_read_b64_tr_b16 a[146:147], v11 offset:1024
    v_mfma_f32_16x16x32_bf16 v[164:167], a[132:135], v[44:47], v[164:167]
    ds_read_b64_tr_b16 a[148:149], v11 offset:16384
    v_mfma_f32_16x16x32_bf16 v[164:167], a[128:131], v[40:43], v[164:167]
    ds_read_b64_tr_b16 a[150:151], v11 offset:17408
    v_mfma_f32_16x16x32_bf16 v[168:171], a[128:131], v[48:51], v[168:171]
    s_add_u32 m0, s93, 16384
    s_add_u32 s56, s62, 114688
    v_mfma_f32_16x16x32_bf16 v[168:171], a[132:135], v[52:55], v[168:171]
    buffer_load_dwordx4 v23, s[28:31], s56 offen lds
    v_mfma_f32_16x16x32_bf16 v[172:175], a[132:135], v[60:63], v[172:175]
    v_mfma_f32_16x16x32_bf16 v[172:175], a[128:131], v[56:59], v[172:175]
    s_waitcnt lgkmcnt(4)
    v_mfma_f32_16x16x32_bf16 v[188:191], a[136:139], v[56:59], v[188:191]
    ds_read_b64_tr_b16 a[152:153], v11 offset:8
    v_mfma_f32_16x16x32_bf16 v[188:191], a[140:143], v[60:63], v[188:191]
    ds_read_b64_tr_b16 a[154:155], v11 offset:1032
    v_mfma_f32_16x16x32_bf16 v[184:187], a[140:143], v[52:55], v[184:187]
    ds_read_b64_tr_b16 a[156:157], v11 offset:16392
    v_mfma_f32_16x16x32_bf16 v[184:187], a[136:139], v[48:51], v[184:187]
    ds_read_b64_tr_b16 a[158:159], v11 offset:17416
    v_mfma_f32_16x16x32_bf16 v[180:183], a[136:139], v[40:43], v[180:183]
    s_add_u32 m0, m0, 4096
    v_mfma_f32_16x16x32_bf16 v[180:183], a[140:143], v[44:47], v[180:183]
    buffer_load_dwordx4 v23, s[32:35], s56 offen lds
    v_mfma_f32_16x16x32_bf16 v[176:179], a[140:143], v[36:39], v[176:179]
    s_add_u32 s61, s61, 524288
    s_and_b32 s61, s61, 0x3fffff
    s_lshr_b32 s62, s61, 13
    s_mul_i32 s62, s62, 3584
    v_mfma_f32_16x16x32_bf16 v[176:179], a[136:139], v[32:35], v[176:179]
    s_add_u32 s63, s63, 1
    s_cmp_eq_u32 s63, 3
    s_cselect_b32 s58, -2, 1
    s_cselect_b32 s63, 0, s63
    s_waitcnt lgkmcnt(4)
    v_mfma_f32_16x16x32_bf16 v[192:195], a[144:147], v[32:35], v[192:195]
    s_lshl_b32 s58, s58, 15
    s_add_u32 s92, s92, s58
    s_add_u32 s93, s93, s58
    ds_read_b64_tr_b16 a[128:129], v12 offset:0
    v_mfma_f32_16x16x32_bf16 v[192:195], a[148:151], v[36:39], v[192:195]
    ds_read_b64_tr_b16 a[130:131], v12 offset:1024
    v_mfma_f32_16x16x32_bf16 v[196:199], a[148:151], v[44:47], v[196:199]
    ds_read_b64_tr_b16 a[132:133], v12 offset:16384
    v_mfma_f32_16x16x32_bf16 v[196:199], a[144:147], v[40:43], v[196:199]
    ds_read_b64_tr_b16 a[134:135], v12 offset:17408
    v_mfma_f32_16x16x32_bf16 v[200:203], a[144:147], v[48:51], v[200:203]
    s_add_u32 m0, s59, 0
    s_add_u32 s56, s60, 0
    v_mfma_f32_16x16x32_bf16 v[200:203], a[148:151], v[52:55], v[200:203]
    buffer_load_dwordx4 v24, s[20:23], s56 offen offset:0 lds
    v_mfma_f32_16x16x32_bf16 v[204:207], a[148:151], v[60:63], v[204:207]
    v_mfma_f32_16x16x32_bf16 v[204:207], a[144:147], v[56:59], v[204:207]
    s_waitcnt lgkmcnt(4)
    v_mfma_f32_16x16x32_bf16 v[220:223], a[152:155], v[56:59], v[220:223]
    ds_read_b64_tr_b16 a[136:137], v13 offset:0
    v_mfma_f32_16x16x32_bf16 v[220:223], a[156:159], v[60:63], v[220:223]
    ds_read_b64_tr_b16 a[138:139], v13 offset:1024
    v_mfma_f32_16x16x32_bf16 v[216:219], a[156:159], v[52:55], v[216:219]
    ds_read_b64_tr_b16 a[140:141], v13 offset:16384
    v_mfma_f32_16x16x32_bf16 v[216:219], a[152:155], v[48:51], v[216:219]
    ds_read_b64_tr_b16 a[142:143], v13 offset:17408
    v_mfma_f32_16x16x32_bf16 v[212:215], a[152:155], v[40:43], v[212:215]
    s_add_u32 s57, s60, 7168
    v_mfma_f32_16x16x32_bf16 v[212:215], a[156:159], v[44:47], v[212:215]
    buffer_load_dwordx4 v25, s[20:23], s57 offen offset:1024 lds
    v_mfma_f32_16x16x32_bf16 v[208:211], a[156:159], v[36:39], v[208:211]
    v_mfma_f32_16x16x32_bf16 v[208:211], a[152:155], v[32:35], v[208:211]
    s_waitcnt lgkmcnt(4)
    v_mfma_f32_16x16x32_bf16 a[0:3], a[128:131], v[32:35], a[0:3]
    ds_read_b64_tr_b16 a[144:145], v14 offset:0
    v_mfma_f32_16x16x32_bf16 a[0:3], a[132:135], v[36:39], a[0:3]
    ds_read_b64_tr_b16 a[146:147], v14 offset:1024
    v_mfma_f32_16x16x32_bf16 a[4:7], a[132:135], v[44:47], a[4:7]
    ds_read_b64_tr_b16 a[148:149], v14 offset:16384
    v_mfma_f32_16x16x32_bf16 a[4:7], a[128:131], v[40:43], a[4:7]
    ds_read_b64_tr_b16 a[150:151], v14 offset:17408
    v_mfma_f32_16x16x32_bf16 a[8:11], a[128:131], v[48:51], a[8:11]
    s_add_u32 s56, s60, 14336
    v_mfma_f32_16x16x32_bf16 a[8:11], a[132:135], v[52:55], a[8:11]
    buffer_load_dwordx4 v24, s[20:23], s56 offen offset:2048 lds
    v_mfma_f32_16x16x32_bf16 a[12:15], a[132:135], v[60:63], a[12:15]
    v_mfma_f32_16x16x32_bf16 a[12:15], a[128:131], v[56:59], a[12:15]
    s_waitcnt lgkmcnt(4)
    v_mfma_f32_16x16x32_bf16 a[28:31], a[136:139], v[56:59], a[28:31]
    ds_read_b64_tr_b16 a[152:153], v15 offset:0
    v_mfma_f32_16x16x32_bf16 a[28:31], a[140:143], v[60:63], a[28:31]
    s_add_u32 s54, s54, 1
    s_cmp_eq_u32 s54, 3
    s_cselect_b32 s95, -2, 1
    s_cselect_b32 s54, 0, s54
    ds_read_b64_tr_b16 a[154:155], v15 offset:1024
    v_mfma_f32_16x16x32_bf16 a[24:27], a[140:143], v[52:55], a[24:27]
    s_lshl_b32 s95, s95, 15
    ds_read_b64_tr_b16 a[156:157], v15 offset:16384
    v_mfma_f32_16x16x32_bf16 a[24:27], a[136:139], v[48:51], a[24:27]
    ds_read_b64_tr_b16 a[158:159], v15 offset:17408
    v_mfma_f32_16x16x32_bf16 a[20:23], a[136:139], v[40:43], a[20:23]
    s_add_u32 s57, s60, 21504
    v_mfma_f32_16x16x32_bf16 a[20:23], a[140:143], v[44:47], a[20:23]
    buffer_load_dwordx4 v25, s[20:23], s57 offen offset:3072 lds
    v_mfma_f32_16x16x32_bf16 a[16:19], a[140:143], v[36:39], a[16:19]
    v_mfma_f32_16x16x32_bf16 a[16:19], a[136:139], v[32:35], a[16:19]
    s_waitcnt lgkmcnt(4)
    v_mfma_f32_16x16x32_bf16 a[32:35], a[144:147], v[32:35], a[32:35]
    ds_read_b64_tr_b16 a[128:129], v12 offset:4096
    v_add_u32 v8, s95, v8
    v_mfma_f32_16x16x32_bf16 a[32:35], a[148:151], v[36:39], a[32:35]
    ds_read_b64_tr_b16 a[130:131], v12 offset:5120
    v_add_u32 v9, s95, v9
    v_mfma_f32_16x16x32_bf16 a[36:39], a[148:151], v[44:47], a[36:39]
    ds_read_b64_tr_b16 a[132:133], v12 offset:20480
    v_add_u32 v10, s95, v10
    v_mfma_f32_16x16x32_bf16 a[36:39], a[144:147], v[40:43], a[36:39]
    s_waitcnt vmcnt(12)
    ds_read_b64_tr_b16 a[134:135], v12 offset:21504
    ds_read_b128 v[64:67], v20 offset:32768
    v_mfma_f32_16x16x32_bf16 a[40:43], a[144:147], v[48:51], a[40:43]
    s_add_u32 m0, s59, 4096
    s_add_u32 s56, s60, 32768
    ds_read_b128 v[68:71], v21 offset:32768
    v_add_u32 v11, s95, v11
    v_mfma_f32_16x16x32_bf16 a[40:43], a[148:151], v[52:55], a[40:43]
    buffer_load_dwordx4 v24, s[20:23], s56 offen offset:0 lds
    v_mfma_f32_16x16x32_bf16 a[44:47], a[148:151], v[60:63], a[44:47]
    ds_read_b128 v[72:75], v20 offset:34816
    v_add_u32 v16, s95, v16
    v_mfma_f32_16x16x32_bf16 a[44:47], a[144:147], v[56:59], a[44:47]
    s_waitcnt lgkmcnt(7)
    ds_read_b128 v[76:79], v21 offset:34816
    v_add_u32 v17, s95, v17
    v_mfma_f32_16x16x32_bf16 a[60:63], a[152:155], v[56:59], a[60:63]
    ds_read_b64_tr_b16 a[136:137], v13 offset:4096
    ds_read_b128 v[80:83], v20 offset:36864
    v_mfma_f32_16x16x32_bf16 a[60:63], a[156:159], v[60:63], a[60:63]
    ds_read_b64_tr_b16 a[138:139], v13 offset:5120
    ds_read_b128 v[84:87], v21 offset:36864
    v_mfma_f32_16x16x32_bf16 a[56:59], a[156:159], v[52:55], a[56:59]
    ds_read_b64_tr_b16 a[140:141], v13 offset:20480
    ds_read_b128 v[88:91], v20 offset:38912
    v_mfma_f32_16x16x32_bf16 a[56:59], a[152:155], v[48:51], a[56:59]
    ds_read_b64_tr_b16 a[142:143], v13 offset:21504
    ds_read_b128 v[92:95], v21 offset:38912
    v_mfma_f32_16x16x32_bf16 a[52:55], a[152:155], v[40:43], a[52:55]
    s_add_u32 s57, s60, 39936
    v_add_u32 v18, s95, v18
    v_add_u32 v19, s95, v19
L_pad0:
    s_cbranch_execz L_pad4
    v_mfma_f32_16x16x32_bf16 a[52:55], a[156:159], v[44:47], a[52:55]
    buffer_load_dwordx4 v25, s[20:23], s57 offen offset:1024 lds
    v_mfma_f32_16x16x32_bf16 a[48:51], a[156:159], v[36:39], a[48:51]
    v_mfma_f32_16x16x32_bf16 a[48:51], a[152:155], v[32:35], a[48:51]
    s_waitcnt lgkmcnt(12)
    v_mfma_f32_16x16x32_bf16 a[64:67], a[128:131], v[32:35], a[64:67]
    ds_read_b64_tr_b16 a[144:145], v14 offset:4096
    v_mfma_f32_16x16x32_bf16 a[64:67], a[132:135], v[36:39], a[64:67]
    ds_read_b64_tr_b16 a[146:147], v14 offset:5120
    v_mfma_f32_16x16x32_bf16 a[68:71], a[132:135], v[44:47], a[68:71]
    ds_read_b64_tr_b16 a[148:149], v14 offset:20480
    v_mfma_f32_16x16x32_bf16 a[68:71], a[128:131], v[40:43], a[68:71]
    ds_read_b64_tr_b16 a[150:151], v14 offset:21504
    v_mfma_f32_16x16x32_bf16 a[72:75], a[128:131], v[48:51], a[72:75]
    s_add_u32 s56, s60, 47104
    v_mfma_f32_16x16x32_bf16 a[72:75], a[132:135], v[52:55], a[72:75]
    buffer_load_dwordx4 v24, s[20:23], s56 offen offset:2048 lds
    v_mfma_f32_16x16x32_bf16 a[76:79], a[132:135], v[60:63], a[76:79]
    v_mfma_f32_16x16x32_bf16 a[76:79], a[128:131], v[56:59], a[76:79]
    s_waitcnt lgkmcnt(5)
    v_mfma_f32_16x16x32_bf16 a[92:95], a[136:139], v[56:59], a[92:95]
    ds_read_b64_tr_b16 a[152:153], v15 offset:4096
    v_mfma_f32_16x16x32_bf16 a[92:95], a[140:143], v[60:63], a[92:95]
    ds_read_b64_tr_b16 a[154:155], v15 offset:5120
    v_mfma_f32_16x16x32_bf16 a[88:91], a[140:143], v[52:55], a[88:91]
    ds_read_b64_tr_b16 a[156:157], v15 offset:20480
    v_mfma_f32_16x16x32_bf16 a[88:91], a[136:139], v[48:51], a[88:91]
    ds_read_b64_tr_b16 a[158:159], v15 offset:21504
    v_mfma_f32_16x16x32_bf16 a[84:87], a[136:139], v[40:43], a[84:87]
    s_add_u32 s57, s60, 54272
    v_mfma_f32_16x16x32_bf16 a[84:87], a[140:143], v[44:47], a[84:87]
    buffer_load_dwordx4 v25, s[20:23], s57 offen offset:3072 lds
    v_mfma_f32_16x16x32_bf16 a[80:83], a[140:143], v[36:39], a[80:83]
    s_add_u32 s60, s60, 128
    s_and_b32 s60, s60, 1023
    v_mfma_f32_16x16x32_bf16 a[80:83], a[136:139], v[32:35], a[80:83]
    s_waitcnt lgkmcnt(0)
    s_barrier
    v_mfma_f32_16x16x32_bf16 a[96:99], a[144:147], v[32:35], a[96:99]
    ds_read_b64_tr_b16 a[128:129], v16 offset:0
    v_add_u32 v12, s95, v12
    v_mfma_f32_16x16x32_bf16 a[96:99], a[148:151], v[36:39], a[96:99]
    ds_read_b64_tr_b16 a[130:131], v16 offset:1024
    v_add_u32 v13, s95, v13
    v_mfma_f32_16x16x32_bf16 a[100:103], a[148:151], v[44:47], a[100:103]
    ds_read_b64_tr_b16 a[132:133], v16 offset:16384
    v_add_u32 v14, s95, v14
    v_mfma_f32_16x16x32_bf16 a[100:103], a[144:147], v[40:43], a[100:103]
    ds_read_b64_tr_b16 a[134:135], v16 offset:17408
    v_add_u32 v15, s95, v15
    v_mfma_f32_16x16x32_bf16 a[104:107], a[144:147], v[48:51], a[104:107]
    v_mfma_f32_16x16x32_bf16 a[104:107], a[148:151], v[52:55], a[104:107]
    v_mfma_f32_16x16x32_bf16 a[108:111], a[148:151], v[60:63], a[108:111]
    v_mfma_f32_16x16x32_bf16 a[108:111], a[144:147], v[56:59], a[108:111]
    s_waitcnt lgkmcnt(0)
    v_mfma_f32_16x16x32_bf16 a[124:127], a[152:155], v[56:59], a[124:127]
    ds_read_b64_tr_b16 a[136:137], v17 offset:0
    v_mfma_f32_16x16x32_bf16 a[124:127], a[156:159], v[60:63], a[124:127]
    ds_read_b64_tr_b16 a[138:139], v17 offset:1024
    v_mfma_f32_16x16x32_bf16 a[120:123], a[156:159], v[52:55], a[120:123]
    ds_read_b64_tr_b16 a[140:141], v17 offset:16384
    v_mfma_f32_16x16x32_bf16 a[120:123], a[152:155], v[48:51], a[120:123]
    ds_read_b64_tr_b16 a[142:143], v17 offset:17408
    v_mfma_f32_16x16x32_bf16 a[116:119], a[152:155], v[40:43], a[116:119]
    v_mfma_f32_16x16x32_bf16 a[116:119], a[156:159], v[44:47], a[116:119]
    v_mfma_f32_16x16x32_bf16 a[112:115], a[156:159], v[36:39], a[112:115]
    v_mfma_f32_16x16x32_bf16 a[112:115], a[152:155], v[32:35], a[112:115]
    v_smfmac_f32_16x16x64_bf16 v[224:227], a[160:163], v[64:71], v27
    s_add_u32 m0, s92, 0
    s_add_u32 s56, s61, 0
    buffer_load_dwordx4 v22, s[24:27], s56 offen lds
    v_smfmac_f32_16x16x64_bf16 v[224:227], a[164:167], v[72:79], v27
    s_waitcnt lgkmcnt(0)
    v_smfmac_f32_16x16x64_bf16 v[228:231], a[160:163], a[128:135], v27
    v_smfmac_f32_16x16x64_bf16 v[228:231], a[164:167], a[136:143], v27
    v_mfma_f32_4x4x4_16b_bf16 v[240:243], v[64:65], v[64:65], v[240:243]
    ds_read_b64_tr_b16 a[144:145], v18 offset:0
    v_mfma_f32_4x4x4_16b_bf16 v[244:247], v[72:73], v[72:73], v[244:247]
    ds_read_b64_tr_b16 a[146:147], v18 offset:1024
    v_mfma_f32_4x4x4_16b_bf16 v[248:251], v[80:81], v[80:81], v[248:251]
    ds_read_b64_tr_b16 a[148:149], v18 offset:16384
    v_mfma_f32_4x4x4_16b_bf16 v[252:255], v[88:89], v[88:89], v[252:255]
    ds_read_b64_tr_b16 a[150:151], v18 offset:17408
    v_mfma_f32_4x4x4_16b_bf16 v[240:243], v[66:67], v[66:67], v[240:243]
    ds_read_b64_tr_b16 a[152:153], v19 offset:0
    v_mfma_f32_4x4x4_16b_bf16 v[244:247], v[74:75], v[74:75], v[244:247]
    ds_read_b64_tr_b16 a[154:155], v19 offset:1024
    v_mfma_f32_4x4x4_16b_bf16 v[248:251], v[82:83], v[82:83], v[248:251]
    ds_read_b64_tr_b16 a[156:157], v19 offset:16384
    v_mfma_f32_4x4x4_16b_bf16 v[252:255], v[90:91], v[90:91], v[252:255]
    ds_read_b64_tr_b16 a[158:159], v19 offset:17408
    v_mfma_f32_4x4x4_16b_bf16 v[240:243], v[68:69], v[68:69], v[240:243]
    ds_read_b64_tr_b16 a[128:129], v8 offset:0
    v_mfma_f32_4x4x4_16b_bf16 v[244:247], v[76:77], v[76:77], v[244:247]
    ds_read_b64_tr_b16 a[130:131], v8 offset:1024
    v_mfma_f32_4x4x4_16b_bf16 v[248:251], v[84:85], v[84:85], v[248:251]
    ds_read_b64_tr_b16 a[132:133], v8 offset:16384
    v_mfma_f32_4x4x4_16b_bf16 v[252:255], v[92:93], v[92:93], v[252:255]
    ds_read_b64_tr_b16 a[134:135], v8 offset:17408
    v_mfma_f32_4x4x4_16b_bf16 v[240:243], v[70:71], v[70:71], v[240:243]
    ds_read_b64_tr_b16 a[136:137], v8 offset:8
    v_mfma_f32_4x4x4_16b_bf16 v[244:247], v[78:79], v[78:79], v[244:247]
    ds_read_b64_tr_b16 a[138:139], v8 offset:1032
    v_mfma_f32_4x4x4_16b_bf16 v[248:251], v[86:87], v[86:87], v[248:251]
    ds_read_b64_tr_b16 a[140:141], v8 offset:16392
    v_mfma_f32_4x4x4_16b_bf16 v[252:255], v[94:95], v[94:95], v[252:255]
    s_add_u32 s57, s61, 31744
    ds_read_b64_tr_b16 a[142:143], v8 offset:17416
    v_smfmac_f32_16x16x64_bf16 v[224:227], a[168:171], v[80:87], v27
    buffer_load_dwordx4 v22, s[24:27], s57 offen offset:1024 lds
    v_smfmac_f32_16x16x64_bf16 v[224:227], a[172:175], v[88:95], v27
    s_waitcnt lgkmcnt(8)
    v_smfmac_f32_16x16x64_bf16 v[228:231], a[168:171], a[144:151], v27
    v_smfmac_f32_16x16x64_bf16 v[228:231], a[172:175], a[152:159], v27
    s_waitcnt lgkmcnt(4)
    v_mfma_f32_16x16x32_bf16 v[96:99], a[128:131], v[64:67], v[96:99]
    ds_read_b64_tr_b16 a[144:145], v9 offset:0
    v_mfma_f32_16x16x32_bf16 v[96:99], a[132:135], v[68:71], v[96:99]
    ds_read_b64_tr_b16 a[146:147], v9 offset:1024
    v_mfma_f32_16x16x32_bf16 v[100:103], a[132:135], v[76:79], v[100:103]
    ds_read_b64_tr_b16 a[148:149], v9 offset:16384
    v_mfma_f32_16x16x32_bf16 v[100:103], a[128:131], v[72:75], v[100:103]
    ds_read_b64_tr_b16 a[150:151], v9 offset:17408
    v_mfma_f32_16x16x32_bf16 v[104:107], a[128:131], v[80:83], v[104:107]
    s_add_u32 m0, s93, 0
    s_add_u32 s56, s62, 0
    v_mfma_f32_16x16x32_bf16 v[104:107], a[132:135], v[84:87], v[104:107]
    buffer_load_dwordx4 v23, s[28:31], s56 offen lds
    v_mfma_f32_16x16x32_bf16 v[108:111], a[132:135], v[92:95], v[108:111]
    v_mfma_f32_16x16x32_bf16 v[108:111], a[128:131], v[88:91], v[108:111]
    s_waitcnt lgkmcnt(4)
    v_mfma_f32_16x16x32_bf16 v[124:127], a[136:139], v[88:91], v[124:127]
    ds_read_b64_tr_b16 a[152:153], v9 offset:8
    v_mfma_f32_16x16x32_bf16 v[124:127], a[140:143], v[92:95], v[124:127]
    ds_read_b64_tr_b16 a[154:155], v9 offset:1032
    v_mfma_f32_16x16x32_bf16 v[120:123], a[140:143], v[84:87], v[120:123]
    ds_read_b64_tr_b16 a[156:157], v9 offset:16392
    v_mfma_f32_16x16x32_bf16 v[120:123], a[136:139], v[80:83], v[120:123]
    ds_read_b64_tr_b16 a[158:159], v9 offset:17416
    v_mfma_f32_16x16x32_bf16 v[116:119], a[136:139], v[72:75], v[116:119]
    s_add_u32 m0, m0, 4096
    v_mfma_f32_16x16x32_bf16 v[116:119], a[140:143], v[76:79], v[116:119]
    buffer_load_dwordx4 v23, s[32:35], s56 offen lds
    v_mfma_f32_16x16x32_bf16 v[112:115], a[140:143], v[68:71], v[112:115]
    v_mfma_f32_16x16x32_bf16 v[112:115], a[136:139], v[64:67], v[112:115]
    s_waitcnt lgkmcnt(4)
    v_mfma_f32_16x16x32_bf16 v[128:131], a[144:147], v[64:67], v[128:131]
    ds_read_b64_tr_b16 a[128:129], v10 offset:0
    v_mfma_f32_16x16x32_bf16 v[128:131], a[148:151], v[68:71], v[128:131]
    ds_read_b64_tr_b16 a[130:131], v10 offset:1024
    v_mfma_f32_16x16x32_bf16 v[132:135], a[148:151], v[76:79], v[132:135]
    ds_read_b64_tr_b16 a[132:133], v10 offset:16384
    v_mfma_f32_16x16x32_bf16 v[132:135], a[144:147], v[72:75], v[132:135]
    ds_read_b64_tr_b16 a[134:135], v10 offset:17408
    v_mfma_f32_16x16x32_bf16 v[136:139], a[144:147], v[80:83], v[136:139]
    s_add_u32 m0, s92, 16384
    s_add_u32 s56, s61, 262144
    v_mfma_f32_16x16x32_bf16 v[136:139], a[148:151], v[84:87], v[136:139]
    buffer_load_dwordx4 v22, s[24:27], s56 offen lds
    v_mfma_f32_16x16x32_bf16 v[140:143], a[148:151], v[92:95], v[140:143]
    v_mfma_f32_16x16x32_bf16 v[140:143], a[144:147], v[88:91], v[140:143]
    s_waitcnt lgkmcnt(4)
    v_mfma_f32_16x16x32_bf16 v[156:159], a[152:155], v[88:91], v[156:159]
    ds_read_b64_tr_b16 a[136:137], v10 offset:8
    v_mfma_f32_16x16x32_bf16 v[156:159], a[156:159], v[92:95], v[156:159]
    ds_read_b64_tr_b16 a[138:139], v10 offset:1032
    v_mfma_f32_16x16x32_bf16 v[152:155], a[156:159], v[84:87], v[152:155]
    ds_read_b64_tr_b16 a[140:141], v10 offset:16392
    v_mfma_f32_16x16x32_bf16 v[152:155], a[152:155], v[80:83], v[152:155]
    ds_read_b64_tr_b16 a[142:143], v10 offset:17416
    v_mfma_f32_16x16x32_bf16 v[148:151], a[152:155], v[72:75], v[148:151]
    s_add_u32 s57, s61, 293888
    v_mfma_f32_16x16x32_bf16 v[148:151], a[156:159], v[76:79], v[148:151]
    buffer_load_dwordx4 v22, s[24:27], s57 offen offset:1024 lds
    v_mfma_f32_16x16x32_bf16 v[144:147], a[156:159], v[68:71], v[144:147]
    v_mfma_f32_16x16x32_bf16 v[144:147], a[152:155], v[64:67], v[144:147]
    s_waitcnt lgkmcnt(4)
    v_mfma_f32_16x16x32_bf16 v[160:163], a[128:131], v[64:67], v[160:163]
    ds_read_b64_tr_b16 a[144:145], v11 offset:0
    v_mfma_f32_16x16x32_bf16 v[160:163], a[132:135], v[68:71], v[160:163]
    ds_read_b64_tr_b16 a[146:147], v11 offset:1024
    v_mfma_f32_16x16x32_bf16 v[164:167], a[132:135], v[76:79], v[164:167]
    ds_read_b64_tr_b16 a[148:149], v11 offset:16384
    v_mfma_f32_16x16x32_bf16 v[164:167], a[128:131], v[72:75], v[164:167]
    ds_read_b64_tr_b16 a[150:151], v11 offset:17408
    v_mfma_f32_16x16x32_bf16 v[168:171], a[128:131], v[80:83], v[168:171]
    s_add_u32 m0, s93, 16384
    s_add_u32 s56, s62, 114688
    v_mfma_f32_16x16x32_bf16 v[168:171], a[132:135], v[84:87], v[168:171]
    buffer_load_dwordx4 v23, s[28:31], s56 offen lds
    v_mfma_f32_16x16x32_bf16 v[172:175], a[132:135], v[92:95], v[172:175]
    v_mfma_f32_16x16x32_bf16 v[172:175], a[128:131], v[88:91], v[172:175]
    s_waitcnt lgkmcnt(4)
    v_mfma_f32_16x16x32_bf16 v[188:191], a[136:139], v[88:91], v[188:191]
    ds_read_b64_tr_b16 a[152:153], v11 offset:8
    v_mfma_f32_16x16x32_bf16 v[188:191], a[140:143], v[92:95], v[188:191]
    ds_read_b64_tr_b16 a[154:155], v11 offset:1032
    v_mfma_f32_16x16x32_bf16 v[184:187], a[140:143], v[84:87], v[184:187]
    ds_read_b64_tr_b16 a[156:157], v11 offset:16392
    v_mfma_f32_16x16x32_bf16 v[184:187], a[136:139], v[80:83], v[184:187]
    ds_read_b64_tr_b16 a[158:159], v11 offset:17416
    v_mfma_f32_16x16x32_bf16 v[180:183], a[136:139], v[72:75], v[180:183]
    s_add_u32 m0, m0, 4096
    v_mfma_f32_16x16x32_bf16 v[180:183], a[140:143], v[76:79], v[180:183]
    buffer_load_dwordx4 v23, s[32:35], s56 offen lds
    v_mfma_f32_16x16x32_bf16 v[176:179], a[140:143], v[68:71], v[176:179]
    s_add_u32 s61, s61, 524288
    s_and_b32 s61, s61, 0x3fffff
    s_lshr_b32 s62, s61, 13
    s_mul_i32 s62, s62, 3584
    v_mfma_f32_16x16x32_bf16 v[176:179], a[136:139], v[64:67], v[176:179]
    s_add_u32 s63, s63, 1
    s_cmp_eq_u32 s63, 3
    s_cselect_b32 s58, -2, 1
    s_cselect_b32 s63, 0, s63
    s_waitcnt lgkmcnt(4)
    v_mfma_f32_16x16x32_bf16 v[192:195], a[144:147], v[64:67], v[192:195]
    s_lshl_b32 s58, s58, 15
    s_add_u32 s92, s92, s58
    s_add_u32 s93, s93, s58
    ds_read_b64_tr_b16 a[128:129], v12 offset:0
    v_mfma_f32_16x16x32_bf16 v[192:195], a[148:151], v[68:71], v[192:195]
    ds_read_b64_tr_b16 a[130:131], v12 offset:1024
    v_mfma_f32_16x16x32_bf16 v[196:199], a[148:151], v[76:79], v[196:199]
    ds_read_b64_tr_b16 a[132:133], v12 offset:16384
    v_mfma_f32_16x16x32_bf16 v[196:199], a[144:147], v[72:75], v[196:199]
    ds_read_b64_tr_b16 a[134:135], v12 offset:17408
    v_mfma_f32_16x16x32_bf16 v[200:203], a[144:147], v[80:83], v[200:203]
    s_add_u32 m0, s59, 32768
    s_add_u32 s56, s60, 0
    v_mfma_f32_16x16x32_bf16 v[200:203], a[148:151], v[84:87], v[200:203]
    buffer_load_dwordx4 v24, s[20:23], s56 offen offset:0 lds
    v_mfma_f32_16x16x32_bf16 v[204:207], a[148:151], v[92:95], v[204:207]
    v_mfma_f32_16x16x32_bf16 v[204:207], a[144:147], v[88:91], v[204:207]
    s_waitcnt lgkmcnt(4)
    v_mfma_f32_16x16x32_bf16 v[220:223], a[152:155], v[88:91], v[220:223]
    ds_read_b64_tr_b16 a[136:137], v13 offset:0
    v_mfma_f32_16x16x32_bf16 v[220:223], a[156:159], v[92:95], v[220:223]
    ds_read_b64_tr_b16 a[138:139], v13 offset:1024
    v_mfma_f32_16x16x32_bf16 v[216:219], a[156:159], v[84:87], v[216:219]
    ds_read_b64_tr_b16 a[140:141], v13 offset:16384
    v_mfma_f32_16x16x32_bf16 v[216:219], a[152:155], v[80:83], v[216:219]
    ds_read_b64_tr_b16 a[142:143], v13 offset:17408
    v_mfma_f32_16x16x32_bf16 v[212:215], a[152:155], v[72:75], v[212:215]
    s_add_u32 s57, s60, 7168
    v_mfma_f32_16x16x32_bf16 v[212:215], a[156:159], v[76:79], v[212:215]
    buffer_load_dwordx4 v25, s[20:23], s57 offen offset:1024 lds
    v_mfma_f32_16x16x32_bf16 v[208:211], a[156:159], v[68:71], v[208:211]
    v_mfma_f32_16x16x32_bf16 v[208:211], a[152:155], v[64:67], v[208:211]
    s_waitcnt lgkmcnt(4)
    v_mfma_f32_16x16x32_bf16 a[0:3], a[128:131], v[64:67], a[0:3]
    ds_read_b64_tr_b16 a[144:145], v14 offset:0
    v_mfma_f32_16x16x32_bf16 a[0:3], a[132:135], v[68:71], a[0:3]
    ds_read_b64_tr_b16 a[146:147], v14 offset:1024
    v_mfma_f32_16x16x32_bf16 a[4:7], a[132:135], v[76:79], a[4:7]
    ds_read_b64_tr_b16 a[148:149], v14 offset:16384
    v_mfma_f32_16x16x32_bf16 a[4:7], a[128:131], v[72:75], a[4:7]
    ds_read_b64_tr_b16 a[150:151], v14 offset:17408
    v_mfma_f32_16x16x32_bf16 a[8:11], a[128:131], v[80:83], a[8:11]
    s_add_u32 s56, s60, 14336
    v_mfma_f32_16x16x32_bf16 a[8:11], a[132:135], v[84:87], a[8:11]
    buffer_load_dwordx4 v24, s[20:23], s56 offen offset:2048 lds
    v_mfma_f32_16x16x32_bf16 a[12:15], a[132:135], v[92:95], a[12:15]
    v_mfma_f32_16x16x32_bf16 a[12:15], a[128:131], v[88:91], a[12:15]
    s_waitcnt lgkmcnt(4)
    v_mfma_f32_16x16x32_bf16 a[28:31], a[136:139], v[88:91], a[28:31]
    ds_read_b64_tr_b16 a[152:153], v15 offset:0
    v_mfma_f32_16x16x32_bf16 a[28:31], a[140:143], v[92:95], a[28:31]
    s_add_u32 s54, s54, 1
    s_cmp_eq_u32 s54, 3
    s_cselect_b32 s95, -2, 1
    s_cselect_b32 s54, 0, s54
    ds_read_b64_tr_b16 a[154:155], v15 offset:1024
    v_mfma_f32_16x16x32_bf16 a[24:27], a[140:143], v[84:87], a[24:27]
    s_lshl_b32 s95, s95, 15
    ds_read_b64_tr_b16 a[156:157], v15 offset:16384
    v_mfma_f32_16x16x32_bf16 a[24:27], a[136:139], v[80:83], a[24:27]
    ds_read_b64_tr_b16 a[158:159], v15 offset:17408
    v_mfma_f32_16x16x32_bf16 a[20:23], a[136:139], v[72:75], a[20:23]
    s_add_u32 s57, s60, 21504
    v_mfma_f32_16x16x32_bf16 a[20:23], a[140:143], v[76:79], a[20:23]
    buffer_load_dwordx4 v25, s[20:23], s57 offen offset:3072 lds
    v_mfma_f32_16x16x32_bf16 a[16:19], a[140:143], v[68:71], a[16:19]
    v_mfma_f32_16x16x32_bf16 a[16:19], a[136:139], v[64:67], a[16:19]
    s_waitcnt lgkmcnt(4)
    v_mfma_f32_16x16x32_bf16 a[32:35], a[144:147], v[64:67], a[32:35]
    ds_read_b64_tr_b16 a[128:129], v12 offset:4096
    v_add_u32 v8, s95, v8
    v_mfma_f32_16x16x32_bf16 a[32:35], a[148:151], v[68:71], a[32:35]
    ds_read_b64_tr_b16 a[130:131], v12 offset:5120
    v_add_u32 v9, s95, v9
    v_mfma_f32_16x16x32_bf16 a[36:39], a[148:151], v[76:79], a[36:39]
    ds_read_b64_tr_b16 a[132:133], v12 offset:20480
    v_add_u32 v10, s95, v10
    v_mfma_f32_16x16x32_bf16 a[36:39], a[144:147], v[72:75], a[36:39]
    s_waitcnt vmcnt(12)
    ds_read_b64_tr_b16 a[134:135], v12 offset:21504
    ds_read_b128 v[32:35], v20 offset:0
    v_mfma_f32_16x16x32_bf16 a[40:43], a[144:147], v[80:83], a[40:43]
    s_add_u32 m0, s59, 36864
    s_add_u32 s56, s60, 32768
    ds_read_b128 v[36:39], v21 offset:0
    v_add_u32 v11, s95, v11
    v_mfma_f32_16x16x32_bf16 a[40:43], a[148:151], v[84:87], a[40:43]
    buffer_load_dwordx4 v24, s[20:23], s56 offen offset:0 lds
    v_mfma_f32_16x16x32_bf16 a[44:47], a[148:151], v[92:95], a[44:47]
    ds_read_b128 v[40:43], v20 offset:2048
    v_add_u32 v16, s95, v16
    v_mfma_f32_16x16x32_bf16 a[44:47], a[144:147], v[88:91], a[44:47]
    s_waitcnt lgkmcnt(7)
    ds_read_b128 v[44:47], v21 offset:2048
    v_add_u32 v17, s95, v17
    v_mfma_f32_16x16x32_bf16 a[60:63], a[152:155], v[88:91], a[60:63]
    ds_read_b64_tr_b16 a[136:137], v13 offset:4096
    ds_read_b128 v[48:51], v20 offset:4096
    v_mfma_f32_16x16x32_bf16 a[60:63], a[156:159], v[92:95], a[60:63]
    ds_read_b64_tr_b16 a[138:139], v13 offset:5120
    ds_read_b128 v[52:55], v21 offset:4096
    v_mfma_f32_16x16x32_bf16 a[56:59], a[156:159], v[84:87], a[56:59]
    ds_read_b64_tr_b16 a[140:141], v13 offset:20480
    ds_read_b128 v[56:59], v20 offset:6144
    v_mfma_f32_16x16x32_bf16 a[56:59], a[152:155], v[80:83], a[56:59]
    ds_read_b64_tr_b16 a[142:143], v13 offset:21504
    ds_read_b128 v[60:63], v21 offset:6144
    v_mfma_f32_16x16x32_bf16 a[52:55], a[152:155], v[72:75], a[52:55]
    s_add_u32 s57, s60, 39936
    v_add_u32 v18, s95, v18
    v_add_u32 v19, s95, v19
    v_mfma_f32_16x16x32_bf16 a[52:55], a[156:159], v[76:79], a[52:55]
    buffer_load_dwordx4 v25, s[20:23], s57 offen offset:1024 lds
    v_mfma_f32_16x16x32_bf16 a[48:51], a[156:159], v[68:71], a[48:51]
    v_mfma_f32_16x16x32_bf16 a[48:51], a[152:155], v[64:67], a[48:51]
    s_waitcnt lgkmcnt(12)
    v_mfma_f32_16x16x32_bf16 a[64:67], a[128:131], v[64:67], a[64:67]
    ds_read_b64_tr_b16 a[144:145], v14 offset:4096
    v_mfma_f32_16x16x32_bf16 a[64:67], a[132:135], v[68:71], a[64:67]
    ds_read_b64_tr_b16 a[146:147], v14 offset:5120
    v_mfma_f32_16x16x32_bf16 a[68:71], a[132:135], v[76:79], a[68:71]
    ds_read_b64_tr_b16 a[148:149], v14 offset:20480
    v_mfma_f32_16x16x32_bf16 a[68:71], a[128:131], v[72:75], a[68:71]
    ds_read_b64_tr_b16 a[150:151], v14 offset:21504
    v_mfma_f32_16x16x32_bf16 a[72:75], a[128:131], v[80:83], a[72:75]
    s_add_u32 s56, s60, 47104
    v_mfma_f32_16x16x32_bf16 a[72:75], a[132:135], v[84:87], a[72:75]
    buffer_load_dwordx4 v24, s[20:23], s56 offen offset:2048 lds
    v_mfma_f32_16x16x32_bf16 a[76:79], a[132:135], v[92:95], a[76:79]
    v_mfma_f32_16x16x32_bf16 a[76:79], a[128:131], v[88:91], a[76:79]
    s_waitcnt lgkmcnt(5)
    v_mfma_f32_16x16x32_bf16 a[92:95], a[136:139], v[88:91], a[92:95]
    ds_read_b64_tr_b16 a[152:153], v15 offset:4096
    v_mfma_f32_16x16x32_bf16 a[92:95], a[140:143], v[92:95], a[92:95]
    ds_read_b64_tr_b16 a[154:155], v15 offset:5120
    v_mfma_f32_16x16x32_bf16 a[88:91], a[140:143], v[84:87], a[88:91]
    ds_read_b64_tr_b16 a[156:157], v15 offset:20480
    v_mfma_f32_16x16x32_bf16 a[88:91], a[136:139], v[80:83], a[88:91]
    ds_read_b64_tr_b16 a[158:159], v15 offset:21504
    v_mfma_f32_16x16x32_bf16 a[84:87], a[136:139], v[72:75], a[84:87]
    s_add_u32 s57, s60, 54272
    v_mfma_f32_16x16x32_bf16 a[84:87], a[140:143], v[76:79], a[84:87]
    buffer_load_dwordx4 v25, s[20:23], s57 offen offset:3072 lds
    v_mfma_f32_16x16x32_bf16 a[80:83], a[140:143], v[68:71], a[80:83]
    s_add_u32 s60, s60, 128
    s_and_b32 s60, s60, 1023
    v_mfma_f32_16x16x32_bf16 a[80:83], a[136:139], v[64:67], a[80:83]
    s_waitcnt lgkmcnt(0)
    s_barrier
    v_mfma_f32_16x16x32_bf16 a[96:99], a[144:147], v[64:67], a[96:99]
    ds_read_b64_tr_b16 a[128:129], v16 offset:0
    v_add_u32 v12, s95, v12
    v_mfma_f32_16x16x32_bf16 a[96:99], a[148:151], v[68:71], a[96:99]
    ds_read_b64_tr_b16 a[130:131], v16 offset:1024
    v_add_u32 v13, s95, v13
    v_mfma_f32_16x16x32_bf16 a[100:103], a[148:151], v[76:79], a[100:103]
    ds_read_b64_tr_b16 a[132:133], v16 offset:16384
    v_add_u32 v14, s95, v14
    v_mfma_f32_16x16x32_bf16 a[100:103], a[144:147], v[72:75], a[100:103]
    ds_read_b64_tr_b16 a[134:135], v16 offset:17408
    v_add_u32 v15, s95, v15
    v_mfma_f32_16x16x32_bf16 a[104:107], a[144:147], v[80:83], a[104:107]
    v_mfma_f32_16x16x32_bf16 a[104:107], a[148:151], v[84:87], a[104:107]
    v_mfma_f32_16x16x32_bf16 a[108:111], a[148:151], v[92:95], a[108:111]
    v_mfma_f32_16x16x32_bf16 a[108:111], a[144:147], v[88:91], a[108:111]
    s_waitcnt lgkmcnt(0)
    v_mfma_f32_16x16x32_bf16 a[124:127], a[152:155], v[88:91], a[124:127]
    ds_read_b64_tr_b16 a[136:137], v17 offset:0
    v_mfma_f32_16x16x32_bf16 a[124:127], a[156:159], v[92:95], a[124:127]
    ds_read_b64_tr_b16 a[138:139], v17 offset:1024
    v_mfma_f32_16x16x32_bf16 a[120:123], a[156:159], v[84:87], a[120:123]
    ds_read_b64_tr_b16 a[140:141], v17 offset:16384
    v_mfma_f32_16x16x32_bf16 a[120:123], a[152:155], v[80:83], a[120:123]
    ds_read_b64_tr_b16 a[142:143], v17 offset:17408
    v_mfma_f32_16x16x32_bf16 a[116:119], a[152:155], v[72:75], a[116:119]
    s_sub_u32 s55, s55, 1
    v_mfma_f32_16x16x32_bf16 a[116:119], a[156:159], v[76:79], a[116:119]
    v_mfma_f32_16x16x32_bf16 a[112:115], a[156:159], v[68:71], a[112:115]
    s_cmp_lg_u32 s55, 0
    v_mfma_f32_16x16x32_bf16 a[112:115], a[152:155], v[64:67], a[112:115]
    s_cbranch_scc1 L_a
.p2align 3
    v_smfmac_f32_16x16x64_bf16 v[224:227], a[160:163], v[32:39], v27
    s_add_u32 m0, s88, 131072
    s_add_u32 s52, s52, 8192
    buffer_load_dwordx4 v28, s[8:11], s52 offen offset:0 lds
    v_smfmac_f32_16x16x64_bf16 v[224:227], a[164:167], v[40:47], v27
    s_waitcnt lgkmcnt(0)
    v_smfmac_f32_16x16x64_bf16 v[228:231], a[160:163], a[128:135], v27
    v_smfmac_f32_16x16x64_bf16 v[228:231], a[164:167], a[136:143], v27
    v_mfma_f32_4x4x4_16b_bf16 v[240:243], v[32:33], v[32:33], v[240:243]
    ds_read_b64_tr_b16 a[144:145], v18 offset:0
    v_mfma_f32_4x4x4_16b_bf16 v[244:247], v[40:41], v[40:41], v[244:247]
    ds_read_b64_tr_b16 a[146:147], v18 offset:1024
    v_mfma_f32_4x4x4_16b_bf16 v[248:251], v[48:49], v[48:49], v[248:251]
    ds_read_b64_tr_b16 a[148:149], v18 offset:16384
    v_mfma_f32_4x4x4_16b_bf16 v[252:255], v[56:57], v[56:57], v[252:255]
    ds_read_b64_tr_b16 a[150:151], v18 offset:17408
    v_mfma_f32_4x4x4_16b_bf16 v[240:243], v[34:35], v[34:35], v[240:243]
    ds_read_b64_tr_b16 a[152:153], v19 offset:0
    v_mfma_f32_4x4x4_16b_bf16 v[244:247], v[42:43], v[42:43], v[244:247]
    ds_read_b64_tr_b16 a[154:155], v19 offset:1024
    v_mfma_f32_4x4x4_16b_bf16 v[248:251], v[50:51], v[50:51], v[248:251]
    ds_read_b64_tr_b16 a[156:157], v19 offset:16384
    v_mfma_f32_4x4x4_16b_bf16 v[252:255], v[58:59], v[58:59], v[252:255]
    ds_read_b64_tr_b16 a[158:159], v19 offset:17408
    v_mfma_f32_4x4x4_16b_bf16 v[240:243], v[36:37], v[36:37], v[240:243]
    ds_read_b64_tr_b16 a[128:129], v8 offset:0
    v_mfma_f32_4x4x4_16b_bf16 v[244:247], v[44:45], v[44:45], v[244:247]
    ds_read_b64_tr_b16 a[130:131], v8 offset:1024
    v_mfma_f32_4x4x4_16b_bf16 v[248:251], v[52:53], v[52:53], v[248:251]
    ds_read_b64_tr_b16 a[132:133], v8 offset:16384
    v_mfma_f32_4x4x4_16b_bf16 v[252:255], v[60:61], v[60:61], v[252:255]
    ds_read_b64_tr_b16 a[134:135], v8 offset:17408
    v_mfma_f32_4x4x4_16b_bf16 v[240:243], v[38:39], v[38:39], v[240:243]
    ds_read_b64_tr_b16 a[136:137], v8 offset:8
    v_mfma_f32_4x4x4_16b_bf16 v[244:247], v[46:47], v[46:47], v[244:247]
    ds_read_b64_tr_b16 a[138:139], v8 offset:1032
    v_mfma_f32_4x4x4_16b_bf16 v[248:251], v[54:55], v[54:55], v[248:251]
    ds_read_b64_tr_b16 a[140:141], v8 offset:16392
    v_mfma_f32_4x4x4_16b_bf16 v[252:255], v[62:63], v[62:63], v[252:255]
    ds_read_b64_tr_b16 a[142:143], v8 offset:17416
    v_smfmac_f32_16x16x64_bf16 v[224:227], a[168:171], v[48:55], v27
    buffer_load_dwordx4 v29, s[8:11], s52 offen offset:1024 lds
    v_smfmac_f32_16x16x64_bf16 v[224:227], a[172:175], v[56:63], v27
    s_waitcnt lgkmcnt(8)
    v_smfmac_f32_16x16x64_bf16 v[228:231], a[168:171], a[144:151], v27
    v_smfmac_f32_16x16x64_bf16 v[228:231], a[172:175], a[152:159], v27
    s_waitcnt lgkmcnt(4)
    v_mfma_f32_16x16x32_bf16 v[96:99], a[128:131], v[32:35], v[96:99]
    ds_read_b64_tr_b16 a[144:145], v9 offset:0
    v_mfma_f32_16x16x32_bf16 v[96:99], a[132:135], v[36:39], v[96:99]
    ds_read_b64_tr_b16 a[146:147], v9 offset:1024
    v_mfma_f32_16x16x32_bf16 v[100:103], a[132:135], v[44:47], v[100:103]
    ds_read_b64_tr_b16 a[148:149], v9 offset:16384
    v_mfma_f32_16x16x32_bf16 v[100:103], a[128:131], v[40:43], v[100:103]
    ds_read_b64_tr_b16 a[150:151], v9 offset:17408
    v_mfma_f32_16x16x32_bf16 v[104:107], a[128:131], v[48:51], v[104:107]
    s_add_u32 m0, s88, 147456
    s_add_u32 s52, s52, 8192
    v_mfma_f32_16x16x32_bf16 v[104:107], a[132:135], v[52:55], v[104:107]
    buffer_load_dwordx4 v28, s[8:11], s52 offen offset:0 lds
    v_mfma_f32_16x16x32_bf16 v[108:111], a[132:135], v[60:63], v[108:111]
    v_mfma_f32_16x16x32_bf16 v[108:111], a[128:131], v[56:59], v[108:111]
    s_waitcnt lgkmcnt(4)
    v_mfma_f32_16x16x32_bf16 v[124:127], a[136:139], v[56:59], v[124:127]
    ds_read_b64_tr_b16 a[152:153], v9 offset:8
    v_mfma_f32_16x16x32_bf16 v[124:127], a[140:143], v[60:63], v[124:127]
    ds_read_b64_tr_b16 a[154:155], v9 offset:1032
    v_mfma_f32_16x16x32_bf16 v[120:123], a[140:143], v[52:55], v[120:123]
    ds_read_b64_tr_b16 a[156:157], v9 offset:16392
    v_mfma_f32_16x16x32_bf16 v[120:123], a[136:139], v[48:51], v[120:123]
    ds_read_b64_tr_b16 a[158:159], v9 offset:17416
    v_mfma_f32_16x16x32_bf16 v[116:119], a[136:139], v[40:43], v[116:119]
    v_mfma_f32_16x16x32_bf16 v[116:119], a[140:143], v[44:47], v[116:119]
    buffer_load_dwordx4 v29, s[8:11], s52 offen offset:1024 lds
    v_mfma_f32_16x16x32_bf16 v[112:115], a[140:143], v[36:39], v[112:115]
    v_mfma_f32_16x16x32_bf16 v[112:115], a[136:139], v[32:35], v[112:115]
    s_waitcnt lgkmcnt(4)
    v_mfma_f32_16x16x32_bf16 v[128:131], a[144:147], v[32:35], v[128:131]
    ds_read_b64_tr_b16 a[128:129], v10 offset:0
    v_mfma_f32_16x16x32_bf16 v[128:131], a[148:151], v[36:39], v[128:131]
    ds_read_b64_tr_b16 a[130:131], v10 offset:1024
    v_mfma_f32_16x16x32_bf16 v[132:135], a[148:151], v[44:47], v[132:135]
    ds_read_b64_tr_b16 a[132:133], v10 offset:16384
    v_mfma_f32_16x16x32_bf16 v[132:135], a[144:147], v[40:43], v[132:135]
    ds_read_b64_tr_b16 a[134:135], v10 offset:17408
    v_mfma_f32_16x16x32_bf16 v[136:139], a[144:147], v[48:51], v[136:139]
    s_add_u32 m0, s88, 0
    s_add_u32 s52, s52, 8192
    v_mfma_f32_16x16x32_bf16 v[136:139], a[148:151], v[52:55], v[136:139]
    buffer_load_dwordx4 v28, s[8:11], s52 offen offset:0 lds
    v_mfma_f32_16x16x32_bf16 v[140:143], a[148:151], v[60:63], v[140:143]
    v_mfma_f32_16x16x32_bf16 v[140:143], a[144:147], v[56:59], v[140:143]
    s_waitcnt lgkmcnt(4)
    v_mfma_f32_16x16x32_bf16 v[156:159], a[152:155], v[56:59], v[156:159]
    ds_read_b64_tr_b16 a[136:137], v10 offset:8
    v_mfma_f32_16x16x32_bf16 v[156:159], a[156:159], v[60:63], v[156:159]
    ds_read_b64_tr_b16 a[138:139], v10 offset:1032
    v_mfma_f32_16x16x32_bf16 v[152:155], a[156:159], v[52:55], v[152:155]
    ds_read_b64_tr_b16 a[140:141], v10 offset:16392
    v_mfma_f32_16x16x32_bf16 v[152:155], a[152:155], v[48:51], v[152:155]
    ds_read_b64_tr_b16 a[142:143], v10 offset:17416
    v_mfma_f32_16x16x32_bf16 v[148:151], a[152:155], v[40:43], v[148:151]
    v_mfma_f32_16x16x32_bf16 v[148:151], a[156:159], v[44:47], v[148:151]
    buffer_load_dwordx4 v29, s[8:11], s52 offen offset:1024 lds
    v_mfma_f32_16x16x32_bf16 v[144:147], a[156:159], v[36:39], v[144:147]
    v_mfma_f32_16x16x32_bf16 v[144:147], a[152:155], v[32:35], v[144:147]
    s_waitcnt lgkmcnt(4)
    v_mfma_f32_16x16x32_bf16 v[160:163], a[128:131], v[32:35], v[160:163]
    ds_read_b64_tr_b16 a[144:145], v11 offset:0
    v_mfma_f32_16x16x32_bf16 v[160:163], a[132:135], v[36:39], v[160:163]
    ds_read_b64_tr_b16 a[146:147], v11 offset:1024
    v_mfma_f32_16x16x32_bf16 v[164:167], a[132:135], v[44:47], v[164:167]
    ds_read_b64_tr_b16 a[148:149], v11 offset:16384
    v_mfma_f32_16x16x32_bf16 v[164:167], a[128:131], v[40:43], v[164:167]
    ds_read_b64_tr_b16 a[150:151], v11 offset:17408
    v_mfma_f32_16x16x32_bf16 v[168:171], a[128:131], v[48:51], v[168:171]
    v_mfma_f32_16x16x32_bf16 v[168:171], a[132:135], v[52:55], v[168:171]
    buffer_load_dwordx4 v30, s[12:15], s52 offen offset:2048 lds
    v_mfma_f32_16x16x32_bf16 v[172:175], a[132:135], v[60:63], v[172:175]
    v_mfma_f32_16x16x32_bf16 v[172:175], a[128:131], v[56:59], v[172:175]
    s_waitcnt lgkmcnt(4)
    v_mfma_f32_16x16x32_bf16 v[188:191], a[136:139], v[56:59], v[188:191]
    ds_read_b64_tr_b16 a[152:153], v11 offset:8
    v_mfma_f32_16x16x32_bf16 v[188:191], a[140:143], v[60:63], v[188:191]
    ds_read_b64_tr_b16 a[154:155], v11 offset:1032
    v_mfma_f32_16x16x32_bf16 v[184:187], a[140:143], v[52:55], v[184:187]
    ds_read_b64_tr_b16 a[156:157], v11 offset:16392
    v_mfma_f32_16x16x32_bf16 v[184:187], a[136:139], v[48:51], v[184:187]
    ds_read_b64_tr_b16 a[158:159], v11 offset:17416
    v_mfma_f32_16x16x32_bf16 v[180:183], a[136:139], v[40:43], v[180:183]
    v_mfma_f32_16x16x32_bf16 v[180:183], a[140:143], v[44:47], v[180:183]
    buffer_load_dwordx4 v31, s[12:15], s52 offen offset:3072 lds
    v_mfma_f32_16x16x32_bf16 v[176:179], a[140:143], v[36:39], v[176:179]
    v_mfma_f32_16x16x32_bf16 v[176:179], a[136:139], v[32:35], v[176:179]
    s_waitcnt lgkmcnt(4)
    v_mfma_f32_16x16x32_bf16 v[192:195], a[144:147], v[32:35], v[192:195]
    ds_read_b64_tr_b16 a[128:129], v12 offset:0
    v_mfma_f32_16x16x32_bf16 v[192:195], a[148:151], v[36:39], v[192:195]
    ds_read_b64_tr_b16 a[130:131], v12 offset:1024
    v_mfma_f32_16x16x32_bf16 v[196:199], a[148:151], v[44:47], v[196:199]
    ds_read_b64_tr_b16 a[132:133], v12 offset:16384
    v_mfma_f32_16x16x32_bf16 v[196:199], a[144:147], v[40:43], v[196:199]
    ds_read_b64_tr_b16 a[134:135], v12 offset:17408
    v_mfma_f32_16x16x32_bf16 v[200:203], a[144:147], v[48:51], v[200:203]
    s_add_u32 m0, s88, 16384
    s_add_u32 s52, s52, 8192
    v_mfma_f32_16x16x32_bf16 v[200:203], a[148:151], v[52:55], v[200:203]
    buffer_load_dwordx4 v28, s[8:11], s52 offen offset:0 lds
    v_mfma_f32_16x16x32_bf16 v[204:207], a[148:151], v[60:63], v[204:207]
L_pad1:
    s_cbranch_execz L_pad5
    v_mfma_f32_16x16x32_bf16 v[204:207], a[144:147], v[56:59], v[204:207]
    s_waitcnt lgkmcnt(4)
    v_mfma_f32_16x16x32_bf16 v[220:223], a[152:155], v[56:59], v[220:223]
    ds_read_b64_tr_b16 a[136:137], v13 offset:0
    v_mfma_f32_16x16x32_bf16 v[220:223], a[156:159], v[60:63], v[220:223]
    ds_read_b64_tr_b16 a[138:139], v13 offset:1024
    v_mfma_f32_16x16x32_bf16 v[216:219], a[156:159], v[52:55], v[216:219]
    ds_read_b64_tr_b16 a[140:141], v13 offset:16384
    v_mfma_f32_16x16x32_bf16 v[216:219], a[152:155], v[48:51], v[216:219]
    ds_read_b64_tr_b16 a[142:143], v13 offset:17408
    v_mfma_f32_16x16x32_bf16 v[212:215], a[152:155], v[40:43], v[212:215]
    v_mfma_f32_16x16x32_bf16 v[212:215], a[156:159], v[44:47], v[212:215]
    buffer_load_dwordx4 v29, s[8:11], s52 offen offset:1024 lds
    v_mfma_f32_16x16x32_bf16 v[208:211], a[156:159], v[36:39], v[208:211]
    v_mfma_f32_16x16x32_bf16 v[208:211], a[152:155], v[32:35], v[208:211]
    s_waitcnt lgkmcnt(4)
    v_mfma_f32_16x16x32_bf16 a[0:3], a[128:131], v[32:35], a[0:3]
    ds_read_b64_tr_b16 a[144:145], v14 offset:0
    v_mfma_f32_16x16x32_bf16 a[0:3], a[132:135], v[36:39], a[0:3]
    ds_read_b64_tr_b16 a[146:147], v14 offset:1024
    v_mfma_f32_16x16x32_bf16 a[4:7], a[132:135], v[44:47], a[4:7]
    ds_read_b64_tr_b16 a[148:149], v14 offset:16384
    v_mfma_f32_16x16x32_bf16 a[4:7], a[128:131], v[40:43], a[4:7]
    ds_read_b64_tr_b16 a[150:151], v14 offset:17408
    v_mfma_f32_16x16x32_bf16 a[8:11], a[128:131], v[48:51], a[8:11]
    v_mfma_f32_16x16x32_bf16 a[8:11], a[132:135], v[52:55], a[8:11]
    buffer_load_dwordx4 v30, s[12:15], s52 offen offset:2048 lds
    v_mfma_f32_16x16x32_bf16 a[12:15], a[132:135], v[60:63], a[12:15]
    v_mfma_f32_16x16x32_bf16 a[12:15], a[128:131], v[56:59], a[12:15]
    s_waitcnt lgkmcnt(4)
    v_mfma_f32_16x16x32_bf16 a[28:31], a[136:139], v[56:59], a[28:31]
    ds_read_b64_tr_b16 a[152:153], v15 offset:0
    v_mfma_f32_16x16x32_bf16 a[28:31], a[140:143], v[60:63], a[28:31]
    s_add_u32 s54, s54, 1
    s_cmp_eq_u32 s54, 3
    s_cselect_b32 s95, -2, 1
    s_cselect_b32 s54, 0, s54
    ds_read_b64_tr_b16 a[154:155], v15 offset:1024
    v_mfma_f32_16x16x32_bf16 a[24:27], a[140:143], v[52:55], a[24:27]
    s_lshl_b32 s95, s95, 15
    ds_read_b64_tr_b16 a[156:157], v15 offset:16384
    v_mfma_f32_16x16x32_bf16 a[24:27], a[136:139], v[48:51], a[24:27]
    ds_read_b64_tr_b16 a[158:159], v15 offset:17408
    v_mfma_f32_16x16x32_bf16 a[20:23], a[136:139], v[40:43], a[20:23]
    v_mfma_f32_16x16x32_bf16 a[20:23], a[140:143], v[44:47], a[20:23]
    buffer_load_dwordx4 v31, s[12:15], s52 offen offset:3072 lds
    v_mfma_f32_16x16x32_bf16 a[16:19], a[140:143], v[36:39], a[16:19]
    v_mfma_f32_16x16x32_bf16 a[16:19], a[136:139], v[32:35], a[16:19]
    s_waitcnt lgkmcnt(4)
    v_mfma_f32_16x16x32_bf16 a[32:35], a[144:147], v[32:35], a[32:35]
    ds_read_b64_tr_b16 a[128:129], v12 offset:4096
    v_add_u32 v8, s95, v8
    v_mfma_f32_16x16x32_bf16 a[32:35], a[148:151], v[36:39], a[32:35]
    ds_read_b64_tr_b16 a[130:131], v12 offset:5120
    v_add_u32 v9, s95, v9
    v_mfma_f32_16x16x32_bf16 a[36:39], a[148:151], v[44:47], a[36:39]
    ds_read_b64_tr_b16 a[132:133], v12 offset:20480
    v_add_u32 v10, s95, v10
    v_mfma_f32_16x16x32_bf16 a[36:39], a[144:147], v[40:43], a[36:39]
    s_waitcnt vmcnt(12)
    ds_read_b64_tr_b16 a[134:135], v12 offset:21504
    ds_read_b128 v[64:67], v20 offset:32768
    v_mfma_f32_16x16x32_bf16 a[40:43], a[144:147], v[48:51], a[40:43]
    ds_read_b128 v[68:71], v21 offset:32768
    v_add_u32 v11, s95, v11
    v_mfma_f32_16x16x32_bf16 a[40:43], a[148:151], v[52:55], a[40:43]
    ds_read_b128 v[72:75], v20 offset:34816
    v_add_u32 v16, s95, v16
    v_mfma_f32_16x16x32_bf16 a[44:47], a[148:151], v[60:63], a[44:47]
    ds_read_b128 v[76:79], v21 offset:34816
    v_add_u32 v17, s95, v17
    v_mfma_f32_16x16x32_bf16 a[44:47], a[144:147], v[56:59], a[44:47]
    s_waitcnt lgkmcnt(8)
    ds_read_b128 v[80:83], v20 offset:36864
    v_add_u32 v18, s95, v18
    v_mfma_f32_16x16x32_bf16 a[60:63], a[152:155], v[56:59], a[60:63]
    ds_read_b64_tr_b16 a[136:137], v13 offset:4096
    ds_read_b128 v[84:87], v21 offset:36864
    v_mfma_f32_16x16x32_bf16 a[60:63], a[156:159], v[60:63], a[60:63]
    ds_read_b64_tr_b16 a[138:139], v13 offset:5120
    ds_read_b128 v[88:91], v20 offset:38912
    v_mfma_f32_16x16x32_bf16 a[56:59], a[156:159], v[52:55], a[56:59]
    ds_read_b64_tr_b16 a[140:141], v13 offset:20480
    ds_read_b128 v[92:95], v21 offset:38912
    v_mfma_f32_16x16x32_bf16 a[56:59], a[152:155], v[48:51], a[56:59]
    ds_read_b64_tr_b16 a[142:143], v13 offset:21504
    v_add_u32 v19, s95, v19
    v_mfma_f32_16x16x32_bf16 a[52:55], a[152:155], v[40:43], a[52:55]
    v_mfma_f32_16x16x32_bf16 a[52:55], a[156:159], v[44:47], a[52:55]
    v_mfma_f32_16x16x32_bf16 a[48:51], a[156:159], v[36:39], a[48:51]
    v_mfma_f32_16x16x32_bf16 a[48:51], a[152:155], v[32:35], a[48:51]
    s_waitcnt lgkmcnt(12)
    v_mfma_f32_16x16x32_bf16 a[64:67], a[128:131], v[32:35], a[64:67]
    ds_read_b64_tr_b16 a[144:145], v14 offset:4096
    v_mfma_f32_16x16x32_bf16 a[64:67], a[132:135], v[36:39], a[64:67]
    ds_read_b64_tr_b16 a[146:147], v14 offset:5120
    v_mfma_f32_16x16x32_bf16 a[68:71], a[132:135], v[44:47], a[68:71]
    ds_read_b64_tr_b16 a[148:149], v14 offset:20480
    v_mfma_f32_16x16x32_bf16 a[68:71], a[128:131], v[40:43], a[68:71]
    ds_read_b64_tr_b16 a[150:151], v14 offset:21504
    v_mfma_f32_16x16x32_bf16 a[72:75], a[128:131], v[48:51], a[72:75]
    v_mfma_f32_16x16x32_bf16 a[72:75], a[132:135], v[52:55], a[72:75]
    v_mfma_f32_16x16x32_bf16 a[76:79], a[132:135], v[60:63], a[76:79]
    v_mfma_f32_16x16x32_bf16 a[76:79], a[128:131], v[56:59], a[76:79]
    s_waitcnt lgkmcnt(4)
    v_mfma_f32_16x16x32_bf16 a[92:95], a[136:139], v[56:59], a[92:95]
    ds_read_b64_tr_b16 a[152:153], v15 offset:4096
    v_mfma_f32_16x16x32_bf16 a[92:95], a[140:143], v[60:63], a[92:95]
    ds_read_b64_tr_b16 a[154:155], v15 offset:5120
    v_mfma_f32_16x16x32_bf16 a[88:91], a[140:143], v[52:55], a[88:91]
    ds_read_b64_tr_b16 a[156:157], v15 offset:20480
    v_mfma_f32_16x16x32_bf16 a[88:91], a[136:139], v[48:51], a[88:91]
    ds_read_b64_tr_b16 a[158:159], v15 offset:21504
    v_mfma_f32_16x16x32_bf16 a[84:87], a[136:139], v[40:43], a[84:87]
    v_mfma_f32_16x16x32_bf16 a[84:87], a[140:143], v[44:47], a[84:87]
    v_mfma_f32_16x16x32_bf16 a[80:83], a[140:143], v[36:39], a[80:83]
    v_mfma_f32_16x16x32_bf16 a[80:83], a[136:139], v[32:35], a[80:83]
    s_waitcnt lgkmcnt(0)
    s_barrier
    v_mfma_f32_16x16x32_bf16 a[96:99], a[144:147], v[32:35], a[96:99]
    ds_read_b64_tr_b16 a[128:129], v16 offset:0
    v_add_u32 v12, s95, v12
    v_mfma_f32_16x16x32_bf16 a[96:99], a[148:151], v[36:39], a[96:99]
    ds_read_b64_tr_b16 a[130:131], v16 offset:1024
    v_add_u32 v13, s95, v13
    v_mfma_f32_16x16x32_bf16 a[100:103], a[148:151], v[44:47], a[100:103]
    ds_read_b64_tr_b16 a[132:133], v16 offset:16384
    v_add_u32 v14, s95, v14
    v_mfma_f32_16x16x32_bf16 a[100:103], a[144:147], v[40:43], a[100:103]
    ds_read_b64_tr_b16 a[134:135], v16 offset:17408
    v_add_u32 v15, s95, v15
    v_mfma_f32_16x16x32_bf16 a[104:107], a[144:147], v[48:51], a[104:107]
    v_mfma_f32_16x16x32_bf16 a[104:107], a[148:151], v[52:55], a[104:107]
    v_mfma_f32_16x16x32_bf16 a[108:111], a[148:151], v[60:63], a[108:111]
    v_mfma_f32_16x16x32_bf16 a[108:111], a[144:147], v[56:59], a[108:111]
    s_waitcnt lgkmcnt(0)
    v_mfma_f32_16x16x32_bf16 a[124:127], a[152:155], v[56:59], a[124:127]
    ds_read_b64_tr_b16 a[136:137], v17 offset:0
    v_mfma_f32_16x16x32_bf16 a[124:127], a[156:159], v[60:63], a[124:127]
    ds_read_b64_tr_b16 a[138:139], v17 offset:1024
    v_mfma_f32_16x16x32_bf16 a[120:123], a[156:159], v[52:55], a[120:123]
    ds_read_b64_tr_b16 a[140:141], v17 offset:16384
    v_mfma_f32_16x16x32_bf16 a[120:123], a[152:155], v[48:51], a[120:123]
    ds_read_b64_tr_b16 a[142:143], v17 offset:17408
    v_mfma_f32_16x16x32_bf16 a[116:119], a[152:155], v[40:43], a[116:119]
    v_mfma_f32_16x16x32_bf16 a[116:119], a[156:159], v[44:47], a[116:119]
    v_mfma_f32_16x16x32_bf16 a[112:115], a[156:159], v[36:39], a[112:115]
    v_mfma_f32_16x16x32_bf16 a[112:115], a[152:155], v[32:35], a[112:115]
    v_smfmac_f32_16x16x64_bf16 v[224:227], a[160:163], v[64:71], v27
    s_add_u32 m0, s88, 32768
    s_add_u32 s52, s52, 8192
    buffer_load_dwordx4 v28, s[8:11], s52 offen offset:0 lds
    v_smfmac_f32_16x16x64_bf16 v[224:227], a[164:167], v[72:79], v27
    s_waitcnt lgkmcnt(0)
    v_smfmac_f32_16x16x64_bf16 v[228:231], a[160:163], a[128:135], v27
    v_smfmac_f32_16x16x64_bf16 v[228:231], a[164:167], a[136:143], v27
    v_mfma_f32_4x4x4_16b_bf16 v[240:243], v[64:65], v[64:65], v[240:243]
    ds_read_b64_tr_b16 a[144:145], v18 offset:0
    v_mfma_f32_4x4x4_16b_bf16 v[244:247], v[72:73], v[72:73], v[244:247]
    ds_read_b64_tr_b16 a[146:147], v18 offset:1024
    v_mfma_f32_4x4x4_16b_bf16 v[248:251], v[80:81], v[80:81], v[248:251]
    ds_read_b64_tr_b16 a[148:149], v18 offset:16384
    v_mfma_f32_4x4x4_16b_bf16 v[252:255], v[88:89], v[88:89], v[252:255]
    ds_read_b64_tr_b16 a[150:151], v18 offset:17408
    v_mfma_f32_4x4x4_16b_bf16 v[240:243], v[66:67], v[66:67], v[240:243]
    ds_read_b64_tr_b16 a[152:153], v19 offset:0
    v_mfma_f32_4x4x4_16b_bf16 v[244:247], v[74:75], v[74:75], v[244:247]
    ds_read_b64_tr_b16 a[154:155], v19 offset:1024
    v_mfma_f32_4x4x4_16b_bf16 v[248:251], v[82:83], v[82:83], v[248:251]
    ds_read_b64_tr_b16 a[156:157], v19 offset:16384
    v_mfma_f32_4x4x4_16b_bf16 v[252:255], v[90:91], v[90:91], v[252:255]
    ds_read_b64_tr_b16 a[158:159], v19 offset:17408
    v_mfma_f32_4x4x4_16b_bf16 v[240:243], v[68:69], v[68:69], v[240:243]
    ds_read_b64_tr_b16 a[128:129], v8 offset:0
    v_mfma_f32_4x4x4_16b_bf16 v[244:247], v[76:77], v[76:77], v[244:247]
    ds_read_b64_tr_b16 a[130:131], v8 offset:1024
    v_mfma_f32_4x4x4_16b_bf16 v[248:251], v[84:85], v[84:85], v[248:251]
    ds_read_b64_tr_b16 a[132:133], v8 offset:16384
    v_mfma_f32_4x4x4_16b_bf16 v[252:255], v[92:93], v[92:93], v[252:255]
    ds_read_b64_tr_b16 a[134:135], v8 offset:17408
    v_mfma_f32_4x4x4_16b_bf16 v[240:243], v[70:71], v[70:71], v[240:243]
    ds_read_b64_tr_b16 a[136:137], v8 offset:8
    v_mfma_f32_4x4x4_16b_bf16 v[244:247], v[78:79], v[78:79], v[244:247]
    ds_read_b64_tr_b16 a[138:139], v8 offset:1032
    v_mfma_f32_4x4x4_16b_bf16 v[248:251], v[86:87], v[86:87], v[248:251]
    ds_read_b64_tr_b16 a[140:141], v8 offset:16392
    v_mfma_f32_4x4x4_16b_bf16 v[252:255], v[94:95], v[94:95], v[252:255]
    ds_read_b64_tr_b16 a[142:143], v8 offset:17416
    v_smfmac_f32_16x16x64_bf16 v[224:227], a[168:171], v[80:87], v27
    buffer_load_dwordx4 v29, s[8:11], s52 offen offset:1024 lds
    v_smfmac_f32_16x16x64_bf16 v[224:227], a[172:175], v[88:95], v27
    s_waitcnt lgkmcnt(8)
    v_smfmac_f32_16x16x64_bf16 v[228:231], a[168:171], a[144:151], v27
    v_smfmac_f32_16x16x64_bf16 v[228:231], a[172:175], a[152:159], v27
    s_waitcnt lgkmcnt(4)
    v_mfma_f32_16x16x32_bf16 v[96:99], a[128:131], v[64:67], v[96:99]
    ds_read_b64_tr_b16 a[144:145], v9 offset:0
    v_mfma_f32_16x16x32_bf16 v[96:99], a[132:135], v[68:71], v[96:99]
    ds_read_b64_tr_b16 a[146:147], v9 offset:1024
    v_mfma_f32_16x16x32_bf16 v[100:103], a[132:135], v[76:79], v[100:103]
    ds_read_b64_tr_b16 a[148:149], v9 offset:16384
    v_mfma_f32_16x16x32_bf16 v[100:103], a[128:131], v[72:75], v[100:103]
    ds_read_b64_tr_b16 a[150:151], v9 offset:17408
    v_mfma_f32_16x16x32_bf16 v[104:107], a[128:131], v[80:83], v[104:107]
    v_mfma_f32_16x16x32_bf16 v[104:107], a[132:135], v[84:87], v[104:107]
    buffer_load_dwordx4 v30, s[12:15], s52 offen offset:2048 lds
    v_mfma_f32_16x16x32_bf16 v[108:111], a[132:135], v[92:95], v[108:111]
    v_lshlrev_b32 v4, 4, v3
    v_add_u32 v4, 81920, v4
    v_mfma_f32_16x16x32_bf16 v[108:111], a[128:131], v[88:91], v[108:111]
    s_waitcnt lgkmcnt(4)
    v_lshlrev_b32 v5, 2, v2
    v_lshl_add_u32 v5, s6, 8, v5
    v_mfma_f32_16x16x32_bf16 v[124:127], a[136:139], v[88:91], v[124:127]
    ds_read_b64_tr_b16 a[152:153], v9 offset:8
    v_add_u32 v5, 81920, v5
    v_mfma_f32_16x16x32_bf16 v[124:127], a[140:143], v[92:95], v[124:127]
    ds_read_b64_tr_b16 a[154:155], v9 offset:1032
    v_mov_b32 v232, v228
    v_mfma_f32_16x16x32_bf16 v[120:123], a[140:143], v[84:87], v[120:123]
    ds_read_b64_tr_b16 a[156:157], v9 offset:16392
    v_mov_b32 v233, v229
    v_mfma_f32_16x16x32_bf16 v[120:123], a[136:139], v[80:83], v[120:123]
    ds_read_b64_tr_b16 a[158:159], v9 offset:17416
    v_mov_b32 v234, v230
    v_mfma_f32_16x16x32_bf16 v[116:119], a[136:139], v[72:75], v[116:119]
    v_mov_b32 v235, v231
    v_mfma_f32_16x16x32_bf16 v[116:119], a[140:143], v[76:79], v[116:119]
    buffer_load_dwordx4 v31, s[12:15], s52 offen offset:3072 lds
    v_mfma_f32_16x16x32_bf16 v[112:115], a[140:143], v[68:71], v[112:115]
    v_permlane16_swap_b32 v228, v232
    v_mfma_f32_16x16x32_bf16 v[112:115], a[136:139], v[64:67], v[112:115]
    s_waitcnt lgkmcnt(4)
    v_permlane16_swap_b32 v229, v233
    v_mfma_f32_16x16x32_bf16 v[128:131], a[144:147], v[64:67], v[128:131]
    ds_read_b64_tr_b16 a[128:129], v10 offset:0
    v_mfma_f32_16x16x32_bf16 v[128:131], a[148:151], v[68:71], v[128:131]
    ds_read_b64_tr_b16 a[130:131], v10 offset:1024
    v_mfma_f32_16x16x32_bf16 v[132:135], a[148:151], v[76:79], v[132:135]
    ds_read_b64_tr_b16 a[132:133], v10 offset:16384
    v_mfma_f32_16x16x32_bf16 v[132:135], a[144:147], v[72:75], v[132:135]
    ds_read_b64_tr_b16 a[134:135], v10 offset:17408
    v_mfma_f32_16x16x32_bf16 v[136:139], a[144:147], v[80:83], v[136:139]
    s_add_u32 m0, s88, 49152
    s_add_u32 s52, s52, 8192
    v_permlane16_swap_b32 v230, v234
    v_mfma_f32_16x16x32_bf16 v[136:139], a[148:151], v[84:87], v[136:139]
    buffer_load_dwordx4 v28, s[8:11], s52 offen offset:0 lds
    v_mfma_f32_16x16x32_bf16 v[140:143], a[148:151], v[92:95], v[140:143]
    v_permlane16_swap_b32 v231, v235
    v_mfma_f32_16x16x32_bf16 v[140:143], a[144:147], v[88:91], v[140:143]
    s_waitcnt lgkmcnt(4)
    v_add_f32 v228, v228, v232
    v_add_f32 v229, v229, v233
    v_mfma_f32_16x16x32_bf16 v[156:159], a[152:155], v[88:91], v[156:159]
    ds_read_b64_tr_b16 a[136:137], v10 offset:8
    v_add_f32 v230, v230, v234
    v_mfma_f32_16x16x32_bf16 v[156:159], a[156:159], v[92:95], v[156:159]
    ds_read_b64_tr_b16 a[138:139], v10 offset:1032
    v_add_f32 v231, v231, v235
    v_mfma_f32_16x16x32_bf16 v[152:155], a[156:159], v[84:87], v[152:155]
    ds_read_b64_tr_b16 a[140:141], v10 offset:16392
    v_and_b32 v6, 3, v1
    v_mfma_f32_16x16x32_bf16 v[152:155], a[152:155], v[80:83], v[152:155]
    ds_read_b64_tr_b16 a[142:143], v10 offset:17416
    v_cmp_eq_u32 s[98:99], 1, v6
    v_mfma_f32_16x16x32_bf16 v[148:151], a[152:155], v[72:75], v[148:151]
    v_cmp_eq_u32 s[100:101], 2, v6
    v_cmp_eq_u32 vcc, 3, v6
    v_mfma_f32_16x16x32_bf16 v[148:151], a[156:159], v[76:79], v[148:151]
    buffer_load_dwordx4 v29, s[8:11], s52 offen offset:1024 lds
    v_mfma_f32_16x16x32_bf16 v[144:147], a[156:159], v[68:71], v[144:147]
    v_mov_b32 v236, v224
    v_mov_b32 v237, v225
    v_mfma_f32_16x16x32_bf16 v[144:147], a[152:155], v[64:67], v[144:147]
    s_waitcnt lgkmcnt(4)
    v_mov_b32 v238, v226
    v_mov_b32 v239, v227
    v_mfma_f32_16x16x32_bf16 v[160:163], a[128:131], v[64:67], v[160:163]
    ds_read_b64_tr_b16 a[144:145], v11 offset:0
    v_mfma_f32_16x16x32_bf16 v[160:163], a[132:135], v[68:71], v[160:163]
    ds_read_b64_tr_b16 a[146:147], v11 offset:1024
    v_mfma_f32_16x16x32_bf16 v[164:167], a[132:135], v[76:79], v[164:167]
    ds_read_b64_tr_b16 a[148:149], v11 offset:16384
    v_mfma_f32_16x16x32_bf16 v[164:167], a[128:131], v[72:75], v[164:167]
    ds_read_b64_tr_b16 a[150:151], v11 offset:17408
    v_mfma_f32_16x16x32_bf16 v[168:171], a[128:131], v[80:83], v[168:171]
    v_permlane16_swap_b32 v224, v236
    v_mfma_f32_16x16x32_bf16 v[168:171], a[132:135], v[84:87], v[168:171]
    buffer_load_dwordx4 v30, s[12:15], s52 offen offset:2048 lds
    v_mfma_f32_16x16x32_bf16 v[172:175], a[132:135], v[92:95], v[172:175]
    v_permlane16_swap_b32 v225, v237
    v_mfma_f32_16x16x32_bf16 v[172:175], a[128:131], v[88:91], v[172:175]
    s_waitcnt lgkmcnt(4)
    v_permlane16_swap_b32 v226, v238
    v_mfma_f32_16x16x32_bf16 v[188:191], a[136:139], v[88:91], v[188:191]
    ds_read_b64_tr_b16 a[152:153], v11 offset:8
    v_mfma_f32_16x16x32_bf16 v[188:191], a[140:143], v[92:95], v[188:191]
    ds_read_b64_tr_b16 a[154:155], v11 offset:1032
    v_mfma_f32_16x16x32_bf16 v[184:187], a[140:143], v[84:87], v[184:187]
    ds_read_b64_tr_b16 a[156:157], v11 offset:16392
    v_mfma_f32_16x16x32_bf16 v[184:187], a[136:139], v[80:83], v[184:187]
    ds_read_b64_tr_b16 a[158:159], v11 offset:17416
    v_mfma_f32_16x16x32_bf16 v[180:183], a[136:139], v[72:75], v[180:183]
    v_permlane16_swap_b32 v227, v239
    v_mfma_f32_16x16x32_bf16 v[180:183], a[140:143], v[76:79], v[180:183]
    buffer_load_dwordx4 v31, s[12:15], s52 offen offset:3072 lds
    v_mfma_f32_16x16x32_bf16 v[176:179], a[140:143], v[68:71], v[176:179]
    ds_write_b32 v5, v228 offset:0
    v_add_f32 v224, v224, v236
    v_mfma_f32_16x16x32_bf16 v[176:179], a[136:139], v[64:67], v[176:179]
    s_waitcnt lgkmcnt(5)
    ds_write_b32 v5, v229 offset:64
    v_add_f32 v225, v225, v237
    v_mfma_f32_16x16x32_bf16 v[192:195], a[144:147], v[64:67], v[192:195]
    ds_read_b64_tr_b16 a[128:129], v12 offset:0
    v_add_f32 v226, v226, v238
    v_mfma_f32_16x16x32_bf16 v[192:195], a[148:151], v[68:71], v[192:195]
    ds_read_b64_tr_b16 a[130:131], v12 offset:1024
    v_add_f32 v227, v227, v239
    v_mfma_f32_16x16x32_bf16 v[196:199], a[148:151], v[76:79], v[196:199]
    ds_read_b64_tr_b16 a[132:133], v12 offset:16384
    v_mul_f32 v224, 0xbb000000, v224
    v_mfma_f32_16x16x32_bf16 v[196:199], a[144:147], v[72:75], v[196:199]
    ds_read_b64_tr_b16 a[134:135], v12 offset:17408
    v_mul_f32 v225, 0xbb000000, v225
    v_mfma_f32_16x16x32_bf16 v[200:203], a[144:147], v[80:83], v[200:203]
    s_add_u32 m0, s88, 65536
    s_add_u32 s52, s52, 8192
    ds_write_b32 v5, v230 offset:128
    v_mul_f32 v226, 0xbb000000, v226
    v_mfma_f32_16x16x32_bf16 v[200:203], a[148:151], v[84:87], v[200:203]
    buffer_load_dwordx4 v28, s[8:11], s52 offen offset:0 lds
    v_mfma_f32_16x16x32_bf16 v[204:207], a[148:151], v[92:95], v[204:207]
    ds_write_b32 v5, v231 offset:192
    v_mul_f32 v227, 0xbb000000, v227
    v_mfma_f32_16x16x32_bf16 v[204:207], a[144:147], v[88:91], v[204:207]
    s_waitcnt lgkmcnt(8)
    v_cndmask_b32 v240, v240, v241, s[98:99]
    v_cndmask_b32 v244, v244, v245, s[98:99]
    v_mfma_f32_16x16x32_bf16 v[220:223], a[152:155], v[88:91], v[220:223]
    ds_read_b64_tr_b16 a[136:137], v13 offset:0
    v_cndmask_b32 v248, v248, v249, s[98:99]
    v_mfma_f32_16x16x32_bf16 v[220:223], a[156:159], v[92:95], v[220:223]
    ds_read_b64_tr_b16 a[138:139], v13 offset:1024
    v_cndmask_b32 v252, v252, v253, s[98:99]
    v_mfma_f32_16x16x32_bf16 v[216:219], a[156:159], v[84:87], v[216:219]
    ds_read_b64_tr_b16 a[140:141], v13 offset:16384
    v_cndmask_b32 v240, v240, v242, s[100:101]
    v_mfma_f32_16x16x32_bf16 v[216:219], a[152:155], v[80:83], v[216:219]
    ds_read_b64_tr_b16 a[142:143], v13 offset:17408
    v_cndmask_b32 v244, v244, v246, s[100:101]
    v_mfma_f32_16x16x32_bf16 v[212:215], a[152:155], v[72:75], v[212:215]
    v_cndmask_b32 v248, v248, v250, s[100:101]
    v_cndmask_b32 v252, v252, v254, s[100:101]
    v_mfma_f32_16x16x32_bf16 v[212:215], a[156:159], v[76:79], v[212:215]
    buffer_load_dwordx4 v29, s[8:11], s52 offen offset:1024 lds
    v_mfma_f32_16x16x32_bf16 v[208:211], a[156:159], v[68:71], v[208:211]
    v_cndmask_b32 v240, v240, v243, vcc
    v_cndmask_b32 v244, v244, v247, vcc
    v_mfma_f32_16x16x32_bf16 v[208:211], a[152:155], v[64:67], v[208:211]
    s_waitcnt lgkmcnt(6)
    v_cndmask_b32 v248, v248, v251, vcc
    v_cndmask_b32 v252, v252, v255, vcc
    s_waitcnt lgkmcnt(4)
    s_barrier
    v_mfma_f32_16x16x32_bf16 a[0:3], a[128:131], v[64:67], a[0:3]
    ds_read_b64_tr_b16 a[144:145], v14 offset:0
    v_mov_b32 v241, v240
    v_mfma_f32_16x16x32_bf16 a[0:3], a[132:135], v[68:71], a[0:3]
    ds_read_b64_tr_b16 a[146:147], v14 offset:1024
    v_mov_b32 v245, v244
    v_mfma_f32_16x16x32_bf16 a[4:7], a[132:135], v[76:79], a[4:7]
    ds_read_b64_tr_b16 a[148:149], v14 offset:16384
    v_mov_b32 v249, v248
    v_mfma_f32_16x16x32_bf16 a[4:7], a[128:131], v[72:75], a[4:7]
    ds_read_b64_tr_b16 a[150:151], v14 offset:17408
    v_mov_b32 v253, v252
    v_mfma_f32_16x16x32_bf16 a[8:11], a[128:131], v[80:83], a[8:11]
    v_permlane32_swap_b32 v240, v241
    v_mfma_f32_16x16x32_bf16 a[8:11], a[132:135], v[84:87], a[8:11]
    buffer_load_dwordx4 v30, s[12:15], s52 offen offset:2048 lds
    v_mfma_f32_16x16x32_bf16 a[12:15], a[132:135], v[92:95], a[12:15]
    v_permlane32_swap_b32 v244, v245
    v_mfma_f32_16x16x32_bf16 a[12:15], a[128:131], v[88:91], a[12:15]
    s_waitcnt lgkmcnt(4)
    v_permlane32_swap_b32 v248, v249
    v_mfma_f32_16x16x32_bf16 a[28:31], a[136:139], v[88:91], a[28:31]
    ds_read_b64_tr_b16 a[152:153], v15 offset:0
    v_mfma_f32_16x16x32_bf16 a[28:31], a[140:143], v[92:95], a[28:31]
    ds_read_b64_tr_b16 a[154:155], v15 offset:1024
    v_mfma_f32_16x16x32_bf16 a[24:27], a[140:143], v[84:87], a[24:27]
    ds_read_b64_tr_b16 a[156:157], v15 offset:16384
    v_mfma_f32_16x16x32_bf16 a[24:27], a[136:139], v[80:83], a[24:27]
    ds_read_b64_tr_b16 a[158:159], v15 offset:17408
    v_mfma_f32_16x16x32_bf16 a[20:23], a[136:139], v[72:75], a[20:23]
    v_permlane32_swap_b32 v252, v253
    v_mfma_f32_16x16x32_bf16 a[20:23], a[140:143], v[76:79], a[20:23]
    buffer_load_dwordx4 v31, s[12:15], s52 offen offset:3072 lds
    v_mfma_f32_16x16x32_bf16 a[16:19], a[140:143], v[68:71], a[16:19]
    v_add_f32 v240, v240, v241
    v_add_f32 v244, v244, v245
    v_mfma_f32_16x16x32_bf16 a[16:19], a[136:139], v[64:67], a[16:19]
    s_waitcnt lgkmcnt(4)
    v_add_f32 v248, v248, v249
    v_add_f32 v252, v252, v253
    v_mfma_f32_16x16x32_bf16 a[32:35], a[144:147], v[64:67], a[32:35]
    ds_read_b64_tr_b16 a[128:129], v12 offset:4096
    v_mov_b32 v241, v240
    v_mfma_f32_16x16x32_bf16 a[32:35], a[148:151], v[68:71], a[32:35]
    ds_read_b64_tr_b16 a[130:131], v12 offset:5120
    v_mov_b32 v245, v244
    v_mfma_f32_16x16x32_bf16 a[36:39], a[148:151], v[76:79], a[36:39]
    ds_read_b64_tr_b16 a[132:133], v12 offset:20480
    v_mov_b32 v249, v248
    v_mfma_f32_16x16x32_bf16 a[36:39], a[144:147], v[72:75], a[36:39]
    ds_read_b64_tr_b16 a[134:135], v12 offset:21504
    v_mov_b32 v253, v252
    v_mfma_f32_16x16x32_bf16 a[40:43], a[144:147], v[80:83], a[40:43]
    ds_read_b128 v[32:35], v4 offset:0
    v_mfma_f32_16x16x32_bf16 a[40:43], a[148:151], v[84:87], a[40:43]
    ds_read_b128 v[36:39], v4 offset:64
    v_mfma_f32_16x16x32_bf16 a[44:47], a[148:151], v[92:95], a[44:47]
    ds_read_b128 v[40:43], v4 offset:128
    v_mfma_f32_16x16x32_bf16 a[44:47], a[144:147], v[88:91], a[44:47]
    s_waitcnt lgkmcnt(7)
    ds_read_b128 v[44:47], v4 offset:192
    v_mfma_f32_16x16x32_bf16 a[60:63], a[152:155], v[88:91], a[60:63]
    ds_read_b64_tr_b16 a[136:137], v13 offset:4096
    v_mfma_f32_16x16x32_bf16 a[60:63], a[156:159], v[92:95], a[60:63]
    ds_read_b64_tr_b16 a[138:139], v13 offset:5120
    v_mfma_f32_16x16x32_bf16 a[56:59], a[156:159], v[84:87], a[56:59]
    ds_read_b64_tr_b16 a[140:141], v13 offset:20480
    v_mfma_f32_16x16x32_bf16 a[56:59], a[152:155], v[80:83], a[56:59]
    ds_read_b64_tr_b16 a[142:143], v13 offset:21504
    v_mfma_f32_16x16x32_bf16 a[52:55], a[152:155], v[72:75], a[52:55]
    ds_read_b128 v[48:51], v4 offset:256
    v_mfma_f32_16x16x32_bf16 a[52:55], a[156:159], v[76:79], a[52:55]
    ds_read_b128 v[52:55], v4 offset:320
    v_mfma_f32_16x16x32_bf16 a[48:51], a[156:159], v[68:71], a[48:51]
    ds_read_b128 v[56:59], v4 offset:384
    v_mfma_f32_16x16x32_bf16 a[48:51], a[152:155], v[64:67], a[48:51]
    s_waitcnt lgkmcnt(11)
    ds_read_b128 v[60:63], v4 offset:448
    v_mfma_f32_16x16x32_bf16 a[64:67], a[128:131], v[64:67], a[64:67]
    ds_read_b64_tr_b16 a[144:145], v14 offset:4096
    v_mfma_f32_16x16x32_bf16 a[64:67], a[132:135], v[68:71], a[64:67]
    ds_read_b64_tr_b16 a[146:147], v14 offset:5120
    v_mfma_f32_16x16x32_bf16 a[68:71], a[132:135], v[76:79], a[68:71]
    ds_read_b64_tr_b16 a[148:149], v14 offset:20480
    v_mfma_f32_16x16x32_bf16 a[68:71], a[128:131], v[72:75], a[68:71]
    ds_read_b64_tr_b16 a[150:151], v14 offset:21504
    v_mfma_f32_16x16x32_bf16 a[72:75], a[128:131], v[80:83], a[72:75]
    v_permlane16_swap_b32 v240, v241
    v_mfma_f32_16x16x32_bf16 a[72:75], a[132:135], v[84:87], a[72:75]
    v_permlane16_swap_b32 v244, v245
    v_mfma_f32_16x16x32_bf16 a[76:79], a[132:135], v[92:95], a[76:79]
    v_permlane16_swap_b32 v248, v249
    v_mfma_f32_16x16x32_bf16 a[76:79], a[128:131], v[88:91], a[76:79]
    s_waitcnt lgkmcnt(8)
    v_permlane16_swap_b32 v252, v253
    v_mfma_f32_16x16x32_bf16 a[92:95], a[136:139], v[88:91], a[92:95]
    ds_read_b64_tr_b16 a[152:153], v15 offset:4096
    v_add_f32 v240, v240, v241
    v_mfma_f32_16x16x32_bf16 a[92:95], a[140:143], v[92:95], a[92:95]
    ds_read_b64_tr_b16 a[154:155], v15 offset:5120
    v_add_f32 v244, v244, v245
    v_mfma_f32_16x16x32_bf16 a[88:91], a[140:143], v[84:87], a[88:91]
    ds_read_b64_tr_b16 a[156:157], v15 offset:20480
    v_add_f32 v248, v248, v249
    v_mfma_f32_16x16x32_bf16 a[88:91], a[136:139], v[80:83], a[88:91]
    ds_read_b64_tr_b16 a[158:159], v15 offset:21504
    v_add_f32 v252, v252, v253
    v_mfma_f32_16x16x32_bf16 a[84:87], a[136:139], v[72:75], a[84:87]
    v_mul_f32 v240, 0x3b000000, v240
    v_mul_f32 v244, 0x3b000000, v244
    v_mfma_f32_16x16x32_bf16 a[84:87], a[140:143], v[76:79], a[84:87]
    v_mul_f32 v248, 0x3b000000, v248
    v_mul_f32 v252, 0x3b000000, v252
    v_mfma_f32_16x16x32_bf16 a[80:83], a[140:143], v[68:71], a[80:83]
    v_fma_f32 v240, -v224, v224, v240
    v_fma_f32 v244, -v225, v225, v244
    v_mfma_f32_16x16x32_bf16 a[80:83], a[136:139], v[64:67], a[80:83]
    s_waitcnt lgkmcnt(0)
    v_fma_f32 v248, -v226, v226, v248
    v_fma_f32 v252, -v227, v227, v252
    v_mfma_f32_16x16x32_bf16 a[96:99], a[144:147], v[64:67], a[96:99]
    v_max_f32 v240, 0, v240
    v_max_f32 v244, 0, v244
    v_mfma_f32_16x16x32_bf16 a[96:99], a[148:151], v[68:71], a[96:99]
    v_max_f32 v248, 0, v248
    v_max_f32 v252, 0, v252
    v_mfma_f32_16x16x32_bf16 a[100:103], a[148:151], v[76:79], a[100:103]
    v_add_f32 v240, 0x3727c5ac, v240
    v_add_f32 v244, 0x3727c5ac, v244
    v_mfma_f32_16x16x32_bf16 a[100:103], a[144:147], v[72:75], a[100:103]
    v_add_f32 v248, 0x3727c5ac, v248
    v_add_f32 v252, 0x3727c5ac, v252
    v_mfma_f32_16x16x32_bf16 a[104:107], a[144:147], v[80:83], a[104:107]
    v_rsq_f32 v232, v240
    v_mfma_f32_16x16x32_bf16 a[104:107], a[148:151], v[84:87], a[104:107]
    v_rsq_f32 v233, v244
    v_mfma_f32_16x16x32_bf16 a[108:111], a[148:151], v[92:95], a[108:111]
    v_rsq_f32 v234, v248
    v_mfma_f32_16x16x32_bf16 a[108:111], a[144:147], v[88:91], a[108:111]
    s_waitcnt lgkmcnt(0)
    v_rsq_f32 v235, v252
    v_mfma_f32_16x16x32_bf16 a[124:127], a[152:155], v[88:91], a[124:127]
    v_rcp_f32 v236, v240
    v_mfma_f32_16x16x32_bf16 a[124:127], a[156:159], v[92:95], a[124:127]
    v_rcp_f32 v237, v244
    v_mfma_f32_16x16x32_bf16 a[120:123], a[156:159], v[84:87], a[120:123]
    v_rcp_f32 v238, v248
    v_mfma_f32_16x16x32_bf16 a[120:123], a[152:155], v[80:83], a[120:123]
    v_rcp_f32 v239, v252
    v_mfma_f32_16x16x32_bf16 a[116:119], a[152:155], v[72:75], a[116:119]
    v_mul_f32 v232, 0x3e0293ee, v232
    v_mul_f32 v233, 0x3e0293ee, v233
    v_mfma_f32_16x16x32_bf16 a[116:119], a[156:159], v[76:79], a[116:119]
    v_mul_f32 v234, 0x3e0293ee, v234
    v_mul_f32 v235, 0x3e0293ee, v235
    v_mfma_f32_16x16x32_bf16 a[112:115], a[156:159], v[68:71], a[112:115]
    v_mfma_f32_16x16x32_bf16 a[112:115], a[152:155], v[64:67], a[112:115]
    s_nop 1
    v_pk_fma_f32 v[96:97], v[32:33], v[224:225], v[96:97] op_sel:[0,0,0] op_sel_hi:[1,0,1]
    v_pk_fma_f32 v[98:99], v[34:35], v[224:225], v[98:99] op_sel:[0,0,0] op_sel_hi:[1,0,1]
    v_pk_fma_f32 v[112:113], v[36:37], v[224:225], v[112:113] op_sel:[0,0,0] op_sel_hi:[1,0,1]
    v_pk_fma_f32 v[114:115], v[38:39], v[224:225], v[114:115] op_sel:[0,0,0] op_sel_hi:[1,0,1]
    v_pk_fma_f32 v[128:129], v[40:41], v[224:225], v[128:129] op_sel:[0,0,0] op_sel_hi:[1,0,1]
    v_pk_fma_f32 v[130:131], v[42:43], v[224:225], v[130:131] op_sel:[0,0,0] op_sel_hi:[1,0,1]
    v_pk_fma_f32 v[144:145], v[44:45], v[224:225], v[144:145] op_sel:[0,0,0] op_sel_hi:[1,0,1]
    v_pk_fma_f32 v[146:147], v[46:47], v[224:225], v[146:147] op_sel:[0,0,0] op_sel_hi:[1,0,1]
    v_pk_fma_f32 v[160:161], v[48:49], v[224:225], v[160:161] op_sel:[0,0,0] op_sel_hi:[1,0,1]
    v_pk_fma_f32 v[162:163], v[50:51], v[224:225], v[162:163] op_sel:[0,0,0] op_sel_hi:[1,0,1]
    v_pk_fma_f32 v[176:177], v[52:53], v[224:225], v[176:177] op_sel:[0,0,0] op_sel_hi:[1,0,1]
    v_pk_fma_f32 v[178:179], v[54:55], v[224:225], v[178:179] op_sel:[0,0,0] op_sel_hi:[1,0,1]
    v_pk_fma_f32 v[192:193], v[56:57], v[224:225], v[192:193] op_sel:[0,0,0] op_sel_hi:[1,0,1]
    v_pk_fma_f32 v[194:195], v[58:59], v[224:225], v[194:195] op_sel:[0,0,0] op_sel_hi:[1,0,1]
    v_pk_fma_f32 v[208:209], v[60:61], v[224:225], v[208:209] op_sel:[0,0,0] op_sel_hi:[1,0,1]
    v_pk_fma_f32 v[210:211], v[62:63], v[224:225], v[210:211] op_sel:[0,0,0] op_sel_hi:[1,0,1]
    v_pk_fma_f32 v[100:101], v[32:33], v[224:225], v[100:101] op_sel:[0,1,0] op_sel_hi:[1,1,1]
    v_pk_fma_f32 v[102:103], v[34:35], v[224:225], v[102:103] op_sel:[0,1,0] op_sel_hi:[1,1,1]
    v_pk_fma_f32 v[116:117], v[36:37], v[224:225], v[116:117] op_sel:[0,1,0] op_sel_hi:[1,1,1]
    v_pk_fma_f32 v[118:119], v[38:39], v[224:225], v[118:119] op_sel:[0,1,0] op_sel_hi:[1,1,1]
    v_pk_fma_f32 v[132:133], v[40:41], v[224:225], v[132:133] op_sel:[0,1,0] op_sel_hi:[1,1,1]
    v_pk_fma_f32 v[134:135], v[42:43], v[224:225], v[134:135] op_sel:[0,1,0] op_sel_hi:[1,1,1]
    v_pk_fma_f32 v[148:149], v[44:45], v[224:225], v[148:149] op_sel:[0,1,0] op_sel_hi:[1,1,1]
    v_pk_fma_f32 v[150:151], v[46:47], v[224:225], v[150:151] op_sel:[0,1,0] op_sel_hi:[1,1,1]
    v_pk_fma_f32 v[164:165], v[48:49], v[224:225], v[164:165] op_sel:[0,1,0] op_sel_hi:[1,1,1]
    v_pk_fma_f32 v[166:167], v[50:51], v[224:225], v[166:167] op_sel:[0,1,0] op_sel_hi:[1,1,1]
    v_pk_fma_f32 v[180:181], v[52:53], v[224:225], v[180:181] op_sel:[0,1,0] op_sel_hi:[1,1,1]
    v_pk_fma_f32 v[182:183], v[54:55], v[224:225], v[182:183] op_sel:[0,1,0] op_sel_hi:[1,1,1]
    v_pk_fma_f32 v[196:197], v[56:57], v[224:225], v[196:197] op_sel:[0,1,0] op_sel_hi:[1,1,1]
    v_pk_fma_f32 v[198:199], v[58:59], v[224:225], v[198:199] op_sel:[0,1,0] op_sel_hi:[1,1,1]
    v_pk_fma_f32 v[212:213], v[60:61], v[224:225], v[212:213] op_sel:[0,1,0] op_sel_hi:[1,1,1]
    v_pk_fma_f32 v[214:215], v[62:63], v[224:225], v[214:215] op_sel:[0,1,0] op_sel_hi:[1,1,1]
    v_pk_fma_f32 v[104:105], v[32:33], v[226:227], v[104:105] op_sel:[0,0,0] op_sel_hi:[1,0,1]
    v_pk_fma_f32 v[106:107], v[34:35], v[226:227], v[106:107] op_sel:[0,0,0] op_sel_hi:[1,0,1]
    v_pk_fma_f32 v[120:121], v[36:37], v[226:227], v[120:121] op_sel:[0,0,0] op_sel_hi:[1,0,1]
    v_pk_fma_f32 v[122:123], v[38:39], v[226:227], v[122:123] op_sel:[0,0,0] op_sel_hi:[1,0,1]
    v_pk_fma_f32 v[136:137], v[40:41], v[226:227], v[136:137] op_sel:[0,0,0] op_sel_hi:[1,0,1]
    v_pk_fma_f32 v[138:139], v[42:43], v[226:227], v[138:139] op_sel:[0,0,0] op_sel_hi:[1,0,1]
    v_pk_fma_f32 v[152:153], v[44:45], v[226:227], v[152:153] op_sel:[0,0,0] op_sel_hi:[1,0,1]
    v_pk_fma_f32 v[154:155], v[46:47], v[226:227], v[154:155] op_sel:[0,0,0] op_sel_hi:[1,0,1]
    v_pk_fma_f32 v[168:169], v[48:49], v[226:227], v[168:169] op_sel:[0,0,0] op_sel_hi:[1,0,1]
    v_pk_fma_f32 v[170:171], v[50:51], v[226:227], v[170:171] op_sel:[0,0,0] op_sel_hi:[1,0,1]
    v_pk_fma_f32 v[184:185], v[52:53], v[226:227], v[184:185] op_sel:[0,0,0] op_sel_hi:[1,0,1]
    v_pk_fma_f32 v[186:187], v[54:55], v[226:227], v[186:187] op_sel:[0,0,0] op_sel_hi:[1,0,1]
    v_pk_fma_f32 v[200:201], v[56:57], v[226:227], v[200:201] op_sel:[0,0,0] op_sel_hi:[1,0,1]
    v_pk_fma_f32 v[202:203], v[58:59], v[226:227], v[202:203] op_sel:[0,0,0] op_sel_hi:[1,0,1]
L_pad2:
    s_cbranch_execz L_pad6
    v_pk_fma_f32 v[216:217], v[60:61], v[226:227], v[216:217] op_sel:[0,0,0] op_sel_hi:[1,0,1]
    v_pk_fma_f32 v[218:219], v[62:63], v[226:227], v[218:219] op_sel:[0,0,0] op_sel_hi:[1,0,1]
    v_pk_fma_f32 v[108:109], v[32:33], v[226:227], v[108:109] op_sel:[0,1,0] op_sel_hi:[1,1,1]
    v_pk_fma_f32 v[110:111], v[34:35], v[226:227], v[110:111] op_sel:[0,1,0] op_sel_hi:[1,1,1]
    v_pk_fma_f32 v[124:125], v[36:37], v[226:227], v[124:125] op_sel:[0,1,0] op_sel_hi:[1,1,1]
    v_pk_fma_f32 v[126:127], v[38:39], v[226:227], v[126:127] op_sel:[0,1,0] op_sel_hi:[1,1,1]
    v_pk_fma_f32 v[140:141], v[40:41], v[226:227], v[140:141] op_sel:[0,1,0] op_sel_hi:[1,1,1]
    v_pk_fma_f32 v[142:143], v[42:43], v[226:227], v[142:143] op_sel:[0,1,0] op_sel_hi:[1,1,1]
    v_pk_fma_f32 v[156:157], v[44:45], v[226:227], v[156:157] op_sel:[0,1,0] op_sel_hi:[1,1,1]
    v_pk_fma_f32 v[158:159], v[46:47], v[226:227], v[158:159] op_sel:[0,1,0] op_sel_hi:[1,1,1]
    v_pk_fma_f32 v[172:173], v[48:49], v[226:227], v[172:173] op_sel:[0,1,0] op_sel_hi:[1,1,1]
    v_pk_fma_f32 v[174:175], v[50:51], v[226:227], v[174:175] op_sel:[0,1,0] op_sel_hi:[1,1,1]
    v_pk_fma_f32 v[188:189], v[52:53], v[226:227], v[188:189] op_sel:[0,1,0] op_sel_hi:[1,1,1]
    v_pk_fma_f32 v[190:191], v[54:55], v[226:227], v[190:191] op_sel:[0,1,0] op_sel_hi:[1,1,1]
    v_pk_fma_f32 v[204:205], v[56:57], v[226:227], v[204:205] op_sel:[0,1,0] op_sel_hi:[1,1,1]
    v_pk_fma_f32 v[206:207], v[58:59], v[226:227], v[206:207] op_sel:[0,1,0] op_sel_hi:[1,1,1]
    v_pk_fma_f32 v[220:221], v[60:61], v[226:227], v[220:221] op_sel:[0,1,0] op_sel_hi:[1,1,1]
    v_pk_fma_f32 v[222:223], v[62:63], v[226:227], v[222:223] op_sel:[0,1,0] op_sel_hi:[1,1,1]
    v_pk_mul_f32 v[96:97], v[96:97], v[232:233] op_sel:[0,0] op_sel_hi:[1,0]
    v_pk_mul_f32 v[98:99], v[98:99], v[232:233] op_sel:[0,0] op_sel_hi:[1,0]
    v_cvt_pk_bf16_f32 v32, v96, v97
    v_cvt_pk_bf16_f32 v33, v98, v99
    v_pk_mul_f32 v[112:113], v[112:113], v[232:233] op_sel:[0,0] op_sel_hi:[1,0]
    v_pk_mul_f32 v[114:115], v[114:115], v[232:233] op_sel:[0,0] op_sel_hi:[1,0]
    v_cvt_pk_bf16_f32 v34, v112, v113
    v_cvt_pk_bf16_f32 v35, v114, v115
    v_pk_mul_f32 v[128:129], v[128:129], v[232:233] op_sel:[0,0] op_sel_hi:[1,0]
    v_pk_mul_f32 v[130:131], v[130:131], v[232:233] op_sel:[0,0] op_sel_hi:[1,0]
    v_cvt_pk_bf16_f32 v36, v128, v129
    v_cvt_pk_bf16_f32 v37, v130, v131
    v_pk_mul_f32 v[144:145], v[144:145], v[232:233] op_sel:[0,0] op_sel_hi:[1,0]
    v_pk_mul_f32 v[146:147], v[146:147], v[232:233] op_sel:[0,0] op_sel_hi:[1,0]
    v_cvt_pk_bf16_f32 v38, v144, v145
    v_cvt_pk_bf16_f32 v39, v146, v147
    v_pk_mul_f32 v[160:161], v[160:161], v[232:233] op_sel:[0,0] op_sel_hi:[1,0]
    v_pk_mul_f32 v[162:163], v[162:163], v[232:233] op_sel:[0,0] op_sel_hi:[1,0]
    v_cvt_pk_bf16_f32 v40, v160, v161
    v_cvt_pk_bf16_f32 v41, v162, v163
    v_pk_mul_f32 v[176:177], v[176:177], v[232:233] op_sel:[0,0] op_sel_hi:[1,0]
    v_pk_mul_f32 v[178:179], v[178:179], v[232:233] op_sel:[0,0] op_sel_hi:[1,0]
    v_cvt_pk_bf16_f32 v42, v176, v177
    v_cvt_pk_bf16_f32 v43, v178, v179
    v_pk_mul_f32 v[192:193], v[192:193], v[232:233] op_sel:[0,0] op_sel_hi:[1,0]
    v_pk_mul_f32 v[194:195], v[194:195], v[232:233] op_sel:[0,0] op_sel_hi:[1,0]
    v_cvt_pk_bf16_f32 v44, v192, v193
    v_cvt_pk_bf16_f32 v45, v194, v195
    v_pk_mul_f32 v[208:209], v[208:209], v[232:233] op_sel:[0,0] op_sel_hi:[1,0]
    v_pk_mul_f32 v[210:211], v[210:211], v[232:233] op_sel:[0,0] op_sel_hi:[1,0]
    v_cvt_pk_bf16_f32 v46, v208, v209
    v_cvt_pk_bf16_f32 v47, v210, v211
    v_pk_mul_f32 v[100:101], v[100:101], v[232:233] op_sel:[0,1] op_sel_hi:[1,1]
    v_pk_mul_f32 v[102:103], v[102:103], v[232:233] op_sel:[0,1] op_sel_hi:[1,1]
    v_cvt_pk_bf16_f32 v48, v100, v101
    v_cvt_pk_bf16_f32 v49, v102, v103
    v_pk_mul_f32 v[116:117], v[116:117], v[232:233] op_sel:[0,1] op_sel_hi:[1,1]
    v_pk_mul_f32 v[118:119], v[118:119], v[232:233] op_sel:[0,1] op_sel_hi:[1,1]
    v_cvt_pk_bf16_f32 v50, v116, v117
    v_cvt_pk_bf16_f32 v51, v118, v119
    v_pk_mul_f32 v[132:133], v[132:133], v[232:233] op_sel:[0,1] op_sel_hi:[1,1]
    v_pk_mul_f32 v[134:135], v[134:135], v[232:233] op_sel:[0,1] op_sel_hi:[1,1]
    v_cvt_pk_bf16_f32 v52, v132, v133
    v_cvt_pk_bf16_f32 v53, v134, v135
    v_pk_mul_f32 v[148:149], v[148:149], v[232:233] op_sel:[0,1] op_sel_hi:[1,1]
    v_pk_mul_f32 v[150:151], v[150:151], v[232:233] op_sel:[0,1] op_sel_hi:[1,1]
    v_cvt_pk_bf16_f32 v54, v148, v149
    v_cvt_pk_bf16_f32 v55, v150, v151
    v_pk_mul_f32 v[164:165], v[164:165], v[232:233] op_sel:[0,1] op_sel_hi:[1,1]
    v_pk_mul_f32 v[166:167], v[166:167], v[232:233] op_sel:[0,1] op_sel_hi:[1,1]
    v_cvt_pk_bf16_f32 v56, v164, v165
    v_cvt_pk_bf16_f32 v57, v166, v167
    v_pk_mul_f32 v[180:181], v[180:181], v[232:233] op_sel:[0,1] op_sel_hi:[1,1]
    v_pk_mul_f32 v[182:183], v[182:183], v[232:233] op_sel:[0,1] op_sel_hi:[1,1]
    v_cvt_pk_bf16_f32 v58, v180, v181
    v_cvt_pk_bf16_f32 v59, v182, v183
    v_pk_mul_f32 v[196:197], v[196:197], v[232:233] op_sel:[0,1] op_sel_hi:[1,1]
    v_pk_mul_f32 v[198:199], v[198:199], v[232:233] op_sel:[0,1] op_sel_hi:[1,1]
    v_cvt_pk_bf16_f32 v60, v196, v197
    v_cvt_pk_bf16_f32 v61, v198, v199
    v_pk_mul_f32 v[212:213], v[212:213], v[232:233] op_sel:[0,1] op_sel_hi:[1,1]
    v_pk_mul_f32 v[214:215], v[214:215], v[232:233] op_sel:[0,1] op_sel_hi:[1,1]
    v_cvt_pk_bf16_f32 v62, v212, v213
    v_cvt_pk_bf16_f32 v63, v214, v215
    v_pk_mul_f32 v[104:105], v[104:105], v[234:235] op_sel:[0,0] op_sel_hi:[1,0]
    v_pk_mul_f32 v[106:107], v[106:107], v[234:235] op_sel:[0,0] op_sel_hi:[1,0]
    v_cvt_pk_bf16_f32 v64, v104, v105
    v_cvt_pk_bf16_f32 v65, v106, v107
    v_pk_mul_f32 v[120:121], v[120:121], v[234:235] op_sel:[0,0] op_sel_hi:[1,0]
    v_pk_mul_f32 v[122:123], v[122:123], v[234:235] op_sel:[0,0] op_sel_hi:[1,0]
    v_cvt_pk_bf16_f32 v66, v120, v121
    v_cvt_pk_bf16_f32 v67, v122, v123
    v_pk_mul_f32 v[136:137], v[136:137], v[234:235] op_sel:[0,0] op_sel_hi:[1,0]
    v_pk_mul_f32 v[138:139], v[138:139], v[234:235] op_sel:[0,0] op_sel_hi:[1,0]
    v_cvt_pk_bf16_f32 v68, v136, v137
    v_cvt_pk_bf16_f32 v69, v138, v139
    v_pk_mul_f32 v[152:153], v[152:153], v[234:235] op_sel:[0,0] op_sel_hi:[1,0]
    v_pk_mul_f32 v[154:155], v[154:155], v[234:235] op_sel:[0,0] op_sel_hi:[1,0]
    v_cvt_pk_bf16_f32 v70, v152, v153
    v_cvt_pk_bf16_f32 v71, v154, v155
    v_pk_mul_f32 v[168:169], v[168:169], v[234:235] op_sel:[0,0] op_sel_hi:[1,0]
    v_pk_mul_f32 v[170:171], v[170:171], v[234:235] op_sel:[0,0] op_sel_hi:[1,0]
    v_cvt_pk_bf16_f32 v72, v168, v169
    v_cvt_pk_bf16_f32 v73, v170, v171
    v_pk_mul_f32 v[184:185], v[184:185], v[234:235] op_sel:[0,0] op_sel_hi:[1,0]
    v_pk_mul_f32 v[186:187], v[186:187], v[234:235] op_sel:[0,0] op_sel_hi:[1,0]
    v_cvt_pk_bf16_f32 v74, v184, v185
    v_cvt_pk_bf16_f32 v75, v186, v187
    v_pk_mul_f32 v[200:201], v[200:201], v[234:235] op_sel:[0,0] op_sel_hi:[1,0]
    v_pk_mul_f32 v[202:203], v[202:203], v[234:235] op_sel:[0,0] op_sel_hi:[1,0]
    v_cvt_pk_bf16_f32 v76, v200, v201
    v_cvt_pk_bf16_f32 v77, v202, v203
    v_pk_mul_f32 v[216:217], v[216:217], v[234:235] op_sel:[0,0] op_sel_hi:[1,0]
    v_pk_mul_f32 v[218:219], v[218:219], v[234:235] op_sel:[0,0] op_sel_hi:[1,0]
    v_cvt_pk_bf16_f32 v78, v216, v217
    v_cvt_pk_bf16_f32 v79, v218, v219
    v_pk_mul_f32 v[108:109], v[108:109], v[234:235] op_sel:[0,1] op_sel_hi:[1,1]
    v_pk_mul_f32 v[110:111], v[110:111], v[234:235] op_sel:[0,1] op_sel_hi:[1,1]
    v_cvt_pk_bf16_f32 v80, v108, v109
    v_cvt_pk_bf16_f32 v81, v110, v111
    v_pk_mul_f32 v[124:125], v[124:125], v[234:235] op_sel:[0,1] op_sel_hi:[1,1]
    v_pk_mul_f32 v[126:127], v[126:127], v[234:235] op_sel:[0,1] op_sel_hi:[1,1]
    v_cvt_pk_bf16_f32 v82, v124, v125
    v_cvt_pk_bf16_f32 v83, v126, v127
    v_pk_mul_f32 v[140:141], v[140:141], v[234:235] op_sel:[0,1] op_sel_hi:[1,1]
    v_pk_mul_f32 v[142:143], v[142:143], v[234:235] op_sel:[0,1] op_sel_hi:[1,1]
    v_cvt_pk_bf16_f32 v84, v140, v141
    v_cvt_pk_bf16_f32 v85, v142, v143
    v_pk_mul_f32 v[156:157], v[156:157], v[234:235] op_sel:[0,1] op_sel_hi:[1,1]
    v_pk_mul_f32 v[158:159], v[158:159], v[234:235] op_sel:[0,1] op_sel_hi:[1,1]
    v_cvt_pk_bf16_f32 v86, v156, v157
    v_cvt_pk_bf16_f32 v87, v158, v159
    v_pk_mul_f32 v[172:173], v[172:173], v[234:235] op_sel:[0,1] op_sel_hi:[1,1]
    v_pk_mul_f32 v[174:175], v[174:175], v[234:235] op_sel:[0,1] op_sel_hi:[1,1]
    v_cvt_pk_bf16_f32 v88, v172, v173
    v_cvt_pk_bf16_f32 v89, v174, v175
    v_pk_mul_f32 v[188:189], v[188:189], v[234:235] op_sel:[0,1] op_sel_hi:[1,1]
    v_pk_mul_f32 v[190:191], v[190:191], v[234:235] op_sel:[0,1] op_sel_hi:[1,1]
    v_cvt_pk_bf16_f32 v90, v188, v189
    v_cvt_pk_bf16_f32 v91, v190, v191
    v_pk_mul_f32 v[204:205], v[204:205], v[234:235] op_sel:[0,1] op_sel_hi:[1,1]
    v_pk_mul_f32 v[206:207], v[206:207], v[234:235] op_sel:[0,1] op_sel_hi:[1,1]
    v_cvt_pk_bf16_f32 v92, v204, v205
    v_cvt_pk_bf16_f32 v93, v206, v207
    v_pk_mul_f32 v[220:221], v[220:221], v[234:235] op_sel:[0,1] op_sel_hi:[1,1]
    v_pk_mul_f32 v[222:223], v[222:223], v[234:235] op_sel:[0,1] op_sel_hi:[1,1]
    v_cvt_pk_bf16_f32 v94, v220, v221
    v_cvt_pk_bf16_f32 v95, v222, v223
    ds_read_b128 v[160:163], v4 offset:512
    ds_read_b128 v[164:167], v4 offset:576
    ds_read_b128 v[168:171], v4 offset:640
    ds_read_b128 v[172:175], v4 offset:704
    ds_read_b128 v[176:179], v4 offset:768
    ds_read_b128 v[180:183], v4 offset:832
    ds_read_b128 v[184:187], v4 offset:896
    ds_read_b128 v[188:191], v4 offset:960
    v_lshrrev_b32 v4, 3, v2
    v_lshlrev_b32 v4, 12, v4
    v_and_b32 v5, 7, v2
    v_lshl_add_u32 v4, v5, 8, v4
    v_xor_b32 v5, v2, v3
    v_lshl_add_u32 v4, v5, 4, v4
    v_xor_b32 v8, 0, v4
    v_add_u32 v12, 65536, v8
    v_add_u32 v220, 131072, v8
    v_xor_b32 v9, 64, v4
    v_add_u32 v13, 65536, v9
    v_add_u32 v221, 131072, v9
    v_xor_b32 v10, 128, v4
    v_add_u32 v14, 65536, v10
    v_add_u32 v222, 131072, v10
    v_xor_b32 v11, 192, v4
    v_add_u32 v15, 65536, v11
    v_add_u32 v223, 131072, v11
    v_bfe_u32 v4, v1, 2, 3
    v_lshlrev_b32 v5, 8, v4
    v_lshl_add_u32 v5, v4, 5, v5
    v_lshrrev_b32 v6, 5, v1
    v_lshl_add_u32 v5, v6, 12, v5
    v_and_b32 v6, 3, v1
    v_lshl_add_u32 v5, v6, 3, v5
    v_xor_b32 v16, 0, v5
    v_add_u32 v244, 65536, v16
    v_xor_b32 v17, 32, v5
    v_add_u32 v245, 65536, v17
    v_xor_b32 v18, 64, v5
    v_add_u32 v246, 65536, v18
    v_xor_b32 v19, 96, v5
    v_add_u32 v247, 65536, v19
    v_xor_b32 v20, 128, v5
    v_add_u32 v248, 65536, v20
    v_xor_b32 v21, 160, v5
    v_add_u32 v249, 65536, v21
    v_xor_b32 v22, 192, v5
    v_add_u32 v250, 65536, v22
    v_xor_b32 v23, 224, v5
    v_add_u32 v251, 65536, v23
    v_mov_b32 v234, 0x4e800000
    v_mov_b32 v235, v27
    v_lshrrev_b32 v4, 3, v2
    v_lshrrev_b32 v5, 5, v1
    v_and_b32 v6, 3, v1
    v_lshl_add_u32 v4, v6, 1, v4
    v_cmp_eq_u32 vcc, v4, v5
    v_mov_b32 v4, 0x3f803f80
    s_nop 0
    v_cndmask_b32 v5, 0, v4, vcc
    v_mov_b32 v24, v5
    v_mov_b32 v25, v5
    v_mov_b32 v26, v5
    v_mov_b32 v27, v5
    v_lshlrev_b32 v7, 4, v1
    s_waitcnt vmcnt(0) lgkmcnt(0)
    s_barrier
    ds_read_b128 a[128:131], v220 offset:0
    ds_read_b128 a[132:135], v221 offset:0
    ds_read_b128 a[136:139], v222 offset:0
    ds_read_b128 a[140:143], v223 offset:0
    ds_read_b128 a[144:147], v220 offset:8192
    ds_read_b128 a[148:151], v221 offset:8192
    ds_read_b128 a[152:155], v222 offset:8192
    ds_read_b128 a[156:159], v223 offset:8192
    s_lshl_b32 s3, s5, 4
    s_lshl_b32 s7, s6, 2
    s_add_u32 s3, s3, s7
    s_mul_i32 s3, s3, 58368
    s_lshr_b32 s63, s4, 3
    s_sub_u32 s7, s4, s63
    s_lshl_b32 s7, s7, 11
    s_add_u32 s3, s3, s7
    s_add_u32 s91, s3, 17825792
    s_mov_b32 s28, s16
    s_mov_b32 s29, s17
    s_and_b32 s7, s4, 7
    s_cmp_lg_u32 s7, 7
    s_cselect_b32 s30, 0x10000000, 0
    s_mov_b32 s32, s48
    s_mov_b32 s33, s49
    s_mov_b32 s34, 4
    s_cmp_eq_u32 s6, 0
    s_cselect_b32 s60, 4, 64
    s_lshl_b32 s54, s89, 2
    s_add_u32 s54, s54, s90
    s_lshl_b32 s54, s54, 2
    s_add_u32 s54, s54, s6
    s_lshl_b32 s3, s54, 2
    s_bfe_u32 s7, s2, 0x20001
    s_add_u32 s3, s3, s7
    s_mul_i32 s3, s3, 12288
    s_add_u32 s92, s3, 35651584
    s_add_u32 s93, s92, 4096
    s_add_u32 s62, s92, 8192
    s_waitcnt lgkmcnt(0)
    s_add_u32 m0, s88, 81920
    s_add_u32 s52, s52, 8192
    buffer_load_dwordx4 v28, s[8:11], s52 offen offset:0 lds
    v_mfma_f32_16x16x32_bf16 v[96:99], a[128:131], v[32:35], 0
    v_accvgpr_read_b32 v128, a0
    v_accvgpr_read_b32 v144, a64
    v_accvgpr_read_b32 v129, a1
    v_accvgpr_read_b32 v145, a65
    v_mfma_f32_16x16x32_bf16 v[96:99], a[132:135], v[36:39], v[96:99]
    v_accvgpr_read_b32 v130, a2
    v_accvgpr_read_b32 v146, a66
    v_accvgpr_read_b32 v131, a3
    v_accvgpr_read_b32 v147, a67
    v_mfma_f32_16x16x32_bf16 v[96:99], a[136:139], v[40:43], v[96:99]
    v_accvgpr_read_b32 v132, a16
    v_accvgpr_read_b32 v148, a80
    v_accvgpr_read_b32 v133, a17
    v_accvgpr_read_b32 v149, a81
    v_mfma_f32_16x16x32_bf16 v[96:99], a[140:143], v[44:47], v[96:99]
    v_accvgpr_read_b32 v134, a18
    v_accvgpr_read_b32 v150, a82
    v_accvgpr_read_b32 v135, a19
    v_accvgpr_read_b32 v151, a83
    v_mfma_f32_16x16x32_bf16 v[100:103], a[144:147], v[32:35], 0
    v_accvgpr_read_b32 v136, a32
    v_accvgpr_read_b32 v152, a96
    v_accvgpr_read_b32 v137, a33
    v_accvgpr_read_b32 v153, a97
    v_mfma_f32_16x16x32_bf16 v[100:103], a[148:151], v[36:39], v[100:103]
    v_accvgpr_read_b32 v138, a34
    v_accvgpr_read_b32 v154, a98
    v_accvgpr_read_b32 v139, a35
    v_accvgpr_read_b32 v155, a99
    v_mfma_f32_16x16x32_bf16 v[100:103], a[152:155], v[40:43], v[100:103]
    v_accvgpr_read_b32 v140, a48
    v_accvgpr_read_b32 v156, a112
    v_accvgpr_read_b32 v141, a49
    v_accvgpr_read_b32 v157, a113
    v_mfma_f32_16x16x32_bf16 v[100:103], a[156:159], v[44:47], v[100:103]
    v_accvgpr_read_b32 v142, a50
    v_accvgpr_read_b32 v158, a114
    v_accvgpr_read_b32 v143, a51
    v_accvgpr_read_b32 v159, a115
    v_pk_fma_f32 v[128:129], v[160:161], v[224:225], v[128:129] op_sel:[0,0,0] op_sel_hi:[1,0,1]
    v_pk_fma_f32 v[130:131], v[162:163], v[224:225], v[130:131] op_sel:[0,0,0] op_sel_hi:[1,0,1]
    v_pk_fma_f32 v[132:133], v[164:165], v[224:225], v[132:133] op_sel:[0,0,0] op_sel_hi:[1,0,1]
    v_pk_fma_f32 v[134:135], v[166:167], v[224:225], v[134:135] op_sel:[0,0,0] op_sel_hi:[1,0,1]
    v_pk_fma_f32 v[136:137], v[168:169], v[224:225], v[136:137] op_sel:[0,0,0] op_sel_hi:[1,0,1]
    v_pk_fma_f32 v[138:139], v[170:171], v[224:225], v[138:139] op_sel:[0,0,0] op_sel_hi:[1,0,1]
    v_pk_fma_f32 v[140:141], v[172:173], v[224:225], v[140:141] op_sel:[0,0,0] op_sel_hi:[1,0,1]
    v_pk_fma_f32 v[142:143], v[174:175], v[224:225], v[142:143] op_sel:[0,0,0] op_sel_hi:[1,0,1]
    v_pk_fma_f32 v[144:145], v[176:177], v[224:225], v[144:145] op_sel:[0,0,0] op_sel_hi:[1,0,1]
    v_pk_fma_f32 v[146:147], v[178:179], v[224:225], v[146:147] op_sel:[0,0,0] op_sel_hi:[1,0,1]
    v_pk_fma_f32 v[148:149], v[180:181], v[224:225], v[148:149] op_sel:[0,0,0] op_sel_hi:[1,0,1]
    v_pk_fma_f32 v[150:151], v[182:183], v[224:225], v[150:151] op_sel:[0,0,0] op_sel_hi:[1,0,1]
    v_pk_fma_f32 v[152:153], v[184:185], v[224:225], v[152:153] op_sel:[0,0,0] op_sel_hi:[1,0,1]
    v_pk_fma_f32 v[154:155], v[186:187], v[224:225], v[154:155] op_sel:[0,0,0] op_sel_hi:[1,0,1]
    v_pk_fma_f32 v[156:157], v[188:189], v[224:225], v[156:157] op_sel:[0,0,0] op_sel_hi:[1,0,1]
    v_pk_fma_f32 v[158:159], v[190:191], v[224:225], v[158:159] op_sel:[0,0,0] op_sel_hi:[1,0,1]
    v_pk_mul_f32 v[128:129], v[128:129], v[236:237] op_sel:[0,0] op_sel_hi:[1,0]
    v_pk_mul_f32 v[130:131], v[130:131], v[236:237] op_sel:[0,0] op_sel_hi:[1,0]
    v_pk_mul_f32 v[132:133], v[132:133], v[236:237] op_sel:[0,0] op_sel_hi:[1,0]
    v_pk_mul_f32 v[134:135], v[134:135], v[236:237] op_sel:[0,0] op_sel_hi:[1,0]
    v_pk_mul_f32 v[136:137], v[136:137], v[236:237] op_sel:[0,0] op_sel_hi:[1,0]
    v_pk_mul_f32 v[138:139], v[138:139], v[236:237] op_sel:[0,0] op_sel_hi:[1,0]
    v_pk_mul_f32 v[140:141], v[140:141], v[236:237] op_sel:[0,0] op_sel_hi:[1,0]
    v_pk_mul_f32 v[142:143], v[142:143], v[236:237] op_sel:[0,0] op_sel_hi:[1,0]
    v_pk_mul_f32 v[128:129], v[128:129], v[144:145]
    v_pk_mul_f32 v[130:131], v[130:131], v[146:147]
    v_pk_mul_f32 v[132:133], v[132:133], v[148:149]
    v_pk_mul_f32 v[134:135], v[134:135], v[150:151]
    v_pk_mul_f32 v[136:137], v[136:137], v[152:153]
    v_pk_mul_f32 v[138:139], v[138:139], v[154:155]
    v_pk_mul_f32 v[140:141], v[140:141], v[156:157]
    v_pk_mul_f32 v[142:143], v[142:143], v[158:159]
    v_cvt_pk_bf16_f32 v144, v128, v129
    v_cvt_pk_bf16_f32 v145, v130, v131
    v_cvt_pk_bf16_f32 v146, v132, v133
    v_cvt_pk_bf16_f32 v147, v134, v135
    v_cvt_pk_bf16_f32 v148, v136, v137
    v_cvt_pk_bf16_f32 v149, v138, v139
    v_cvt_pk_bf16_f32 v150, v140, v141
    v_cvt_pk_bf16_f32 v151, v142, v143
    v_accvgpr_write_b32 a224, v144
    v_accvgpr_write_b32 a225, v145
    v_accvgpr_write_b32 a226, v146
    v_accvgpr_write_b32 a227, v147
    v_accvgpr_write_b32 a228, v148
    v_accvgpr_write_b32 a229, v149
    v_accvgpr_write_b32 a230, v150
    v_accvgpr_write_b32 a231, v151
    buffer_load_dwordx4 v29, s[8:11], s52 offen offset:1024 lds
    v_mfma_f32_16x16x32_bf16 v[104:107], a[128:131], v[48:51], 0
    v_accvgpr_read_b32 v128, a4
    v_accvgpr_read_b32 v144, a68
    v_accvgpr_read_b32 v129, a5
    v_accvgpr_read_b32 v145, a69
    v_mfma_f32_16x16x32_bf16 v[104:107], a[132:135], v[52:55], v[104:107]
    v_accvgpr_read_b32 v130, a6
    v_accvgpr_read_b32 v146, a70
    v_accvgpr_read_b32 v131, a7
    v_accvgpr_read_b32 v147, a71
    v_mfma_f32_16x16x32_bf16 v[104:107], a[136:139], v[56:59], v[104:107]
    v_accvgpr_read_b32 v132, a20
    v_accvgpr_read_b32 v148, a84
    v_accvgpr_read_b32 v133, a21
    v_accvgpr_read_b32 v149, a85
    v_mfma_f32_16x16x32_bf16 v[104:107], a[140:143], v[60:63], v[104:107]
    v_accvgpr_read_b32 v134, a22
    v_accvgpr_read_b32 v150, a86
    v_accvgpr_read_b32 v135, a23
    v_accvgpr_read_b32 v151, a87
    v_mfma_f32_16x16x32_bf16 v[108:111], a[144:147], v[48:51], 0
    v_accvgpr_read_b32 v136, a36
    v_accvgpr_read_b32 v152, a100
    v_accvgpr_read_b32 v137, a37
    v_accvgpr_read_b32 v153, a101
    v_mfma_f32_16x16x32_bf16 v[108:111], a[148:151], v[52:55], v[108:111]
    v_accvgpr_read_b32 v138, a38
    v_accvgpr_read_b32 v154, a102
    v_accvgpr_read_b32 v139, a39
    v_accvgpr_read_b32 v155, a103
    v_mfma_f32_16x16x32_bf16 v[108:111], a[152:155], v[56:59], v[108:111]
    v_accvgpr_read_b32 v140, a52
    v_accvgpr_read_b32 v156, a116
    v_accvgpr_read_b32 v141, a53
    v_accvgpr_read_b32 v157, a117
    v_mfma_f32_16x16x32_bf16 v[108:111], a[156:159], v[60:63], v[108:111]
    v_accvgpr_read_b32 v142, a54
    v_accvgpr_read_b32 v158, a118
    v_accvgpr_read_b32 v143, a55
    v_accvgpr_read_b32 v159, a119
    v_pk_fma_f32 v[128:129], v[160:161], v[224:225], v[128:129] op_sel:[0,1,0] op_sel_hi:[1,1,1]
    v_pk_fma_f32 v[130:131], v[162:163], v[224:225], v[130:131] op_sel:[0,1,0] op_sel_hi:[1,1,1]
    v_pk_fma_f32 v[132:133], v[164:165], v[224:225], v[132:133] op_sel:[0,1,0] op_sel_hi:[1,1,1]
    v_pk_fma_f32 v[134:135], v[166:167], v[224:225], v[134:135] op_sel:[0,1,0] op_sel_hi:[1,1,1]
    v_pk_fma_f32 v[136:137], v[168:169], v[224:225], v[136:137] op_sel:[0,1,0] op_sel_hi:[1,1,1]
    v_pk_fma_f32 v[138:139], v[170:171], v[224:225], v[138:139] op_sel:[0,1,0] op_sel_hi:[1,1,1]
    v_pk_fma_f32 v[140:141], v[172:173], v[224:225], v[140:141] op_sel:[0,1,0] op_sel_hi:[1,1,1]
    v_pk_fma_f32 v[142:143], v[174:175], v[224:225], v[142:143] op_sel:[0,1,0] op_sel_hi:[1,1,1]
    v_pk_fma_f32 v[144:145], v[176:177], v[224:225], v[144:145] op_sel:[0,1,0] op_sel_hi:[1,1,1]
    v_pk_fma_f32 v[146:147], v[178:179], v[224:225], v[146:147] op_sel:[0,1,0] op_sel_hi:[1,1,1]
    v_pk_fma_f32 v[148:149], v[180:181], v[224:225], v[148:149] op_sel:[0,1,0] op_sel_hi:[1,1,1]
    v_pk_fma_f32 v[150:151], v[182:183], v[224:225], v[150:151] op_sel:[0,1,0] op_sel_hi:[1,1,1]
    v_pk_fma_f32 v[152:153], v[184:185], v[224:225], v[152:153] op_sel:[0,1,0] op_sel_hi:[1,1,1]
    v_pk_fma_f32 v[154:155], v[186:187], v[224:225], v[154:155] op_sel:[0,1,0] op_sel_hi:[1,1,1]
    v_pk_fma_f32 v[156:157], v[188:189], v[224:225], v[156:157] op_sel:[0,1,0] op_sel_hi:[1,1,1]
    v_pk_fma_f32 v[158:159], v[190:191], v[224:225], v[158:159] op_sel:[0,1,0] op_sel_hi:[1,1,1]
    v_pk_mul_f32 v[128:129], v[128:129], v[236:237] op_sel:[0,1] op_sel_hi:[1,1]
    v_pk_mul_f32 v[130:131], v[130:131], v[236:237] op_sel:[0,1] op_sel_hi:[1,1]
    v_pk_mul_f32 v[132:133], v[132:133], v[236:237] op_sel:[0,1] op_sel_hi:[1,1]
    v_pk_mul_f32 v[134:135], v[134:135], v[236:237] op_sel:[0,1] op_sel_hi:[1,1]
    v_pk_mul_f32 v[136:137], v[136:137], v[236:237] op_sel:[0,1] op_sel_hi:[1,1]
    v_pk_mul_f32 v[138:139], v[138:139], v[236:237] op_sel:[0,1] op_sel_hi:[1,1]
    v_pk_mul_f32 v[140:141], v[140:141], v[236:237] op_sel:[0,1] op_sel_hi:[1,1]
    v_pk_mul_f32 v[142:143], v[142:143], v[236:237] op_sel:[0,1] op_sel_hi:[1,1]
    v_pk_mul_f32 v[128:129], v[128:129], v[144:145]
    v_pk_mul_f32 v[130:131], v[130:131], v[146:147]
    v_pk_mul_f32 v[132:133], v[132:133], v[148:149]
    v_pk_mul_f32 v[134:135], v[134:135], v[150:151]
    v_pk_mul_f32 v[136:137], v[136:137], v[152:153]
    v_pk_mul_f32 v[138:139], v[138:139], v[154:155]
    v_pk_mul_f32 v[140:141], v[140:141], v[156:157]
    v_pk_mul_f32 v[142:143], v[142:143], v[158:159]
    v_cvt_pk_bf16_f32 v144, v128, v129
    v_cvt_pk_bf16_f32 v145, v130, v131
    v_cvt_pk_bf16_f32 v146, v132, v133
    v_cvt_pk_bf16_f32 v147, v134, v135
    v_cvt_pk_bf16_f32 v148, v136, v137
    v_cvt_pk_bf16_f32 v149, v138, v139
    v_cvt_pk_bf16_f32 v150, v140, v141
    v_cvt_pk_bf16_f32 v151, v142, v143
    v_accvgpr_write_b32 a232, v144
    v_accvgpr_write_b32 a233, v145
    v_accvgpr_write_b32 a234, v146
    v_accvgpr_write_b32 a235, v147
    v_accvgpr_write_b32 a236, v148
    v_accvgpr_write_b32 a237, v149
    v_accvgpr_write_b32 a238, v150
    v_accvgpr_write_b32 a239, v151
    buffer_load_dwordx4 v30, s[12:15], s52 offen offset:2048 lds
    v_mfma_f32_16x16x32_bf16 v[112:115], a[128:131], v[64:67], 0
    v_accvgpr_read_b32 v128, a8
    v_accvgpr_read_b32 v144, a72
    v_accvgpr_read_b32 v129, a9
    v_accvgpr_read_b32 v145, a73
    v_mfma_f32_16x16x32_bf16 v[112:115], a[132:135], v[68:71], v[112:115]
    v_accvgpr_read_b32 v130, a10
    v_accvgpr_read_b32 v146, a74
    v_accvgpr_read_b32 v131, a11
    v_accvgpr_read_b32 v147, a75
    v_mfma_f32_16x16x32_bf16 v[112:115], a[136:139], v[72:75], v[112:115]
    v_accvgpr_read_b32 v132, a24
    v_accvgpr_read_b32 v148, a88
    v_accvgpr_read_b32 v133, a25
    v_accvgpr_read_b32 v149, a89
    v_mfma_f32_16x16x32_bf16 v[112:115], a[140:143], v[76:79], v[112:115]
    v_accvgpr_read_b32 v134, a26
    v_accvgpr_read_b32 v150, a90
    v_accvgpr_read_b32 v135, a27
    v_accvgpr_read_b32 v151, a91
    v_mfma_f32_16x16x32_bf16 v[116:119], a[144:147], v[64:67], 0
    v_accvgpr_read_b32 v136, a40
    v_accvgpr_read_b32 v152, a104
    v_accvgpr_read_b32 v137, a41
    v_accvgpr_read_b32 v153, a105
    v_mfma_f32_16x16x32_bf16 v[116:119], a[148:151], v[68:71], v[116:119]
    v_accvgpr_read_b32 v138, a42
    v_accvgpr_read_b32 v154, a106
    v_accvgpr_read_b32 v139, a43
    v_accvgpr_read_b32 v155, a107
    v_mfma_f32_16x16x32_bf16 v[116:119], a[152:155], v[72:75], v[116:119]
    v_accvgpr_read_b32 v140, a56
    v_accvgpr_read_b32 v156, a120
    v_accvgpr_read_b32 v141, a57
    v_accvgpr_read_b32 v157, a121
    v_mfma_f32_16x16x32_bf16 v[116:119], a[156:159], v[76:79], v[116:119]
    v_accvgpr_read_b32 v142, a58
    v_accvgpr_read_b32 v158, a122
    v_accvgpr_read_b32 v143, a59
    v_accvgpr_read_b32 v159, a123
    v_pk_fma_f32 v[128:129], v[160:161], v[226:227], v[128:129] op_sel:[0,0,0] op_sel_hi:[1,0,1]
    v_pk_fma_f32 v[130:131], v[162:163], v[226:227], v[130:131] op_sel:[0,0,0] op_sel_hi:[1,0,1]
    v_pk_fma_f32 v[132:133], v[164:165], v[226:227], v[132:133] op_sel:[0,0,0] op_sel_hi:[1,0,1]
    v_pk_fma_f32 v[134:135], v[166:167], v[226:227], v[134:135] op_sel:[0,0,0] op_sel_hi:[1,0,1]
    v_pk_fma_f32 v[136:137], v[168:169], v[226:227], v[136:137] op_sel:[0,0,0] op_sel_hi:[1,0,1]
    v_pk_fma_f32 v[138:139], v[170:171], v[226:227], v[138:139] op_sel:[0,0,0] op_sel_hi:[1,0,1]
    v_pk_fma_f32 v[140:141], v[172:173], v[226:227], v[140:141] op_sel:[0,0,0] op_sel_hi:[1,0,1]
    v_pk_fma_f32 v[142:143], v[174:175], v[226:227], v[142:143] op_sel:[0,0,0] op_sel_hi:[1,0,1]
    v_pk_fma_f32 v[144:145], v[176:177], v[226:227], v[144:145] op_sel:[0,0,0] op_sel_hi:[1,0,1]
    v_pk_fma_f32 v[146:147], v[178:179], v[226:227], v[146:147] op_sel:[0,0,0] op_sel_hi:[1,0,1]
    v_pk_fma_f32 v[148:149], v[180:181], v[226:227], v[148:149] op_sel:[0,0,0] op_sel_hi:[1,0,1]
    v_pk_fma_f32 v[150:151], v[182:183], v[226:227], v[150:151] op_sel:[0,0,0] op_sel_hi:[1,0,1]
    v_pk_fma_f32 v[152:153], v[184:185], v[226:227], v[152:153] op_sel:[0,0,0] op_sel_hi:[1,0,1]
    v_pk_fma_f32 v[154:155], v[186:187], v[226:227], v[154:155] op_sel:[0,0,0] op_sel_hi:[1,0,1]
    v_pk_fma_f32 v[156:157], v[188:189], v[226:227], v[156:157] op_sel:[0,0,0] op_sel_hi:[1,0,1]
    v_pk_fma_f32 v[158:159], v[190:191], v[226:227], v[158:159] op_sel:[0,0,0] op_sel_hi:[1,0,1]
    v_pk_mul_f32 v[128:129], v[128:129], v[238:239] op_sel:[0,0] op_sel_hi:[1,0]
    v_pk_mul_f32 v[130:131], v[130:131], v[238:239] op_sel:[0,0] op_sel_hi:[1,0]
    v_pk_mul_f32 v[132:133], v[132:133], v[238:239] op_sel:[0,0] op_sel_hi:[1,0]
    v_pk_mul_f32 v[134:135], v[134:135], v[238:239] op_sel:[0,0] op_sel_hi:[1,0]
    v_pk_mul_f32 v[136:137], v[136:137], v[238:239] op_sel:[0,0] op_sel_hi:[1,0]
    v_pk_mul_f32 v[138:139], v[138:139], v[238:239] op_sel:[0,0] op_sel_hi:[1,0]
    v_pk_mul_f32 v[140:141], v[140:141], v[238:239] op_sel:[0,0] op_sel_hi:[1,0]
    v_pk_mul_f32 v[142:143], v[142:143], v[238:239] op_sel:[0,0] op_sel_hi:[1,0]
    v_pk_mul_f32 v[128:129], v[128:129], v[144:145]
    v_pk_mul_f32 v[130:131], v[130:131], v[146:147]
    v_pk_mul_f32 v[132:133], v[132:133], v[148:149]
    v_pk_mul_f32 v[134:135], v[134:135], v[150:151]
    v_pk_mul_f32 v[136:137], v[136:137], v[152:153]
    v_pk_mul_f32 v[138:139], v[138:139], v[154:155]
    v_pk_mul_f32 v[140:141], v[140:141], v[156:157]
    v_pk_mul_f32 v[142:143], v[142:143], v[158:159]
    v_cvt_pk_bf16_f32 v144, v128, v129
    v_cvt_pk_bf16_f32 v145, v130, v131
    v_cvt_pk_bf16_f32 v146, v132, v133
    v_cvt_pk_bf16_f32 v147, v134, v135
    v_cvt_pk_bf16_f32 v148, v136, v137
    v_cvt_pk_bf16_f32 v149, v138, v139
    v_cvt_pk_bf16_f32 v150, v140, v141
    v_cvt_pk_bf16_f32 v151, v142, v143
    v_accvgpr_write_b32 a240, v144
    v_accvgpr_write_b32 a241, v145
    v_accvgpr_write_b32 a242, v146
    v_accvgpr_write_b32 a243, v147
    v_accvgpr_write_b32 a244, v148
    v_accvgpr_write_b32 a245, v149
    v_accvgpr_write_b32 a246, v150
    v_accvgpr_write_b32 a247, v151
    buffer_load_dwordx4 v31, s[12:15], s52 offen offset:3072 lds
    v_mfma_f32_16x16x32_bf16 v[120:123], a[128:131], v[80:83], 0
    v_accvgpr_read_b32 v128, a12
    v_accvgpr_read_b32 v144, a76
    v_accvgpr_read_b32 v129, a13
    v_accvgpr_read_b32 v145, a77
    v_mfma_f32_16x16x32_bf16 v[120:123], a[132:135], v[84:87], v[120:123]
    v_accvgpr_read_b32 v130, a14
    v_accvgpr_read_b32 v146, a78
    v_accvgpr_read_b32 v131, a15
    v_accvgpr_read_b32 v147, a79
    v_mfma_f32_16x16x32_bf16 v[120:123], a[136:139], v[88:91], v[120:123]
    v_accvgpr_read_b32 v132, a28
    v_accvgpr_read_b32 v148, a92
    v_accvgpr_read_b32 v133, a29
    v_accvgpr_read_b32 v149, a93
L_pad3:
    s_cbranch_execz L_pad7
    v_mfma_f32_16x16x32_bf16 v[120:123], a[140:143], v[92:95], v[120:123]
    v_accvgpr_read_b32 v134, a30
    v_accvgpr_read_b32 v150, a94
    v_accvgpr_read_b32 v135, a31
    v_accvgpr_read_b32 v151, a95
    v_mfma_f32_16x16x32_bf16 v[124:127], a[144:147], v[80:83], 0
    v_accvgpr_read_b32 v136, a44
    v_accvgpr_read_b32 v152, a108
    v_accvgpr_read_b32 v137, a45
    v_accvgpr_read_b32 v153, a109
    v_mfma_f32_16x16x32_bf16 v[124:127], a[148:151], v[84:87], v[124:127]
    v_accvgpr_read_b32 v138, a46
    v_accvgpr_read_b32 v154, a110
    v_accvgpr_read_b32 v139, a47
    v_accvgpr_read_b32 v155, a111
    v_mfma_f32_16x16x32_bf16 v[124:127], a[152:155], v[88:91], v[124:127]
    v_accvgpr_read_b32 v140, a60
    v_accvgpr_read_b32 v156, a124
    v_accvgpr_read_b32 v141, a61
    v_accvgpr_read_b32 v157, a125
    v_mfma_f32_16x16x32_bf16 v[124:127], a[156:159], v[92:95], v[124:127]
    v_accvgpr_read_b32 v142, a62
    v_accvgpr_read_b32 v158, a126
    v_accvgpr_read_b32 v143, a63
    v_accvgpr_read_b32 v159, a127
    v_pk_fma_f32 v[128:129], v[160:161], v[226:227], v[128:129] op_sel:[0,1,0] op_sel_hi:[1,1,1]
    v_pk_fma_f32 v[130:131], v[162:163], v[226:227], v[130:131] op_sel:[0,1,0] op_sel_hi:[1,1,1]
    v_pk_fma_f32 v[132:133], v[164:165], v[226:227], v[132:133] op_sel:[0,1,0] op_sel_hi:[1,1,1]
    v_pk_fma_f32 v[134:135], v[166:167], v[226:227], v[134:135] op_sel:[0,1,0] op_sel_hi:[1,1,1]
    v_pk_fma_f32 v[136:137], v[168:169], v[226:227], v[136:137] op_sel:[0,1,0] op_sel_hi:[1,1,1]
    v_pk_fma_f32 v[138:139], v[170:171], v[226:227], v[138:139] op_sel:[0,1,0] op_sel_hi:[1,1,1]
    v_pk_fma_f32 v[140:141], v[172:173], v[226:227], v[140:141] op_sel:[0,1,0] op_sel_hi:[1,1,1]
    v_pk_fma_f32 v[142:143], v[174:175], v[226:227], v[142:143] op_sel:[0,1,0] op_sel_hi:[1,1,1]
    v_pk_fma_f32 v[144:145], v[176:177], v[226:227], v[144:145] op_sel:[0,1,0] op_sel_hi:[1,1,1]
    v_pk_fma_f32 v[146:147], v[178:179], v[226:227], v[146:147] op_sel:[0,1,0] op_sel_hi:[1,1,1]
    v_pk_fma_f32 v[148:149], v[180:181], v[226:227], v[148:149] op_sel:[0,1,0] op_sel_hi:[1,1,1]
    v_pk_fma_f32 v[150:151], v[182:183], v[226:227], v[150:151] op_sel:[0,1,0] op_sel_hi:[1,1,1]
    v_pk_fma_f32 v[152:153], v[184:185], v[226:227], v[152:153] op_sel:[0,1,0] op_sel_hi:[1,1,1]
    v_pk_fma_f32 v[154:155], v[186:187], v[226:227], v[154:155] op_sel:[0,1,0] op_sel_hi:[1,1,1]
    v_pk_fma_f32 v[156:157], v[188:189], v[226:227], v[156:157] op_sel:[0,1,0] op_sel_hi:[1,1,1]
    v_pk_fma_f32 v[158:159], v[190:191], v[226:227], v[158:159] op_sel:[0,1,0] op_sel_hi:[1,1,1]
    v_pk_mul_f32 v[128:129], v[128:129], v[238:239] op_sel:[0,1] op_sel_hi:[1,1]
    v_pk_mul_f32 v[130:131], v[130:131], v[238:239] op_sel:[0,1] op_sel_hi:[1,1]
    v_pk_mul_f32 v[132:133], v[132:133], v[238:239] op_sel:[0,1] op_sel_hi:[1,1]
    v_pk_mul_f32 v[134:135], v[134:135], v[238:239] op_sel:[0,1] op_sel_hi:[1,1]
    v_pk_mul_f32 v[136:137], v[136:137], v[238:239] op_sel:[0,1] op_sel_hi:[1,1]
    v_pk_mul_f32 v[138:139], v[138:139], v[238:239] op_sel:[0,1] op_sel_hi:[1,1]
    v_pk_mul_f32 v[140:141], v[140:141], v[238:239] op_sel:[0,1] op_sel_hi:[1,1]
    v_pk_mul_f32 v[142:143], v[142:143], v[238:239] op_sel:[0,1] op_sel_hi:[1,1]
    v_pk_mul_f32 v[128:129], v[128:129], v[144:145]
    v_pk_mul_f32 v[130:131], v[130:131], v[146:147]
    v_pk_mul_f32 v[132:133], v[132:133], v[148:149]
    v_pk_mul_f32 v[134:135], v[134:135], v[150:151]
    v_pk_mul_f32 v[136:137], v[136:137], v[152:153]
    v_pk_mul_f32 v[138:139], v[138:139], v[154:155]
    v_pk_mul_f32 v[140:141], v[140:141], v[156:157]
    v_pk_mul_f32 v[142:143], v[142:143], v[158:159]
    v_cvt_pk_bf16_f32 v144, v128, v129
    v_cvt_pk_bf16_f32 v145, v130, v131
    v_cvt_pk_bf16_f32 v146, v132, v133
    v_cvt_pk_bf16_f32 v147, v134, v135
    v_cvt_pk_bf16_f32 v148, v136, v137
    v_cvt_pk_bf16_f32 v149, v138, v139
    v_cvt_pk_bf16_f32 v150, v140, v141
    v_cvt_pk_bf16_f32 v151, v142, v143
    v_accvgpr_write_b32 a248, v144
    v_accvgpr_write_b32 a249, v145
    v_accvgpr_write_b32 a250, v146
    v_accvgpr_write_b32 a251, v147
    v_accvgpr_write_b32 a252, v148
    v_accvgpr_write_b32 a253, v149
    v_accvgpr_write_b32 a254, v150
    v_accvgpr_write_b32 a255, v151
    ds_read_b128 a[128:131], v220 offset:16384
    ds_read_b128 a[132:135], v221 offset:16384
    ds_read_b128 a[136:139], v222 offset:16384
    ds_read_b128 a[140:143], v223 offset:16384
    ds_read_b128 a[144:147], v220 offset:24576
    ds_read_b128 a[148:151], v221 offset:24576
    ds_read_b128 a[152:155], v222 offset:24576
    ds_read_b128 a[156:159], v223 offset:24576
    v_mov_b32 v224, 0
    v_mov_b32 v225, 0
    v_mov_b32 v226, 0
    v_mov_b32 v227, 0
    v_mov_b32 v228, 0
    v_mov_b32 v229, 0
    v_mov_b32 v230, 0
    v_mov_b32 v231, 0
    v_mov_b32 v232, 0
    v_mov_b32 v233, 0
    v_max3_f32 v212, v96, v97, v98
    v_max3_f32 v213, v104, v105, v106
    v_max3_f32 v214, v112, v113, v114
    v_max3_f32 v215, v120, v121, v122
    v_max3_f32 v212, v212, v99, v100
    v_max3_f32 v213, v213, v107, v108
    v_max3_f32 v214, v214, v115, v116
    v_max3_f32 v215, v215, v123, v124
    v_max3_f32 v212, v212, v101, v102
    v_max3_f32 v213, v213, v109, v110
    v_max3_f32 v214, v214, v117, v118
    v_max3_f32 v215, v215, v125, v126
    v_max_f32 v212, v212, v103
    v_max_f32 v213, v213, v111
    v_max_f32 v214, v214, v119
    v_max_f32 v215, v215, v127
    v_mov_b32 v216, v212
    v_mov_b32 v217, v213
    v_mov_b32 v218, v214
    v_mov_b32 v219, v215
    s_nop 0
    v_permlane32_swap_b32 v212, v216
    v_permlane32_swap_b32 v213, v217
    v_permlane32_swap_b32 v214, v218
    v_permlane32_swap_b32 v215, v219
    v_max_f32 v212, v212, v216
    v_max_f32 v213, v213, v217
    v_max_f32 v214, v214, v218
    v_max_f32 v215, v215, v219
    v_mov_b32 v216, v212
    v_mov_b32 v217, v213
    v_mov_b32 v218, v214
    v_mov_b32 v219, v215
    s_nop 0
    v_permlane16_swap_b32 v212, v216
    v_permlane16_swap_b32 v213, v217
    v_permlane16_swap_b32 v214, v218
    v_permlane16_swap_b32 v215, v219
    v_max_f32 v212, v212, v216
    v_max_f32 v213, v213, v217
    v_max_f32 v214, v214, v218
    v_max_f32 v215, v215, v219
    v_sub_f32 v96, v96, v212
    v_sub_f32 v97, v97, v212
    v_sub_f32 v98, v98, v212
    v_sub_f32 v99, v99, v212
    v_sub_f32 v100, v100, v212
    v_sub_f32 v101, v101, v212
    v_sub_f32 v102, v102, v212
    v_sub_f32 v103, v103, v212
    v_sub_f32 v160, 0, v212
    v_sub_f32 v161, 0, v212
    v_sub_f32 v162, 0, v212
    v_sub_f32 v163, 0, v212
    v_sub_f32 v104, v104, v213
    v_sub_f32 v105, v105, v213
    v_sub_f32 v106, v106, v213
    v_sub_f32 v107, v107, v213
    v_sub_f32 v108, v108, v213
    v_sub_f32 v109, v109, v213
    v_sub_f32 v110, v110, v213
    v_sub_f32 v111, v111, v213
    v_sub_f32 v164, 0, v213
    v_sub_f32 v165, 0, v213
    v_sub_f32 v166, 0, v213
    v_sub_f32 v167, 0, v213
    v_sub_f32 v112, v112, v214
    v_sub_f32 v113, v113, v214
    v_sub_f32 v114, v114, v214
    v_sub_f32 v115, v115, v214
    v_sub_f32 v116, v116, v214
    v_sub_f32 v117, v117, v214
    v_sub_f32 v118, v118, v214
    v_sub_f32 v119, v119, v214
    v_sub_f32 v168, 0, v214
    v_sub_f32 v169, 0, v214
    v_sub_f32 v170, 0, v214
    v_sub_f32 v171, 0, v214
    v_sub_f32 v120, v120, v215
    v_sub_f32 v121, v121, v215
    v_sub_f32 v122, v122, v215
    v_sub_f32 v123, v123, v215
    v_sub_f32 v124, v124, v215
    v_sub_f32 v125, v125, v215
    v_sub_f32 v126, v126, v215
    v_sub_f32 v127, v127, v215
    v_sub_f32 v172, 0, v215
    v_sub_f32 v173, 0, v215
    v_sub_f32 v174, 0, v215
    v_sub_f32 v175, 0, v215
    v_exp_f32 v128, v112
    v_exp_f32 v129, v113
    v_exp_f32 v130, v114
    v_exp_f32 v131, v115
    v_exp_f32 v132, v116
    v_exp_f32 v133, v117
    v_mov_b32 v223, 1
    v_cvt_pk_bf16_f32 v192, v128, v129
    v_cvt_pk_bf16_f32 v193, v130, v131
    v_cvt_pk_bf16_f32 v194, v132, v133
    s_waitcnt lgkmcnt(0)
    s_mov_b32 s55, 5
.p2align 3
    v_mfma_f32_16x16x32_bf16 v[128:131], a[128:131], v[32:35], v[160:163]
    v_exp_f32 v210, v118
    v_mfma_f32_16x16x32_bf16 v[128:131], a[132:135], v[36:39], v[128:131]
    ds_read_b64_tr_b16 a[160:161], v16 offset:2048
    ds_read_b64_tr_b16 a[162:163], v16 offset:10240
    v_mfma_f32_16x16x32_bf16 v[128:131], a[136:139], v[40:43], v[128:131]
    v_exp_f32 v211, v119
    v_mfma_f32_16x16x32_bf16 v[128:131], a[140:143], v[44:47], v[128:131]
    ds_read_b64_tr_b16 a[164:165], v17 offset:2048
    v_cvt_pk_bf16_f32 v195, v210, v211
    v_mfma_f32_16x16x32_bf16 v[132:135], a[156:159], v[44:47], v[160:163]
    v_exp_f32 v208, v120
    v_mfma_f32_16x16x32_bf16 v[132:135], a[152:155], v[40:43], v[132:135]
    ds_read_b64_tr_b16 a[166:167], v17 offset:10240
    ds_read_b64_tr_b16 a[168:169], v18 offset:2048
    v_mfma_f32_16x16x32_bf16 v[132:135], a[148:151], v[36:39], v[132:135]
    v_exp_f32 v209, v121
    v_mfma_f32_16x16x32_bf16 v[132:135], a[144:147], v[32:35], v[132:135]
    ds_read_b64_tr_b16 a[170:171], v18 offset:10240
    v_cvt_pk_bf16_f32 v196, v208, v209
    v_mfma_f32_16x16x32_bf16 v[140:143], a[144:147], v[48:51], v[164:167]
    v_exp_f32 v210, v122
    v_mfma_f32_16x16x32_bf16 v[140:143], a[148:151], v[52:55], v[140:143]
    ds_read_b64_tr_b16 a[172:173], v19 offset:2048
    ds_read_b64_tr_b16 a[174:175], v19 offset:10240
    v_mfma_f32_16x16x32_bf16 v[140:143], a[152:155], v[56:59], v[140:143]
    v_exp_f32 v211, v123
    v_mfma_f32_16x16x32_bf16 v[140:143], a[156:159], v[60:63], v[140:143]
    ds_read_b64_tr_b16 a[176:177], v20 offset:2048
    v_cvt_pk_bf16_f32 v197, v210, v211
    v_mfma_f32_16x16x32_bf16 v[136:139], a[140:143], v[60:63], v[164:167]
    v_exp_f32 v208, v124
    v_mfma_f32_16x16x32_bf16 v[136:139], a[136:139], v[56:59], v[136:139]
    ds_read_b64_tr_b16 a[178:179], v20 offset:10240
    ds_read_b64_tr_b16 a[180:181], v21 offset:2048
    v_mfma_f32_16x16x32_bf16 v[136:139], a[132:135], v[52:55], v[136:139]
    v_exp_f32 v209, v125
    v_mfma_f32_16x16x32_bf16 v[136:139], a[128:131], v[48:51], v[136:139]
    ds_read_b64_tr_b16 a[182:183], v21 offset:10240
    v_cvt_pk_bf16_f32 v198, v208, v209
    v_mfma_f32_16x16x32_bf16 v[144:147], a[128:131], v[64:67], v[168:171]
    v_exp_f32 v210, v126
    v_mfma_f32_16x16x32_bf16 v[144:147], a[132:135], v[68:71], v[144:147]
    ds_read_b64_tr_b16 a[184:185], v22 offset:2048
    ds_read_b64_tr_b16 a[186:187], v22 offset:10240
    v_mfma_f32_16x16x32_bf16 v[144:147], a[136:139], v[72:75], v[144:147]
    v_exp_f32 v211, v127
    v_mfma_f32_16x16x32_bf16 v[144:147], a[140:143], v[76:79], v[144:147]
    ds_read_b64_tr_b16 a[188:189], v23 offset:2048
    v_cvt_pk_bf16_f32 v199, v210, v211
    v_mfma_f32_16x16x32_bf16 v[148:151], a[156:159], v[76:79], v[168:171]
    ds_read_b64_tr_b16 a[190:191], v23 offset:10240
    v_mov_b32 v233, v228
    v_mfma_f32_16x16x32_bf16 v[148:151], a[152:155], v[72:75], v[148:151]
    v_exp_f32 v208, v96
    v_mfma_f32_16x16x32_bf16 v[148:151], a[148:151], v[68:71], v[148:151]
    v_mfma_f32_16x16x32_bf16 v[148:151], a[144:147], v[64:67], v[148:151]
    v_exp_f32 v209, v97
    v_smfmac_f32_16x16x64_bf16 v[228:231], v[24:27], v[192:199], v235
    v_cvt_pk_bf16_f32 v176, v208, v209
    v_mfma_f32_16x16x32_bf16 v[156:159], a[144:147], v[80:83], v[172:175]
    v_exp_f32 v210, v98
    v_mfma_f32_16x16x32_bf16 v[156:159], a[148:151], v[84:87], v[156:159]
    v_mfma_f32_16x16x32_bf16 v[156:159], a[152:155], v[88:91], v[156:159]
    v_exp_f32 v211, v99
    v_mfma_f32_16x16x32_bf16 v[156:159], a[156:159], v[92:95], v[156:159]
    v_cvt_pk_bf16_f32 v177, v210, v211
    v_cmp_nle_f32 vcc, v228, v234
    v_mfma_f32_16x16x32_bf16 v[152:155], a[140:143], v[92:95], v[172:175]
    v_exp_f32 v208, v100
    v_mfma_f32_16x16x32_bf16 v[152:155], a[136:139], v[88:91], v[152:155]
    v_mfma_f32_16x16x32_bf16 v[152:155], a[132:135], v[84:87], v[152:155]
    v_exp_f32 v209, v101
    v_mfma_f32_16x16x32_bf16 v[152:155], a[128:131], v[80:83], v[152:155]
    s_waitcnt lgkmcnt(0)
    v_cvt_pk_bf16_f32 v178, v208, v209
    s_cbranch_vccnz L_slow0_f0
L_back0_f0:
    v_exp_f32 v210, v102
    v_mfma_f32_16x16x32_bf16 a[64:67], a[160:163], v[192:195], 0
    ds_read_b128 a[128:131], v8 offset:0
    ds_read_b128 a[132:135], v9 offset:0
    v_exp_f32 v211, v103
    v_mfma_f32_16x16x32_bf16 a[68:71], a[164:167], v[192:195], 0
    ds_read_b128 a[136:139], v10 offset:0
    v_cvt_pk_bf16_f32 v179, v210, v211
    v_exp_f32 v208, v104
    v_mfma_f32_16x16x32_bf16 a[72:75], a[168:171], v[192:195], 0
    ds_read_b128 a[140:143], v11 offset:0
    ds_read_b128 a[144:147], v8 offset:8192
    s_add_u32 s52, s52, 8192
    v_exp_f32 v209, v105
    v_mfma_f32_16x16x32_bf16 a[76:79], a[172:175], v[192:195], 0
    ds_read_b128 a[148:151], v9 offset:8192
    v_cvt_pk_bf16_f32 v180, v208, v209
    s_add_u32 m0, s88, 98304
    v_exp_f32 v210, v106
    v_mfma_f32_16x16x32_bf16 a[80:83], a[176:179], v[192:195], 0
    buffer_load_dwordx4 v28, s[8:11], s52 offen offset:0 lds
    v_exp_f32 v211, v107
    v_mfma_f32_16x16x32_bf16 a[84:87], a[180:183], v[192:195], 0
    ds_read_b128 a[152:155], v10 offset:8192
    v_cvt_pk_bf16_f32 v181, v210, v211
    v_exp_f32 v208, v108
    v_mfma_f32_16x16x32_bf16 a[88:91], a[184:187], v[192:195], 0
    buffer_load_dwordx4 v29, s[8:11], s52 offen offset:1024 lds
    v_exp_f32 v209, v109
    v_mfma_f32_16x16x32_bf16 a[92:95], a[188:191], v[192:195], 0
    ds_read_b128 a[156:159], v11 offset:8192
    v_cvt_pk_bf16_f32 v182, v208, v209
    v_exp_f32 v210, v110
    v_mfma_f32_16x16x32_bf16 a[124:127], a[188:191], v[196:199], 0
    buffer_load_dwordx4 v30, s[12:15], s52 offen offset:2048 lds
    v_exp_f32 v211, v111
    v_mfma_f32_16x16x32_bf16 a[120:123], a[184:187], v[196:199], 0
    v_cvt_pk_bf16_f32 v183, v210, v211
    v_mov_b32 v232, v224
    v_mfma_f32_16x16x32_bf16 a[116:119], a[180:183], v[196:199], 0
    v_exp_f32 v208, v128
    buffer_load_dwordx4 v31, s[12:15], s52 offen offset:3072 lds
    v_mfma_f32_16x16x32_bf16 a[112:115], a[176:179], v[196:199], 0
    v_exp_f32 v209, v129
    v_smfmac_f32_16x16x64_bf16 v[224:227], v[24:27], v[176:183], v235
    v_cvt_pk_bf16_f32 v184, v208, v209
    v_exp_f32 v210, v130
    v_mfma_f32_16x16x32_bf16 a[108:111], a[172:175], v[196:199], 0
    s_nop 2
    v_exp_f32 v211, v131
    v_mfma_f32_16x16x32_bf16 a[104:107], a[168:171], v[196:199], 0
    v_cvt_pk_bf16_f32 v185, v210, v211
    v_cmp_nle_f32 vcc, v224, v234
    v_exp_f32 v208, v132
    v_mfma_f32_16x16x32_bf16 a[100:103], a[164:167], v[196:199], 0
    buffer_store_dwordx4 a[224:227], v7, s[28:31], s91 offen offset:0 sc1
    v_exp_f32 v209, v133
    v_mfma_f32_16x16x32_bf16 a[96:99], a[160:163], v[196:199], 0
    s_waitcnt lgkmcnt(0)
    v_cvt_pk_bf16_f32 v186, v208, v209
    s_cbranch_vccnz L_slow1_f0
L_back1_f0:
    v_mfma_f32_16x16x32_bf16 v[112:115], a[128:131], v[64:67], v[168:171]
    v_exp_f32 v210, v134
    v_mfma_f32_16x16x32_bf16 v[112:115], a[132:135], v[68:71], v[112:115]
    ds_read_b64_tr_b16 a[192:193], v16 offset:18432
    ds_read_b64_tr_b16 a[194:195], v16 offset:26624
    v_mfma_f32_16x16x32_bf16 v[112:115], a[136:139], v[72:75], v[112:115]
    v_exp_f32 v211, v135
    v_mfma_f32_16x16x32_bf16 v[112:115], a[140:143], v[76:79], v[112:115]
    ds_read_b64_tr_b16 a[196:197], v17 offset:18432
    v_cvt_pk_bf16_f32 v187, v210, v211
    v_mfma_f32_16x16x32_bf16 v[116:119], a[156:159], v[76:79], v[168:171]
    v_exp_f32 v208, v136
    v_mfma_f32_16x16x32_bf16 v[116:119], a[152:155], v[72:75], v[116:119]
    ds_read_b64_tr_b16 a[198:199], v17 offset:26624
    ds_read_b64_tr_b16 a[200:201], v18 offset:18432
    v_mfma_f32_16x16x32_bf16 v[116:119], a[148:151], v[68:71], v[116:119]
    v_exp_f32 v209, v137
    v_mfma_f32_16x16x32_bf16 v[116:119], a[144:147], v[64:67], v[116:119]
    ds_read_b64_tr_b16 a[202:203], v18 offset:26624
    v_cvt_pk_bf16_f32 v188, v208, v209
    v_mfma_f32_16x16x32_bf16 v[124:127], a[144:147], v[80:83], v[172:175]
    v_exp_f32 v210, v138
    v_mfma_f32_16x16x32_bf16 v[124:127], a[148:151], v[84:87], v[124:127]
    ds_read_b64_tr_b16 a[204:205], v19 offset:18432
    ds_read_b64_tr_b16 a[206:207], v19 offset:26624
    v_mfma_f32_16x16x32_bf16 v[124:127], a[152:155], v[88:91], v[124:127]
    v_exp_f32 v211, v139
    v_mfma_f32_16x16x32_bf16 v[124:127], a[156:159], v[92:95], v[124:127]
    ds_read_b64_tr_b16 a[208:209], v20 offset:18432
    v_cvt_pk_bf16_f32 v189, v210, v211
    v_mfma_f32_16x16x32_bf16 v[120:123], a[140:143], v[92:95], v[172:175]
    v_exp_f32 v208, v140
    v_mfma_f32_16x16x32_bf16 v[120:123], a[136:139], v[88:91], v[120:123]
    ds_read_b64_tr_b16 a[210:211], v20 offset:26624
    ds_read_b64_tr_b16 a[212:213], v21 offset:18432
    v_mfma_f32_16x16x32_bf16 v[120:123], a[132:135], v[84:87], v[120:123]
    v_exp_f32 v209, v141
    v_mfma_f32_16x16x32_bf16 v[120:123], a[128:131], v[80:83], v[120:123]
    ds_read_b64_tr_b16 a[214:215], v21 offset:26624
    v_cvt_pk_bf16_f32 v190, v208, v209
    v_mfma_f32_16x16x32_bf16 v[96:99], a[128:131], v[32:35], v[160:163]
    v_exp_f32 v210, v142
    v_mfma_f32_16x16x32_bf16 v[96:99], a[132:135], v[36:39], v[96:99]
    ds_read_b64_tr_b16 a[216:217], v22 offset:18432
    ds_read_b64_tr_b16 a[218:219], v22 offset:26624
    v_mfma_f32_16x16x32_bf16 v[96:99], a[136:139], v[40:43], v[96:99]
    v_exp_f32 v211, v143
    v_mfma_f32_16x16x32_bf16 v[96:99], a[140:143], v[44:47], v[96:99]
    ds_read_b64_tr_b16 a[220:221], v23 offset:18432
    v_cvt_pk_bf16_f32 v191, v210, v211
    v_mfma_f32_16x16x32_bf16 v[100:103], a[156:159], v[44:47], v[160:163]
    ds_read_b64_tr_b16 a[222:223], v23 offset:26624
    v_mov_b32 v232, v224
    v_mfma_f32_16x16x32_bf16 v[100:103], a[152:155], v[40:43], v[100:103]
    v_exp_f32 v208, v144
    v_mfma_f32_16x16x32_bf16 v[100:103], a[148:151], v[36:39], v[100:103]
    v_lshlrev_b32 v4, 1, v3
    v_xor_b32 v4, v4, v2
    v_mfma_f32_16x16x32_bf16 v[100:103], a[144:147], v[32:35], v[100:103]
    v_exp_f32 v209, v145
    v_smfmac_f32_16x16x64_bf16 v[224:227], v[24:27], v[184:191], v235
    v_cvt_pk_bf16_f32 v200, v208, v209
    v_lshlrev_b32 v4, 4, v4
    v_mfma_f32_16x16x32_bf16 v[108:111], a[144:147], v[48:51], v[164:167]
    v_exp_f32 v210, v146
    v_mfma_f32_16x16x32_bf16 v[108:111], a[148:151], v[52:55], v[108:111]
    v_lshl_add_u32 v4, v3, 10, v4
    v_xor_b32 v5, 128, v4
    v_mfma_f32_16x16x32_bf16 v[108:111], a[152:155], v[56:59], v[108:111]
    v_exp_f32 v211, v147
    v_mfma_f32_16x16x32_bf16 v[108:111], a[156:159], v[60:63], v[108:111]
    v_cvt_pk_bf16_f32 v201, v210, v211
    v_cmp_nle_f32 vcc, v224, v234
    v_mfma_f32_16x16x32_bf16 v[104:107], a[140:143], v[60:63], v[164:167]
    v_exp_f32 v208, v148
    v_mfma_f32_16x16x32_bf16 v[104:107], a[136:139], v[56:59], v[104:107]
    v_mfma_f32_16x16x32_bf16 v[104:107], a[132:135], v[52:55], v[104:107]
    v_exp_f32 v209, v149
    v_mfma_f32_16x16x32_bf16 v[104:107], a[128:131], v[48:51], v[104:107]
    s_waitcnt lgkmcnt(0)
    v_cvt_pk_bf16_f32 v202, v208, v209
    s_cbranch_vccnz L_slow0_f1
L_back0_f1:
    v_mfma_f32_16x16x32_bf16 a[0:3], a[160:163], v[176:179], 0
    v_exp_f32 v210, v150
    v_mfma_f32_16x16x32_bf16 a[0:3], a[192:195], v[184:187], a[0:3]
    ds_read_b128 a[128:131], v8 offset:16384
    ds_read_b128 a[132:135], v9 offset:16384
    v_mfma_f32_16x16x32_bf16 a[4:7], a[196:199], v[184:187], 0
    v_exp_f32 v211, v151
    v_mfma_f32_16x16x32_bf16 a[4:7], a[164:167], v[176:179], a[4:7]
    ds_read_b128 a[136:139], v10 offset:16384
    v_cvt_pk_bf16_f32 v203, v210, v211
    v_mfma_f32_16x16x32_bf16 a[8:11], a[168:171], v[176:179], 0
    v_exp_f32 v208, v152
    v_mfma_f32_16x16x32_bf16 a[8:11], a[200:203], v[184:187], a[8:11]
    ds_read_b128 a[140:143], v11 offset:16384
    ds_read_b128 a[144:147], v8 offset:24576
    v_mfma_f32_16x16x32_bf16 a[12:15], a[204:207], v[184:187], 0
    s_add_u32 s52, s52, 8192
    v_exp_f32 v209, v153
    v_mfma_f32_16x16x32_bf16 a[12:15], a[172:175], v[176:179], a[12:15]
    ds_read_b128 a[148:151], v9 offset:24576
    v_cvt_pk_bf16_f32 v204, v208, v209
    v_mfma_f32_16x16x32_bf16 a[16:19], a[176:179], v[176:179], 0
    s_add_u32 m0, s88, 114688
    v_exp_f32 v210, v154
    v_mfma_f32_16x16x32_bf16 a[16:19], a[208:211], v[184:187], a[16:19]
    buffer_load_dwordx4 v28, s[8:11], s52 offen offset:0 lds
    v_mfma_f32_16x16x32_bf16 a[20:23], a[212:215], v[184:187], 0
    v_exp_f32 v211, v155
    v_mfma_f32_16x16x32_bf16 a[20:23], a[180:183], v[176:179], a[20:23]
    ds_read_b128 a[152:155], v10 offset:24576
    v_cvt_pk_bf16_f32 v205, v210, v211
    v_mfma_f32_16x16x32_bf16 a[24:27], a[184:187], v[176:179], 0
    v_exp_f32 v208, v156
    v_mfma_f32_16x16x32_bf16 a[24:27], a[216:219], v[184:187], a[24:27]
    buffer_load_dwordx4 v29, s[8:11], s52 offen offset:1024 lds
    v_mfma_f32_16x16x32_bf16 a[28:31], a[220:223], v[184:187], 0
    v_exp_f32 v209, v157
    v_mfma_f32_16x16x32_bf16 a[28:31], a[188:191], v[176:179], a[28:31]
    ds_read_b128 a[156:159], v11 offset:24576
    v_cvt_pk_bf16_f32 v206, v208, v209
    v_mfma_f32_16x16x32_bf16 a[60:63], a[188:191], v[180:183], 0
    v_exp_f32 v210, v158
    v_mfma_f32_16x16x32_bf16 a[60:63], a[220:223], v[188:191], a[60:63]
    buffer_load_dwordx4 v30, s[12:15], s52 offen offset:2048 lds
    v_mfma_f32_16x16x32_bf16 a[56:59], a[216:219], v[188:191], 0
    v_exp_f32 v211, v159
    v_mfma_f32_16x16x32_bf16 a[56:59], a[184:187], v[180:183], a[56:59]
    v_cvt_pk_bf16_f32 v207, v210, v211
    v_mfma_f32_16x16x32_bf16 a[52:55], a[180:183], v[180:183], 0
    v_mov_b32 v233, v228
    v_mfma_f32_16x16x32_bf16 a[52:55], a[212:215], v[188:191], a[52:55]
    v_exp_f32 v208, v112
    v_mfma_f32_16x16x32_bf16 a[48:51], a[208:211], v[188:191], 0
    buffer_load_dwordx4 v31, s[12:15], s52 offen offset:3072 lds
    v_mfma_f32_16x16x32_bf16 a[48:51], a[176:179], v[180:183], a[48:51]
    v_exp_f32 v209, v113
    v_smfmac_f32_16x16x64_bf16 v[228:231], v[24:27], v[200:207], v235
    v_cvt_pk_bf16_f32 v192, v208, v209
    v_mfma_f32_16x16x32_bf16 a[44:47], a[172:175], v[180:183], 0
    v_exp_f32 v210, v114
    v_mfma_f32_16x16x32_bf16 a[44:47], a[204:207], v[188:191], a[44:47]
    v_mfma_f32_16x16x32_bf16 a[40:43], a[200:203], v[188:191], 0
    v_exp_f32 v211, v115
    v_mfma_f32_16x16x32_bf16 a[40:43], a[168:171], v[180:183], a[40:43]
    v_cvt_pk_bf16_f32 v193, v210, v211
    v_cmp_nle_f32 vcc, v228, v234
    v_mfma_f32_16x16x32_bf16 a[36:39], a[164:167], v[180:183], 0
    v_exp_f32 v208, v116
    v_mfma_f32_16x16x32_bf16 a[36:39], a[196:199], v[188:191], a[36:39]
    buffer_store_dwordx4 a[228:231], v7, s[28:31], s91 offen offset:1024 sc1
    v_mfma_f32_16x16x32_bf16 a[32:35], a[192:195], v[188:191], 0
    v_exp_f32 v209, v117
    v_mfma_f32_16x16x32_bf16 a[32:35], a[160:163], v[180:183], a[32:35]
    s_waitcnt vmcnt(10) lgkmcnt(0)
    s_barrier
    v_cvt_pk_bf16_f32 v194, v208, v209
    s_cbranch_vccnz L_slow1_f1
L_back1_f1:
    v_mfma_f32_16x16x32_bf16 v[128:131], a[128:131], v[32:35], v[160:163]
    v_exp_f32 v210, v118
    v_mfma_f32_16x16x32_bf16 v[128:131], a[132:135], v[36:39], v[128:131]
    ds_read_b64_tr_b16 a[160:161], v16 offset:34816
    ds_read_b64_tr_b16 a[162:163], v16 offset:43008
    v_mfma_f32_16x16x32_bf16 v[128:131], a[136:139], v[40:43], v[128:131]
    v_exp_f32 v211, v119
    v_mfma_f32_16x16x32_bf16 v[128:131], a[140:143], v[44:47], v[128:131]
    ds_read_b64_tr_b16 a[164:165], v17 offset:34816
    v_cvt_pk_bf16_f32 v195, v210, v211
    v_mfma_f32_16x16x32_bf16 v[132:135], a[156:159], v[44:47], v[160:163]
    v_exp_f32 v208, v120
    v_mfma_f32_16x16x32_bf16 v[132:135], a[152:155], v[40:43], v[132:135]
    ds_read_b64_tr_b16 a[166:167], v17 offset:43008
    ds_read_b64_tr_b16 a[168:169], v18 offset:34816
    v_mfma_f32_16x16x32_bf16 v[132:135], a[148:151], v[36:39], v[132:135]
    v_exp_f32 v209, v121
    v_mfma_f32_16x16x32_bf16 v[132:135], a[144:147], v[32:35], v[132:135]
    ds_read_b64_tr_b16 a[170:171], v18 offset:43008
    v_cvt_pk_bf16_f32 v196, v208, v209
    v_mfma_f32_16x16x32_bf16 v[140:143], a[144:147], v[48:51], v[164:167]
    v_exp_f32 v210, v122
    v_mfma_f32_16x16x32_bf16 v[140:143], a[148:151], v[52:55], v[140:143]
    ds_read_b64_tr_b16 a[172:173], v19 offset:34816
    ds_read_b64_tr_b16 a[174:175], v19 offset:43008
    v_mfma_f32_16x16x32_bf16 v[140:143], a[152:155], v[56:59], v[140:143]
    v_exp_f32 v211, v123
    v_mfma_f32_16x16x32_bf16 v[140:143], a[156:159], v[60:63], v[140:143]
    ds_read_b64_tr_b16 a[176:177], v20 offset:34816
    v_cvt_pk_bf16_f32 v197, v210, v211
    v_mfma_f32_16x16x32_bf16 v[136:139], a[140:143], v[60:63], v[164:167]
    v_exp_f32 v208, v124
    v_mfma_f32_16x16x32_bf16 v[136:139], a[136:139], v[56:59], v[136:139]
    ds_read_b64_tr_b16 a[178:179], v20 offset:43008
    ds_read_b64_tr_b16 a[180:181], v21 offset:34816
    v_mfma_f32_16x16x32_bf16 v[136:139], a[132:135], v[52:55], v[136:139]
    v_exp_f32 v209, v125
    v_mfma_f32_16x16x32_bf16 v[136:139], a[128:131], v[48:51], v[136:139]
    ds_read_b64_tr_b16 a[182:183], v21 offset:43008
    v_cvt_pk_bf16_f32 v198, v208, v209
    v_mfma_f32_16x16x32_bf16 v[144:147], a[128:131], v[64:67], v[168:171]
    v_exp_f32 v210, v126
    v_mfma_f32_16x16x32_bf16 v[144:147], a[132:135], v[68:71], v[144:147]
    ds_read_b64_tr_b16 a[184:185], v22 offset:34816
    ds_read_b64_tr_b16 a[186:187], v22 offset:43008
    v_mfma_f32_16x16x32_bf16 v[144:147], a[136:139], v[72:75], v[144:147]
    v_exp_f32 v211, v127
    v_mfma_f32_16x16x32_bf16 v[144:147], a[140:143], v[76:79], v[144:147]
    ds_read_b64_tr_b16 a[188:189], v23 offset:34816
    v_cvt_pk_bf16_f32 v199, v210, v211
    v_mfma_f32_16x16x32_bf16 v[148:151], a[156:159], v[76:79], v[168:171]
    ds_read_b64_tr_b16 a[190:191], v23 offset:43008
    v_mov_b32 v233, v228
    v_mfma_f32_16x16x32_bf16 v[148:151], a[152:155], v[72:75], v[148:151]
    v_exp_f32 v208, v96
    v_mfma_f32_16x16x32_bf16 v[148:151], a[148:151], v[68:71], v[148:151]
    v_mfma_f32_16x16x32_bf16 v[148:151], a[144:147], v[64:67], v[148:151]
    v_exp_f32 v209, v97
    v_smfmac_f32_16x16x64_bf16 v[228:231], v[24:27], v[192:199], v235
    v_cvt_pk_bf16_f32 v176, v208, v209
    v_mfma_f32_16x16x32_bf16 v[156:159], a[144:147], v[80:83], v[172:175]
    s_lshl_b32 s58, s6, 8
    s_add_u32 m0, s59, 131072
    s_add_u32 s56, s58, 0
    v_exp_f32 v210, v98
    v_mfma_f32_16x16x32_bf16 v[156:159], a[148:151], v[84:87], v[156:159]
    buffer_load_dwordx4 v4, s[36:39], s56 offen lds
    v_mfma_f32_16x16x32_bf16 v[156:159], a[152:155], v[88:91], v[156:159]
    v_exp_f32 v211, v99
    v_mfma_f32_16x16x32_bf16 v[156:159], a[156:159], v[92:95], v[156:159]
    v_cvt_pk_bf16_f32 v177, v210, v211
    v_cmp_nle_f32 vcc, v228, v234
    v_mfma_f32_16x16x32_bf16 v[152:155], a[140:143], v[92:95], v[172:175]
    s_add_u32 m0, s59, 132096
    s_add_u32 s56, s58, 4096
    v_exp_f32 v208, v100
    v_mfma_f32_16x16x32_bf16 v[152:155], a[136:139], v[88:91], v[152:155]
    buffer_load_dwordx4 v5, s[36:39], s56 offen lds
    v_mfma_f32_16x16x32_bf16 v[152:155], a[132:135], v[84:87], v[152:155]
    v_exp_f32 v209, v101
    v_mfma_f32_16x16x32_bf16 v[152:155], a[128:131], v[80:83], v[152:155]
    s_waitcnt lgkmcnt(0)
    v_cvt_pk_bf16_f32 v178, v208, v209
    s_cbranch_vccnz L_slow0_f2
L_back0_f2:
    v_mfma_f32_16x16x32_bf16 a[64:67], a[192:195], v[200:203], a[64:67]
    v_exp_f32 v210, v102
    v_mfma_f32_16x16x32_bf16 a[64:67], a[160:163], v[192:195], a[64:67]
    ds_read_b128 a[128:131], v8 offset:32768
    ds_read_b128 a[132:135], v9 offset:32768
    v_mfma_f32_16x16x32_bf16 a[68:71], a[164:167], v[192:195], a[68:71]
    v_exp_f32 v211, v103
    v_mfma_f32_16x16x32_bf16 a[68:71], a[196:199], v[200:203], a[68:71]
    ds_read_b128 a[136:139], v10 offset:32768
    v_cvt_pk_bf16_f32 v179, v210, v211
    v_mfma_f32_16x16x32_bf16 a[72:75], a[200:203], v[200:203], a[72:75]
    v_exp_f32 v208, v104
    v_mfma_f32_16x16x32_bf16 a[72:75], a[168:171], v[192:195], a[72:75]
    ds_read_b128 a[140:143], v11 offset:32768
    ds_read_b128 a[144:147], v8 offset:40960
    v_mfma_f32_16x16x32_bf16 a[76:79], a[172:175], v[192:195], a[76:79]
    s_add_u32 s52, s52, 8192
    v_exp_f32 v209, v105
    v_mfma_f32_16x16x32_bf16 a[76:79], a[204:207], v[200:203], a[76:79]
    ds_read_b128 a[148:151], v9 offset:40960
    v_cvt_pk_bf16_f32 v180, v208, v209
    v_mfma_f32_16x16x32_bf16 a[80:83], a[208:211], v[200:203], a[80:83]
    s_add_u32 m0, s88, 0
    v_exp_f32 v210, v106
    v_mfma_f32_16x16x32_bf16 a[80:83], a[176:179], v[192:195], a[80:83]
    buffer_load_dwordx4 v28, s[8:11], s52 offen offset:0 lds
    v_mfma_f32_16x16x32_bf16 a[84:87], a[180:183], v[192:195], a[84:87]
    v_exp_f32 v211, v107
    v_mfma_f32_16x16x32_bf16 a[84:87], a[212:215], v[200:203], a[84:87]
    ds_read_b128 a[152:155], v10 offset:40960
    v_cvt_pk_bf16_f32 v181, v210, v211
    v_mfma_f32_16x16x32_bf16 a[88:91], a[216:219], v[200:203], a[88:91]
    v_exp_f32 v208, v108
    v_mfma_f32_16x16x32_bf16 a[88:91], a[184:187], v[192:195], a[88:91]
    buffer_load_dwordx4 v29, s[8:11], s52 offen offset:1024 lds
    v_mfma_f32_16x16x32_bf16 a[92:95], a[188:191], v[192:195], a[92:95]
    v_exp_f32 v209, v109
    v_mfma_f32_16x16x32_bf16 a[92:95], a[220:223], v[200:203], a[92:95]
    ds_read_b128 a[156:159], v11 offset:40960
    v_cvt_pk_bf16_f32 v182, v208, v209
    v_mfma_f32_16x16x32_bf16 a[124:127], a[220:223], v[204:207], a[124:127]
    v_exp_f32 v210, v110
    v_mfma_f32_16x16x32_bf16 a[124:127], a[188:191], v[196:199], a[124:127]
    buffer_load_dwordx4 v30, s[12:15], s52 offen offset:2048 lds
    v_mfma_f32_16x16x32_bf16 a[120:123], a[184:187], v[196:199], a[120:123]
L_pad4:
    s_cbranch_execz L_pad8
    v_exp_f32 v211, v111
    v_mfma_f32_16x16x32_bf16 a[120:123], a[216:219], v[204:207], a[120:123]
    v_cvt_pk_bf16_f32 v183, v210, v211
    v_mfma_f32_16x16x32_bf16 a[116:119], a[212:215], v[204:207], a[116:119]
    v_mov_b32 v232, v224
    v_mfma_f32_16x16x32_bf16 a[116:119], a[180:183], v[196:199], a[116:119]
    v_exp_f32 v208, v128
    v_mfma_f32_16x16x32_bf16 a[112:115], a[176:179], v[196:199], a[112:115]
    buffer_load_dwordx4 v31, s[12:15], s52 offen offset:3072 lds
    v_mfma_f32_16x16x32_bf16 a[112:115], a[208:211], v[204:207], a[112:115]
    v_exp_f32 v209, v129
    v_smfmac_f32_16x16x64_bf16 v[224:227], v[24:27], v[176:183], v235
    v_cvt_pk_bf16_f32 v184, v208, v209
    v_mfma_f32_16x16x32_bf16 a[108:111], a[204:207], v[204:207], a[108:111]
    v_exp_f32 v210, v130
    v_mfma_f32_16x16x32_bf16 a[108:111], a[172:175], v[196:199], a[108:111]
    v_mfma_f32_16x16x32_bf16 a[104:107], a[168:171], v[196:199], a[104:107]
    v_exp_f32 v211, v131
    v_mfma_f32_16x16x32_bf16 a[104:107], a[200:203], v[204:207], a[104:107]
    v_cvt_pk_bf16_f32 v185, v210, v211
    v_cmp_nle_f32 vcc, v224, v234
    v_mfma_f32_16x16x32_bf16 a[100:103], a[196:199], v[204:207], a[100:103]
    v_exp_f32 v208, v132
    v_mfma_f32_16x16x32_bf16 a[100:103], a[164:167], v[196:199], a[100:103]
    v_mfma_f32_16x16x32_bf16 a[96:99], a[160:163], v[196:199], a[96:99]
    v_exp_f32 v209, v133
    v_mfma_f32_16x16x32_bf16 a[96:99], a[192:195], v[204:207], a[96:99]
    s_waitcnt lgkmcnt(0)
    v_cvt_pk_bf16_f32 v186, v208, v209
    s_cbranch_vccnz L_slow1_f2
L_back1_f2:
    v_mfma_f32_16x16x32_bf16 v[112:115], a[128:131], v[64:67], v[168:171]
    v_exp_f32 v210, v134
    v_mfma_f32_16x16x32_bf16 v[112:115], a[132:135], v[68:71], v[112:115]
    ds_read_b64_tr_b16 a[192:193], v16 offset:51200
    ds_read_b64_tr_b16 a[194:195], v16 offset:59392
    v_mfma_f32_16x16x32_bf16 v[112:115], a[136:139], v[72:75], v[112:115]
    v_exp_f32 v211, v135
    v_mfma_f32_16x16x32_bf16 v[112:115], a[140:143], v[76:79], v[112:115]
    ds_read_b64_tr_b16 a[196:197], v17 offset:51200
    v_cvt_pk_bf16_f32 v187, v210, v211
    v_mfma_f32_16x16x32_bf16 v[116:119], a[156:159], v[76:79], v[168:171]
    v_exp_f32 v208, v136
    v_mfma_f32_16x16x32_bf16 v[116:119], a[152:155], v[72:75], v[116:119]
    ds_read_b64_tr_b16 a[198:199], v17 offset:59392
    ds_read_b64_tr_b16 a[200:201], v18 offset:51200
    v_mfma_f32_16x16x32_bf16 v[116:119], a[148:151], v[68:71], v[116:119]
    v_exp_f32 v209, v137
    v_mfma_f32_16x16x32_bf16 v[116:119], a[144:147], v[64:67], v[116:119]
    ds_read_b64_tr_b16 a[202:203], v18 offset:59392
    v_cvt_pk_bf16_f32 v188, v208, v209
    v_mfma_f32_16x16x32_bf16 v[124:127], a[144:147], v[80:83], v[172:175]
    v_exp_f32 v210, v138
    v_mfma_f32_16x16x32_bf16 v[124:127], a[148:151], v[84:87], v[124:127]
    ds_read_b64_tr_b16 a[204:205], v19 offset:51200
    ds_read_b64_tr_b16 a[206:207], v19 offset:59392
    v_mfma_f32_16x16x32_bf16 v[124:127], a[152:155], v[88:91], v[124:127]
    v_exp_f32 v211, v139
    v_mfma_f32_16x16x32_bf16 v[124:127], a[156:159], v[92:95], v[124:127]
    ds_read_b64_tr_b16 a[208:209], v20 offset:51200
    v_cvt_pk_bf16_f32 v189, v210, v211
    v_mfma_f32_16x16x32_bf16 v[120:123], a[140:143], v[92:95], v[172:175]
    v_exp_f32 v208, v140
    v_mfma_f32_16x16x32_bf16 v[120:123], a[136:139], v[88:91], v[120:123]
    ds_read_b64_tr_b16 a[210:211], v20 offset:59392
    ds_read_b64_tr_b16 a[212:213], v21 offset:51200
    v_mfma_f32_16x16x32_bf16 v[120:123], a[132:135], v[84:87], v[120:123]
    v_exp_f32 v209, v141
    v_mfma_f32_16x16x32_bf16 v[120:123], a[128:131], v[80:83], v[120:123]
    ds_read_b64_tr_b16 a[214:215], v21 offset:59392
    v_cvt_pk_bf16_f32 v190, v208, v209
    v_mfma_f32_16x16x32_bf16 v[96:99], a[128:131], v[32:35], v[160:163]
    v_exp_f32 v210, v142
    v_mfma_f32_16x16x32_bf16 v[96:99], a[132:135], v[36:39], v[96:99]
    ds_read_b64_tr_b16 a[216:217], v22 offset:51200
    ds_read_b64_tr_b16 a[218:219], v22 offset:59392
    v_mfma_f32_16x16x32_bf16 v[96:99], a[136:139], v[40:43], v[96:99]
    v_exp_f32 v211, v143
    v_mfma_f32_16x16x32_bf16 v[96:99], a[140:143], v[44:47], v[96:99]
    ds_read_b64_tr_b16 a[220:221], v23 offset:51200
    v_cvt_pk_bf16_f32 v191, v210, v211
    v_mfma_f32_16x16x32_bf16 v[100:103], a[156:159], v[44:47], v[160:163]
    ds_read_b64_tr_b16 a[222:223], v23 offset:59392
    v_mov_b32 v232, v224
    v_mfma_f32_16x16x32_bf16 v[100:103], a[152:155], v[40:43], v[100:103]
    v_exp_f32 v208, v144
    v_mfma_f32_16x16x32_bf16 v[100:103], a[148:151], v[36:39], v[100:103]
    v_mfma_f32_16x16x32_bf16 v[100:103], a[144:147], v[32:35], v[100:103]
    v_exp_f32 v209, v145
    v_smfmac_f32_16x16x64_bf16 v[224:227], v[24:27], v[184:191], v235
    v_cvt_pk_bf16_f32 v200, v208, v209
    v_mfma_f32_16x16x32_bf16 v[108:111], a[144:147], v[48:51], v[164:167]
    s_add_u32 m0, s59, 133120
    s_add_u32 s56, s58, 8192
    v_exp_f32 v210, v146
    v_mfma_f32_16x16x32_bf16 v[108:111], a[148:151], v[52:55], v[108:111]
    buffer_load_dwordx4 v4, s[36:39], s56 offen lds
    v_mfma_f32_16x16x32_bf16 v[108:111], a[152:155], v[56:59], v[108:111]
    v_exp_f32 v211, v147
    v_mfma_f32_16x16x32_bf16 v[108:111], a[156:159], v[60:63], v[108:111]
    v_cvt_pk_bf16_f32 v201, v210, v211
    v_cmp_nle_f32 vcc, v224, v234
    v_mfma_f32_16x16x32_bf16 v[104:107], a[140:143], v[60:63], v[164:167]
    s_add_u32 m0, s59, 134144
    s_add_u32 s56, s58, 12288
    v_exp_f32 v208, v148
    v_mfma_f32_16x16x32_bf16 v[104:107], a[136:139], v[56:59], v[104:107]
    buffer_load_dwordx4 v5, s[36:39], s56 offen lds
    v_mfma_f32_16x16x32_bf16 v[104:107], a[132:135], v[52:55], v[104:107]
    v_exp_f32 v209, v149
    v_mfma_f32_16x16x32_bf16 v[104:107], a[128:131], v[48:51], v[104:107]
    s_waitcnt lgkmcnt(0)
    v_cvt_pk_bf16_f32 v202, v208, v209
    s_cbranch_vccnz L_slow0_f3
L_back0_f3:
    v_mfma_f32_16x16x32_bf16 a[0:3], a[160:163], v[176:179], a[0:3]
    v_exp_f32 v210, v150
    v_mfma_f32_16x16x32_bf16 a[0:3], a[192:195], v[184:187], a[0:3]
    ds_read_b128 a[128:131], v8 offset:49152
    ds_read_b128 a[132:135], v9 offset:49152
    v_mfma_f32_16x16x32_bf16 a[4:7], a[196:199], v[184:187], a[4:7]
    v_exp_f32 v211, v151
    v_mfma_f32_16x16x32_bf16 a[4:7], a[164:167], v[176:179], a[4:7]
    ds_read_b128 a[136:139], v10 offset:49152
    v_cvt_pk_bf16_f32 v203, v210, v211
    v_mfma_f32_16x16x32_bf16 a[8:11], a[168:171], v[176:179], a[8:11]
    v_exp_f32 v208, v152
    v_mfma_f32_16x16x32_bf16 a[8:11], a[200:203], v[184:187], a[8:11]
    ds_read_b128 a[140:143], v11 offset:49152
    ds_read_b128 a[144:147], v8 offset:57344
    v_mfma_f32_16x16x32_bf16 a[12:15], a[204:207], v[184:187], a[12:15]
    s_add_u32 s52, s52, 8192
    v_exp_f32 v209, v153
    v_mfma_f32_16x16x32_bf16 a[12:15], a[172:175], v[176:179], a[12:15]
    ds_read_b128 a[148:151], v9 offset:57344
    v_cvt_pk_bf16_f32 v204, v208, v209
    v_mfma_f32_16x16x32_bf16 a[16:19], a[176:179], v[176:179], a[16:19]
    s_add_u32 m0, s88, 16384
    v_exp_f32 v210, v154
    v_mfma_f32_16x16x32_bf16 a[16:19], a[208:211], v[184:187], a[16:19]
    buffer_load_dwordx4 v28, s[8:11], s52 offen offset:0 lds
    v_mfma_f32_16x16x32_bf16 a[20:23], a[212:215], v[184:187], a[20:23]
    v_exp_f32 v211, v155
    v_mfma_f32_16x16x32_bf16 a[20:23], a[180:183], v[176:179], a[20:23]
    ds_read_b128 a[152:155], v10 offset:57344
    v_cvt_pk_bf16_f32 v205, v210, v211
    v_mfma_f32_16x16x32_bf16 a[24:27], a[184:187], v[176:179], a[24:27]
    v_exp_f32 v208, v156
    v_mfma_f32_16x16x32_bf16 a[24:27], a[216:219], v[184:187], a[24:27]
    buffer_load_dwordx4 v29, s[8:11], s52 offen offset:1024 lds
    v_mfma_f32_16x16x32_bf16 a[28:31], a[220:223], v[184:187], a[28:31]
    v_exp_f32 v209, v157
    v_mfma_f32_16x16x32_bf16 a[28:31], a[188:191], v[176:179], a[28:31]
    ds_read_b128 a[156:159], v11 offset:57344
    v_cvt_pk_bf16_f32 v206, v208, v209
    v_mfma_f32_16x16x32_bf16 a[60:63], a[188:191], v[180:183], a[60:63]
    v_exp_f32 v210, v158
    v_mfma_f32_16x16x32_bf16 a[60:63], a[220:223], v[188:191], a[60:63]
    buffer_load_dwordx4 v30, s[12:15], s52 offen offset:2048 lds
    v_mfma_f32_16x16x32_bf16 a[56:59], a[216:219], v[188:191], a[56:59]
    v_exp_f32 v211, v159
    v_mfma_f32_16x16x32_bf16 a[56:59], a[184:187], v[180:183], a[56:59]
    v_cvt_pk_bf16_f32 v207, v210, v211
    v_mfma_f32_16x16x32_bf16 a[52:55], a[180:183], v[180:183], a[52:55]
    v_mov_b32 v233, v228
    v_mfma_f32_16x16x32_bf16 a[52:55], a[212:215], v[188:191], a[52:55]
    v_exp_f32 v208, v112
    v_mfma_f32_16x16x32_bf16 a[48:51], a[208:211], v[188:191], a[48:51]
    buffer_load_dwordx4 v31, s[12:15], s52 offen offset:3072 lds
    v_mfma_f32_16x16x32_bf16 a[48:51], a[176:179], v[180:183], a[48:51]
    v_exp_f32 v209, v113
    v_smfmac_f32_16x16x64_bf16 v[228:231], v[24:27], v[200:207], v235
    v_cvt_pk_bf16_f32 v192, v208, v209
    v_mfma_f32_16x16x32_bf16 a[44:47], a[172:175], v[180:183], a[44:47]
    v_exp_f32 v210, v114
    v_mfma_f32_16x16x32_bf16 a[44:47], a[204:207], v[188:191], a[44:47]
    v_mfma_f32_16x16x32_bf16 a[40:43], a[200:203], v[188:191], a[40:43]
    v_exp_f32 v211, v115
    v_mfma_f32_16x16x32_bf16 a[40:43], a[168:171], v[180:183], a[40:43]
    v_cvt_pk_bf16_f32 v193, v210, v211
    v_cmp_nle_f32 vcc, v228, v234
    v_mfma_f32_16x16x32_bf16 a[36:39], a[164:167], v[180:183], a[36:39]
    v_exp_f32 v208, v116
    v_mfma_f32_16x16x32_bf16 a[36:39], a[196:199], v[188:191], a[36:39]
    v_mfma_f32_16x16x32_bf16 a[32:35], a[192:195], v[188:191], a[32:35]
    v_exp_f32 v209, v117
    v_mfma_f32_16x16x32_bf16 a[32:35], a[160:163], v[180:183], a[32:35]
    s_waitcnt vmcnt(22) lgkmcnt(0)
    s_barrier
    v_cvt_pk_bf16_f32 v194, v208, v209
    s_cbranch_vccnz L_slow1_f3
L_back1_f3:
    v_mfma_f32_16x16x32_bf16 v[128:131], a[128:131], v[32:35], v[160:163]
    v_exp_f32 v210, v118
    v_mfma_f32_16x16x32_bf16 v[128:131], a[132:135], v[36:39], v[128:131]
    ds_read_b64_tr_b16 a[160:161], v244 offset:2048
    ds_read_b64_tr_b16 a[162:163], v244 offset:10240
    v_mfma_f32_16x16x32_bf16 v[128:131], a[136:139], v[40:43], v[128:131]
    v_exp_f32 v211, v119
    v_mfma_f32_16x16x32_bf16 v[128:131], a[140:143], v[44:47], v[128:131]
    ds_read_b64_tr_b16 a[164:165], v245 offset:2048
    v_cvt_pk_bf16_f32 v195, v210, v211
    v_mfma_f32_16x16x32_bf16 v[132:135], a[156:159], v[44:47], v[160:163]
    v_exp_f32 v208, v120
    v_mfma_f32_16x16x32_bf16 v[132:135], a[152:155], v[40:43], v[132:135]
    ds_read_b64_tr_b16 a[166:167], v245 offset:10240
    ds_read_b64_tr_b16 a[168:169], v246 offset:2048
    v_mfma_f32_16x16x32_bf16 v[132:135], a[148:151], v[36:39], v[132:135]
    v_exp_f32 v209, v121
    v_mfma_f32_16x16x32_bf16 v[132:135], a[144:147], v[32:35], v[132:135]
    ds_read_b64_tr_b16 a[170:171], v246 offset:10240
    v_cvt_pk_bf16_f32 v196, v208, v209
    v_mfma_f32_16x16x32_bf16 v[140:143], a[144:147], v[48:51], v[164:167]
    v_exp_f32 v210, v122
    v_mfma_f32_16x16x32_bf16 v[140:143], a[148:151], v[52:55], v[140:143]
    ds_read_b64_tr_b16 a[172:173], v247 offset:2048
    ds_read_b64_tr_b16 a[174:175], v247 offset:10240
    v_mfma_f32_16x16x32_bf16 v[140:143], a[152:155], v[56:59], v[140:143]
    v_exp_f32 v211, v123
    v_mfma_f32_16x16x32_bf16 v[140:143], a[156:159], v[60:63], v[140:143]
    ds_read_b64_tr_b16 a[176:177], v248 offset:2048
    v_cvt_pk_bf16_f32 v197, v210, v211
    v_mfma_f32_16x16x32_bf16 v[136:139], a[140:143], v[60:63], v[164:167]
    v_exp_f32 v208, v124
    v_mfma_f32_16x16x32_bf16 v[136:139], a[136:139], v[56:59], v[136:139]
    ds_read_b64_tr_b16 a[178:179], v248 offset:10240
    ds_read_b64_tr_b16 a[180:181], v249 offset:2048
    v_mfma_f32_16x16x32_bf16 v[136:139], a[132:135], v[52:55], v[136:139]
    v_exp_f32 v209, v125
    v_mfma_f32_16x16x32_bf16 v[136:139], a[128:131], v[48:51], v[136:139]
    ds_read_b64_tr_b16 a[182:183], v249 offset:10240
    v_cvt_pk_bf16_f32 v198, v208, v209
    v_mfma_f32_16x16x32_bf16 v[144:147], a[128:131], v[64:67], v[168:171]
    v_exp_f32 v210, v126
    v_mfma_f32_16x16x32_bf16 v[144:147], a[132:135], v[68:71], v[144:147]
    ds_read_b64_tr_b16 a[184:185], v250 offset:2048
    ds_read_b64_tr_b16 a[186:187], v250 offset:10240
    v_mfma_f32_16x16x32_bf16 v[144:147], a[136:139], v[72:75], v[144:147]
    v_exp_f32 v211, v127
    v_mfma_f32_16x16x32_bf16 v[144:147], a[140:143], v[76:79], v[144:147]
    ds_read_b64_tr_b16 a[188:189], v251 offset:2048
    v_cvt_pk_bf16_f32 v199, v210, v211
    v_mfma_f32_16x16x32_bf16 v[148:151], a[156:159], v[76:79], v[168:171]
    ds_read_b64_tr_b16 a[190:191], v251 offset:10240
    v_mov_b32 v233, v228
    v_mfma_f32_16x16x32_bf16 v[148:151], a[152:155], v[72:75], v[148:151]
    v_exp_f32 v208, v96
    v_mfma_f32_16x16x32_bf16 v[148:151], a[148:151], v[68:71], v[148:151]
    v_mfma_f32_16x16x32_bf16 v[148:151], a[144:147], v[64:67], v[148:151]
    v_exp_f32 v209, v97
    v_smfmac_f32_16x16x64_bf16 v[228:231], v[24:27], v[192:199], v235
    v_cvt_pk_bf16_f32 v176, v208, v209
    v_mfma_f32_16x16x32_bf16 v[156:159], a[144:147], v[80:83], v[172:175]
    s_add_u32 m0, s59, 135168
    s_add_u32 s56, s58, 16384
    v_exp_f32 v210, v98
    v_mfma_f32_16x16x32_bf16 v[156:159], a[148:151], v[84:87], v[156:159]
    buffer_load_dwordx4 v4, s[36:39], s56 offen lds
    v_mfma_f32_16x16x32_bf16 v[156:159], a[152:155], v[88:91], v[156:159]
    v_exp_f32 v211, v99
    v_mfma_f32_16x16x32_bf16 v[156:159], a[156:159], v[92:95], v[156:159]
    v_cvt_pk_bf16_f32 v177, v210, v211
    v_cmp_nle_f32 vcc, v228, v234
    v_mfma_f32_16x16x32_bf16 v[152:155], a[140:143], v[92:95], v[172:175]
    s_add_u32 m0, s59, 136192
    s_add_u32 s56, s58, 20480
    v_exp_f32 v208, v100
    v_mfma_f32_16x16x32_bf16 v[152:155], a[136:139], v[88:91], v[152:155]
    buffer_load_dwordx4 v5, s[36:39], s56 offen lds
    v_mfma_f32_16x16x32_bf16 v[152:155], a[132:135], v[84:87], v[152:155]
    v_exp_f32 v209, v101
    v_mfma_f32_16x16x32_bf16 v[152:155], a[128:131], v[80:83], v[152:155]
    s_waitcnt lgkmcnt(0)
    v_cvt_pk_bf16_f32 v178, v208, v209
    s_cbranch_vccnz L_slow0_f4
L_back0_f4:
    v_mfma_f32_16x16x32_bf16 a[64:67], a[192:195], v[200:203], a[64:67]
    v_exp_f32 v210, v102
    v_mfma_f32_16x16x32_bf16 a[64:67], a[160:163], v[192:195], a[64:67]
    ds_read_b128 a[128:131], v12 offset:0
    ds_read_b128 a[132:135], v13 offset:0
    v_mfma_f32_16x16x32_bf16 a[68:71], a[164:167], v[192:195], a[68:71]
    v_exp_f32 v211, v103
    v_mfma_f32_16x16x32_bf16 a[68:71], a[196:199], v[200:203], a[68:71]
    ds_read_b128 a[136:139], v14 offset:0
    v_cvt_pk_bf16_f32 v179, v210, v211
    v_mfma_f32_16x16x32_bf16 a[72:75], a[200:203], v[200:203], a[72:75]
    v_exp_f32 v208, v104
    v_mfma_f32_16x16x32_bf16 a[72:75], a[168:171], v[192:195], a[72:75]
    ds_read_b128 a[140:143], v15 offset:0
    ds_read_b128 a[144:147], v12 offset:8192
    v_mfma_f32_16x16x32_bf16 a[76:79], a[172:175], v[192:195], a[76:79]
    s_add_u32 s52, s52, 8192
    v_exp_f32 v209, v105
    v_mfma_f32_16x16x32_bf16 a[76:79], a[204:207], v[200:203], a[76:79]
    ds_read_b128 a[148:151], v13 offset:8192
    v_cvt_pk_bf16_f32 v180, v208, v209
    v_mfma_f32_16x16x32_bf16 a[80:83], a[208:211], v[200:203], a[80:83]
    s_add_u32 m0, s88, 32768
    v_exp_f32 v210, v106
    v_mfma_f32_16x16x32_bf16 a[80:83], a[176:179], v[192:195], a[80:83]
    buffer_load_dwordx4 v28, s[8:11], s52 offen offset:0 lds
    v_mfma_f32_16x16x32_bf16 a[84:87], a[180:183], v[192:195], a[84:87]
    v_exp_f32 v211, v107
    v_mfma_f32_16x16x32_bf16 a[84:87], a[212:215], v[200:203], a[84:87]
    ds_read_b128 a[152:155], v14 offset:8192
    v_cvt_pk_bf16_f32 v181, v210, v211
    v_mfma_f32_16x16x32_bf16 a[88:91], a[216:219], v[200:203], a[88:91]
    v_exp_f32 v208, v108
    v_mfma_f32_16x16x32_bf16 a[88:91], a[184:187], v[192:195], a[88:91]
    buffer_load_dwordx4 v29, s[8:11], s52 offen offset:1024 lds
    v_mfma_f32_16x16x32_bf16 a[92:95], a[188:191], v[192:195], a[92:95]
    v_exp_f32 v209, v109
    v_mfma_f32_16x16x32_bf16 a[92:95], a[220:223], v[200:203], a[92:95]
    ds_read_b128 a[156:159], v15 offset:8192
    v_cvt_pk_bf16_f32 v182, v208, v209
    v_mfma_f32_16x16x32_bf16 a[124:127], a[220:223], v[204:207], a[124:127]
    v_exp_f32 v210, v110
    v_mfma_f32_16x16x32_bf16 a[124:127], a[188:191], v[196:199], a[124:127]
    buffer_load_dwordx4 v30, s[12:15], s52 offen offset:2048 lds
    v_mfma_f32_16x16x32_bf16 a[120:123], a[184:187], v[196:199], a[120:123]
    v_exp_f32 v211, v111
    v_mfma_f32_16x16x32_bf16 a[120:123], a[216:219], v[204:207], a[120:123]
    v_cvt_pk_bf16_f32 v183, v210, v211
    v_mfma_f32_16x16x32_bf16 a[116:119], a[212:215], v[204:207], a[116:119]
    v_mov_b32 v232, v224
    v_mfma_f32_16x16x32_bf16 a[116:119], a[180:183], v[196:199], a[116:119]
    v_exp_f32 v208, v128
    v_mfma_f32_16x16x32_bf16 a[112:115], a[176:179], v[196:199], a[112:115]
    buffer_load_dwordx4 v31, s[12:15], s52 offen offset:3072 lds
    v_mfma_f32_16x16x32_bf16 a[112:115], a[208:211], v[204:207], a[112:115]
    v_exp_f32 v209, v129
    v_smfmac_f32_16x16x64_bf16 v[224:227], v[24:27], v[176:183], v235
    v_cvt_pk_bf16_f32 v184, v208, v209
    v_mfma_f32_16x16x32_bf16 a[108:111], a[204:207], v[204:207], a[108:111]
    v_exp_f32 v210, v130
    v_mfma_f32_16x16x32_bf16 a[108:111], a[172:175], v[196:199], a[108:111]
    v_mfma_f32_16x16x32_bf16 a[104:107], a[168:171], v[196:199], a[104:107]
    v_exp_f32 v211, v131
    v_mfma_f32_16x16x32_bf16 a[104:107], a[200:203], v[204:207], a[104:107]
    v_cvt_pk_bf16_f32 v185, v210, v211
    v_cmp_nle_f32 vcc, v224, v234
    v_mfma_f32_16x16x32_bf16 a[100:103], a[196:199], v[204:207], a[100:103]
    v_exp_f32 v208, v132
    v_mfma_f32_16x16x32_bf16 a[100:103], a[164:167], v[196:199], a[100:103]
    v_mfma_f32_16x16x32_bf16 a[96:99], a[160:163], v[196:199], a[96:99]
    v_exp_f32 v209, v133
    v_mfma_f32_16x16x32_bf16 a[96:99], a[192:195], v[204:207], a[96:99]
    s_waitcnt lgkmcnt(0)
    v_cvt_pk_bf16_f32 v186, v208, v209
    s_cbranch_vccnz L_slow1_f4
L_back1_f4:
    v_mfma_f32_16x16x32_bf16 v[112:115], a[128:131], v[64:67], v[168:171]
    v_exp_f32 v210, v134
    v_mfma_f32_16x16x32_bf16 v[112:115], a[132:135], v[68:71], v[112:115]
    ds_read_b64_tr_b16 a[192:193], v244 offset:18432
    ds_read_b64_tr_b16 a[194:195], v244 offset:26624
    v_mfma_f32_16x16x32_bf16 v[112:115], a[136:139], v[72:75], v[112:115]
    v_exp_f32 v211, v135
    v_mfma_f32_16x16x32_bf16 v[112:115], a[140:143], v[76:79], v[112:115]
    ds_read_b64_tr_b16 a[196:197], v245 offset:18432
    v_cvt_pk_bf16_f32 v187, v210, v211
    v_mfma_f32_16x16x32_bf16 v[116:119], a[156:159], v[76:79], v[168:171]
    v_exp_f32 v208, v136
    v_mfma_f32_16x16x32_bf16 v[116:119], a[152:155], v[72:75], v[116:119]
    ds_read_b64_tr_b16 a[198:199], v245 offset:26624
    ds_read_b64_tr_b16 a[200:201], v246 offset:18432
    v_mfma_f32_16x16x32_bf16 v[116:119], a[148:151], v[68:71], v[116:119]
    v_exp_f32 v209, v137
    v_mfma_f32_16x16x32_bf16 v[116:119], a[144:147], v[64:67], v[116:119]
    ds_read_b64_tr_b16 a[202:203], v246 offset:26624
    v_cvt_pk_bf16_f32 v188, v208, v209
    v_mfma_f32_16x16x32_bf16 v[124:127], a[144:147], v[80:83], v[172:175]
    v_exp_f32 v210, v138
    v_mfma_f32_16x16x32_bf16 v[124:127], a[148:151], v[84:87], v[124:127]
    ds_read_b64_tr_b16 a[204:205], v247 offset:18432
    ds_read_b64_tr_b16 a[206:207], v247 offset:26624
    v_mfma_f32_16x16x32_bf16 v[124:127], a[152:155], v[88:91], v[124:127]
    v_exp_f32 v211, v139
    v_mfma_f32_16x16x32_bf16 v[124:127], a[156:159], v[92:95], v[124:127]
    ds_read_b64_tr_b16 a[208:209], v248 offset:18432
    v_cvt_pk_bf16_f32 v189, v210, v211
    v_mfma_f32_16x16x32_bf16 v[120:123], a[140:143], v[92:95], v[172:175]
    v_exp_f32 v208, v140
    v_mfma_f32_16x16x32_bf16 v[120:123], a[136:139], v[88:91], v[120:123]
    ds_read_b64_tr_b16 a[210:211], v248 offset:26624
    ds_read_b64_tr_b16 a[212:213], v249 offset:18432
    v_mfma_f32_16x16x32_bf16 v[120:123], a[132:135], v[84:87], v[120:123]
    v_exp_f32 v209, v141
    v_mfma_f32_16x16x32_bf16 v[120:123], a[128:131], v[80:83], v[120:123]
    ds_read_b64_tr_b16 a[214:215], v249 offset:26624
    v_cvt_pk_bf16_f32 v190, v208, v209
    v_mfma_f32_16x16x32_bf16 v[96:99], a[128:131], v[32:35], v[160:163]
    v_exp_f32 v210, v142
    v_mfma_f32_16x16x32_bf16 v[96:99], a[132:135], v[36:39], v[96:99]
    ds_read_b64_tr_b16 a[216:217], v250 offset:18432
    ds_read_b64_tr_b16 a[218:219], v250 offset:26624
    v_mfma_f32_16x16x32_bf16 v[96:99], a[136:139], v[40:43], v[96:99]
    v_exp_f32 v211, v143
    v_mfma_f32_16x16x32_bf16 v[96:99], a[140:143], v[44:47], v[96:99]
    ds_read_b64_tr_b16 a[220:221], v251 offset:18432
    v_cvt_pk_bf16_f32 v191, v210, v211
    v_mfma_f32_16x16x32_bf16 v[100:103], a[156:159], v[44:47], v[160:163]
    ds_read_b64_tr_b16 a[222:223], v251 offset:26624
    v_mov_b32 v232, v224
    v_mfma_f32_16x16x32_bf16 v[100:103], a[152:155], v[40:43], v[100:103]
    v_exp_f32 v208, v144
    v_mfma_f32_16x16x32_bf16 v[100:103], a[148:151], v[36:39], v[100:103]
    v_mfma_f32_16x16x32_bf16 v[100:103], a[144:147], v[32:35], v[100:103]
    v_exp_f32 v209, v145
    v_smfmac_f32_16x16x64_bf16 v[224:227], v[24:27], v[184:191], v235
    v_cvt_pk_bf16_f32 v200, v208, v209
    v_mfma_f32_16x16x32_bf16 v[108:111], a[144:147], v[48:51], v[164:167]
    s_add_u32 m0, s59, 137216
    s_add_u32 s56, s58, 24576
    v_exp_f32 v210, v146
    v_mfma_f32_16x16x32_bf16 v[108:111], a[148:151], v[52:55], v[108:111]
    buffer_load_dwordx4 v4, s[36:39], s56 offen lds
    v_mfma_f32_16x16x32_bf16 v[108:111], a[152:155], v[56:59], v[108:111]
    v_exp_f32 v211, v147
    v_mfma_f32_16x16x32_bf16 v[108:111], a[156:159], v[60:63], v[108:111]
    v_cvt_pk_bf16_f32 v201, v210, v211
    v_cmp_nle_f32 vcc, v224, v234
    v_mfma_f32_16x16x32_bf16 v[104:107], a[140:143], v[60:63], v[164:167]
    s_add_u32 m0, s59, 138240
    s_add_u32 s56, s58, 28672
    v_exp_f32 v208, v148
    v_mfma_f32_16x16x32_bf16 v[104:107], a[136:139], v[56:59], v[104:107]
    buffer_load_dwordx4 v5, s[36:39], s56 offen lds
    v_mfma_f32_16x16x32_bf16 v[104:107], a[132:135], v[52:55], v[104:107]
    v_exp_f32 v209, v149
    v_mfma_f32_16x16x32_bf16 v[104:107], a[128:131], v[48:51], v[104:107]
    s_waitcnt lgkmcnt(0)
    v_cvt_pk_bf16_f32 v202, v208, v209
    s_cbranch_vccnz L_slow0_f5
L_back0_f5:
    v_mfma_f32_16x16x32_bf16 a[0:3], a[160:163], v[176:179], a[0:3]
    v_exp_f32 v210, v150
    v_mfma_f32_16x16x32_bf16 a[0:3], a[192:195], v[184:187], a[0:3]
    ds_read_b128 a[128:131], v12 offset:16384
    ds_read_b128 a[132:135], v13 offset:16384
    v_mfma_f32_16x16x32_bf16 a[4:7], a[196:199], v[184:187], a[4:7]
    v_exp_f32 v211, v151
    v_mfma_f32_16x16x32_bf16 a[4:7], a[164:167], v[176:179], a[4:7]
    ds_read_b128 a[136:139], v14 offset:16384
    v_cvt_pk_bf16_f32 v203, v210, v211
    v_mfma_f32_16x16x32_bf16 a[8:11], a[168:171], v[176:179], a[8:11]
    v_exp_f32 v208, v152
    v_mfma_f32_16x16x32_bf16 a[8:11], a[200:203], v[184:187], a[8:11]
    ds_read_b128 a[140:143], v15 offset:16384
    ds_read_b128 a[144:147], v12 offset:24576
    v_mfma_f32_16x16x32_bf16 a[12:15], a[204:207], v[184:187], a[12:15]
    s_add_u32 s52, s52, 8192
    v_exp_f32 v209, v153
    v_mfma_f32_16x16x32_bf16 a[12:15], a[172:175], v[176:179], a[12:15]
    ds_read_b128 a[148:151], v13 offset:24576
    v_cvt_pk_bf16_f32 v204, v208, v209
    v_mfma_f32_16x16x32_bf16 a[16:19], a[176:179], v[176:179], a[16:19]
    s_add_u32 m0, s88, 49152
    v_exp_f32 v210, v154
    v_mfma_f32_16x16x32_bf16 a[16:19], a[208:211], v[184:187], a[16:19]
    buffer_load_dwordx4 v28, s[8:11], s52 offen offset:0 lds
    v_mfma_f32_16x16x32_bf16 a[20:23], a[212:215], v[184:187], a[20:23]
    v_exp_f32 v211, v155
    v_mfma_f32_16x16x32_bf16 a[20:23], a[180:183], v[176:179], a[20:23]
    ds_read_b128 a[152:155], v14 offset:24576
    v_cvt_pk_bf16_f32 v205, v210, v211
    v_mfma_f32_16x16x32_bf16 a[24:27], a[184:187], v[176:179], a[24:27]
    v_exp_f32 v208, v156
    v_mfma_f32_16x16x32_bf16 a[24:27], a[216:219], v[184:187], a[24:27]
    buffer_load_dwordx4 v29, s[8:11], s52 offen offset:1024 lds
    v_mfma_f32_16x16x32_bf16 a[28:31], a[220:223], v[184:187], a[28:31]
    v_exp_f32 v209, v157
    v_mfma_f32_16x16x32_bf16 a[28:31], a[188:191], v[176:179], a[28:31]
    ds_read_b128 a[156:159], v15 offset:24576
    v_cvt_pk_bf16_f32 v206, v208, v209
    v_mfma_f32_16x16x32_bf16 a[60:63], a[188:191], v[180:183], a[60:63]
    v_exp_f32 v210, v158
    v_mfma_f32_16x16x32_bf16 a[60:63], a[220:223], v[188:191], a[60:63]
    buffer_load_dwordx4 v30, s[12:15], s52 offen offset:2048 lds
    v_mfma_f32_16x16x32_bf16 a[56:59], a[216:219], v[188:191], a[56:59]
    v_exp_f32 v211, v159
    v_mfma_f32_16x16x32_bf16 a[56:59], a[184:187], v[180:183], a[56:59]
    v_cvt_pk_bf16_f32 v207, v210, v211
    v_mfma_f32_16x16x32_bf16 a[52:55], a[180:183], v[180:183], a[52:55]
    v_mov_b32 v233, v228
    v_mfma_f32_16x16x32_bf16 a[52:55], a[212:215], v[188:191], a[52:55]
    v_exp_f32 v208, v112
    v_mfma_f32_16x16x32_bf16 a[48:51], a[208:211], v[188:191], a[48:51]
    buffer_load_dwordx4 v31, s[12:15], s52 offen offset:3072 lds
    v_mfma_f32_16x16x32_bf16 a[48:51], a[176:179], v[180:183], a[48:51]
    v_exp_f32 v209, v113
    v_smfmac_f32_16x16x64_bf16 v[228:231], v[24:27], v[200:207], v235
    v_cvt_pk_bf16_f32 v192, v208, v209
    v_mfma_f32_16x16x32_bf16 a[44:47], a[172:175], v[180:183], a[44:47]
    v_exp_f32 v210, v114
    v_mfma_f32_16x16x32_bf16 a[44:47], a[204:207], v[188:191], a[44:47]
    v_mfma_f32_16x16x32_bf16 a[40:43], a[200:203], v[188:191], a[40:43]
    v_exp_f32 v211, v115
    v_mfma_f32_16x16x32_bf16 a[40:43], a[168:171], v[180:183], a[40:43]
    v_cvt_pk_bf16_f32 v193, v210, v211
    v_cmp_nle_f32 vcc, v228, v234
    v_mfma_f32_16x16x32_bf16 a[36:39], a[164:167], v[180:183], a[36:39]
    s_add_u32 s91, s91, 58368
    v_exp_f32 v208, v116
    v_mfma_f32_16x16x32_bf16 a[36:39], a[196:199], v[188:191], a[36:39]
    buffer_store_dwordx4 a[232:235], v7, s[28:31], s91 offen offset:0 sc1
    v_mfma_f32_16x16x32_bf16 a[32:35], a[192:195], v[188:191], a[32:35]
    v_exp_f32 v209, v117
    v_mfma_f32_16x16x32_bf16 a[32:35], a[160:163], v[180:183], a[32:35]
    s_waitcnt vmcnt(26) lgkmcnt(0)
    s_barrier
    v_cvt_pk_bf16_f32 v194, v208, v209
    s_cbranch_vccnz L_slow1_f5
L_back1_f5:
    v_mfma_f32_16x16x32_bf16 v[128:131], a[128:131], v[32:35], v[160:163]
    v_exp_f32 v210, v118
    v_mfma_f32_16x16x32_bf16 v[128:131], a[132:135], v[36:39], v[128:131]
    ds_read_b64_tr_b16 a[160:161], v244 offset:34816
    ds_read_b64_tr_b16 a[162:163], v244 offset:43008
    v_mfma_f32_16x16x32_bf16 v[128:131], a[136:139], v[40:43], v[128:131]
    v_exp_f32 v211, v119
    v_mfma_f32_16x16x32_bf16 v[128:131], a[140:143], v[44:47], v[128:131]
    ds_read_b64_tr_b16 a[164:165], v245 offset:34816
    v_cvt_pk_bf16_f32 v195, v210, v211
    v_mfma_f32_16x16x32_bf16 v[132:135], a[156:159], v[44:47], v[160:163]
    v_exp_f32 v208, v120
    v_mfma_f32_16x16x32_bf16 v[132:135], a[152:155], v[40:43], v[132:135]
    ds_read_b64_tr_b16 a[166:167], v245 offset:43008
    ds_read_b64_tr_b16 a[168:169], v246 offset:34816
    v_mfma_f32_16x16x32_bf16 v[132:135], a[148:151], v[36:39], v[132:135]
    v_exp_f32 v209, v121
    v_mfma_f32_16x16x32_bf16 v[132:135], a[144:147], v[32:35], v[132:135]
    ds_read_b64_tr_b16 a[170:171], v246 offset:43008
    v_cvt_pk_bf16_f32 v196, v208, v209
    v_mfma_f32_16x16x32_bf16 v[140:143], a[144:147], v[48:51], v[164:167]
    v_exp_f32 v210, v122
    v_mfma_f32_16x16x32_bf16 v[140:143], a[148:151], v[52:55], v[140:143]
    ds_read_b64_tr_b16 a[172:173], v247 offset:34816
    ds_read_b64_tr_b16 a[174:175], v247 offset:43008
    v_mfma_f32_16x16x32_bf16 v[140:143], a[152:155], v[56:59], v[140:143]
    v_exp_f32 v211, v123
    v_mfma_f32_16x16x32_bf16 v[140:143], a[156:159], v[60:63], v[140:143]
    ds_read_b64_tr_b16 a[176:177], v248 offset:34816
    v_cvt_pk_bf16_f32 v197, v210, v211
    v_mfma_f32_16x16x32_bf16 v[136:139], a[140:143], v[60:63], v[164:167]
    v_exp_f32 v208, v124
    v_mfma_f32_16x16x32_bf16 v[136:139], a[136:139], v[56:59], v[136:139]
    ds_read_b64_tr_b16 a[178:179], v248 offset:43008
    ds_read_b64_tr_b16 a[180:181], v249 offset:34816
    v_mfma_f32_16x16x32_bf16 v[136:139], a[132:135], v[52:55], v[136:139]
    v_exp_f32 v209, v125
    v_mfma_f32_16x16x32_bf16 v[136:139], a[128:131], v[48:51], v[136:139]
    ds_read_b64_tr_b16 a[182:183], v249 offset:43008
    v_cvt_pk_bf16_f32 v198, v208, v209
    v_mfma_f32_16x16x32_bf16 v[144:147], a[128:131], v[64:67], v[168:171]
    v_exp_f32 v210, v126
    v_mfma_f32_16x16x32_bf16 v[144:147], a[132:135], v[68:71], v[144:147]
    ds_read_b64_tr_b16 a[184:185], v250 offset:34816
    ds_read_b64_tr_b16 a[186:187], v250 offset:43008
    v_mfma_f32_16x16x32_bf16 v[144:147], a[136:139], v[72:75], v[144:147]
    v_exp_f32 v211, v127
    v_mfma_f32_16x16x32_bf16 v[144:147], a[140:143], v[76:79], v[144:147]
    ds_read_b64_tr_b16 a[188:189], v251 offset:34816
    v_cvt_pk_bf16_f32 v199, v210, v211
    v_mfma_f32_16x16x32_bf16 v[148:151], a[156:159], v[76:79], v[168:171]
    ds_read_b64_tr_b16 a[190:191], v251 offset:43008
    v_mov_b32 v233, v228
    v_mfma_f32_16x16x32_bf16 v[148:151], a[152:155], v[72:75], v[148:151]
    v_exp_f32 v208, v96
    v_mfma_f32_16x16x32_bf16 v[148:151], a[148:151], v[68:71], v[148:151]
    v_mfma_f32_16x16x32_bf16 v[148:151], a[144:147], v[64:67], v[148:151]
    v_exp_f32 v209, v97
    v_smfmac_f32_16x16x64_bf16 v[228:231], v[24:27], v[192:199], v235
    v_cvt_pk_bf16_f32 v176, v208, v209
    v_mfma_f32_16x16x32_bf16 v[156:159], a[144:147], v[80:83], v[172:175]
    v_exp_f32 v210, v98
    v_mfma_f32_16x16x32_bf16 v[156:159], a[148:151], v[84:87], v[156:159]
    v_mfma_f32_16x16x32_bf16 v[156:159], a[152:155], v[88:91], v[156:159]
    v_exp_f32 v211, v99
    v_mfma_f32_16x16x32_bf16 v[156:159], a[156:159], v[92:95], v[156:159]
    v_cvt_pk_bf16_f32 v177, v210, v211
    v_cmp_nle_f32 vcc, v228, v234
    v_mfma_f32_16x16x32_bf16 v[152:155], a[140:143], v[92:95], v[172:175]
    v_exp_f32 v208, v100
    v_mfma_f32_16x16x32_bf16 v[152:155], a[136:139], v[88:91], v[152:155]
    v_mfma_f32_16x16x32_bf16 v[152:155], a[132:135], v[84:87], v[152:155]
    v_exp_f32 v209, v101
    v_mfma_f32_16x16x32_bf16 v[152:155], a[128:131], v[80:83], v[152:155]
    s_waitcnt lgkmcnt(0)
    v_cvt_pk_bf16_f32 v178, v208, v209
    s_cbranch_vccnz L_slow0_f6
L_back0_f6:
    v_mfma_f32_16x16x32_bf16 a[64:67], a[192:195], v[200:203], a[64:67]
    v_exp_f32 v210, v102
    v_mfma_f32_16x16x32_bf16 a[64:67], a[160:163], v[192:195], a[64:67]
L_pad5:
    s_cbranch_execz L_pad9
    ds_read_b128 a[128:131], v12 offset:32768
    ds_read_b128 a[132:135], v13 offset:32768
    v_mfma_f32_16x16x32_bf16 a[68:71], a[164:167], v[192:195], a[68:71]
    v_exp_f32 v211, v103
    v_mfma_f32_16x16x32_bf16 a[68:71], a[196:199], v[200:203], a[68:71]
    ds_read_b128 a[136:139], v14 offset:32768
    v_cvt_pk_bf16_f32 v179, v210, v211
    v_mfma_f32_16x16x32_bf16 a[72:75], a[200:203], v[200:203], a[72:75]
    v_exp_f32 v208, v104
    v_mfma_f32_16x16x32_bf16 a[72:75], a[168:171], v[192:195], a[72:75]
    ds_read_b128 a[140:143], v15 offset:32768
    ds_read_b128 a[144:147], v12 offset:40960
    v_mfma_f32_16x16x32_bf16 a[76:79], a[172:175], v[192:195], a[76:79]
    s_add_u32 s52, s52, 8192
    v_exp_f32 v209, v105
    v_mfma_f32_16x16x32_bf16 a[76:79], a[204:207], v[200:203], a[76:79]
    ds_read_b128 a[148:151], v13 offset:40960
    v_cvt_pk_bf16_f32 v180, v208, v209
    v_mfma_f32_16x16x32_bf16 a[80:83], a[208:211], v[200:203], a[80:83]
    s_add_u32 m0, s88, 65536
    v_exp_f32 v210, v106
    v_mfma_f32_16x16x32_bf16 a[80:83], a[176:179], v[192:195], a[80:83]
    buffer_load_dwordx4 v28, s[8:11], s52 offen offset:0 lds
    v_mfma_f32_16x16x32_bf16 a[84:87], a[180:183], v[192:195], a[84:87]
    v_exp_f32 v211, v107
    v_mfma_f32_16x16x32_bf16 a[84:87], a[212:215], v[200:203], a[84:87]
    ds_read_b128 a[152:155], v14 offset:40960
    v_cvt_pk_bf16_f32 v181, v210, v211
    v_mfma_f32_16x16x32_bf16 a[88:91], a[216:219], v[200:203], a[88:91]
    v_exp_f32 v208, v108
    v_mfma_f32_16x16x32_bf16 a[88:91], a[184:187], v[192:195], a[88:91]
    buffer_load_dwordx4 v29, s[8:11], s52 offen offset:1024 lds
    v_mfma_f32_16x16x32_bf16 a[92:95], a[188:191], v[192:195], a[92:95]
    v_exp_f32 v209, v109
    v_mfma_f32_16x16x32_bf16 a[92:95], a[220:223], v[200:203], a[92:95]
    ds_read_b128 a[156:159], v15 offset:40960
    v_cvt_pk_bf16_f32 v182, v208, v209
    v_mfma_f32_16x16x32_bf16 a[124:127], a[220:223], v[204:207], a[124:127]
    v_exp_f32 v210, v110
    v_mfma_f32_16x16x32_bf16 a[124:127], a[188:191], v[196:199], a[124:127]
    buffer_load_dwordx4 v30, s[12:15], s52 offen offset:2048 lds
    v_mfma_f32_16x16x32_bf16 a[120:123], a[184:187], v[196:199], a[120:123]
    v_exp_f32 v211, v111
    v_mfma_f32_16x16x32_bf16 a[120:123], a[216:219], v[204:207], a[120:123]
    v_cvt_pk_bf16_f32 v183, v210, v211
    v_mfma_f32_16x16x32_bf16 a[116:119], a[212:215], v[204:207], a[116:119]
    v_mov_b32 v232, v224
    v_mfma_f32_16x16x32_bf16 a[116:119], a[180:183], v[196:199], a[116:119]
    v_exp_f32 v208, v128
    v_mfma_f32_16x16x32_bf16 a[112:115], a[176:179], v[196:199], a[112:115]
    buffer_load_dwordx4 v31, s[12:15], s52 offen offset:3072 lds
    v_mfma_f32_16x16x32_bf16 a[112:115], a[208:211], v[204:207], a[112:115]
    v_exp_f32 v209, v129
    v_smfmac_f32_16x16x64_bf16 v[224:227], v[24:27], v[176:183], v235
    v_cvt_pk_bf16_f32 v184, v208, v209
    v_mfma_f32_16x16x32_bf16 a[108:111], a[204:207], v[204:207], a[108:111]
    v_exp_f32 v210, v130
    v_mfma_f32_16x16x32_bf16 a[108:111], a[172:175], v[196:199], a[108:111]
    buffer_store_dwordx4 a[236:239], v7, s[28:31], s91 offen offset:1024 sc1
    v_mfma_f32_16x16x32_bf16 a[104:107], a[168:171], v[196:199], a[104:107]
    v_exp_f32 v211, v131
    v_mfma_f32_16x16x32_bf16 a[104:107], a[200:203], v[204:207], a[104:107]
    v_cvt_pk_bf16_f32 v185, v210, v211
    v_cmp_nle_f32 vcc, v224, v234
    v_mfma_f32_16x16x32_bf16 a[100:103], a[196:199], v[204:207], a[100:103]
    s_add_u32 s91, s91, 58368
    v_exp_f32 v208, v132
    v_mfma_f32_16x16x32_bf16 a[100:103], a[164:167], v[196:199], a[100:103]
    buffer_store_dwordx4 a[240:243], v7, s[28:31], s91 offen offset:0 sc1
    v_mfma_f32_16x16x32_bf16 a[96:99], a[160:163], v[196:199], a[96:99]
    v_exp_f32 v209, v133
    v_mfma_f32_16x16x32_bf16 a[96:99], a[192:195], v[204:207], a[96:99]
    s_waitcnt lgkmcnt(0)
    v_cvt_pk_bf16_f32 v186, v208, v209
    s_cbranch_vccnz L_slow1_f6
L_back1_f6:
    v_mfma_f32_16x16x32_bf16 v[112:115], a[128:131], v[64:67], v[168:171]
    v_exp_f32 v210, v134
    v_mfma_f32_16x16x32_bf16 v[112:115], a[132:135], v[68:71], v[112:115]
    ds_read_b64_tr_b16 a[192:193], v244 offset:51200
    ds_read_b64_tr_b16 a[194:195], v244 offset:59392
    v_mfma_f32_16x16x32_bf16 v[112:115], a[136:139], v[72:75], v[112:115]
    v_exp_f32 v211, v135
    v_mfma_f32_16x16x32_bf16 v[112:115], a[140:143], v[76:79], v[112:115]
    ds_read_b64_tr_b16 a[196:197], v245 offset:51200
    v_cvt_pk_bf16_f32 v187, v210, v211
    v_mfma_f32_16x16x32_bf16 v[116:119], a[156:159], v[76:79], v[168:171]
    v_exp_f32 v208, v136
    v_mfma_f32_16x16x32_bf16 v[116:119], a[152:155], v[72:75], v[116:119]
    ds_read_b64_tr_b16 a[198:199], v245 offset:59392
    ds_read_b64_tr_b16 a[200:201], v246 offset:51200
    v_mfma_f32_16x16x32_bf16 v[116:119], a[148:151], v[68:71], v[116:119]
    v_exp_f32 v209, v137
    v_mfma_f32_16x16x32_bf16 v[116:119], a[144:147], v[64:67], v[116:119]
    ds_read_b64_tr_b16 a[202:203], v246 offset:59392
    v_cvt_pk_bf16_f32 v188, v208, v209
    v_mfma_f32_16x16x32_bf16 v[124:127], a[144:147], v[80:83], v[172:175]
    v_exp_f32 v210, v138
    v_mfma_f32_16x16x32_bf16 v[124:127], a[148:151], v[84:87], v[124:127]
    ds_read_b64_tr_b16 a[204:205], v247 offset:51200
    ds_read_b64_tr_b16 a[206:207], v247 offset:59392
    v_mfma_f32_16x16x32_bf16 v[124:127], a[152:155], v[88:91], v[124:127]
    v_exp_f32 v211, v139
    v_mfma_f32_16x16x32_bf16 v[124:127], a[156:159], v[92:95], v[124:127]
    ds_read_b64_tr_b16 a[208:209], v248 offset:51200
    v_cvt_pk_bf16_f32 v189, v210, v211
    v_mfma_f32_16x16x32_bf16 v[120:123], a[140:143], v[92:95], v[172:175]
    v_exp_f32 v208, v140
    v_mfma_f32_16x16x32_bf16 v[120:123], a[136:139], v[88:91], v[120:123]
    ds_read_b64_tr_b16 a[210:211], v248 offset:59392
    ds_read_b64_tr_b16 a[212:213], v249 offset:51200
    v_mfma_f32_16x16x32_bf16 v[120:123], a[132:135], v[84:87], v[120:123]
    v_exp_f32 v209, v141
    v_mfma_f32_16x16x32_bf16 v[120:123], a[128:131], v[80:83], v[120:123]
    ds_read_b64_tr_b16 a[214:215], v249 offset:59392
    v_cvt_pk_bf16_f32 v190, v208, v209
    v_mfma_f32_16x16x32_bf16 v[96:99], a[128:131], v[32:35], v[160:163]
    v_exp_f32 v210, v142
    v_mfma_f32_16x16x32_bf16 v[96:99], a[132:135], v[36:39], v[96:99]
    ds_read_b64_tr_b16 a[216:217], v250 offset:51200
    ds_read_b64_tr_b16 a[218:219], v250 offset:59392
    v_mfma_f32_16x16x32_bf16 v[96:99], a[136:139], v[40:43], v[96:99]
    v_exp_f32 v211, v143
    v_mfma_f32_16x16x32_bf16 v[96:99], a[140:143], v[44:47], v[96:99]
    ds_read_b64_tr_b16 a[220:221], v251 offset:51200
    v_cvt_pk_bf16_f32 v191, v210, v211
    v_mfma_f32_16x16x32_bf16 v[100:103], a[156:159], v[44:47], v[160:163]
    ds_read_b64_tr_b16 a[222:223], v251 offset:59392
    v_mov_b32 v232, v224
    v_mfma_f32_16x16x32_bf16 v[100:103], a[152:155], v[40:43], v[100:103]
    v_exp_f32 v208, v144
    v_mfma_f32_16x16x32_bf16 v[100:103], a[148:151], v[36:39], v[100:103]
    v_lshrrev_b32 v240, 2, v1
    v_and_b32 v241, 7, v240
    v_mfma_f32_16x16x32_bf16 v[100:103], a[144:147], v[32:35], v[100:103]
    v_exp_f32 v209, v145
    v_smfmac_f32_16x16x64_bf16 v[224:227], v[24:27], v[184:191], v235
    v_cvt_pk_bf16_f32 v200, v208, v209
    v_lshlrev_b32 v240, 8, v240
    v_mfma_f32_16x16x32_bf16 v[108:111], a[144:147], v[48:51], v[164:167]
    v_exp_f32 v210, v146
    v_mfma_f32_16x16x32_bf16 v[108:111], a[148:151], v[52:55], v[108:111]
    v_lshl_add_u32 v240, v241, 5, v240
    v_and_b32 v241, 3, v1
    v_mfma_f32_16x16x32_bf16 v[108:111], a[152:155], v[56:59], v[108:111]
    v_exp_f32 v211, v147
    v_mfma_f32_16x16x32_bf16 v[108:111], a[156:159], v[60:63], v[108:111]
    v_cvt_pk_bf16_f32 v201, v210, v211
    v_cmp_nle_f32 vcc, v224, v234
    v_mfma_f32_16x16x32_bf16 v[104:107], a[140:143], v[60:63], v[164:167]
    v_exp_f32 v208, v148
    v_mfma_f32_16x16x32_bf16 v[104:107], a[136:139], v[56:59], v[104:107]
    v_lshlrev_b32 v241, 5, v241
    v_xor_b32 v240, v241, v240
    v_mfma_f32_16x16x32_bf16 v[104:107], a[132:135], v[52:55], v[104:107]
    v_exp_f32 v209, v149
    v_mfma_f32_16x16x32_bf16 v[104:107], a[128:131], v[48:51], v[104:107]
    s_waitcnt lgkmcnt(0)
    v_cvt_pk_bf16_f32 v202, v208, v209
    v_add_u32 v240, s59, v240
    s_cbranch_vccnz L_slow0_f7
L_back0_f7:
    v_mfma_f32_16x16x32_bf16 a[0:3], a[160:163], v[176:179], a[0:3]
    v_exp_f32 v210, v150
    v_mfma_f32_16x16x32_bf16 a[0:3], a[192:195], v[184:187], a[0:3]
    ds_read_b128 a[128:131], v12 offset:49152
    ds_read_b128 a[132:135], v13 offset:49152
    v_mfma_f32_16x16x32_bf16 a[4:7], a[196:199], v[184:187], a[4:7]
    v_exp_f32 v211, v151
    v_mfma_f32_16x16x32_bf16 a[4:7], a[164:167], v[176:179], a[4:7]
    ds_read_b128 a[136:139], v14 offset:49152
    v_cvt_pk_bf16_f32 v203, v210, v211
    v_mfma_f32_16x16x32_bf16 a[8:11], a[168:171], v[176:179], a[8:11]
    v_exp_f32 v208, v152
    v_mfma_f32_16x16x32_bf16 a[8:11], a[200:203], v[184:187], a[8:11]
    ds_read_b128 a[140:143], v15 offset:49152
    ds_read_b128 a[144:147], v12 offset:57344
    v_mfma_f32_16x16x32_bf16 a[12:15], a[204:207], v[184:187], a[12:15]
    s_add_u32 s52, s52, 8192
    v_exp_f32 v209, v153
    v_mfma_f32_16x16x32_bf16 a[12:15], a[172:175], v[176:179], a[12:15]
    ds_read_b128 a[148:151], v13 offset:57344
    v_cvt_pk_bf16_f32 v204, v208, v209
    v_mfma_f32_16x16x32_bf16 a[16:19], a[176:179], v[176:179], a[16:19]
    s_add_u32 m0, s88, 81920
    v_exp_f32 v210, v154
    v_mfma_f32_16x16x32_bf16 a[16:19], a[208:211], v[184:187], a[16:19]
    buffer_load_dwordx4 v28, s[8:11], s52 offen offset:0 lds
    v_mfma_f32_16x16x32_bf16 a[20:23], a[212:215], v[184:187], a[20:23]
    v_exp_f32 v211, v155
    v_mfma_f32_16x16x32_bf16 a[20:23], a[180:183], v[176:179], a[20:23]
    ds_read_b128 a[152:155], v14 offset:57344
    v_cvt_pk_bf16_f32 v205, v210, v211
    v_mfma_f32_16x16x32_bf16 a[24:27], a[184:187], v[176:179], a[24:27]
    v_exp_f32 v208, v156
    v_mfma_f32_16x16x32_bf16 a[24:27], a[216:219], v[184:187], a[24:27]
    buffer_load_dwordx4 v29, s[8:11], s52 offen offset:1024 lds
    v_mfma_f32_16x16x32_bf16 a[28:31], a[220:223], v[184:187], a[28:31]
    v_exp_f32 v209, v157
    v_mfma_f32_16x16x32_bf16 a[28:31], a[188:191], v[176:179], a[28:31]
    ds_read_b128 a[156:159], v15 offset:57344
    v_cvt_pk_bf16_f32 v206, v208, v209
    v_mfma_f32_16x16x32_bf16 a[60:63], a[188:191], v[180:183], a[60:63]
    v_exp_f32 v210, v158
    v_mfma_f32_16x16x32_bf16 a[60:63], a[220:223], v[188:191], a[60:63]
    buffer_load_dwordx4 v30, s[12:15], s52 offen offset:2048 lds
    v_mfma_f32_16x16x32_bf16 a[56:59], a[216:219], v[188:191], a[56:59]
    v_exp_f32 v211, v159
    v_mfma_f32_16x16x32_bf16 a[56:59], a[184:187], v[180:183], a[56:59]
    v_cvt_pk_bf16_f32 v207, v210, v211
    v_add_u32 v240, 131072, v240
    v_mfma_f32_16x16x32_bf16 a[52:55], a[180:183], v[180:183], a[52:55]
    v_mov_b32 v233, v228
    v_xor_b32 v241, 8, v240
    v_mfma_f32_16x16x32_bf16 a[52:55], a[212:215], v[188:191], a[52:55]
    v_exp_f32 v208, v112
    v_mfma_f32_16x16x32_bf16 a[48:51], a[208:211], v[188:191], a[48:51]
    buffer_load_dwordx4 v31, s[12:15], s52 offen offset:3072 lds
    v_mfma_f32_16x16x32_bf16 a[48:51], a[176:179], v[180:183], a[48:51]
    v_exp_f32 v209, v113
    v_smfmac_f32_16x16x64_bf16 v[228:231], v[24:27], v[200:207], v235
    v_cvt_pk_bf16_f32 v192, v208, v209
    v_xor_b32 v242, 16, v240
    v_mfma_f32_16x16x32_bf16 a[44:47], a[172:175], v[180:183], a[44:47]
    v_exp_f32 v210, v114
    v_mfma_f32_16x16x32_bf16 a[44:47], a[204:207], v[188:191], a[44:47]
    v_xor_b32 v243, 24, v240
    v_xor_b32 v252, 128, v240
    v_mfma_f32_16x16x32_bf16 a[40:43], a[200:203], v[188:191], a[40:43]
    v_exp_f32 v211, v115
    v_mfma_f32_16x16x32_bf16 a[40:43], a[168:171], v[180:183], a[40:43]
    v_cvt_pk_bf16_f32 v193, v210, v211
    v_cmp_nle_f32 vcc, v228, v234
    v_mfma_f32_16x16x32_bf16 a[36:39], a[164:167], v[180:183], a[36:39]
    v_exp_f32 v208, v116
    v_mfma_f32_16x16x32_bf16 a[36:39], a[196:199], v[188:191], a[36:39]
    buffer_store_dwordx4 a[244:247], v7, s[28:31], s91 offen offset:1024 sc1
    v_mfma_f32_16x16x32_bf16 a[32:35], a[192:195], v[188:191], a[32:35]
    v_exp_f32 v209, v117
    v_mfma_f32_16x16x32_bf16 a[32:35], a[160:163], v[180:183], a[32:35]
    s_waitcnt vmcnt(24) lgkmcnt(0)
    s_barrier
    v_cvt_pk_bf16_f32 v194, v208, v209
    v_xor_b32 v253, 136, v240
    s_cbranch_vccnz L_slow1_f7
L_back1_f7:
    v_mfma_f32_16x16x32_bf16 v[128:131], a[128:131], v[32:35], v[160:163]
    v_exp_f32 v210, v118
    v_mfma_f32_16x16x32_bf16 v[128:131], a[132:135], v[36:39], v[128:131]
    ds_read_b64_tr_b16 a[160:161], v16 offset:2048
    ds_read_b64_tr_b16 a[162:163], v16 offset:10240
    v_mfma_f32_16x16x32_bf16 v[128:131], a[136:139], v[40:43], v[128:131]
    v_exp_f32 v211, v119
    v_mfma_f32_16x16x32_bf16 v[128:131], a[140:143], v[44:47], v[128:131]
    ds_read_b64_tr_b16 a[164:165], v17 offset:2048
    v_cvt_pk_bf16_f32 v195, v210, v211
    v_mfma_f32_16x16x32_bf16 v[132:135], a[156:159], v[44:47], v[160:163]
    v_exp_f32 v208, v120
    v_mfma_f32_16x16x32_bf16 v[132:135], a[152:155], v[40:43], v[132:135]
    ds_read_b64_tr_b16 a[166:167], v17 offset:10240
    ds_read_b64_tr_b16 a[168:169], v18 offset:2048
    v_mfma_f32_16x16x32_bf16 v[132:135], a[148:151], v[36:39], v[132:135]
    v_exp_f32 v209, v121
    v_mfma_f32_16x16x32_bf16 v[132:135], a[144:147], v[32:35], v[132:135]
    ds_read_b64_tr_b16 a[170:171], v18 offset:10240
    v_cvt_pk_bf16_f32 v196, v208, v209
    v_mfma_f32_16x16x32_bf16 v[140:143], a[144:147], v[48:51], v[164:167]
    v_exp_f32 v210, v122
    v_mfma_f32_16x16x32_bf16 v[140:143], a[148:151], v[52:55], v[140:143]
    ds_read_b64_tr_b16 a[172:173], v19 offset:2048
    ds_read_b64_tr_b16 a[174:175], v19 offset:10240
    v_mfma_f32_16x16x32_bf16 v[140:143], a[152:155], v[56:59], v[140:143]
    v_exp_f32 v211, v123
    v_mfma_f32_16x16x32_bf16 v[140:143], a[156:159], v[60:63], v[140:143]
    ds_read_b64_tr_b16 a[176:177], v20 offset:2048
    v_cvt_pk_bf16_f32 v197, v210, v211
    v_mfma_f32_16x16x32_bf16 v[136:139], a[140:143], v[60:63], v[164:167]
    v_exp_f32 v208, v124
    v_mfma_f32_16x16x32_bf16 v[136:139], a[136:139], v[56:59], v[136:139]
    ds_read_b64_tr_b16 a[178:179], v20 offset:10240
    ds_read_b64_tr_b16 a[180:181], v21 offset:2048
    v_mfma_f32_16x16x32_bf16 v[136:139], a[132:135], v[52:55], v[136:139]
    v_exp_f32 v209, v125
    v_mfma_f32_16x16x32_bf16 v[136:139], a[128:131], v[48:51], v[136:139]
    ds_read_b64_tr_b16 a[182:183], v21 offset:10240
    v_cvt_pk_bf16_f32 v198, v208, v209
    v_mfma_f32_16x16x32_bf16 v[144:147], a[128:131], v[64:67], v[168:171]
    v_exp_f32 v210, v126
    v_mfma_f32_16x16x32_bf16 v[144:147], a[132:135], v[68:71], v[144:147]
    ds_read_b64_tr_b16 a[184:185], v22 offset:2048
    ds_read_b64_tr_b16 a[186:187], v22 offset:10240
    v_mfma_f32_16x16x32_bf16 v[144:147], a[136:139], v[72:75], v[144:147]
    v_exp_f32 v211, v127
    v_mfma_f32_16x16x32_bf16 v[144:147], a[140:143], v[76:79], v[144:147]
    ds_read_b64_tr_b16 a[188:189], v23 offset:2048
    v_cvt_pk_bf16_f32 v199, v210, v211
    v_mfma_f32_16x16x32_bf16 v[148:151], a[156:159], v[76:79], v[168:171]
    ds_read_b64_tr_b16 a[190:191], v23 offset:10240
    v_mov_b32 v233, v228
    v_mfma_f32_16x16x32_bf16 v[148:151], a[152:155], v[72:75], v[148:151]
    v_exp_f32 v208, v96
    v_mfma_f32_16x16x32_bf16 v[148:151], a[148:151], v[68:71], v[148:151]
    v_xor_b32 v254, 144, v240
    v_xor_b32 v255, 152, v240
    v_mfma_f32_16x16x32_bf16 v[148:151], a[144:147], v[64:67], v[148:151]
    v_exp_f32 v209, v97
    v_smfmac_f32_16x16x64_bf16 v[228:231], v[24:27], v[192:199], v235
    v_cvt_pk_bf16_f32 v176, v208, v209
    v_mfma_f32_16x16x32_bf16 v[156:159], a[144:147], v[80:83], v[172:175]
    v_exp_f32 v210, v98
    v_mfma_f32_16x16x32_bf16 v[156:159], a[148:151], v[84:87], v[156:159]
    v_mfma_f32_16x16x32_bf16 v[156:159], a[152:155], v[88:91], v[156:159]
    v_exp_f32 v211, v99
    v_mfma_f32_16x16x32_bf16 v[156:159], a[156:159], v[92:95], v[156:159]
    v_cvt_pk_bf16_f32 v177, v210, v211
    v_cmp_nle_f32 vcc, v228, v234
    v_mfma_f32_16x16x32_bf16 v[152:155], a[140:143], v[92:95], v[172:175]
    v_exp_f32 v208, v100
    v_mfma_f32_16x16x32_bf16 v[152:155], a[136:139], v[88:91], v[152:155]
    v_mfma_f32_16x16x32_bf16 v[152:155], a[132:135], v[84:87], v[152:155]
    v_exp_f32 v209, v101
    v_mfma_f32_16x16x32_bf16 v[152:155], a[128:131], v[80:83], v[152:155]
    s_waitcnt lgkmcnt(0)
    v_cvt_pk_bf16_f32 v178, v208, v209
    s_cbranch_vccnz L_slow0_f8
L_back0_f8:
    v_mfma_f32_16x16x32_bf16 a[64:67], a[192:195], v[200:203], a[64:67]
    v_exp_f32 v210, v102
    v_mfma_f32_16x16x32_bf16 a[64:67], a[160:163], v[192:195], a[64:67]
    ds_read_b128 a[128:131], v8 offset:0
    ds_read_b128 a[132:135], v9 offset:0
    v_mfma_f32_16x16x32_bf16 a[68:71], a[164:167], v[192:195], a[68:71]
    v_exp_f32 v211, v103
    v_mfma_f32_16x16x32_bf16 a[68:71], a[196:199], v[200:203], a[68:71]
    ds_read_b128 a[136:139], v10 offset:0
    v_cvt_pk_bf16_f32 v179, v210, v211
    v_mfma_f32_16x16x32_bf16 a[72:75], a[200:203], v[200:203], a[72:75]
    v_exp_f32 v208, v104
    v_mfma_f32_16x16x32_bf16 a[72:75], a[168:171], v[192:195], a[72:75]
    ds_read_b128 a[140:143], v11 offset:0
    ds_read_b128 a[144:147], v8 offset:8192
    v_mfma_f32_16x16x32_bf16 a[76:79], a[172:175], v[192:195], a[76:79]
    s_add_u32 s52, s52, 8192
    v_exp_f32 v209, v105
    v_mfma_f32_16x16x32_bf16 a[76:79], a[204:207], v[200:203], a[76:79]
    ds_read_b128 a[148:151], v9 offset:8192
    v_cvt_pk_bf16_f32 v180, v208, v209
    v_mfma_f32_16x16x32_bf16 a[80:83], a[208:211], v[200:203], a[80:83]
    s_add_u32 m0, s88, 98304
    v_exp_f32 v210, v106
    v_mfma_f32_16x16x32_bf16 a[80:83], a[176:179], v[192:195], a[80:83]
    buffer_load_dwordx4 v28, s[8:11], s52 offen offset:0 lds
    v_mfma_f32_16x16x32_bf16 a[84:87], a[180:183], v[192:195], a[84:87]
    v_exp_f32 v211, v107
    v_mfma_f32_16x16x32_bf16 a[84:87], a[212:215], v[200:203], a[84:87]
    ds_read_b128 a[152:155], v10 offset:8192
    v_cvt_pk_bf16_f32 v181, v210, v211
    v_mfma_f32_16x16x32_bf16 a[88:91], a[216:219], v[200:203], a[88:91]
    v_exp_f32 v208, v108
    v_mfma_f32_16x16x32_bf16 a[88:91], a[184:187], v[192:195], a[88:91]
    buffer_load_dwordx4 v29, s[8:11], s52 offen offset:1024 lds
    v_mfma_f32_16x16x32_bf16 a[92:95], a[188:191], v[192:195], a[92:95]
    v_exp_f32 v209, v109
    v_mfma_f32_16x16x32_bf16 a[92:95], a[220:223], v[200:203], a[92:95]
    ds_read_b128 a[156:159], v11 offset:8192
    v_cvt_pk_bf16_f32 v182, v208, v209
    v_mfma_f32_16x16x32_bf16 a[124:127], a[220:223], v[204:207], a[124:127]
    v_exp_f32 v210, v110
    v_mfma_f32_16x16x32_bf16 a[124:127], a[188:191], v[196:199], a[124:127]
    buffer_load_dwordx4 v30, s[12:15], s52 offen offset:2048 lds
    v_mfma_f32_16x16x32_bf16 a[120:123], a[184:187], v[196:199], a[120:123]
    v_exp_f32 v211, v111
    v_mfma_f32_16x16x32_bf16 a[120:123], a[216:219], v[204:207], a[120:123]
    v_cvt_pk_bf16_f32 v183, v210, v211
    v_mfma_f32_16x16x32_bf16 a[116:119], a[212:215], v[204:207], a[116:119]
    v_mov_b32 v232, v224
    v_mfma_f32_16x16x32_bf16 a[116:119], a[180:183], v[196:199], a[116:119]
    v_exp_f32 v208, v128
    v_mfma_f32_16x16x32_bf16 a[112:115], a[176:179], v[196:199], a[112:115]
    buffer_load_dwordx4 v31, s[12:15], s52 offen offset:3072 lds
    v_mfma_f32_16x16x32_bf16 a[112:115], a[208:211], v[204:207], a[112:115]
    v_exp_f32 v209, v129
    v_smfmac_f32_16x16x64_bf16 v[224:227], v[24:27], v[176:183], v235
    v_cvt_pk_bf16_f32 v184, v208, v209
    v_mfma_f32_16x16x32_bf16 a[108:111], a[204:207], v[204:207], a[108:111]
    v_exp_f32 v210, v130
    v_mfma_f32_16x16x32_bf16 a[108:111], a[172:175], v[196:199], a[108:111]
    v_mfma_f32_16x16x32_bf16 a[104:107], a[168:171], v[196:199], a[104:107]
    v_exp_f32 v211, v131
    v_mfma_f32_16x16x32_bf16 a[104:107], a[200:203], v[204:207], a[104:107]
    v_cvt_pk_bf16_f32 v185, v210, v211
    v_cmp_nle_f32 vcc, v224, v234
    v_mfma_f32_16x16x32_bf16 a[100:103], a[196:199], v[204:207], a[100:103]
    s_add_u32 s91, s91, 58368
    v_exp_f32 v208, v132
    v_mfma_f32_16x16x32_bf16 a[100:103], a[164:167], v[196:199], a[100:103]
    buffer_store_dwordx4 a[248:251], v7, s[28:31], s91 offen offset:0 sc1
    v_mfma_f32_16x16x32_bf16 a[96:99], a[160:163], v[196:199], a[96:99]
    v_exp_f32 v209, v133
    v_mfma_f32_16x16x32_bf16 a[96:99], a[192:195], v[204:207], a[96:99]
    s_waitcnt lgkmcnt(0)
    v_cvt_pk_bf16_f32 v186, v208, v209
    s_cbranch_vccnz L_slow1_f8
L_back1_f8:
    v_mfma_f32_16x16x32_bf16 v[112:115], a[128:131], v[64:67], v[168:171]
    v_exp_f32 v210, v134
    v_mfma_f32_16x16x32_bf16 v[112:115], a[132:135], v[68:71], v[112:115]
    ds_read_b64_tr_b16 a[192:193], v16 offset:18432
    ds_read_b64_tr_b16 a[194:195], v16 offset:26624
    v_mfma_f32_16x16x32_bf16 v[112:115], a[136:139], v[72:75], v[112:115]
    s_sub_u32 s3, s2, 128
    s_add_u32 s7, s2, 56
    v_exp_f32 v211, v135
    v_mfma_f32_16x16x32_bf16 v[112:115], a[140:143], v[76:79], v[112:115]
    ds_read_b64_tr_b16 a[196:197], v17 offset:18432
    v_cvt_pk_bf16_f32 v187, v210, v211
    v_mfma_f32_16x16x32_bf16 v[116:119], a[156:159], v[76:79], v[168:171]
    s_cmp_lt_u32 s2, 128
    s_cselect_b32 s3, s7, s3
    s_lshl_b32 s3, s3, 12
    s_mul_i32 s7, s6, 1507328
    v_exp_f32 v208, v136
    v_mfma_f32_16x16x32_bf16 v[116:119], a[152:155], v[72:75], v[116:119]
    ds_read_b64_tr_b16 a[198:199], v17 offset:26624
    ds_read_b64_tr_b16 a[200:201], v18 offset:18432
    v_mfma_f32_16x16x32_bf16 v[116:119], a[148:151], v[68:71], v[116:119]
    s_add_u32 s3, s3, s7
    s_add_u32 s3, s3, 26279936
    s_add_u32 s7, s3, 753664
    v_exp_f32 v209, v137
    v_mfma_f32_16x16x32_bf16 v[116:119], a[144:147], v[64:67], v[116:119]
    ds_read_b64_tr_b16 a[202:203], v18 offset:26624
    v_cvt_pk_bf16_f32 v188, v208, v209
    v_mfma_f32_16x16x32_bf16 v[124:127], a[144:147], v[80:83], v[172:175]
    v_exp_f32 v210, v138
    v_mfma_f32_16x16x32_bf16 v[124:127], a[148:151], v[84:87], v[124:127]
    ds_read_b64_tr_b16 a[204:205], v19 offset:18432
    ds_read_b64_tr_b16 a[206:207], v19 offset:26624
    v_mfma_f32_16x16x32_bf16 v[124:127], a[152:155], v[88:91], v[124:127]
    v_exp_f32 v211, v139
    v_mfma_f32_16x16x32_bf16 v[124:127], a[156:159], v[92:95], v[124:127]
    ds_read_b64_tr_b16 a[208:209], v20 offset:18432
    v_cvt_pk_bf16_f32 v189, v210, v211
    v_mfma_f32_16x16x32_bf16 v[120:123], a[140:143], v[92:95], v[172:175]
    v_exp_f32 v208, v140
    v_mfma_f32_16x16x32_bf16 v[120:123], a[136:139], v[88:91], v[120:123]
    ds_read_b64_tr_b16 a[210:211], v20 offset:26624
    ds_read_b64_tr_b16 a[212:213], v21 offset:18432
    v_mfma_f32_16x16x32_bf16 v[120:123], a[132:135], v[84:87], v[120:123]
    v_exp_f32 v209, v141
    v_mfma_f32_16x16x32_bf16 v[120:123], a[128:131], v[80:83], v[120:123]
    ds_read_b64_tr_b16 a[214:215], v21 offset:26624
    v_cvt_pk_bf16_f32 v190, v208, v209
    v_mfma_f32_16x16x32_bf16 v[96:99], a[128:131], v[32:35], v[160:163]
    v_exp_f32 v210, v142
    v_mfma_f32_16x16x32_bf16 v[96:99], a[132:135], v[36:39], v[96:99]
    ds_read_b64_tr_b16 a[216:217], v22 offset:18432
    ds_read_b64_tr_b16 a[218:219], v22 offset:26624
    v_mfma_f32_16x16x32_bf16 v[96:99], a[136:139], v[40:43], v[96:99]
    v_exp_f32 v211, v143
    v_mfma_f32_16x16x32_bf16 v[96:99], a[140:143], v[44:47], v[96:99]
    ds_read_b64_tr_b16 a[220:221], v23 offset:18432
    v_cvt_pk_bf16_f32 v191, v210, v211
    v_mfma_f32_16x16x32_bf16 v[100:103], a[156:159], v[44:47], v[160:163]
    ds_read_b64_tr_b16 a[222:223], v23 offset:26624
    v_mov_b32 v232, v224
    v_mfma_f32_16x16x32_bf16 v[100:103], a[152:155], v[40:43], v[100:103]
    v_exp_f32 v208, v144
    v_mfma_f32_16x16x32_bf16 v[100:103], a[148:151], v[36:39], v[100:103]
    v_mfma_f32_16x16x32_bf16 v[100:103], a[144:147], v[32:35], v[100:103]
    v_exp_f32 v209, v145
    v_smfmac_f32_16x16x64_bf16 v[224:227], v[24:27], v[184:191], v235
    v_cvt_pk_bf16_f32 v200, v208, v209
    v_mfma_f32_16x16x32_bf16 v[108:111], a[144:147], v[48:51], v[164:167]
    v_exp_f32 v210, v146
    v_mfma_f32_16x16x32_bf16 v[108:111], a[148:151], v[52:55], v[108:111]
    v_mfma_f32_16x16x32_bf16 v[108:111], a[152:155], v[56:59], v[108:111]
    v_exp_f32 v211, v147
    v_mfma_f32_16x16x32_bf16 v[108:111], a[156:159], v[60:63], v[108:111]
    v_cvt_pk_bf16_f32 v201, v210, v211
    v_cmp_nle_f32 vcc, v224, v234
    v_mfma_f32_16x16x32_bf16 v[104:107], a[140:143], v[60:63], v[164:167]
    v_exp_f32 v208, v148
    v_mfma_f32_16x16x32_bf16 v[104:107], a[136:139], v[56:59], v[104:107]
    v_mfma_f32_16x16x32_bf16 v[104:107], a[132:135], v[52:55], v[104:107]
    v_exp_f32 v209, v149
    v_mfma_f32_16x16x32_bf16 v[104:107], a[128:131], v[48:51], v[104:107]
    s_waitcnt lgkmcnt(0)
    v_cvt_pk_bf16_f32 v202, v208, v209
    s_cbranch_vccnz L_slow0_f9
L_back0_f9:
    v_mfma_f32_16x16x32_bf16 a[0:3], a[160:163], v[176:179], a[0:3]
    v_exp_f32 v210, v150
    v_mfma_f32_16x16x32_bf16 a[0:3], a[192:195], v[184:187], a[0:3]
    ds_read_b128 a[128:131], v8 offset:16384
    ds_read_b128 a[132:135], v9 offset:16384
    v_mfma_f32_16x16x32_bf16 a[4:7], a[196:199], v[184:187], a[4:7]
    v_exp_f32 v211, v151
    v_mfma_f32_16x16x32_bf16 a[4:7], a[164:167], v[176:179], a[4:7]
    ds_read_b128 a[136:139], v10 offset:16384
    v_cvt_pk_bf16_f32 v203, v210, v211
    v_mfma_f32_16x16x32_bf16 a[8:11], a[168:171], v[176:179], a[8:11]
    v_exp_f32 v208, v152
    v_mfma_f32_16x16x32_bf16 a[8:11], a[200:203], v[184:187], a[8:11]
    ds_read_b128 a[140:143], v11 offset:16384
    ds_read_b128 a[144:147], v8 offset:24576
    v_mfma_f32_16x16x32_bf16 a[12:15], a[204:207], v[184:187], a[12:15]
    s_add_u32 s52, s52, 8192
    v_exp_f32 v209, v153
    v_mfma_f32_16x16x32_bf16 a[12:15], a[172:175], v[176:179], a[12:15]
    ds_read_b128 a[148:151], v9 offset:24576
    v_cvt_pk_bf16_f32 v204, v208, v209
    v_mfma_f32_16x16x32_bf16 a[16:19], a[176:179], v[176:179], a[16:19]
    s_add_u32 m0, s88, 114688
    v_exp_f32 v210, v154
    v_mfma_f32_16x16x32_bf16 a[16:19], a[208:211], v[184:187], a[16:19]
    buffer_load_dwordx4 v28, s[8:11], s52 offen offset:0 lds
    v_mfma_f32_16x16x32_bf16 a[20:23], a[212:215], v[184:187], a[20:23]
    v_exp_f32 v211, v155
    v_mfma_f32_16x16x32_bf16 a[20:23], a[180:183], v[176:179], a[20:23]
    ds_read_b128 a[152:155], v10 offset:24576
    v_cvt_pk_bf16_f32 v205, v210, v211
    v_mfma_f32_16x16x32_bf16 a[24:27], a[184:187], v[176:179], a[24:27]
    v_exp_f32 v208, v156
    v_mfma_f32_16x16x32_bf16 a[24:27], a[216:219], v[184:187], a[24:27]
    buffer_load_dwordx4 v29, s[8:11], s52 offen offset:1024 lds
    v_mfma_f32_16x16x32_bf16 a[28:31], a[220:223], v[184:187], a[28:31]
    v_exp_f32 v209, v157
    v_mfma_f32_16x16x32_bf16 a[28:31], a[188:191], v[176:179], a[28:31]
    ds_read_b128 a[156:159], v11 offset:24576
    v_cvt_pk_bf16_f32 v206, v208, v209
    v_mfma_f32_16x16x32_bf16 a[60:63], a[188:191], v[180:183], a[60:63]
    v_exp_f32 v210, v158
    v_mfma_f32_16x16x32_bf16 a[60:63], a[220:223], v[188:191], a[60:63]
    buffer_load_dwordx4 v30, s[12:15], s52 offen offset:2048 lds
    v_mfma_f32_16x16x32_bf16 a[56:59], a[216:219], v[188:191], a[56:59]
    v_exp_f32 v211, v159
    v_mfma_f32_16x16x32_bf16 a[56:59], a[184:187], v[180:183], a[56:59]
    v_cvt_pk_bf16_f32 v207, v210, v211
    v_mfma_f32_16x16x32_bf16 a[52:55], a[180:183], v[180:183], a[52:55]
    v_mov_b32 v233, v228
    v_mfma_f32_16x16x32_bf16 a[52:55], a[212:215], v[188:191], a[52:55]
    v_exp_f32 v208, v112
    v_mfma_f32_16x16x32_bf16 a[48:51], a[208:211], v[188:191], a[48:51]
    buffer_load_dwordx4 v31, s[12:15], s52 offen offset:3072 lds
    v_mfma_f32_16x16x32_bf16 a[48:51], a[176:179], v[180:183], a[48:51]
    v_exp_f32 v209, v113
    v_smfmac_f32_16x16x64_bf16 v[228:231], v[24:27], v[200:207], v235
    v_cvt_pk_bf16_f32 v192, v208, v209
    v_mfma_f32_16x16x32_bf16 a[44:47], a[172:175], v[180:183], a[44:47]
    v_exp_f32 v210, v114
    v_mfma_f32_16x16x32_bf16 a[44:47], a[204:207], v[188:191], a[44:47]
    v_mfma_f32_16x16x32_bf16 a[40:43], a[200:203], v[188:191], a[40:43]
    v_exp_f32 v211, v115
    v_mfma_f32_16x16x32_bf16 a[40:43], a[168:171], v[180:183], a[40:43]
    v_cvt_pk_bf16_f32 v193, v210, v211
    v_cmp_nle_f32 vcc, v228, v234
    v_mfma_f32_16x16x32_bf16 a[36:39], a[164:167], v[180:183], a[36:39]
    v_exp_f32 v208, v116
    v_mfma_f32_16x16x32_bf16 a[36:39], a[196:199], v[188:191], a[36:39]
    buffer_store_dwordx4 a[252:255], v7, s[28:31], s91 offen offset:1024 sc1
    v_mfma_f32_16x16x32_bf16 a[32:35], a[192:195], v[188:191], a[32:35]
    v_exp_f32 v209, v117
    v_mfma_f32_16x16x32_bf16 a[32:35], a[160:163], v[180:183], a[32:35]
    s_waitcnt vmcnt(22) lgkmcnt(0)
    s_barrier
    v_cvt_pk_bf16_f32 v194, v208, v209
    s_cbranch_vccnz L_slow1_f9
L_back1_f9:
    v_mfma_f32_16x16x32_bf16 v[128:131], a[128:131], v[32:35], v[160:163]
    v_exp_f32 v210, v118
    v_mfma_f32_16x16x32_bf16 v[128:131], a[132:135], v[36:39], v[128:131]
    ds_read_b64_tr_b16 a[160:161], v16 offset:34816
    ds_read_b64_tr_b16 a[162:163], v16 offset:43008
    v_mfma_f32_16x16x32_bf16 v[128:131], a[136:139], v[40:43], v[128:131]
    v_exp_f32 v211, v119
    v_mfma_f32_16x16x32_bf16 v[128:131], a[140:143], v[44:47], v[128:131]
    ds_read_b64_tr_b16 a[164:165], v17 offset:34816
    v_cvt_pk_bf16_f32 v195, v210, v211
    v_mfma_f32_16x16x32_bf16 v[132:135], a[156:159], v[44:47], v[160:163]
    v_exp_f32 v208, v120
    v_mfma_f32_16x16x32_bf16 v[132:135], a[152:155], v[40:43], v[132:135]
    ds_read_b64_tr_b16 a[166:167], v17 offset:43008
    ds_read_b64_tr_b16 a[168:169], v18 offset:34816
    v_mfma_f32_16x16x32_bf16 v[132:135], a[148:151], v[36:39], v[132:135]
    v_exp_f32 v209, v121
    v_mfma_f32_16x16x32_bf16 v[132:135], a[144:147], v[32:35], v[132:135]
    ds_read_b64_tr_b16 a[170:171], v18 offset:43008
    v_cvt_pk_bf16_f32 v196, v208, v209
    v_mfma_f32_16x16x32_bf16 v[140:143], a[144:147], v[48:51], v[164:167]
    v_exp_f32 v210, v122
    v_mfma_f32_16x16x32_bf16 v[140:143], a[148:151], v[52:55], v[140:143]
    ds_read_b64_tr_b16 a[172:173], v19 offset:34816
    ds_read_b64_tr_b16 a[174:175], v19 offset:43008
    v_mfma_f32_16x16x32_bf16 v[140:143], a[152:155], v[56:59], v[140:143]
    v_exp_f32 v211, v123
    v_mfma_f32_16x16x32_bf16 v[140:143], a[156:159], v[60:63], v[140:143]
    ds_read_b64_tr_b16 a[176:177], v20 offset:34816
    v_cvt_pk_bf16_f32 v197, v210, v211
L_pad6:
    s_cbranch_execz L_pad10
    v_mfma_f32_16x16x32_bf16 v[136:139], a[140:143], v[60:63], v[164:167]
    v_exp_f32 v208, v124
    v_mfma_f32_16x16x32_bf16 v[136:139], a[136:139], v[56:59], v[136:139]
    ds_read_b64_tr_b16 a[178:179], v20 offset:43008
    ds_read_b64_tr_b16 a[180:181], v21 offset:34816
    v_mfma_f32_16x16x32_bf16 v[136:139], a[132:135], v[52:55], v[136:139]
    v_exp_f32 v209, v125
    v_mfma_f32_16x16x32_bf16 v[136:139], a[128:131], v[48:51], v[136:139]
    ds_read_b64_tr_b16 a[182:183], v21 offset:43008
    v_cvt_pk_bf16_f32 v198, v208, v209
    v_mfma_f32_16x16x32_bf16 v[144:147], a[128:131], v[64:67], v[168:171]
    v_exp_f32 v210, v126
    v_mfma_f32_16x16x32_bf16 v[144:147], a[132:135], v[68:71], v[144:147]
    ds_read_b64_tr_b16 a[184:185], v22 offset:34816
    ds_read_b64_tr_b16 a[186:187], v22 offset:43008
    v_mfma_f32_16x16x32_bf16 v[144:147], a[136:139], v[72:75], v[144:147]
    v_exp_f32 v211, v127
    v_mfma_f32_16x16x32_bf16 v[144:147], a[140:143], v[76:79], v[144:147]
    ds_read_b64_tr_b16 a[188:189], v23 offset:34816
    v_cvt_pk_bf16_f32 v199, v210, v211
    v_mfma_f32_16x16x32_bf16 v[148:151], a[156:159], v[76:79], v[168:171]
    ds_read_b64_tr_b16 a[190:191], v23 offset:43008
    v_mov_b32 v233, v228
    v_mfma_f32_16x16x32_bf16 v[148:151], a[152:155], v[72:75], v[148:151]
    v_exp_f32 v208, v96
    v_mfma_f32_16x16x32_bf16 v[148:151], a[148:151], v[68:71], v[148:151]
    ds_read_b64_tr_b16 a[224:225], v240 offset:0
    ds_read_b64_tr_b16 a[226:227], v240 offset:4096
    v_mfma_f32_16x16x32_bf16 v[148:151], a[144:147], v[64:67], v[148:151]
    v_exp_f32 v209, v97
    v_smfmac_f32_16x16x64_bf16 v[228:231], v[24:27], v[192:199], v235
    ds_read_b64_tr_b16 a[228:229], v241 offset:0
    v_cvt_pk_bf16_f32 v176, v208, v209
    v_mfma_f32_16x16x32_bf16 v[156:159], a[144:147], v[80:83], v[172:175]
    v_exp_f32 v210, v98
    v_mfma_f32_16x16x32_bf16 v[156:159], a[148:151], v[84:87], v[156:159]
    ds_read_b64_tr_b16 a[230:231], v241 offset:4096
    v_mfma_f32_16x16x32_bf16 v[156:159], a[152:155], v[88:91], v[156:159]
    v_exp_f32 v211, v99
    v_mfma_f32_16x16x32_bf16 v[156:159], a[156:159], v[92:95], v[156:159]
    v_cvt_pk_bf16_f32 v177, v210, v211
    v_cmp_nle_f32 vcc, v228, v234
    v_mfma_f32_16x16x32_bf16 v[152:155], a[140:143], v[92:95], v[172:175]
    v_exp_f32 v208, v100
    v_mfma_f32_16x16x32_bf16 v[152:155], a[136:139], v[88:91], v[152:155]
    v_mfma_f32_16x16x32_bf16 v[152:155], a[132:135], v[84:87], v[152:155]
    v_exp_f32 v209, v101
    v_mfma_f32_16x16x32_bf16 v[152:155], a[128:131], v[80:83], v[152:155]
    s_waitcnt lgkmcnt(0)
    v_cvt_pk_bf16_f32 v178, v208, v209
    s_cbranch_vccnz L_slow0_f10
L_back0_f10:
    v_mfma_f32_16x16x32_bf16 a[64:67], a[192:195], v[200:203], a[64:67]
    v_exp_f32 v210, v102
    v_mfma_f32_16x16x32_bf16 a[64:67], a[160:163], v[192:195], a[64:67]
    ds_read_b128 a[128:131], v8 offset:32768
    ds_read_b128 a[132:135], v9 offset:32768
    v_mfma_f32_16x16x32_bf16 a[68:71], a[164:167], v[192:195], a[68:71]
    v_exp_f32 v211, v103
    v_mfma_f32_16x16x32_bf16 a[68:71], a[196:199], v[200:203], a[68:71]
    ds_read_b128 a[136:139], v10 offset:32768
    v_cvt_pk_bf16_f32 v179, v210, v211
    v_mfma_f32_16x16x32_bf16 a[72:75], a[200:203], v[200:203], a[72:75]
    v_exp_f32 v208, v104
    v_mfma_f32_16x16x32_bf16 a[72:75], a[168:171], v[192:195], a[72:75]
    ds_read_b128 a[140:143], v11 offset:32768
    ds_read_b128 a[144:147], v8 offset:40960
    v_mfma_f32_16x16x32_bf16 a[76:79], a[172:175], v[192:195], a[76:79]
    s_add_u32 s52, s52, 8192
    v_exp_f32 v209, v105
    v_mfma_f32_16x16x32_bf16 a[76:79], a[204:207], v[200:203], a[76:79]
    ds_read_b128 a[148:151], v9 offset:40960
    v_cvt_pk_bf16_f32 v180, v208, v209
    v_mfma_f32_16x16x32_bf16 a[80:83], a[208:211], v[200:203], a[80:83]
    s_add_u32 m0, s88, 0
    v_exp_f32 v210, v106
    v_mfma_f32_16x16x32_bf16 a[80:83], a[176:179], v[192:195], a[80:83]
    buffer_load_dwordx4 v28, s[8:11], s52 offen offset:0 lds
    v_mfma_f32_16x16x32_bf16 a[84:87], a[180:183], v[192:195], a[84:87]
    v_exp_f32 v211, v107
    v_mfma_f32_16x16x32_bf16 a[84:87], a[212:215], v[200:203], a[84:87]
    ds_read_b128 a[152:155], v10 offset:40960
    v_cvt_pk_bf16_f32 v181, v210, v211
    v_mfma_f32_16x16x32_bf16 a[88:91], a[216:219], v[200:203], a[88:91]
    v_exp_f32 v208, v108
    v_mfma_f32_16x16x32_bf16 a[88:91], a[184:187], v[192:195], a[88:91]
    buffer_load_dwordx4 v29, s[8:11], s52 offen offset:1024 lds
    v_mfma_f32_16x16x32_bf16 a[92:95], a[188:191], v[192:195], a[92:95]
    v_exp_f32 v209, v109
    v_mfma_f32_16x16x32_bf16 a[92:95], a[220:223], v[200:203], a[92:95]
    ds_read_b128 a[156:159], v11 offset:40960
    v_cvt_pk_bf16_f32 v182, v208, v209
    v_mfma_f32_16x16x32_bf16 a[124:127], a[220:223], v[204:207], a[124:127]
    v_exp_f32 v210, v110
    v_mfma_f32_16x16x32_bf16 a[124:127], a[188:191], v[196:199], a[124:127]
    buffer_load_dwordx4 v30, s[12:15], s52 offen offset:2048 lds
    v_mfma_f32_16x16x32_bf16 a[120:123], a[184:187], v[196:199], a[120:123]
    v_exp_f32 v211, v111
    v_mfma_f32_16x16x32_bf16 a[120:123], a[216:219], v[204:207], a[120:123]
    v_cvt_pk_bf16_f32 v183, v210, v211
    v_mfma_f32_16x16x32_bf16 a[116:119], a[212:215], v[204:207], a[116:119]
    v_mov_b32 v232, v224
    v_mfma_f32_16x16x32_bf16 a[116:119], a[180:183], v[196:199], a[116:119]
    v_exp_f32 v208, v128
    v_mfma_f32_16x16x32_bf16 a[112:115], a[176:179], v[196:199], a[112:115]
    buffer_load_dwordx4 v31, s[12:15], s52 offen offset:3072 lds
    v_mfma_f32_16x16x32_bf16 a[112:115], a[208:211], v[204:207], a[112:115]
    v_exp_f32 v209, v129
    v_smfmac_f32_16x16x64_bf16 v[224:227], v[24:27], v[176:183], v235
    v_cvt_pk_bf16_f32 v184, v208, v209
    v_mfma_f32_16x16x32_bf16 a[108:111], a[204:207], v[204:207], a[108:111]
    v_exp_f32 v210, v130
    v_mfma_f32_16x16x32_bf16 a[108:111], a[172:175], v[196:199], a[108:111]
    v_mfma_f32_16x16x32_bf16 a[104:107], a[168:171], v[196:199], a[104:107]
    v_exp_f32 v211, v131
    v_mfma_f32_16x16x32_bf16 a[104:107], a[200:203], v[204:207], a[104:107]
    v_cvt_pk_bf16_f32 v185, v210, v211
    v_cmp_nle_f32 vcc, v224, v234
    v_mfma_f32_16x16x32_bf16 a[100:103], a[196:199], v[204:207], a[100:103]
    v_exp_f32 v208, v132
    v_mfma_f32_16x16x32_bf16 a[100:103], a[164:167], v[196:199], a[100:103]
    buffer_store_dwordx4 a[224:227], v7, s[40:43], s3 offen offset:0 sc1
    v_mfma_f32_16x16x32_bf16 a[96:99], a[160:163], v[196:199], a[96:99]
    v_exp_f32 v209, v133
    v_mfma_f32_16x16x32_bf16 a[96:99], a[192:195], v[204:207], a[96:99]
    s_waitcnt lgkmcnt(0)
    v_cvt_pk_bf16_f32 v186, v208, v209
    s_cbranch_vccnz L_slow1_f10
L_back1_f10:
    v_mfma_f32_16x16x32_bf16 v[112:115], a[128:131], v[64:67], v[168:171]
    v_exp_f32 v210, v134
    v_mfma_f32_16x16x32_bf16 v[112:115], a[132:135], v[68:71], v[112:115]
    ds_read_b64_tr_b16 a[192:193], v16 offset:51200
    ds_read_b64_tr_b16 a[194:195], v16 offset:59392
    v_mfma_f32_16x16x32_bf16 v[112:115], a[136:139], v[72:75], v[112:115]
    v_exp_f32 v211, v135
    v_mfma_f32_16x16x32_bf16 v[112:115], a[140:143], v[76:79], v[112:115]
    ds_read_b64_tr_b16 a[196:197], v17 offset:51200
    v_cvt_pk_bf16_f32 v187, v210, v211
    v_mfma_f32_16x16x32_bf16 v[116:119], a[156:159], v[76:79], v[168:171]
    v_exp_f32 v208, v136
    v_mfma_f32_16x16x32_bf16 v[116:119], a[152:155], v[72:75], v[116:119]
    ds_read_b64_tr_b16 a[198:199], v17 offset:59392
    ds_read_b64_tr_b16 a[200:201], v18 offset:51200
    v_mfma_f32_16x16x32_bf16 v[116:119], a[148:151], v[68:71], v[116:119]
    v_exp_f32 v209, v137
    v_mfma_f32_16x16x32_bf16 v[116:119], a[144:147], v[64:67], v[116:119]
    ds_read_b64_tr_b16 a[202:203], v18 offset:59392
    v_cvt_pk_bf16_f32 v188, v208, v209
    v_mfma_f32_16x16x32_bf16 v[124:127], a[144:147], v[80:83], v[172:175]
    v_exp_f32 v210, v138
    v_mfma_f32_16x16x32_bf16 v[124:127], a[148:151], v[84:87], v[124:127]
    ds_read_b64_tr_b16 a[204:205], v19 offset:51200
    ds_read_b64_tr_b16 a[206:207], v19 offset:59392
    v_mfma_f32_16x16x32_bf16 v[124:127], a[152:155], v[88:91], v[124:127]
    v_exp_f32 v211, v139
    v_mfma_f32_16x16x32_bf16 v[124:127], a[156:159], v[92:95], v[124:127]
    ds_read_b64_tr_b16 a[208:209], v20 offset:51200
    v_cvt_pk_bf16_f32 v189, v210, v211
    v_mfma_f32_16x16x32_bf16 v[120:123], a[140:143], v[92:95], v[172:175]
    v_exp_f32 v208, v140
    v_mfma_f32_16x16x32_bf16 v[120:123], a[136:139], v[88:91], v[120:123]
    ds_read_b64_tr_b16 a[210:211], v20 offset:59392
    ds_read_b64_tr_b16 a[212:213], v21 offset:51200
    v_mfma_f32_16x16x32_bf16 v[120:123], a[132:135], v[84:87], v[120:123]
    v_exp_f32 v209, v141
    v_mfma_f32_16x16x32_bf16 v[120:123], a[128:131], v[80:83], v[120:123]
    ds_read_b64_tr_b16 a[214:215], v21 offset:59392
    v_cvt_pk_bf16_f32 v190, v208, v209
    v_mfma_f32_16x16x32_bf16 v[96:99], a[128:131], v[32:35], v[160:163]
    v_exp_f32 v210, v142
    v_mfma_f32_16x16x32_bf16 v[96:99], a[132:135], v[36:39], v[96:99]
    ds_read_b64_tr_b16 a[216:217], v22 offset:51200
    ds_read_b64_tr_b16 a[218:219], v22 offset:59392
    v_mfma_f32_16x16x32_bf16 v[96:99], a[136:139], v[40:43], v[96:99]
    v_exp_f32 v211, v143
    v_mfma_f32_16x16x32_bf16 v[96:99], a[140:143], v[44:47], v[96:99]
    ds_read_b64_tr_b16 a[220:221], v23 offset:51200
    v_cvt_pk_bf16_f32 v191, v210, v211
    v_mfma_f32_16x16x32_bf16 v[100:103], a[156:159], v[44:47], v[160:163]
    ds_read_b64_tr_b16 a[222:223], v23 offset:59392
    v_mov_b32 v232, v224
    v_mfma_f32_16x16x32_bf16 v[100:103], a[152:155], v[40:43], v[100:103]
    v_exp_f32 v208, v144
    v_mfma_f32_16x16x32_bf16 v[100:103], a[148:151], v[36:39], v[100:103]
    ds_read_b64_tr_b16 a[232:233], v242 offset:0
    ds_read_b64_tr_b16 a[234:235], v242 offset:4096
    v_mfma_f32_16x16x32_bf16 v[100:103], a[144:147], v[32:35], v[100:103]
    v_exp_f32 v209, v145
    v_smfmac_f32_16x16x64_bf16 v[224:227], v[24:27], v[184:191], v235
    ds_read_b64_tr_b16 a[236:237], v243 offset:0
    v_cvt_pk_bf16_f32 v200, v208, v209
    v_mfma_f32_16x16x32_bf16 v[108:111], a[144:147], v[48:51], v[164:167]
    v_exp_f32 v210, v146
    v_mfma_f32_16x16x32_bf16 v[108:111], a[148:151], v[52:55], v[108:111]
    ds_read_b64_tr_b16 a[238:239], v243 offset:4096
    v_mfma_f32_16x16x32_bf16 v[108:111], a[152:155], v[56:59], v[108:111]
    v_exp_f32 v211, v147
    v_mfma_f32_16x16x32_bf16 v[108:111], a[156:159], v[60:63], v[108:111]
    v_cvt_pk_bf16_f32 v201, v210, v211
    v_cmp_nle_f32 vcc, v224, v234
    v_mfma_f32_16x16x32_bf16 v[104:107], a[140:143], v[60:63], v[164:167]
    v_exp_f32 v208, v148
    v_mfma_f32_16x16x32_bf16 v[104:107], a[136:139], v[56:59], v[104:107]
    v_mfma_f32_16x16x32_bf16 v[104:107], a[132:135], v[52:55], v[104:107]
    v_exp_f32 v209, v149
    v_mfma_f32_16x16x32_bf16 v[104:107], a[128:131], v[48:51], v[104:107]
    s_waitcnt lgkmcnt(0)
    v_cvt_pk_bf16_f32 v202, v208, v209
    s_cbranch_vccnz L_slow0_f11
L_back0_f11:
    v_mfma_f32_16x16x32_bf16 a[0:3], a[160:163], v[176:179], a[0:3]
    v_exp_f32 v210, v150
    v_mfma_f32_16x16x32_bf16 a[0:3], a[192:195], v[184:187], a[0:3]
    ds_read_b128 a[128:131], v8 offset:49152
    ds_read_b128 a[132:135], v9 offset:49152
    v_mfma_f32_16x16x32_bf16 a[4:7], a[196:199], v[184:187], a[4:7]
    v_exp_f32 v211, v151
    v_mfma_f32_16x16x32_bf16 a[4:7], a[164:167], v[176:179], a[4:7]
    ds_read_b128 a[136:139], v10 offset:49152
    v_cvt_pk_bf16_f32 v203, v210, v211
    v_mfma_f32_16x16x32_bf16 a[8:11], a[168:171], v[176:179], a[8:11]
    v_exp_f32 v208, v152
    v_mfma_f32_16x16x32_bf16 a[8:11], a[200:203], v[184:187], a[8:11]
    ds_read_b128 a[140:143], v11 offset:49152
    ds_read_b128 a[144:147], v8 offset:57344
    v_mfma_f32_16x16x32_bf16 a[12:15], a[204:207], v[184:187], a[12:15]
    s_add_u32 s52, s52, 8192
    v_exp_f32 v209, v153
    v_mfma_f32_16x16x32_bf16 a[12:15], a[172:175], v[176:179], a[12:15]
    ds_read_b128 a[148:151], v9 offset:57344
    v_cvt_pk_bf16_f32 v204, v208, v209
    v_mfma_f32_16x16x32_bf16 a[16:19], a[176:179], v[176:179], a[16:19]
    s_add_u32 m0, s88, 16384
    v_exp_f32 v210, v154
    v_mfma_f32_16x16x32_bf16 a[16:19], a[208:211], v[184:187], a[16:19]
    buffer_load_dwordx4 v28, s[8:11], s52 offen offset:0 lds
    v_mfma_f32_16x16x32_bf16 a[20:23], a[212:215], v[184:187], a[20:23]
    v_exp_f32 v211, v155
    v_mfma_f32_16x16x32_bf16 a[20:23], a[180:183], v[176:179], a[20:23]
    ds_read_b128 a[152:155], v10 offset:57344
    v_cvt_pk_bf16_f32 v205, v210, v211
    v_mfma_f32_16x16x32_bf16 a[24:27], a[184:187], v[176:179], a[24:27]
    v_exp_f32 v208, v156
    v_mfma_f32_16x16x32_bf16 a[24:27], a[216:219], v[184:187], a[24:27]
    buffer_load_dwordx4 v29, s[8:11], s52 offen offset:1024 lds
    v_mfma_f32_16x16x32_bf16 a[28:31], a[220:223], v[184:187], a[28:31]
    v_exp_f32 v209, v157
    v_mfma_f32_16x16x32_bf16 a[28:31], a[188:191], v[176:179], a[28:31]
    ds_read_b128 a[156:159], v11 offset:57344
    v_cvt_pk_bf16_f32 v206, v208, v209
    v_mfma_f32_16x16x32_bf16 a[60:63], a[188:191], v[180:183], a[60:63]
    v_exp_f32 v210, v158
    v_mfma_f32_16x16x32_bf16 a[60:63], a[220:223], v[188:191], a[60:63]
    buffer_load_dwordx4 v30, s[12:15], s52 offen offset:2048 lds
    v_mfma_f32_16x16x32_bf16 a[56:59], a[216:219], v[188:191], a[56:59]
    v_exp_f32 v211, v159
    v_mfma_f32_16x16x32_bf16 a[56:59], a[184:187], v[180:183], a[56:59]
    v_cvt_pk_bf16_f32 v207, v210, v211
    v_mfma_f32_16x16x32_bf16 a[52:55], a[180:183], v[180:183], a[52:55]
    v_mov_b32 v233, v228
    v_mfma_f32_16x16x32_bf16 a[52:55], a[212:215], v[188:191], a[52:55]
    v_exp_f32 v208, v112
    v_mfma_f32_16x16x32_bf16 a[48:51], a[208:211], v[188:191], a[48:51]
    buffer_load_dwordx4 v31, s[12:15], s52 offen offset:3072 lds
    v_mfma_f32_16x16x32_bf16 a[48:51], a[176:179], v[180:183], a[48:51]
    v_exp_f32 v209, v113
    v_smfmac_f32_16x16x64_bf16 v[228:231], v[24:27], v[200:207], v235
    v_cvt_pk_bf16_f32 v192, v208, v209
    v_mfma_f32_16x16x32_bf16 a[44:47], a[172:175], v[180:183], a[44:47]
    v_exp_f32 v210, v114
    v_mfma_f32_16x16x32_bf16 a[44:47], a[204:207], v[188:191], a[44:47]
    buffer_store_dwordx4 a[228:231], v7, s[40:43], s3 offen offset:1024 sc1
    v_mfma_f32_16x16x32_bf16 a[40:43], a[200:203], v[188:191], a[40:43]
    v_exp_f32 v211, v115
    v_mfma_f32_16x16x32_bf16 a[40:43], a[168:171], v[180:183], a[40:43]
    v_cvt_pk_bf16_f32 v193, v210, v211
    v_cmp_nle_f32 vcc, v228, v234
    v_mfma_f32_16x16x32_bf16 a[36:39], a[164:167], v[180:183], a[36:39]
    v_exp_f32 v208, v116
    v_mfma_f32_16x16x32_bf16 a[36:39], a[196:199], v[188:191], a[36:39]
    buffer_store_dwordx4 a[232:235], v7, s[40:43], s3 offen offset:2048 sc1
    v_mfma_f32_16x16x32_bf16 a[32:35], a[192:195], v[188:191], a[32:35]
    v_exp_f32 v209, v117
    v_mfma_f32_16x16x32_bf16 a[32:35], a[160:163], v[180:183], a[32:35]
    s_waitcnt vmcnt(22) lgkmcnt(0)
    s_barrier
    v_cvt_pk_bf16_f32 v194, v208, v209
    s_cbranch_vccnz L_slow1_f11
L_back1_f11:
    v_mfma_f32_16x16x32_bf16 v[128:131], a[128:131], v[32:35], v[160:163]
    v_exp_f32 v210, v118
    v_mfma_f32_16x16x32_bf16 v[128:131], a[132:135], v[36:39], v[128:131]
    ds_read_b64_tr_b16 a[160:161], v244 offset:2048
    ds_read_b64_tr_b16 a[162:163], v244 offset:10240
    v_mfma_f32_16x16x32_bf16 v[128:131], a[136:139], v[40:43], v[128:131]
    v_exp_f32 v211, v119
    v_mfma_f32_16x16x32_bf16 v[128:131], a[140:143], v[44:47], v[128:131]
    ds_read_b64_tr_b16 a[164:165], v245 offset:2048
    v_cvt_pk_bf16_f32 v195, v210, v211
    v_mfma_f32_16x16x32_bf16 v[132:135], a[156:159], v[44:47], v[160:163]
    v_exp_f32 v208, v120
    v_mfma_f32_16x16x32_bf16 v[132:135], a[152:155], v[40:43], v[132:135]
    ds_read_b64_tr_b16 a[166:167], v245 offset:10240
    ds_read_b64_tr_b16 a[168:169], v246 offset:2048
    v_mfma_f32_16x16x32_bf16 v[132:135], a[148:151], v[36:39], v[132:135]
    v_exp_f32 v209, v121
    v_mfma_f32_16x16x32_bf16 v[132:135], a[144:147], v[32:35], v[132:135]
    ds_read_b64_tr_b16 a[170:171], v246 offset:10240
    v_cvt_pk_bf16_f32 v196, v208, v209
    v_mfma_f32_16x16x32_bf16 v[140:143], a[144:147], v[48:51], v[164:167]
    v_exp_f32 v210, v122
    v_mfma_f32_16x16x32_bf16 v[140:143], a[148:151], v[52:55], v[140:143]
    ds_read_b64_tr_b16 a[172:173], v247 offset:2048
    ds_read_b64_tr_b16 a[174:175], v247 offset:10240
    v_mfma_f32_16x16x32_bf16 v[140:143], a[152:155], v[56:59], v[140:143]
    v_exp_f32 v211, v123
    v_mfma_f32_16x16x32_bf16 v[140:143], a[156:159], v[60:63], v[140:143]
    ds_read_b64_tr_b16 a[176:177], v248 offset:2048
    v_cvt_pk_bf16_f32 v197, v210, v211
    v_mfma_f32_16x16x32_bf16 v[136:139], a[140:143], v[60:63], v[164:167]
    v_exp_f32 v208, v124
    v_mfma_f32_16x16x32_bf16 v[136:139], a[136:139], v[56:59], v[136:139]
    ds_read_b64_tr_b16 a[178:179], v248 offset:10240
    ds_read_b64_tr_b16 a[180:181], v249 offset:2048
    v_mfma_f32_16x16x32_bf16 v[136:139], a[132:135], v[52:55], v[136:139]
    v_exp_f32 v209, v125
    v_mfma_f32_16x16x32_bf16 v[136:139], a[128:131], v[48:51], v[136:139]
    ds_read_b64_tr_b16 a[182:183], v249 offset:10240
    v_cvt_pk_bf16_f32 v198, v208, v209
    v_mfma_f32_16x16x32_bf16 v[144:147], a[128:131], v[64:67], v[168:171]
    v_exp_f32 v210, v126
    v_mfma_f32_16x16x32_bf16 v[144:147], a[132:135], v[68:71], v[144:147]
    ds_read_b64_tr_b16 a[184:185], v250 offset:2048
    ds_read_b64_tr_b16 a[186:187], v250 offset:10240
    v_mfma_f32_16x16x32_bf16 v[144:147], a[136:139], v[72:75], v[144:147]
    v_exp_f32 v211, v127
    v_mfma_f32_16x16x32_bf16 v[144:147], a[140:143], v[76:79], v[144:147]
    ds_read_b64_tr_b16 a[188:189], v251 offset:2048
    v_cvt_pk_bf16_f32 v199, v210, v211
    v_mfma_f32_16x16x32_bf16 v[148:151], a[156:159], v[76:79], v[168:171]
    ds_read_b64_tr_b16 a[190:191], v251 offset:10240
    v_mov_b32 v233, v228
    v_mfma_f32_16x16x32_bf16 v[148:151], a[152:155], v[72:75], v[148:151]
    v_exp_f32 v208, v96
    v_mfma_f32_16x16x32_bf16 v[148:151], a[148:151], v[68:71], v[148:151]
    ds_read_b64_tr_b16 a[240:241], v252 offset:0
    ds_read_b64_tr_b16 a[242:243], v252 offset:4096
    v_mfma_f32_16x16x32_bf16 v[148:151], a[144:147], v[64:67], v[148:151]
    v_exp_f32 v209, v97
    v_smfmac_f32_16x16x64_bf16 v[228:231], v[24:27], v[192:199], v235
    ds_read_b64_tr_b16 a[244:245], v253 offset:0
    v_cvt_pk_bf16_f32 v176, v208, v209
    v_mfma_f32_16x16x32_bf16 v[156:159], a[144:147], v[80:83], v[172:175]
    v_exp_f32 v210, v98
    v_mfma_f32_16x16x32_bf16 v[156:159], a[148:151], v[84:87], v[156:159]
    ds_read_b64_tr_b16 a[246:247], v253 offset:4096
    v_mfma_f32_16x16x32_bf16 v[156:159], a[152:155], v[88:91], v[156:159]
    v_exp_f32 v211, v99
    v_mfma_f32_16x16x32_bf16 v[156:159], a[156:159], v[92:95], v[156:159]
    v_cvt_pk_bf16_f32 v177, v210, v211
    v_cmp_nle_f32 vcc, v228, v234
    v_mfma_f32_16x16x32_bf16 v[152:155], a[140:143], v[92:95], v[172:175]
    v_exp_f32 v208, v100
    v_mfma_f32_16x16x32_bf16 v[152:155], a[136:139], v[88:91], v[152:155]
    v_mfma_f32_16x16x32_bf16 v[152:155], a[132:135], v[84:87], v[152:155]
    v_exp_f32 v209, v101
    v_mfma_f32_16x16x32_bf16 v[152:155], a[128:131], v[80:83], v[152:155]
    s_waitcnt lgkmcnt(0)
    v_cvt_pk_bf16_f32 v178, v208, v209
    s_cbranch_vccnz L_slow0_f12
L_back0_f12:
    v_mfma_f32_16x16x32_bf16 a[64:67], a[192:195], v[200:203], a[64:67]
    v_exp_f32 v210, v102
    v_mfma_f32_16x16x32_bf16 a[64:67], a[160:163], v[192:195], a[64:67]
    ds_read_b128 a[128:131], v12 offset:0
    ds_read_b128 a[132:135], v13 offset:0
    v_mfma_f32_16x16x32_bf16 a[68:71], a[164:167], v[192:195], a[68:71]
    v_exp_f32 v211, v103
    v_mfma_f32_16x16x32_bf16 a[68:71], a[196:199], v[200:203], a[68:71]
    ds_read_b128 a[136:139], v14 offset:0
    v_cvt_pk_bf16_f32 v179, v210, v211
    v_mfma_f32_16x16x32_bf16 a[72:75], a[200:203], v[200:203], a[72:75]
    v_exp_f32 v208, v104
    v_mfma_f32_16x16x32_bf16 a[72:75], a[168:171], v[192:195], a[72:75]
    ds_read_b128 a[140:143], v15 offset:0
    ds_read_b128 a[144:147], v12 offset:8192
    v_mfma_f32_16x16x32_bf16 a[76:79], a[172:175], v[192:195], a[76:79]
    s_add_u32 s52, s52, 8192
    v_exp_f32 v209, v105
    v_mfma_f32_16x16x32_bf16 a[76:79], a[204:207], v[200:203], a[76:79]
    ds_read_b128 a[148:151], v13 offset:8192
    v_cvt_pk_bf16_f32 v180, v208, v209
    v_mfma_f32_16x16x32_bf16 a[80:83], a[208:211], v[200:203], a[80:83]
    s_add_u32 m0, s88, 32768
    v_exp_f32 v210, v106
    v_mfma_f32_16x16x32_bf16 a[80:83], a[176:179], v[192:195], a[80:83]
    buffer_load_dwordx4 v28, s[8:11], s52 offen offset:0 lds
    v_mfma_f32_16x16x32_bf16 a[84:87], a[180:183], v[192:195], a[84:87]
    v_exp_f32 v211, v107
    v_mfma_f32_16x16x32_bf16 a[84:87], a[212:215], v[200:203], a[84:87]
    ds_read_b128 a[152:155], v14 offset:8192
    v_cvt_pk_bf16_f32 v181, v210, v211
    v_mfma_f32_16x16x32_bf16 a[88:91], a[216:219], v[200:203], a[88:91]
    v_exp_f32 v208, v108
    v_mfma_f32_16x16x32_bf16 a[88:91], a[184:187], v[192:195], a[88:91]
    buffer_load_dwordx4 v29, s[8:11], s52 offen offset:1024 lds
    v_mfma_f32_16x16x32_bf16 a[92:95], a[188:191], v[192:195], a[92:95]
    v_exp_f32 v209, v109
    v_mfma_f32_16x16x32_bf16 a[92:95], a[220:223], v[200:203], a[92:95]
    ds_read_b128 a[156:159], v15 offset:8192
    v_cvt_pk_bf16_f32 v182, v208, v209
    v_mfma_f32_16x16x32_bf16 a[124:127], a[220:223], v[204:207], a[124:127]
    v_exp_f32 v210, v110
    v_mfma_f32_16x16x32_bf16 a[124:127], a[188:191], v[196:199], a[124:127]
    buffer_load_dwordx4 v30, s[12:15], s52 offen offset:2048 lds
    v_mfma_f32_16x16x32_bf16 a[120:123], a[184:187], v[196:199], a[120:123]
    v_exp_f32 v211, v111
    v_mfma_f32_16x16x32_bf16 a[120:123], a[216:219], v[204:207], a[120:123]
    v_cvt_pk_bf16_f32 v183, v210, v211
    v_mfma_f32_16x16x32_bf16 a[116:119], a[212:215], v[204:207], a[116:119]
    v_mov_b32 v232, v224
    v_mfma_f32_16x16x32_bf16 a[116:119], a[180:183], v[196:199], a[116:119]
    v_exp_f32 v208, v128
    v_mfma_f32_16x16x32_bf16 a[112:115], a[176:179], v[196:199], a[112:115]
    buffer_load_dwordx4 v31, s[12:15], s52 offen offset:3072 lds
    v_mfma_f32_16x16x32_bf16 a[112:115], a[208:211], v[204:207], a[112:115]
    v_exp_f32 v209, v129
    v_smfmac_f32_16x16x64_bf16 v[224:227], v[24:27], v[176:183], v235
    v_cvt_pk_bf16_f32 v184, v208, v209
    v_mfma_f32_16x16x32_bf16 a[108:111], a[204:207], v[204:207], a[108:111]
    v_exp_f32 v210, v130
    v_mfma_f32_16x16x32_bf16 a[108:111], a[172:175], v[196:199], a[108:111]
    v_mfma_f32_16x16x32_bf16 a[104:107], a[168:171], v[196:199], a[104:107]
    v_exp_f32 v211, v131
    v_mfma_f32_16x16x32_bf16 a[104:107], a[200:203], v[204:207], a[104:107]
    v_cvt_pk_bf16_f32 v185, v210, v211
    v_cmp_nle_f32 vcc, v224, v234
    v_mfma_f32_16x16x32_bf16 a[100:103], a[196:199], v[204:207], a[100:103]
    v_exp_f32 v208, v132
    v_mfma_f32_16x16x32_bf16 a[100:103], a[164:167], v[196:199], a[100:103]
    buffer_store_dwordx4 a[236:239], v7, s[40:43], s3 offen offset:3072 sc1
    v_mfma_f32_16x16x32_bf16 a[96:99], a[160:163], v[196:199], a[96:99]
    v_exp_f32 v209, v133
    v_mfma_f32_16x16x32_bf16 a[96:99], a[192:195], v[204:207], a[96:99]
    s_waitcnt lgkmcnt(0)
    v_cvt_pk_bf16_f32 v186, v208, v209
    s_cbranch_vccnz L_slow1_f12
L_back1_f12:
    v_mfma_f32_16x16x32_bf16 v[112:115], a[128:131], v[64:67], v[168:171]
    v_exp_f32 v210, v134
    v_mfma_f32_16x16x32_bf16 v[112:115], a[132:135], v[68:71], v[112:115]
    ds_read_b64_tr_b16 a[192:193], v244 offset:18432
    ds_read_b64_tr_b16 a[194:195], v244 offset:26624
    v_mfma_f32_16x16x32_bf16 v[112:115], a[136:139], v[72:75], v[112:115]
    v_exp_f32 v211, v135
    v_mfma_f32_16x16x32_bf16 v[112:115], a[140:143], v[76:79], v[112:115]
    ds_read_b64_tr_b16 a[196:197], v245 offset:18432
    v_cvt_pk_bf16_f32 v187, v210, v211
    v_mfma_f32_16x16x32_bf16 v[116:119], a[156:159], v[76:79], v[168:171]
    v_exp_f32 v208, v136
    v_mfma_f32_16x16x32_bf16 v[116:119], a[152:155], v[72:75], v[116:119]
    ds_read_b64_tr_b16 a[198:199], v245 offset:26624
    ds_read_b64_tr_b16 a[200:201], v246 offset:18432
    v_mfma_f32_16x16x32_bf16 v[116:119], a[148:151], v[68:71], v[116:119]
    v_exp_f32 v209, v137
    v_mfma_f32_16x16x32_bf16 v[116:119], a[144:147], v[64:67], v[116:119]
    ds_read_b64_tr_b16 a[202:203], v246 offset:26624
    v_cvt_pk_bf16_f32 v188, v208, v209
    v_mfma_f32_16x16x32_bf16 v[124:127], a[144:147], v[80:83], v[172:175]
    v_exp_f32 v210, v138
    v_mfma_f32_16x16x32_bf16 v[124:127], a[148:151], v[84:87], v[124:127]
    ds_read_b64_tr_b16 a[204:205], v247 offset:18432
    ds_read_b64_tr_b16 a[206:207], v247 offset:26624
    v_mfma_f32_16x16x32_bf16 v[124:127], a[152:155], v[88:91], v[124:127]
    v_exp_f32 v211, v139
    v_mfma_f32_16x16x32_bf16 v[124:127], a[156:159], v[92:95], v[124:127]
    ds_read_b64_tr_b16 a[208:209], v248 offset:18432
    v_cvt_pk_bf16_f32 v189, v210, v211
    v_mfma_f32_16x16x32_bf16 v[120:123], a[140:143], v[92:95], v[172:175]
    v_exp_f32 v208, v140
    v_mfma_f32_16x16x32_bf16 v[120:123], a[136:139], v[88:91], v[120:123]
    ds_read_b64_tr_b16 a[210:211], v248 offset:26624
    ds_read_b64_tr_b16 a[212:213], v249 offset:18432
    v_mfma_f32_16x16x32_bf16 v[120:123], a[132:135], v[84:87], v[120:123]
    v_exp_f32 v209, v141
    v_mfma_f32_16x16x32_bf16 v[120:123], a[128:131], v[80:83], v[120:123]
    ds_read_b64_tr_b16 a[214:215], v249 offset:26624
    v_cvt_pk_bf16_f32 v190, v208, v209
    v_mfma_f32_16x16x32_bf16 v[96:99], a[128:131], v[32:35], v[160:163]
    v_exp_f32 v210, v142
    v_mfma_f32_16x16x32_bf16 v[96:99], a[132:135], v[36:39], v[96:99]
    ds_read_b64_tr_b16 a[216:217], v250 offset:18432
    ds_read_b64_tr_b16 a[218:219], v250 offset:26624
    v_mfma_f32_16x16x32_bf16 v[96:99], a[136:139], v[40:43], v[96:99]
    v_exp_f32 v211, v143
    v_mfma_f32_16x16x32_bf16 v[96:99], a[140:143], v[44:47], v[96:99]
    ds_read_b64_tr_b16 a[220:221], v251 offset:18432
    v_cvt_pk_bf16_f32 v191, v210, v211
    v_mfma_f32_16x16x32_bf16 v[100:103], a[156:159], v[44:47], v[160:163]
    ds_read_b64_tr_b16 a[222:223], v251 offset:26624
    v_mov_b32 v232, v224
    v_mfma_f32_16x16x32_bf16 v[100:103], a[152:155], v[40:43], v[100:103]
    v_exp_f32 v208, v144
    v_mfma_f32_16x16x32_bf16 v[100:103], a[148:151], v[36:39], v[100:103]
    ds_read_b64_tr_b16 a[248:249], v254 offset:0
    ds_read_b64_tr_b16 a[250:251], v254 offset:4096
    v_mfma_f32_16x16x32_bf16 v[100:103], a[144:147], v[32:35], v[100:103]
    v_exp_f32 v209, v145
    v_smfmac_f32_16x16x64_bf16 v[224:227], v[24:27], v[184:191], v235
    ds_read_b64_tr_b16 a[252:253], v255 offset:0
    v_cvt_pk_bf16_f32 v200, v208, v209
    v_mfma_f32_16x16x32_bf16 v[108:111], a[144:147], v[48:51], v[164:167]
    v_exp_f32 v210, v146
    v_mfma_f32_16x16x32_bf16 v[108:111], a[148:151], v[52:55], v[108:111]
    ds_read_b64_tr_b16 a[254:255], v255 offset:4096
    v_mfma_f32_16x16x32_bf16 v[108:111], a[152:155], v[56:59], v[108:111]
    v_exp_f32 v211, v147
    v_mfma_f32_16x16x32_bf16 v[108:111], a[156:159], v[60:63], v[108:111]
    v_cvt_pk_bf16_f32 v201, v210, v211
    v_cmp_nle_f32 vcc, v224, v234
    v_mfma_f32_16x16x32_bf16 v[104:107], a[140:143], v[60:63], v[164:167]
    v_exp_f32 v208, v148
    v_mfma_f32_16x16x32_bf16 v[104:107], a[136:139], v[56:59], v[104:107]
    v_mfma_f32_16x16x32_bf16 v[104:107], a[132:135], v[52:55], v[104:107]
    v_exp_f32 v209, v149
    v_mfma_f32_16x16x32_bf16 v[104:107], a[128:131], v[48:51], v[104:107]
    s_waitcnt lgkmcnt(0)
    v_cvt_pk_bf16_f32 v202, v208, v209
    s_cbranch_vccnz L_slow0_f13
L_back0_f13:
    v_mfma_f32_16x16x32_bf16 a[0:3], a[160:163], v[176:179], a[0:3]
    v_exp_f32 v210, v150
    v_mfma_f32_16x16x32_bf16 a[0:3], a[192:195], v[184:187], a[0:3]
    ds_read_b128 a[128:131], v12 offset:16384
    ds_read_b128 a[132:135], v13 offset:16384
    v_mfma_f32_16x16x32_bf16 a[4:7], a[196:199], v[184:187], a[4:7]
    v_exp_f32 v211, v151
    v_mfma_f32_16x16x32_bf16 a[4:7], a[164:167], v[176:179], a[4:7]
    ds_read_b128 a[136:139], v14 offset:16384
    v_cvt_pk_bf16_f32 v203, v210, v211
    v_mfma_f32_16x16x32_bf16 a[8:11], a[168:171], v[176:179], a[8:11]
    v_exp_f32 v208, v152
    v_mfma_f32_16x16x32_bf16 a[8:11], a[200:203], v[184:187], a[8:11]
    ds_read_b128 a[140:143], v15 offset:16384
    ds_read_b128 a[144:147], v12 offset:24576
    v_mfma_f32_16x16x32_bf16 a[12:15], a[204:207], v[184:187], a[12:15]
    s_add_u32 s52, s52, 8192
    v_exp_f32 v209, v153
    v_mfma_f32_16x16x32_bf16 a[12:15], a[172:175], v[176:179], a[12:15]
    ds_read_b128 a[148:151], v13 offset:24576
    v_cvt_pk_bf16_f32 v204, v208, v209
    v_mfma_f32_16x16x32_bf16 a[16:19], a[176:179], v[176:179], a[16:19]
    s_add_u32 m0, s88, 49152
    v_exp_f32 v210, v154
    v_mfma_f32_16x16x32_bf16 a[16:19], a[208:211], v[184:187], a[16:19]
    buffer_load_dwordx4 v28, s[8:11], s52 offen offset:0 lds
    v_mfma_f32_16x16x32_bf16 a[20:23], a[212:215], v[184:187], a[20:23]
    v_exp_f32 v211, v155
    v_mfma_f32_16x16x32_bf16 a[20:23], a[180:183], v[176:179], a[20:23]
    ds_read_b128 a[152:155], v14 offset:24576
    v_cvt_pk_bf16_f32 v205, v210, v211
    v_mfma_f32_16x16x32_bf16 a[24:27], a[184:187], v[176:179], a[24:27]
    v_exp_f32 v208, v156
    v_mfma_f32_16x16x32_bf16 a[24:27], a[216:219], v[184:187], a[24:27]
    buffer_load_dwordx4 v29, s[8:11], s52 offen offset:1024 lds
    v_mfma_f32_16x16x32_bf16 a[28:31], a[220:223], v[184:187], a[28:31]
    v_exp_f32 v209, v157
    v_mfma_f32_16x16x32_bf16 a[28:31], a[188:191], v[176:179], a[28:31]
    ds_read_b128 a[156:159], v15 offset:24576
    v_cvt_pk_bf16_f32 v206, v208, v209
    v_mfma_f32_16x16x32_bf16 a[60:63], a[188:191], v[180:183], a[60:63]
    v_exp_f32 v210, v158
    v_mfma_f32_16x16x32_bf16 a[60:63], a[220:223], v[188:191], a[60:63]
    buffer_load_dwordx4 v30, s[12:15], s52 offen offset:2048 lds
    v_mfma_f32_16x16x32_bf16 a[56:59], a[216:219], v[188:191], a[56:59]
    v_exp_f32 v211, v159
    v_mfma_f32_16x16x32_bf16 a[56:59], a[184:187], v[180:183], a[56:59]
    v_cvt_pk_bf16_f32 v207, v210, v211
    v_mfma_f32_16x16x32_bf16 a[52:55], a[180:183], v[180:183], a[52:55]
    v_mov_b32 v233, v228
    v_mfma_f32_16x16x32_bf16 a[52:55], a[212:215], v[188:191], a[52:55]
    v_exp_f32 v208, v112
    v_mfma_f32_16x16x32_bf16 a[48:51], a[208:211], v[188:191], a[48:51]
    buffer_load_dwordx4 v31, s[12:15], s52 offen offset:3072 lds
    v_mfma_f32_16x16x32_bf16 a[48:51], a[176:179], v[180:183], a[48:51]
    v_exp_f32 v209, v113
    v_smfmac_f32_16x16x64_bf16 v[228:231], v[24:27], v[200:207], v235
    v_cvt_pk_bf16_f32 v192, v208, v209
    v_mfma_f32_16x16x32_bf16 a[44:47], a[172:175], v[180:183], a[44:47]
    v_exp_f32 v210, v114
    v_mfma_f32_16x16x32_bf16 a[44:47], a[204:207], v[188:191], a[44:47]
    v_mfma_f32_16x16x32_bf16 a[40:43], a[200:203], v[188:191], a[40:43]
    v_exp_f32 v211, v115
L_pad7:
    s_cbranch_execz L_pad11
    v_mfma_f32_16x16x32_bf16 a[40:43], a[168:171], v[180:183], a[40:43]
    v_cvt_pk_bf16_f32 v193, v210, v211
    v_cmp_nle_f32 vcc, v228, v234
    v_mfma_f32_16x16x32_bf16 a[36:39], a[164:167], v[180:183], a[36:39]
    v_exp_f32 v208, v116
    v_mfma_f32_16x16x32_bf16 a[36:39], a[196:199], v[188:191], a[36:39]
    buffer_store_dwordx4 a[240:243], v7, s[40:43], s7 offen offset:0 sc1
    v_mfma_f32_16x16x32_bf16 a[32:35], a[192:195], v[188:191], a[32:35]
    v_exp_f32 v209, v117
    v_mfma_f32_16x16x32_bf16 a[32:35], a[160:163], v[180:183], a[32:35]
    s_waitcnt vmcnt(22) lgkmcnt(0)
    s_barrier
    v_cvt_pk_bf16_f32 v194, v208, v209
    s_cbranch_vccnz L_slow1_f13
L_back1_f13:
    v_mfma_f32_16x16x32_bf16 v[128:131], a[128:131], v[32:35], v[160:163]
    v_exp_f32 v210, v118
    v_mfma_f32_16x16x32_bf16 v[128:131], a[132:135], v[36:39], v[128:131]
    ds_read_b64_tr_b16 a[160:161], v244 offset:34816
    ds_read_b64_tr_b16 a[162:163], v244 offset:43008
    v_mfma_f32_16x16x32_bf16 v[128:131], a[136:139], v[40:43], v[128:131]
    v_exp_f32 v211, v119
    v_mfma_f32_16x16x32_bf16 v[128:131], a[140:143], v[44:47], v[128:131]
    ds_read_b64_tr_b16 a[164:165], v245 offset:34816
    v_cvt_pk_bf16_f32 v195, v210, v211
    v_mfma_f32_16x16x32_bf16 v[132:135], a[156:159], v[44:47], v[160:163]
    v_exp_f32 v208, v120
    v_mfma_f32_16x16x32_bf16 v[132:135], a[152:155], v[40:43], v[132:135]
    ds_read_b64_tr_b16 a[166:167], v245 offset:43008
    ds_read_b64_tr_b16 a[168:169], v246 offset:34816
    v_mfma_f32_16x16x32_bf16 v[132:135], a[148:151], v[36:39], v[132:135]
    v_exp_f32 v209, v121
    v_mfma_f32_16x16x32_bf16 v[132:135], a[144:147], v[32:35], v[132:135]
    ds_read_b64_tr_b16 a[170:171], v246 offset:43008
    v_cvt_pk_bf16_f32 v196, v208, v209
    v_mfma_f32_16x16x32_bf16 v[140:143], a[144:147], v[48:51], v[164:167]
    v_exp_f32 v210, v122
    v_mfma_f32_16x16x32_bf16 v[140:143], a[148:151], v[52:55], v[140:143]
    ds_read_b64_tr_b16 a[172:173], v247 offset:34816
    ds_read_b64_tr_b16 a[174:175], v247 offset:43008
    v_mfma_f32_16x16x32_bf16 v[140:143], a[152:155], v[56:59], v[140:143]
    v_exp_f32 v211, v123
    v_mfma_f32_16x16x32_bf16 v[140:143], a[156:159], v[60:63], v[140:143]
    ds_read_b64_tr_b16 a[176:177], v248 offset:34816
    v_cvt_pk_bf16_f32 v197, v210, v211
    v_mfma_f32_16x16x32_bf16 v[136:139], a[140:143], v[60:63], v[164:167]
    v_exp_f32 v208, v124
    v_mfma_f32_16x16x32_bf16 v[136:139], a[136:139], v[56:59], v[136:139]
    ds_read_b64_tr_b16 a[178:179], v248 offset:43008
    ds_read_b64_tr_b16 a[180:181], v249 offset:34816
    v_mfma_f32_16x16x32_bf16 v[136:139], a[132:135], v[52:55], v[136:139]
    v_exp_f32 v209, v125
    v_mfma_f32_16x16x32_bf16 v[136:139], a[128:131], v[48:51], v[136:139]
    ds_read_b64_tr_b16 a[182:183], v249 offset:43008
    v_cvt_pk_bf16_f32 v198, v208, v209
    v_mfma_f32_16x16x32_bf16 v[144:147], a[128:131], v[64:67], v[168:171]
    v_exp_f32 v210, v126
    v_mfma_f32_16x16x32_bf16 v[144:147], a[132:135], v[68:71], v[144:147]
    ds_read_b64_tr_b16 a[184:185], v250 offset:34816
    ds_read_b64_tr_b16 a[186:187], v250 offset:43008
    v_mfma_f32_16x16x32_bf16 v[144:147], a[136:139], v[72:75], v[144:147]
    v_exp_f32 v211, v127
    v_mfma_f32_16x16x32_bf16 v[144:147], a[140:143], v[76:79], v[144:147]
    ds_read_b64_tr_b16 a[188:189], v251 offset:34816
    v_cvt_pk_bf16_f32 v199, v210, v211
    v_mfma_f32_16x16x32_bf16 v[148:151], a[156:159], v[76:79], v[168:171]
    ds_read_b64_tr_b16 a[190:191], v251 offset:43008
    v_mov_b32 v233, v228
    v_mfma_f32_16x16x32_bf16 v[148:151], a[152:155], v[72:75], v[148:151]
    v_exp_f32 v208, v96
    v_mfma_f32_16x16x32_bf16 v[148:151], a[148:151], v[68:71], v[148:151]
    v_mfma_f32_16x16x32_bf16 v[148:151], a[144:147], v[64:67], v[148:151]
    v_exp_f32 v209, v97
    v_smfmac_f32_16x16x64_bf16 v[228:231], v[24:27], v[192:199], v235
    v_cvt_pk_bf16_f32 v176, v208, v209
    v_mfma_f32_16x16x32_bf16 v[156:159], a[144:147], v[80:83], v[172:175]
    v_exp_f32 v210, v98
    v_mfma_f32_16x16x32_bf16 v[156:159], a[148:151], v[84:87], v[156:159]
    v_mfma_f32_16x16x32_bf16 v[156:159], a[152:155], v[88:91], v[156:159]
    v_exp_f32 v211, v99
    v_mfma_f32_16x16x32_bf16 v[156:159], a[156:159], v[92:95], v[156:159]
    v_cvt_pk_bf16_f32 v177, v210, v211
    v_cmp_nle_f32 vcc, v228, v234
    v_mfma_f32_16x16x32_bf16 v[152:155], a[140:143], v[92:95], v[172:175]
    v_exp_f32 v208, v100
    v_mfma_f32_16x16x32_bf16 v[152:155], a[136:139], v[88:91], v[152:155]
    v_mfma_f32_16x16x32_bf16 v[152:155], a[132:135], v[84:87], v[152:155]
    v_exp_f32 v209, v101
    v_mfma_f32_16x16x32_bf16 v[152:155], a[128:131], v[80:83], v[152:155]
    s_waitcnt lgkmcnt(0)
    v_cvt_pk_bf16_f32 v178, v208, v209
    s_cbranch_vccnz L_slow0_f14
L_back0_f14:
    v_mfma_f32_16x16x32_bf16 a[64:67], a[192:195], v[200:203], a[64:67]
    v_exp_f32 v210, v102
    v_mfma_f32_16x16x32_bf16 a[64:67], a[160:163], v[192:195], a[64:67]
    ds_read_b128 a[128:131], v12 offset:32768
    ds_read_b128 a[132:135], v13 offset:32768
    v_mfma_f32_16x16x32_bf16 a[68:71], a[164:167], v[192:195], a[68:71]
    v_exp_f32 v211, v103
    v_mfma_f32_16x16x32_bf16 a[68:71], a[196:199], v[200:203], a[68:71]
    ds_read_b128 a[136:139], v14 offset:32768
    v_cvt_pk_bf16_f32 v179, v210, v211
    v_mfma_f32_16x16x32_bf16 a[72:75], a[200:203], v[200:203], a[72:75]
    v_exp_f32 v208, v104
    v_mfma_f32_16x16x32_bf16 a[72:75], a[168:171], v[192:195], a[72:75]
    ds_read_b128 a[140:143], v15 offset:32768
    ds_read_b128 a[144:147], v12 offset:40960
    v_mfma_f32_16x16x32_bf16 a[76:79], a[172:175], v[192:195], a[76:79]
    s_add_u32 s52, s52, 8192
    v_exp_f32 v209, v105
    v_mfma_f32_16x16x32_bf16 a[76:79], a[204:207], v[200:203], a[76:79]
    ds_read_b128 a[148:151], v13 offset:40960
    v_cvt_pk_bf16_f32 v180, v208, v209
    v_mfma_f32_16x16x32_bf16 a[80:83], a[208:211], v[200:203], a[80:83]
    s_add_u32 m0, s88, 65536
    v_exp_f32 v210, v106
    v_mfma_f32_16x16x32_bf16 a[80:83], a[176:179], v[192:195], a[80:83]
    buffer_load_dwordx4 v28, s[8:11], s52 offen offset:0 lds
    v_mfma_f32_16x16x32_bf16 a[84:87], a[180:183], v[192:195], a[84:87]
    v_exp_f32 v211, v107
    v_mfma_f32_16x16x32_bf16 a[84:87], a[212:215], v[200:203], a[84:87]
    ds_read_b128 a[152:155], v14 offset:40960
    v_cvt_pk_bf16_f32 v181, v210, v211
    v_mfma_f32_16x16x32_bf16 a[88:91], a[216:219], v[200:203], a[88:91]
    v_exp_f32 v208, v108
    v_mfma_f32_16x16x32_bf16 a[88:91], a[184:187], v[192:195], a[88:91]
    buffer_load_dwordx4 v29, s[8:11], s52 offen offset:1024 lds
    v_mfma_f32_16x16x32_bf16 a[92:95], a[188:191], v[192:195], a[92:95]
    v_exp_f32 v209, v109
    v_mfma_f32_16x16x32_bf16 a[92:95], a[220:223], v[200:203], a[92:95]
    ds_read_b128 a[156:159], v15 offset:40960
    v_cvt_pk_bf16_f32 v182, v208, v209
    v_mfma_f32_16x16x32_bf16 a[124:127], a[220:223], v[204:207], a[124:127]
    v_exp_f32 v210, v110
    v_mfma_f32_16x16x32_bf16 a[124:127], a[188:191], v[196:199], a[124:127]
    buffer_load_dwordx4 v30, s[12:15], s52 offen offset:2048 lds
    v_mfma_f32_16x16x32_bf16 a[120:123], a[184:187], v[196:199], a[120:123]
    v_exp_f32 v211, v111
    v_mfma_f32_16x16x32_bf16 a[120:123], a[216:219], v[204:207], a[120:123]
    v_cvt_pk_bf16_f32 v183, v210, v211
    v_mfma_f32_16x16x32_bf16 a[116:119], a[212:215], v[204:207], a[116:119]
    v_mov_b32 v232, v224
    v_mfma_f32_16x16x32_bf16 a[116:119], a[180:183], v[196:199], a[116:119]
    v_exp_f32 v208, v128
    v_mfma_f32_16x16x32_bf16 a[112:115], a[176:179], v[196:199], a[112:115]
    buffer_load_dwordx4 v31, s[12:15], s52 offen offset:3072 lds
    v_mfma_f32_16x16x32_bf16 a[112:115], a[208:211], v[204:207], a[112:115]
    v_exp_f32 v209, v129
    v_smfmac_f32_16x16x64_bf16 v[224:227], v[24:27], v[176:183], v235
    v_cvt_pk_bf16_f32 v184, v208, v209
    v_mfma_f32_16x16x32_bf16 a[108:111], a[204:207], v[204:207], a[108:111]
    v_exp_f32 v210, v130
    v_mfma_f32_16x16x32_bf16 a[108:111], a[172:175], v[196:199], a[108:111]
    buffer_store_dwordx4 a[244:247], v7, s[40:43], s7 offen offset:1024 sc1
    v_mfma_f32_16x16x32_bf16 a[104:107], a[168:171], v[196:199], a[104:107]
    v_exp_f32 v211, v131
    v_mfma_f32_16x16x32_bf16 a[104:107], a[200:203], v[204:207], a[104:107]
    v_cvt_pk_bf16_f32 v185, v210, v211
    v_cmp_nle_f32 vcc, v224, v234
    v_mfma_f32_16x16x32_bf16 a[100:103], a[196:199], v[204:207], a[100:103]
    v_exp_f32 v208, v132
    v_mfma_f32_16x16x32_bf16 a[100:103], a[164:167], v[196:199], a[100:103]
    buffer_store_dwordx4 a[248:251], v7, s[40:43], s7 offen offset:2048 sc1
    v_mfma_f32_16x16x32_bf16 a[96:99], a[160:163], v[196:199], a[96:99]
    v_exp_f32 v209, v133
    v_mfma_f32_16x16x32_bf16 a[96:99], a[192:195], v[204:207], a[96:99]
    s_waitcnt lgkmcnt(0)
    v_cvt_pk_bf16_f32 v186, v208, v209
    s_cbranch_vccnz L_slow1_f14
L_back1_f14:
    v_mfma_f32_16x16x32_bf16 v[112:115], a[128:131], v[64:67], v[168:171]
    v_exp_f32 v210, v134
    v_mfma_f32_16x16x32_bf16 v[112:115], a[132:135], v[68:71], v[112:115]
    ds_read_b64_tr_b16 a[192:193], v244 offset:51200
    ds_read_b64_tr_b16 a[194:195], v244 offset:59392
    v_mfma_f32_16x16x32_bf16 v[112:115], a[136:139], v[72:75], v[112:115]
    v_exp_f32 v211, v135
    v_mfma_f32_16x16x32_bf16 v[112:115], a[140:143], v[76:79], v[112:115]
    ds_read_b64_tr_b16 a[196:197], v245 offset:51200
    v_cvt_pk_bf16_f32 v187, v210, v211
    v_mfma_f32_16x16x32_bf16 v[116:119], a[156:159], v[76:79], v[168:171]
    v_exp_f32 v208, v136
    v_mfma_f32_16x16x32_bf16 v[116:119], a[152:155], v[72:75], v[116:119]
    ds_read_b64_tr_b16 a[198:199], v245 offset:59392
    ds_read_b64_tr_b16 a[200:201], v246 offset:51200
    v_mfma_f32_16x16x32_bf16 v[116:119], a[148:151], v[68:71], v[116:119]
    v_exp_f32 v209, v137
    v_mfma_f32_16x16x32_bf16 v[116:119], a[144:147], v[64:67], v[116:119]
    ds_read_b64_tr_b16 a[202:203], v246 offset:59392
    v_cvt_pk_bf16_f32 v188, v208, v209
    v_mfma_f32_16x16x32_bf16 v[124:127], a[144:147], v[80:83], v[172:175]
    v_exp_f32 v210, v138
    v_mfma_f32_16x16x32_bf16 v[124:127], a[148:151], v[84:87], v[124:127]
    ds_read_b64_tr_b16 a[204:205], v247 offset:51200
    ds_read_b64_tr_b16 a[206:207], v247 offset:59392
    v_mfma_f32_16x16x32_bf16 v[124:127], a[152:155], v[88:91], v[124:127]
    v_exp_f32 v211, v139
    v_mfma_f32_16x16x32_bf16 v[124:127], a[156:159], v[92:95], v[124:127]
    ds_read_b64_tr_b16 a[208:209], v248 offset:51200
    v_cvt_pk_bf16_f32 v189, v210, v211
    v_mfma_f32_16x16x32_bf16 v[120:123], a[140:143], v[92:95], v[172:175]
    v_exp_f32 v208, v140
    v_mfma_f32_16x16x32_bf16 v[120:123], a[136:139], v[88:91], v[120:123]
    ds_read_b64_tr_b16 a[210:211], v248 offset:59392
    ds_read_b64_tr_b16 a[212:213], v249 offset:51200
    v_mfma_f32_16x16x32_bf16 v[120:123], a[132:135], v[84:87], v[120:123]
    v_exp_f32 v209, v141
    v_mfma_f32_16x16x32_bf16 v[120:123], a[128:131], v[80:83], v[120:123]
    ds_read_b64_tr_b16 a[214:215], v249 offset:59392
    v_cvt_pk_bf16_f32 v190, v208, v209
    v_mfma_f32_16x16x32_bf16 v[96:99], a[128:131], v[32:35], v[160:163]
    v_exp_f32 v210, v142
    v_mfma_f32_16x16x32_bf16 v[96:99], a[132:135], v[36:39], v[96:99]
    ds_read_b64_tr_b16 a[216:217], v250 offset:51200
    ds_read_b64_tr_b16 a[218:219], v250 offset:59392
    v_mfma_f32_16x16x32_bf16 v[96:99], a[136:139], v[40:43], v[96:99]
    v_exp_f32 v211, v143
    v_mfma_f32_16x16x32_bf16 v[96:99], a[140:143], v[44:47], v[96:99]
    ds_read_b64_tr_b16 a[220:221], v251 offset:51200
    v_cvt_pk_bf16_f32 v191, v210, v211
    v_mfma_f32_16x16x32_bf16 v[100:103], a[156:159], v[44:47], v[160:163]
    ds_read_b64_tr_b16 a[222:223], v251 offset:59392
    v_mov_b32 v232, v224
    v_mfma_f32_16x16x32_bf16 v[100:103], a[152:155], v[40:43], v[100:103]
    v_exp_f32 v208, v144
    v_mfma_f32_16x16x32_bf16 v[100:103], a[148:151], v[36:39], v[100:103]
    v_mfma_f32_16x16x32_bf16 v[100:103], a[144:147], v[32:35], v[100:103]
    v_exp_f32 v209, v145
    v_smfmac_f32_16x16x64_bf16 v[224:227], v[24:27], v[184:191], v235
    v_cvt_pk_bf16_f32 v200, v208, v209
    v_mfma_f32_16x16x32_bf16 v[108:111], a[144:147], v[48:51], v[164:167]
    v_exp_f32 v210, v146
    v_mfma_f32_16x16x32_bf16 v[108:111], a[148:151], v[52:55], v[108:111]
    v_mfma_f32_16x16x32_bf16 v[108:111], a[152:155], v[56:59], v[108:111]
    v_exp_f32 v211, v147
    v_mfma_f32_16x16x32_bf16 v[108:111], a[156:159], v[60:63], v[108:111]
    v_cvt_pk_bf16_f32 v201, v210, v211
    v_cmp_nle_f32 vcc, v224, v234
    v_mfma_f32_16x16x32_bf16 v[104:107], a[140:143], v[60:63], v[164:167]
    v_exp_f32 v208, v148
    v_mfma_f32_16x16x32_bf16 v[104:107], a[136:139], v[56:59], v[104:107]
    v_mfma_f32_16x16x32_bf16 v[104:107], a[132:135], v[52:55], v[104:107]
    v_exp_f32 v209, v149
    v_mfma_f32_16x16x32_bf16 v[104:107], a[128:131], v[48:51], v[104:107]
    s_waitcnt lgkmcnt(0)
    v_cvt_pk_bf16_f32 v202, v208, v209
    s_cbranch_vccnz L_slow0_f15
L_back0_f15:
    v_mfma_f32_16x16x32_bf16 a[0:3], a[160:163], v[176:179], a[0:3]
    v_exp_f32 v210, v150
    v_mfma_f32_16x16x32_bf16 a[0:3], a[192:195], v[184:187], a[0:3]
    ds_read_b128 a[128:131], v12 offset:49152
    ds_read_b128 a[132:135], v13 offset:49152
    v_mfma_f32_16x16x32_bf16 a[4:7], a[196:199], v[184:187], a[4:7]
    v_exp_f32 v211, v151
    v_mfma_f32_16x16x32_bf16 a[4:7], a[164:167], v[176:179], a[4:7]
    ds_read_b128 a[136:139], v14 offset:49152
    v_cvt_pk_bf16_f32 v203, v210, v211
    v_mfma_f32_16x16x32_bf16 a[8:11], a[168:171], v[176:179], a[8:11]
    v_exp_f32 v208, v152
    v_mfma_f32_16x16x32_bf16 a[8:11], a[200:203], v[184:187], a[8:11]
    ds_read_b128 a[140:143], v15 offset:49152
    ds_read_b128 a[144:147], v12 offset:57344
    v_mfma_f32_16x16x32_bf16 a[12:15], a[204:207], v[184:187], a[12:15]
    s_add_u32 s52, s52, 8192
    v_exp_f32 v209, v153
    v_mfma_f32_16x16x32_bf16 a[12:15], a[172:175], v[176:179], a[12:15]
    ds_read_b128 a[148:151], v13 offset:57344
    v_cvt_pk_bf16_f32 v204, v208, v209
    v_mfma_f32_16x16x32_bf16 a[16:19], a[176:179], v[176:179], a[16:19]
    s_add_u32 m0, s88, 81920
    v_exp_f32 v210, v154
    v_mfma_f32_16x16x32_bf16 a[16:19], a[208:211], v[184:187], a[16:19]
    buffer_load_dwordx4 v28, s[8:11], s52 offen offset:0 lds
    v_mfma_f32_16x16x32_bf16 a[20:23], a[212:215], v[184:187], a[20:23]
    v_exp_f32 v211, v155
    v_mfma_f32_16x16x32_bf16 a[20:23], a[180:183], v[176:179], a[20:23]
    ds_read_b128 a[152:155], v14 offset:57344
    v_cvt_pk_bf16_f32 v205, v210, v211
    v_mfma_f32_16x16x32_bf16 a[24:27], a[184:187], v[176:179], a[24:27]
    v_exp_f32 v208, v156
    v_mfma_f32_16x16x32_bf16 a[24:27], a[216:219], v[184:187], a[24:27]
    buffer_load_dwordx4 v29, s[8:11], s52 offen offset:1024 lds
    v_mfma_f32_16x16x32_bf16 a[28:31], a[220:223], v[184:187], a[28:31]
    v_exp_f32 v209, v157
    v_mfma_f32_16x16x32_bf16 a[28:31], a[188:191], v[176:179], a[28:31]
    ds_read_b128 a[156:159], v15 offset:57344
    v_cvt_pk_bf16_f32 v206, v208, v209
    v_mfma_f32_16x16x32_bf16 a[60:63], a[188:191], v[180:183], a[60:63]
    v_exp_f32 v210, v158
    v_mfma_f32_16x16x32_bf16 a[60:63], a[220:223], v[188:191], a[60:63]
    buffer_load_dwordx4 v30, s[12:15], s52 offen offset:2048 lds
    v_mfma_f32_16x16x32_bf16 a[56:59], a[216:219], v[188:191], a[56:59]
    v_exp_f32 v211, v159
    v_mfma_f32_16x16x32_bf16 a[56:59], a[184:187], v[180:183], a[56:59]
    v_cvt_pk_bf16_f32 v207, v210, v211
    v_mfma_f32_16x16x32_bf16 a[52:55], a[180:183], v[180:183], a[52:55]
    v_mov_b32 v233, v228
    v_mfma_f32_16x16x32_bf16 a[52:55], a[212:215], v[188:191], a[52:55]
    v_exp_f32 v208, v112
    v_mfma_f32_16x16x32_bf16 a[48:51], a[208:211], v[188:191], a[48:51]
    buffer_load_dwordx4 v31, s[12:15], s52 offen offset:3072 lds
    v_mfma_f32_16x16x32_bf16 a[48:51], a[176:179], v[180:183], a[48:51]
    v_exp_f32 v209, v113
    v_smfmac_f32_16x16x64_bf16 v[228:231], v[24:27], v[200:207], v235
    v_cvt_pk_bf16_f32 v192, v208, v209
    v_mfma_f32_16x16x32_bf16 a[44:47], a[172:175], v[180:183], a[44:47]
    v_exp_f32 v210, v114
    v_mfma_f32_16x16x32_bf16 a[44:47], a[204:207], v[188:191], a[44:47]
    v_mfma_f32_16x16x32_bf16 a[40:43], a[200:203], v[188:191], a[40:43]
    v_exp_f32 v211, v115
    v_mfma_f32_16x16x32_bf16 a[40:43], a[168:171], v[180:183], a[40:43]
    v_cvt_pk_bf16_f32 v193, v210, v211
    v_cmp_nle_f32 vcc, v228, v234
    v_mfma_f32_16x16x32_bf16 a[36:39], a[164:167], v[180:183], a[36:39]
    v_exp_f32 v208, v116
    v_mfma_f32_16x16x32_bf16 a[36:39], a[196:199], v[188:191], a[36:39]
    buffer_store_dwordx4 a[252:255], v7, s[40:43], s7 offen offset:3072 sc1
    v_mfma_f32_16x16x32_bf16 a[32:35], a[192:195], v[188:191], a[32:35]
    v_exp_f32 v209, v117
    v_mfma_f32_16x16x32_bf16 a[32:35], a[160:163], v[180:183], a[32:35]
    s_waitcnt vmcnt(23) lgkmcnt(0)
    s_barrier
    v_cvt_pk_bf16_f32 v194, v208, v209
    s_cbranch_vccnz L_slow1_f15
L_back1_f15:
.p2align 6
L_attn:
    v_mfma_f32_16x16x32_bf16 v[128:131], a[128:131], v[32:35], v[160:163]
    v_exp_f32 v210, v118
    v_mfma_f32_16x16x32_bf16 v[128:131], a[132:135], v[36:39], v[128:131]
    ds_read_b64_tr_b16 a[160:161], v16 offset:2048
    ds_read_b64_tr_b16 a[162:163], v16 offset:10240
    v_mfma_f32_16x16x32_bf16 v[128:131], a[136:139], v[40:43], v[128:131]
    v_exp_f32 v211, v119
    v_mfma_f32_16x16x32_bf16 v[128:131], a[140:143], v[44:47], v[128:131]
    ds_read_b64_tr_b16 a[164:165], v17 offset:2048
    v_cvt_pk_bf16_f32 v195, v210, v211
    v_mfma_f32_16x16x32_bf16 v[132:135], a[156:159], v[44:47], v[160:163]
    v_exp_f32 v208, v120
    v_mfma_f32_16x16x32_bf16 v[132:135], a[152:155], v[40:43], v[132:135]
    ds_read_b64_tr_b16 a[166:167], v17 offset:10240
    ds_read_b64_tr_b16 a[168:169], v18 offset:2048
    v_mfma_f32_16x16x32_bf16 v[132:135], a[148:151], v[36:39], v[132:135]
    v_exp_f32 v209, v121
    v_mfma_f32_16x16x32_bf16 v[132:135], a[144:147], v[32:35], v[132:135]
    ds_read_b64_tr_b16 a[170:171], v18 offset:10240
    v_cvt_pk_bf16_f32 v196, v208, v209
    v_mfma_f32_16x16x32_bf16 v[140:143], a[144:147], v[48:51], v[164:167]
    v_exp_f32 v210, v122
    v_mfma_f32_16x16x32_bf16 v[140:143], a[148:151], v[52:55], v[140:143]
    ds_read_b64_tr_b16 a[172:173], v19 offset:2048
    ds_read_b64_tr_b16 a[174:175], v19 offset:10240
    v_mfma_f32_16x16x32_bf16 v[140:143], a[152:155], v[56:59], v[140:143]
    v_exp_f32 v211, v123
    v_mfma_f32_16x16x32_bf16 v[140:143], a[156:159], v[60:63], v[140:143]
    ds_read_b64_tr_b16 a[176:177], v20 offset:2048
    v_cvt_pk_bf16_f32 v197, v210, v211
    v_mfma_f32_16x16x32_bf16 v[136:139], a[140:143], v[60:63], v[164:167]
    v_exp_f32 v208, v124
    v_mfma_f32_16x16x32_bf16 v[136:139], a[136:139], v[56:59], v[136:139]
    ds_read_b64_tr_b16 a[178:179], v20 offset:10240
    ds_read_b64_tr_b16 a[180:181], v21 offset:2048
    v_mfma_f32_16x16x32_bf16 v[136:139], a[132:135], v[52:55], v[136:139]
    v_exp_f32 v209, v125
    v_mfma_f32_16x16x32_bf16 v[136:139], a[128:131], v[48:51], v[136:139]
    ds_read_b64_tr_b16 a[182:183], v21 offset:10240
    v_cvt_pk_bf16_f32 v198, v208, v209
    v_mfma_f32_16x16x32_bf16 v[144:147], a[128:131], v[64:67], v[168:171]
    v_exp_f32 v210, v126
    v_mfma_f32_16x16x32_bf16 v[144:147], a[132:135], v[68:71], v[144:147]
    ds_read_b64_tr_b16 a[184:185], v22 offset:2048
    ds_read_b64_tr_b16 a[186:187], v22 offset:10240
    v_mfma_f32_16x16x32_bf16 v[144:147], a[136:139], v[72:75], v[144:147]
    v_exp_f32 v211, v127
    v_mfma_f32_16x16x32_bf16 v[144:147], a[140:143], v[76:79], v[144:147]
    ds_read_b64_tr_b16 a[188:189], v23 offset:2048
    v_cvt_pk_bf16_f32 v199, v210, v211
    v_mfma_f32_16x16x32_bf16 v[148:151], a[156:159], v[76:79], v[168:171]
    ds_read_b64_tr_b16 a[190:191], v23 offset:10240
    v_mov_b32 v233, v228
    v_mfma_f32_16x16x32_bf16 v[148:151], a[152:155], v[72:75], v[148:151]
    v_exp_f32 v208, v96
    v_mfma_f32_16x16x32_bf16 v[148:151], a[148:151], v[68:71], v[148:151]
    v_mfma_f32_16x16x32_bf16 v[148:151], a[144:147], v[64:67], v[148:151]
    v_exp_f32 v209, v97
    v_smfmac_f32_16x16x64_bf16 v[228:231], v[24:27], v[192:199], v235
    v_cvt_pk_bf16_f32 v176, v208, v209
    v_mfma_f32_16x16x32_bf16 v[156:159], a[144:147], v[80:83], v[172:175]
    v_exp_f32 v210, v98
    v_mfma_f32_16x16x32_bf16 v[156:159], a[148:151], v[84:87], v[156:159]
    v_mfma_f32_16x16x32_bf16 v[156:159], a[152:155], v[88:91], v[156:159]
    v_exp_f32 v211, v99
    v_mfma_f32_16x16x32_bf16 v[156:159], a[156:159], v[92:95], v[156:159]
    v_cvt_pk_bf16_f32 v177, v210, v211
    v_cmp_nle_f32 vcc, v228, v234
    v_mfma_f32_16x16x32_bf16 v[152:155], a[140:143], v[92:95], v[172:175]
    v_exp_f32 v208, v100
    v_mfma_f32_16x16x32_bf16 v[152:155], a[136:139], v[88:91], v[152:155]
    v_mfma_f32_16x16x32_bf16 v[152:155], a[132:135], v[84:87], v[152:155]
    v_exp_f32 v209, v101
    v_mfma_f32_16x16x32_bf16 v[152:155], a[128:131], v[80:83], v[152:155]
    s_waitcnt lgkmcnt(0)
    v_cvt_pk_bf16_f32 v178, v208, v209
    s_cbranch_vccnz L_slow0_s0
L_back0_s0:
    v_mfma_f32_16x16x32_bf16 a[64:67], a[192:195], v[200:203], a[64:67]
    v_exp_f32 v210, v102
    v_mfma_f32_16x16x32_bf16 a[64:67], a[160:163], v[192:195], a[64:67]
    ds_read_b128 a[128:131], v8 offset:0
    ds_read_b128 a[132:135], v9 offset:0
    v_mfma_f32_16x16x32_bf16 a[68:71], a[164:167], v[192:195], a[68:71]
    v_exp_f32 v211, v103
    v_mfma_f32_16x16x32_bf16 a[68:71], a[196:199], v[200:203], a[68:71]
    ds_read_b128 a[136:139], v10 offset:0
    v_cvt_pk_bf16_f32 v179, v210, v211
    v_mfma_f32_16x16x32_bf16 a[72:75], a[200:203], v[200:203], a[72:75]
    v_exp_f32 v208, v104
    v_mfma_f32_16x16x32_bf16 a[72:75], a[168:171], v[192:195], a[72:75]
    ds_read_b128 a[140:143], v11 offset:0
    ds_read_b128 a[144:147], v8 offset:8192
    v_mfma_f32_16x16x32_bf16 a[76:79], a[172:175], v[192:195], a[76:79]
    s_add_u32 s52, s52, 8192
    v_exp_f32 v209, v105
    v_mfma_f32_16x16x32_bf16 a[76:79], a[204:207], v[200:203], a[76:79]
    ds_read_b128 a[148:151], v9 offset:8192
    v_cvt_pk_bf16_f32 v180, v208, v209
    v_mfma_f32_16x16x32_bf16 a[80:83], a[208:211], v[200:203], a[80:83]
    s_add_u32 m0, s88, 98304
    v_exp_f32 v210, v106
    v_mfma_f32_16x16x32_bf16 a[80:83], a[176:179], v[192:195], a[80:83]
    buffer_load_dwordx4 v28, s[8:11], s52 offen offset:0 lds
    v_mfma_f32_16x16x32_bf16 a[84:87], a[180:183], v[192:195], a[84:87]
    v_exp_f32 v211, v107
    v_mfma_f32_16x16x32_bf16 a[84:87], a[212:215], v[200:203], a[84:87]
    ds_read_b128 a[152:155], v10 offset:8192
    v_cvt_pk_bf16_f32 v181, v210, v211
    v_mfma_f32_16x16x32_bf16 a[88:91], a[216:219], v[200:203], a[88:91]
    v_exp_f32 v208, v108
    v_mfma_f32_16x16x32_bf16 a[88:91], a[184:187], v[192:195], a[88:91]
    buffer_load_dwordx4 v29, s[8:11], s52 offen offset:1024 lds
    v_mfma_f32_16x16x32_bf16 a[92:95], a[188:191], v[192:195], a[92:95]
    v_exp_f32 v209, v109
    v_mfma_f32_16x16x32_bf16 a[92:95], a[220:223], v[200:203], a[92:95]
    ds_read_b128 a[156:159], v11 offset:8192
    v_cvt_pk_bf16_f32 v182, v208, v209
    v_mfma_f32_16x16x32_bf16 a[124:127], a[220:223], v[204:207], a[124:127]
    v_exp_f32 v210, v110
    v_mfma_f32_16x16x32_bf16 a[124:127], a[188:191], v[196:199], a[124:127]
    buffer_load_dwordx4 v30, s[12:15], s52 offen offset:2048 lds
    v_mfma_f32_16x16x32_bf16 a[120:123], a[184:187], v[196:199], a[120:123]
    v_exp_f32 v211, v111
    v_mfma_f32_16x16x32_bf16 a[120:123], a[216:219], v[204:207], a[120:123]
    v_cvt_pk_bf16_f32 v183, v210, v211
    v_mfma_f32_16x16x32_bf16 a[116:119], a[212:215], v[204:207], a[116:119]
    v_mov_b32 v232, v224
    v_mfma_f32_16x16x32_bf16 a[116:119], a[180:183], v[196:199], a[116:119]
    v_exp_f32 v208, v128
    v_mfma_f32_16x16x32_bf16 a[112:115], a[176:179], v[196:199], a[112:115]
    buffer_load_dwordx4 v31, s[12:15], s52 offen offset:3072 lds
    v_mfma_f32_16x16x32_bf16 a[112:115], a[208:211], v[204:207], a[112:115]
    v_exp_f32 v209, v129
    v_smfmac_f32_16x16x64_bf16 v[224:227], v[24:27], v[176:183], v235
    v_cvt_pk_bf16_f32 v184, v208, v209
    v_mfma_f32_16x16x32_bf16 a[108:111], a[204:207], v[204:207], a[108:111]
    v_exp_f32 v210, v130
    v_mfma_f32_16x16x32_bf16 a[108:111], a[172:175], v[196:199], a[108:111]
    v_mfma_f32_16x16x32_bf16 a[104:107], a[168:171], v[196:199], a[104:107]
    v_exp_f32 v211, v131
    v_mfma_f32_16x16x32_bf16 a[104:107], a[200:203], v[204:207], a[104:107]
    v_cvt_pk_bf16_f32 v185, v210, v211
    v_cmp_nle_f32 vcc, v224, v234
    v_mfma_f32_16x16x32_bf16 a[100:103], a[196:199], v[204:207], a[100:103]
    v_exp_f32 v208, v132
    v_mfma_f32_16x16x32_bf16 a[100:103], a[164:167], v[196:199], a[100:103]
    v_mfma_f32_16x16x32_bf16 a[96:99], a[160:163], v[196:199], a[96:99]
    v_exp_f32 v209, v133
    v_mfma_f32_16x16x32_bf16 a[96:99], a[192:195], v[204:207], a[96:99]
    s_waitcnt lgkmcnt(0)
    v_cvt_pk_bf16_f32 v186, v208, v209
    s_cbranch_vccnz L_slow1_s0
L_back1_s0:
    v_mfma_f32_16x16x32_bf16 v[112:115], a[128:131], v[64:67], v[168:171]
    v_exp_f32 v210, v134
    v_mfma_f32_16x16x32_bf16 v[112:115], a[132:135], v[68:71], v[112:115]
    ds_read_b64_tr_b16 a[192:193], v16 offset:18432
    ds_read_b64_tr_b16 a[194:195], v16 offset:26624
    v_mfma_f32_16x16x32_bf16 v[112:115], a[136:139], v[72:75], v[112:115]
    v_exp_f32 v211, v135
    v_mfma_f32_16x16x32_bf16 v[112:115], a[140:143], v[76:79], v[112:115]
    ds_read_b64_tr_b16 a[196:197], v17 offset:18432
    v_cvt_pk_bf16_f32 v187, v210, v211
    v_mfma_f32_16x16x32_bf16 v[116:119], a[156:159], v[76:79], v[168:171]
    v_exp_f32 v208, v136
    v_mfma_f32_16x16x32_bf16 v[116:119], a[152:155], v[72:75], v[116:119]
    ds_read_b64_tr_b16 a[198:199], v17 offset:26624
    ds_read_b64_tr_b16 a[200:201], v18 offset:18432
    v_mfma_f32_16x16x32_bf16 v[116:119], a[148:151], v[68:71], v[116:119]
    v_exp_f32 v209, v137
    v_mfma_f32_16x16x32_bf16 v[116:119], a[144:147], v[64:67], v[116:119]
    ds_read_b64_tr_b16 a[202:203], v18 offset:26624
    v_cvt_pk_bf16_f32 v188, v208, v209
    v_mfma_f32_16x16x32_bf16 v[124:127], a[144:147], v[80:83], v[172:175]
    v_exp_f32 v210, v138
    v_mfma_f32_16x16x32_bf16 v[124:127], a[148:151], v[84:87], v[124:127]
    ds_read_b64_tr_b16 a[204:205], v19 offset:18432
    ds_read_b64_tr_b16 a[206:207], v19 offset:26624
    v_mfma_f32_16x16x32_bf16 v[124:127], a[152:155], v[88:91], v[124:127]
    v_exp_f32 v211, v139
    v_mfma_f32_16x16x32_bf16 v[124:127], a[156:159], v[92:95], v[124:127]
    ds_read_b64_tr_b16 a[208:209], v20 offset:18432
    v_cvt_pk_bf16_f32 v189, v210, v211
    v_mfma_f32_16x16x32_bf16 v[120:123], a[140:143], v[92:95], v[172:175]
    v_exp_f32 v208, v140
    v_mfma_f32_16x16x32_bf16 v[120:123], a[136:139], v[88:91], v[120:123]
    ds_read_b64_tr_b16 a[210:211], v20 offset:26624
    ds_read_b64_tr_b16 a[212:213], v21 offset:18432
    v_mfma_f32_16x16x32_bf16 v[120:123], a[132:135], v[84:87], v[120:123]
    v_exp_f32 v209, v141
    v_mfma_f32_16x16x32_bf16 v[120:123], a[128:131], v[80:83], v[120:123]
    ds_read_b64_tr_b16 a[214:215], v21 offset:26624
    v_cvt_pk_bf16_f32 v190, v208, v209
    v_mfma_f32_16x16x32_bf16 v[96:99], a[128:131], v[32:35], v[160:163]
    v_exp_f32 v210, v142
    v_mfma_f32_16x16x32_bf16 v[96:99], a[132:135], v[36:39], v[96:99]
    ds_read_b64_tr_b16 a[216:217], v22 offset:18432
    ds_read_b64_tr_b16 a[218:219], v22 offset:26624
    v_mfma_f32_16x16x32_bf16 v[96:99], a[136:139], v[40:43], v[96:99]
    v_exp_f32 v211, v143
    v_mfma_f32_16x16x32_bf16 v[96:99], a[140:143], v[44:47], v[96:99]
    ds_read_b64_tr_b16 a[220:221], v23 offset:18432
    v_cvt_pk_bf16_f32 v191, v210, v211
    v_mfma_f32_16x16x32_bf16 v[100:103], a[156:159], v[44:47], v[160:163]
    ds_read_b64_tr_b16 a[222:223], v23 offset:26624
    v_mov_b32 v232, v224
    v_mfma_f32_16x16x32_bf16 v[100:103], a[152:155], v[40:43], v[100:103]
    v_exp_f32 v208, v144
    v_mfma_f32_16x16x32_bf16 v[100:103], a[148:151], v[36:39], v[100:103]
    v_mfma_f32_16x16x32_bf16 v[100:103], a[144:147], v[32:35], v[100:103]
    v_exp_f32 v209, v145
    v_smfmac_f32_16x16x64_bf16 v[224:227], v[24:27], v[184:191], v235
    v_cvt_pk_bf16_f32 v200, v208, v209
    v_mfma_f32_16x16x32_bf16 v[108:111], a[144:147], v[48:51], v[164:167]
    v_exp_f32 v210, v146
    v_mfma_f32_16x16x32_bf16 v[108:111], a[148:151], v[52:55], v[108:111]
    v_mfma_f32_16x16x32_bf16 v[108:111], a[152:155], v[56:59], v[108:111]
    v_exp_f32 v211, v147
    v_mfma_f32_16x16x32_bf16 v[108:111], a[156:159], v[60:63], v[108:111]
    v_cvt_pk_bf16_f32 v201, v210, v211
    v_cmp_nle_f32 vcc, v224, v234
    v_mfma_f32_16x16x32_bf16 v[104:107], a[140:143], v[60:63], v[164:167]
    v_exp_f32 v208, v148
    v_mfma_f32_16x16x32_bf16 v[104:107], a[136:139], v[56:59], v[104:107]
    v_mfma_f32_16x16x32_bf16 v[104:107], a[132:135], v[52:55], v[104:107]
    v_exp_f32 v209, v149
    v_mfma_f32_16x16x32_bf16 v[104:107], a[128:131], v[48:51], v[104:107]
    s_waitcnt lgkmcnt(0)
    v_cvt_pk_bf16_f32 v202, v208, v209
    s_cbranch_vccnz L_slow0_s1
L_back0_s1:
    v_mfma_f32_16x16x32_bf16 a[0:3], a[160:163], v[176:179], a[0:3]
    v_exp_f32 v210, v150
    v_mfma_f32_16x16x32_bf16 a[0:3], a[192:195], v[184:187], a[0:3]
    ds_read_b128 a[128:131], v8 offset:16384
    ds_read_b128 a[132:135], v9 offset:16384
    v_mfma_f32_16x16x32_bf16 a[4:7], a[196:199], v[184:187], a[4:7]
    v_exp_f32 v211, v151
    v_mfma_f32_16x16x32_bf16 a[4:7], a[164:167], v[176:179], a[4:7]
    ds_read_b128 a[136:139], v10 offset:16384
    v_cvt_pk_bf16_f32 v203, v210, v211
    v_mfma_f32_16x16x32_bf16 a[8:11], a[168:171], v[176:179], a[8:11]
    v_exp_f32 v208, v152
    v_mfma_f32_16x16x32_bf16 a[8:11], a[200:203], v[184:187], a[8:11]
    ds_read_b128 a[140:143], v11 offset:16384
    ds_read_b128 a[144:147], v8 offset:24576
    v_mfma_f32_16x16x32_bf16 a[12:15], a[204:207], v[184:187], a[12:15]
    s_add_u32 s52, s52, 8192
    v_exp_f32 v209, v153
    v_mfma_f32_16x16x32_bf16 a[12:15], a[172:175], v[176:179], a[12:15]
    ds_read_b128 a[148:151], v9 offset:24576
    v_cvt_pk_bf16_f32 v204, v208, v209
    v_mfma_f32_16x16x32_bf16 a[16:19], a[176:179], v[176:179], a[16:19]
    s_add_u32 m0, s88, 114688
    v_exp_f32 v210, v154
    v_mfma_f32_16x16x32_bf16 a[16:19], a[208:211], v[184:187], a[16:19]
    buffer_load_dwordx4 v28, s[8:11], s52 offen offset:0 lds
    v_mfma_f32_16x16x32_bf16 a[20:23], a[212:215], v[184:187], a[20:23]
    v_exp_f32 v211, v155
    v_mfma_f32_16x16x32_bf16 a[20:23], a[180:183], v[176:179], a[20:23]
    ds_read_b128 a[152:155], v10 offset:24576
    v_cvt_pk_bf16_f32 v205, v210, v211
    v_mfma_f32_16x16x32_bf16 a[24:27], a[184:187], v[176:179], a[24:27]
    v_exp_f32 v208, v156
    v_mfma_f32_16x16x32_bf16 a[24:27], a[216:219], v[184:187], a[24:27]
    buffer_load_dwordx4 v29, s[8:11], s52 offen offset:1024 lds
    v_mfma_f32_16x16x32_bf16 a[28:31], a[220:223], v[184:187], a[28:31]
    v_exp_f32 v209, v157
L_pad8:
    s_cbranch_execz L_pad12
    v_mfma_f32_16x16x32_bf16 a[28:31], a[188:191], v[176:179], a[28:31]
    ds_read_b128 a[156:159], v11 offset:24576
    v_cvt_pk_bf16_f32 v206, v208, v209
    v_mfma_f32_16x16x32_bf16 a[60:63], a[188:191], v[180:183], a[60:63]
    v_exp_f32 v210, v158
    v_mfma_f32_16x16x32_bf16 a[60:63], a[220:223], v[188:191], a[60:63]
    buffer_load_dwordx4 v30, s[12:15], s52 offen offset:2048 lds
    v_mfma_f32_16x16x32_bf16 a[56:59], a[216:219], v[188:191], a[56:59]
    v_exp_f32 v211, v159
    v_mfma_f32_16x16x32_bf16 a[56:59], a[184:187], v[180:183], a[56:59]
    v_cvt_pk_bf16_f32 v207, v210, v211
    v_mfma_f32_16x16x32_bf16 a[52:55], a[180:183], v[180:183], a[52:55]
    v_mov_b32 v233, v228
    v_mfma_f32_16x16x32_bf16 a[52:55], a[212:215], v[188:191], a[52:55]
    v_exp_f32 v208, v112
    v_mfma_f32_16x16x32_bf16 a[48:51], a[208:211], v[188:191], a[48:51]
    buffer_load_dwordx4 v31, s[12:15], s52 offen offset:3072 lds
    v_mfma_f32_16x16x32_bf16 a[48:51], a[176:179], v[180:183], a[48:51]
    v_exp_f32 v209, v113
    v_smfmac_f32_16x16x64_bf16 v[228:231], v[24:27], v[200:207], v235
    v_cvt_pk_bf16_f32 v192, v208, v209
    v_mfma_f32_16x16x32_bf16 a[44:47], a[172:175], v[180:183], a[44:47]
    v_exp_f32 v210, v114
    v_mfma_f32_16x16x32_bf16 a[44:47], a[204:207], v[188:191], a[44:47]
    v_mfma_f32_16x16x32_bf16 a[40:43], a[200:203], v[188:191], a[40:43]
    v_exp_f32 v211, v115
    v_mfma_f32_16x16x32_bf16 a[40:43], a[168:171], v[180:183], a[40:43]
    v_cvt_pk_bf16_f32 v193, v210, v211
    v_cmp_nle_f32 vcc, v228, v234
    v_mfma_f32_16x16x32_bf16 a[36:39], a[164:167], v[180:183], a[36:39]
    v_exp_f32 v208, v116
    v_mfma_f32_16x16x32_bf16 a[36:39], a[196:199], v[188:191], a[36:39]
    v_mfma_f32_16x16x32_bf16 a[32:35], a[192:195], v[188:191], a[32:35]
    v_exp_f32 v209, v117
    v_mfma_f32_16x16x32_bf16 a[32:35], a[160:163], v[180:183], a[32:35]
    s_waitcnt vmcnt(16) lgkmcnt(0)
    s_barrier
    v_cvt_pk_bf16_f32 v194, v208, v209
    s_cbranch_vccnz L_slow1_s1
L_back1_s1:
    v_mfma_f32_16x16x32_bf16 v[128:131], a[128:131], v[32:35], v[160:163]
    v_exp_f32 v210, v118
    v_mfma_f32_16x16x32_bf16 v[128:131], a[132:135], v[36:39], v[128:131]
    ds_read_b64_tr_b16 a[160:161], v16 offset:34816
    ds_read_b64_tr_b16 a[162:163], v16 offset:43008
    v_mfma_f32_16x16x32_bf16 v[128:131], a[136:139], v[40:43], v[128:131]
    v_exp_f32 v211, v119
    v_mfma_f32_16x16x32_bf16 v[128:131], a[140:143], v[44:47], v[128:131]
    ds_read_b64_tr_b16 a[164:165], v17 offset:34816
    v_cvt_pk_bf16_f32 v195, v210, v211
    v_mfma_f32_16x16x32_bf16 v[132:135], a[156:159], v[44:47], v[160:163]
    v_exp_f32 v208, v120
    v_mfma_f32_16x16x32_bf16 v[132:135], a[152:155], v[40:43], v[132:135]
    ds_read_b64_tr_b16 a[166:167], v17 offset:43008
    ds_read_b64_tr_b16 a[168:169], v18 offset:34816
    v_mfma_f32_16x16x32_bf16 v[132:135], a[148:151], v[36:39], v[132:135]
    v_exp_f32 v209, v121
    v_mfma_f32_16x16x32_bf16 v[132:135], a[144:147], v[32:35], v[132:135]
    ds_read_b64_tr_b16 a[170:171], v18 offset:43008
    v_cvt_pk_bf16_f32 v196, v208, v209
    v_mfma_f32_16x16x32_bf16 v[140:143], a[144:147], v[48:51], v[164:167]
    v_exp_f32 v210, v122
    v_mfma_f32_16x16x32_bf16 v[140:143], a[148:151], v[52:55], v[140:143]
    ds_read_b64_tr_b16 a[172:173], v19 offset:34816
    ds_read_b64_tr_b16 a[174:175], v19 offset:43008
    v_mfma_f32_16x16x32_bf16 v[140:143], a[152:155], v[56:59], v[140:143]
    v_exp_f32 v211, v123
    v_mfma_f32_16x16x32_bf16 v[140:143], a[156:159], v[60:63], v[140:143]
    ds_read_b64_tr_b16 a[176:177], v20 offset:34816
    v_cvt_pk_bf16_f32 v197, v210, v211
    v_mfma_f32_16x16x32_bf16 v[136:139], a[140:143], v[60:63], v[164:167]
    v_exp_f32 v208, v124
    v_mfma_f32_16x16x32_bf16 v[136:139], a[136:139], v[56:59], v[136:139]
    ds_read_b64_tr_b16 a[178:179], v20 offset:43008
    ds_read_b64_tr_b16 a[180:181], v21 offset:34816
    v_mfma_f32_16x16x32_bf16 v[136:139], a[132:135], v[52:55], v[136:139]
    v_exp_f32 v209, v125
    v_mfma_f32_16x16x32_bf16 v[136:139], a[128:131], v[48:51], v[136:139]
    ds_read_b64_tr_b16 a[182:183], v21 offset:43008
    v_cvt_pk_bf16_f32 v198, v208, v209
    v_mfma_f32_16x16x32_bf16 v[144:147], a[128:131], v[64:67], v[168:171]
    v_exp_f32 v210, v126
    v_mfma_f32_16x16x32_bf16 v[144:147], a[132:135], v[68:71], v[144:147]
    ds_read_b64_tr_b16 a[184:185], v22 offset:34816
    ds_read_b64_tr_b16 a[186:187], v22 offset:43008
    v_mfma_f32_16x16x32_bf16 v[144:147], a[136:139], v[72:75], v[144:147]
    v_exp_f32 v211, v127
    v_mfma_f32_16x16x32_bf16 v[144:147], a[140:143], v[76:79], v[144:147]
    ds_read_b64_tr_b16 a[188:189], v23 offset:34816
    v_cvt_pk_bf16_f32 v199, v210, v211
    v_mfma_f32_16x16x32_bf16 v[148:151], a[156:159], v[76:79], v[168:171]
    ds_read_b64_tr_b16 a[190:191], v23 offset:43008
    v_mov_b32 v233, v228
    v_mfma_f32_16x16x32_bf16 v[148:151], a[152:155], v[72:75], v[148:151]
    s_cmp_eq_u32 s55, s60
    v_exp_f32 v208, v96
    v_mfma_f32_16x16x32_bf16 v[148:151], a[148:151], v[68:71], v[148:151]
    s_cbranch_scc1 L_cnt
L_cnt_ok:
    v_mfma_f32_16x16x32_bf16 v[148:151], a[144:147], v[64:67], v[148:151]
    v_exp_f32 v209, v97
    v_smfmac_f32_16x16x64_bf16 v[228:231], v[24:27], v[192:199], v235
    v_cvt_pk_bf16_f32 v176, v208, v209
    v_mfma_f32_16x16x32_bf16 v[156:159], a[144:147], v[80:83], v[172:175]
    v_exp_f32 v210, v98
    v_mfma_f32_16x16x32_bf16 v[156:159], a[148:151], v[84:87], v[156:159]
    v_mfma_f32_16x16x32_bf16 v[156:159], a[152:155], v[88:91], v[156:159]
    v_exp_f32 v211, v99
    v_mfma_f32_16x16x32_bf16 v[156:159], a[156:159], v[92:95], v[156:159]
    v_cvt_pk_bf16_f32 v177, v210, v211
    v_cmp_nle_f32 vcc, v228, v234
    v_mfma_f32_16x16x32_bf16 v[152:155], a[140:143], v[92:95], v[172:175]
    v_exp_f32 v208, v100
    v_mfma_f32_16x16x32_bf16 v[152:155], a[136:139], v[88:91], v[152:155]
    v_mfma_f32_16x16x32_bf16 v[152:155], a[132:135], v[84:87], v[152:155]
    v_exp_f32 v209, v101
    v_mfma_f32_16x16x32_bf16 v[152:155], a[128:131], v[80:83], v[152:155]
    s_waitcnt lgkmcnt(0)
    v_cvt_pk_bf16_f32 v178, v208, v209
    s_cbranch_vccnz L_slow0_s2
L_back0_s2:
    v_mfma_f32_16x16x32_bf16 a[64:67], a[192:195], v[200:203], a[64:67]
    v_exp_f32 v210, v102
    v_mfma_f32_16x16x32_bf16 a[64:67], a[160:163], v[192:195], a[64:67]
    ds_read_b128 a[128:131], v8 offset:32768
    ds_read_b128 a[132:135], v9 offset:32768
    v_mfma_f32_16x16x32_bf16 a[68:71], a[164:167], v[192:195], a[68:71]
    v_exp_f32 v211, v103
    v_mfma_f32_16x16x32_bf16 a[68:71], a[196:199], v[200:203], a[68:71]
    ds_read_b128 a[136:139], v10 offset:32768
    v_cvt_pk_bf16_f32 v179, v210, v211
    v_mfma_f32_16x16x32_bf16 a[72:75], a[200:203], v[200:203], a[72:75]
    v_exp_f32 v208, v104
    v_mfma_f32_16x16x32_bf16 a[72:75], a[168:171], v[192:195], a[72:75]
    ds_read_b128 a[140:143], v11 offset:32768
    ds_read_b128 a[144:147], v8 offset:40960
    v_mfma_f32_16x16x32_bf16 a[76:79], a[172:175], v[192:195], a[76:79]
    s_add_u32 s52, s52, 8192
    v_exp_f32 v209, v105
    v_mfma_f32_16x16x32_bf16 a[76:79], a[204:207], v[200:203], a[76:79]
    ds_read_b128 a[148:151], v9 offset:40960
    v_cvt_pk_bf16_f32 v180, v208, v209
    v_mfma_f32_16x16x32_bf16 a[80:83], a[208:211], v[200:203], a[80:83]
    s_add_u32 m0, s88, 0
    v_exp_f32 v210, v106
    v_mfma_f32_16x16x32_bf16 a[80:83], a[176:179], v[192:195], a[80:83]
    buffer_load_dwordx4 v28, s[8:11], s52 offen offset:0 lds
    v_mfma_f32_16x16x32_bf16 a[84:87], a[180:183], v[192:195], a[84:87]
    v_exp_f32 v211, v107
    v_mfma_f32_16x16x32_bf16 a[84:87], a[212:215], v[200:203], a[84:87]
    ds_read_b128 a[152:155], v10 offset:40960
    v_cvt_pk_bf16_f32 v181, v210, v211
    v_mfma_f32_16x16x32_bf16 a[88:91], a[216:219], v[200:203], a[88:91]
    v_exp_f32 v208, v108
    v_mfma_f32_16x16x32_bf16 a[88:91], a[184:187], v[192:195], a[88:91]
    buffer_load_dwordx4 v29, s[8:11], s52 offen offset:1024 lds
    v_mfma_f32_16x16x32_bf16 a[92:95], a[188:191], v[192:195], a[92:95]
    v_exp_f32 v209, v109
    v_mfma_f32_16x16x32_bf16 a[92:95], a[220:223], v[200:203], a[92:95]
    ds_read_b128 a[156:159], v11 offset:40960
    v_cvt_pk_bf16_f32 v182, v208, v209
    v_mfma_f32_16x16x32_bf16 a[124:127], a[220:223], v[204:207], a[124:127]
    v_exp_f32 v210, v110
    v_mfma_f32_16x16x32_bf16 a[124:127], a[188:191], v[196:199], a[124:127]
    buffer_load_dwordx4 v30, s[12:15], s52 offen offset:2048 lds
    v_mfma_f32_16x16x32_bf16 a[120:123], a[184:187], v[196:199], a[120:123]
    v_exp_f32 v211, v111
    v_mfma_f32_16x16x32_bf16 a[120:123], a[216:219], v[204:207], a[120:123]
    v_cvt_pk_bf16_f32 v183, v210, v211
    v_mfma_f32_16x16x32_bf16 a[116:119], a[212:215], v[204:207], a[116:119]
    v_mov_b32 v232, v224
    v_mfma_f32_16x16x32_bf16 a[116:119], a[180:183], v[196:199], a[116:119]
    v_exp_f32 v208, v128
    v_mfma_f32_16x16x32_bf16 a[112:115], a[176:179], v[196:199], a[112:115]
    buffer_load_dwordx4 v31, s[12:15], s52 offen offset:3072 lds
    v_mfma_f32_16x16x32_bf16 a[112:115], a[208:211], v[204:207], a[112:115]
    v_exp_f32 v209, v129
    v_smfmac_f32_16x16x64_bf16 v[224:227], v[24:27], v[176:183], v235
    v_cvt_pk_bf16_f32 v184, v208, v209
    v_mfma_f32_16x16x32_bf16 a[108:111], a[204:207], v[204:207], a[108:111]
    v_exp_f32 v210, v130
    v_mfma_f32_16x16x32_bf16 a[108:111], a[172:175], v[196:199], a[108:111]
    v_mfma_f32_16x16x32_bf16 a[104:107], a[168:171], v[196:199], a[104:107]
    v_exp_f32 v211, v131
    v_mfma_f32_16x16x32_bf16 a[104:107], a[200:203], v[204:207], a[104:107]
    v_cvt_pk_bf16_f32 v185, v210, v211
    v_cmp_nle_f32 vcc, v224, v234
    v_mfma_f32_16x16x32_bf16 a[100:103], a[196:199], v[204:207], a[100:103]
    v_exp_f32 v208, v132
    v_mfma_f32_16x16x32_bf16 a[100:103], a[164:167], v[196:199], a[100:103]
    v_mfma_f32_16x16x32_bf16 a[96:99], a[160:163], v[196:199], a[96:99]
    v_exp_f32 v209, v133
    v_mfma_f32_16x16x32_bf16 a[96:99], a[192:195], v[204:207], a[96:99]
    s_waitcnt lgkmcnt(0)
    v_cvt_pk_bf16_f32 v186, v208, v209
    s_cbranch_vccnz L_slow1_s2
L_back1_s2:
    v_mfma_f32_16x16x32_bf16 v[112:115], a[128:131], v[64:67], v[168:171]
    v_exp_f32 v210, v134
    v_mfma_f32_16x16x32_bf16 v[112:115], a[132:135], v[68:71], v[112:115]
    ds_read_b64_tr_b16 a[192:193], v16 offset:51200
    ds_read_b64_tr_b16 a[194:195], v16 offset:59392
    v_mfma_f32_16x16x32_bf16 v[112:115], a[136:139], v[72:75], v[112:115]
    v_exp_f32 v211, v135
    v_mfma_f32_16x16x32_bf16 v[112:115], a[140:143], v[76:79], v[112:115]
    ds_read_b64_tr_b16 a[196:197], v17 offset:51200
    v_cvt_pk_bf16_f32 v187, v210, v211
    v_mfma_f32_16x16x32_bf16 v[116:119], a[156:159], v[76:79], v[168:171]
    v_exp_f32 v208, v136
    v_mfma_f32_16x16x32_bf16 v[116:119], a[152:155], v[72:75], v[116:119]
    ds_read_b64_tr_b16 a[198:199], v17 offset:59392
    ds_read_b64_tr_b16 a[200:201], v18 offset:51200
    v_mfma_f32_16x16x32_bf16 v[116:119], a[148:151], v[68:71], v[116:119]
    v_exp_f32 v209, v137
    v_mfma_f32_16x16x32_bf16 v[116:119], a[144:147], v[64:67], v[116:119]
    ds_read_b64_tr_b16 a[202:203], v18 offset:59392
    v_cvt_pk_bf16_f32 v188, v208, v209
    v_mfma_f32_16x16x32_bf16 v[124:127], a[144:147], v[80:83], v[172:175]
    v_exp_f32 v210, v138
    v_mfma_f32_16x16x32_bf16 v[124:127], a[148:151], v[84:87], v[124:127]
    ds_read_b64_tr_b16 a[204:205], v19 offset:51200
    ds_read_b64_tr_b16 a[206:207], v19 offset:59392
    v_mfma_f32_16x16x32_bf16 v[124:127], a[152:155], v[88:91], v[124:127]
    v_exp_f32 v211, v139
    v_mfma_f32_16x16x32_bf16 v[124:127], a[156:159], v[92:95], v[124:127]
    ds_read_b64_tr_b16 a[208:209], v20 offset:51200
    v_cvt_pk_bf16_f32 v189, v210, v211
    v_mfma_f32_16x16x32_bf16 v[120:123], a[140:143], v[92:95], v[172:175]
    v_exp_f32 v208, v140
    v_mfma_f32_16x16x32_bf16 v[120:123], a[136:139], v[88:91], v[120:123]
    ds_read_b64_tr_b16 a[210:211], v20 offset:59392
    ds_read_b64_tr_b16 a[212:213], v21 offset:51200
    v_mfma_f32_16x16x32_bf16 v[120:123], a[132:135], v[84:87], v[120:123]
    v_exp_f32 v209, v141
    v_mfma_f32_16x16x32_bf16 v[120:123], a[128:131], v[80:83], v[120:123]
    ds_read_b64_tr_b16 a[214:215], v21 offset:59392
    v_cvt_pk_bf16_f32 v190, v208, v209
    v_mfma_f32_16x16x32_bf16 v[96:99], a[128:131], v[32:35], v[160:163]
    v_exp_f32 v210, v142
    v_mfma_f32_16x16x32_bf16 v[96:99], a[132:135], v[36:39], v[96:99]
    ds_read_b64_tr_b16 a[216:217], v22 offset:51200
    ds_read_b64_tr_b16 a[218:219], v22 offset:59392
    v_mfma_f32_16x16x32_bf16 v[96:99], a[136:139], v[40:43], v[96:99]
    v_exp_f32 v211, v143
    v_mfma_f32_16x16x32_bf16 v[96:99], a[140:143], v[44:47], v[96:99]
    ds_read_b64_tr_b16 a[220:221], v23 offset:51200
    v_cvt_pk_bf16_f32 v191, v210, v211
    v_mfma_f32_16x16x32_bf16 v[100:103], a[156:159], v[44:47], v[160:163]
    ds_read_b64_tr_b16 a[222:223], v23 offset:59392
    v_mov_b32 v232, v224
    v_mfma_f32_16x16x32_bf16 v[100:103], a[152:155], v[40:43], v[100:103]
    v_exp_f32 v208, v144
    v_mfma_f32_16x16x32_bf16 v[100:103], a[148:151], v[36:39], v[100:103]
    v_mfma_f32_16x16x32_bf16 v[100:103], a[144:147], v[32:35], v[100:103]
    v_exp_f32 v209, v145
    v_smfmac_f32_16x16x64_bf16 v[224:227], v[24:27], v[184:191], v235
    v_cvt_pk_bf16_f32 v200, v208, v209
    v_mfma_f32_16x16x32_bf16 v[108:111], a[144:147], v[48:51], v[164:167]
    v_exp_f32 v210, v146
    v_mfma_f32_16x16x32_bf16 v[108:111], a[148:151], v[52:55], v[108:111]
    v_mfma_f32_16x16x32_bf16 v[108:111], a[152:155], v[56:59], v[108:111]
    v_exp_f32 v211, v147
    v_mfma_f32_16x16x32_bf16 v[108:111], a[156:159], v[60:63], v[108:111]
    v_cvt_pk_bf16_f32 v201, v210, v211
    v_cmp_nle_f32 vcc, v224, v234
    v_mfma_f32_16x16x32_bf16 v[104:107], a[140:143], v[60:63], v[164:167]
    v_exp_f32 v208, v148
    v_mfma_f32_16x16x32_bf16 v[104:107], a[136:139], v[56:59], v[104:107]
    v_mfma_f32_16x16x32_bf16 v[104:107], a[132:135], v[52:55], v[104:107]
    v_exp_f32 v209, v149
    v_mfma_f32_16x16x32_bf16 v[104:107], a[128:131], v[48:51], v[104:107]
    s_waitcnt lgkmcnt(0)
    v_cvt_pk_bf16_f32 v202, v208, v209
    s_cbranch_vccnz L_slow0_s3
L_back0_s3:
    v_mfma_f32_16x16x32_bf16 a[0:3], a[160:163], v[176:179], a[0:3]
    v_exp_f32 v210, v150
    v_mfma_f32_16x16x32_bf16 a[0:3], a[192:195], v[184:187], a[0:3]
    ds_read_b128 a[128:131], v8 offset:49152
    ds_read_b128 a[132:135], v9 offset:49152
    v_mfma_f32_16x16x32_bf16 a[4:7], a[196:199], v[184:187], a[4:7]
    v_exp_f32 v211, v151
    v_mfma_f32_16x16x32_bf16 a[4:7], a[164:167], v[176:179], a[4:7]
    ds_read_b128 a[136:139], v10 offset:49152
    v_cvt_pk_bf16_f32 v203, v210, v211
    v_mfma_f32_16x16x32_bf16 a[8:11], a[168:171], v[176:179], a[8:11]
    v_exp_f32 v208, v152
    v_mfma_f32_16x16x32_bf16 a[8:11], a[200:203], v[184:187], a[8:11]
    ds_read_b128 a[140:143], v11 offset:49152
    ds_read_b128 a[144:147], v8 offset:57344
    v_mfma_f32_16x16x32_bf16 a[12:15], a[204:207], v[184:187], a[12:15]
    s_add_u32 s52, s52, 8192
    v_exp_f32 v209, v153
    v_mfma_f32_16x16x32_bf16 a[12:15], a[172:175], v[176:179], a[12:15]
    ds_read_b128 a[148:151], v9 offset:57344
    v_cvt_pk_bf16_f32 v204, v208, v209
    v_mfma_f32_16x16x32_bf16 a[16:19], a[176:179], v[176:179], a[16:19]
    s_add_u32 m0, s88, 16384
    v_exp_f32 v210, v154
    v_mfma_f32_16x16x32_bf16 a[16:19], a[208:211], v[184:187], a[16:19]
    buffer_load_dwordx4 v28, s[8:11], s52 offen offset:0 lds
    v_mfma_f32_16x16x32_bf16 a[20:23], a[212:215], v[184:187], a[20:23]
    v_exp_f32 v211, v155
    v_mfma_f32_16x16x32_bf16 a[20:23], a[180:183], v[176:179], a[20:23]
    ds_read_b128 a[152:155], v10 offset:57344
    v_cvt_pk_bf16_f32 v205, v210, v211
    v_mfma_f32_16x16x32_bf16 a[24:27], a[184:187], v[176:179], a[24:27]
    v_exp_f32 v208, v156
    v_mfma_f32_16x16x32_bf16 a[24:27], a[216:219], v[184:187], a[24:27]
    buffer_load_dwordx4 v29, s[8:11], s52 offen offset:1024 lds
    v_mfma_f32_16x16x32_bf16 a[28:31], a[220:223], v[184:187], a[28:31]
    v_exp_f32 v209, v157
    v_mfma_f32_16x16x32_bf16 a[28:31], a[188:191], v[176:179], a[28:31]
    ds_read_b128 a[156:159], v11 offset:57344
    v_cvt_pk_bf16_f32 v206, v208, v209
    v_mfma_f32_16x16x32_bf16 a[60:63], a[188:191], v[180:183], a[60:63]
    v_exp_f32 v210, v158
    v_mfma_f32_16x16x32_bf16 a[60:63], a[220:223], v[188:191], a[60:63]
    buffer_load_dwordx4 v30, s[12:15], s52 offen offset:2048 lds
    v_mfma_f32_16x16x32_bf16 a[56:59], a[216:219], v[188:191], a[56:59]
    v_exp_f32 v211, v159
    v_mfma_f32_16x16x32_bf16 a[56:59], a[184:187], v[180:183], a[56:59]
    v_cvt_pk_bf16_f32 v207, v210, v211
    v_mfma_f32_16x16x32_bf16 a[52:55], a[180:183], v[180:183], a[52:55]
    v_mov_b32 v233, v228
    v_mfma_f32_16x16x32_bf16 a[52:55], a[212:215], v[188:191], a[52:55]
    v_exp_f32 v208, v112
    v_mfma_f32_16x16x32_bf16 a[48:51], a[208:211], v[188:191], a[48:51]
    buffer_load_dwordx4 v31, s[12:15], s52 offen offset:3072 lds
    v_mfma_f32_16x16x32_bf16 a[48:51], a[176:179], v[180:183], a[48:51]
    v_exp_f32 v209, v113
    v_smfmac_f32_16x16x64_bf16 v[228:231], v[24:27], v[200:207], v235
    v_cvt_pk_bf16_f32 v192, v208, v209
    v_mfma_f32_16x16x32_bf16 a[44:47], a[172:175], v[180:183], a[44:47]
    v_exp_f32 v210, v114
    v_mfma_f32_16x16x32_bf16 a[44:47], a[204:207], v[188:191], a[44:47]
    v_mfma_f32_16x16x32_bf16 a[40:43], a[200:203], v[188:191], a[40:43]
    v_exp_f32 v211, v115
    v_mfma_f32_16x16x32_bf16 a[40:43], a[168:171], v[180:183], a[40:43]
    v_cvt_pk_bf16_f32 v193, v210, v211
    v_cmp_nle_f32 vcc, v228, v234
    v_mfma_f32_16x16x32_bf16 a[36:39], a[164:167], v[180:183], a[36:39]
    v_exp_f32 v208, v116
    v_mfma_f32_16x16x32_bf16 a[36:39], a[196:199], v[188:191], a[36:39]
    v_mfma_f32_16x16x32_bf16 a[32:35], a[192:195], v[188:191], a[32:35]
    v_exp_f32 v209, v117
    v_mfma_f32_16x16x32_bf16 a[32:35], a[160:163], v[180:183], a[32:35]
    s_waitcnt vmcnt(16) lgkmcnt(0)
    s_barrier
    v_cvt_pk_bf16_f32 v194, v208, v209
    s_cbranch_vccnz L_slow1_s3
L_back1_s3:
    v_mfma_f32_16x16x32_bf16 v[128:131], a[128:131], v[32:35], v[160:163]
    v_exp_f32 v210, v118
    v_mfma_f32_16x16x32_bf16 v[128:131], a[132:135], v[36:39], v[128:131]
    ds_read_b64_tr_b16 a[160:161], v244 offset:2048
    ds_read_b64_tr_b16 a[162:163], v244 offset:10240
    v_mfma_f32_16x16x32_bf16 v[128:131], a[136:139], v[40:43], v[128:131]
    v_exp_f32 v211, v119
    v_mfma_f32_16x16x32_bf16 v[128:131], a[140:143], v[44:47], v[128:131]
    ds_read_b64_tr_b16 a[164:165], v245 offset:2048
    v_cvt_pk_bf16_f32 v195, v210, v211
    v_mfma_f32_16x16x32_bf16 v[132:135], a[156:159], v[44:47], v[160:163]
    v_exp_f32 v208, v120
    v_mfma_f32_16x16x32_bf16 v[132:135], a[152:155], v[40:43], v[132:135]
    ds_read_b64_tr_b16 a[166:167], v245 offset:10240
    ds_read_b64_tr_b16 a[168:169], v246 offset:2048
    v_mfma_f32_16x16x32_bf16 v[132:135], a[148:151], v[36:39], v[132:135]
    v_exp_f32 v209, v121
    v_mfma_f32_16x16x32_bf16 v[132:135], a[144:147], v[32:35], v[132:135]
    ds_read_b64_tr_b16 a[170:171], v246 offset:10240
    v_cvt_pk_bf16_f32 v196, v208, v209
    v_mfma_f32_16x16x32_bf16 v[140:143], a[144:147], v[48:51], v[164:167]
    v_exp_f32 v210, v122
    v_mfma_f32_16x16x32_bf16 v[140:143], a[148:151], v[52:55], v[140:143]
    ds_read_b64_tr_b16 a[172:173], v247 offset:2048
    ds_read_b64_tr_b16 a[174:175], v247 offset:10240
    v_mfma_f32_16x16x32_bf16 v[140:143], a[152:155], v[56:59], v[140:143]
    v_exp_f32 v211, v123
    v_mfma_f32_16x16x32_bf16 v[140:143], a[156:159], v[60:63], v[140:143]
    ds_read_b64_tr_b16 a[176:177], v248 offset:2048
    v_cvt_pk_bf16_f32 v197, v210, v211
    v_mfma_f32_16x16x32_bf16 v[136:139], a[140:143], v[60:63], v[164:167]
    v_exp_f32 v208, v124
    v_mfma_f32_16x16x32_bf16 v[136:139], a[136:139], v[56:59], v[136:139]
    ds_read_b64_tr_b16 a[178:179], v248 offset:10240
    ds_read_b64_tr_b16 a[180:181], v249 offset:2048
    v_mfma_f32_16x16x32_bf16 v[136:139], a[132:135], v[52:55], v[136:139]
    v_exp_f32 v209, v125
    v_mfma_f32_16x16x32_bf16 v[136:139], a[128:131], v[48:51], v[136:139]
    ds_read_b64_tr_b16 a[182:183], v249 offset:10240
    v_cvt_pk_bf16_f32 v198, v208, v209
    v_mfma_f32_16x16x32_bf16 v[144:147], a[128:131], v[64:67], v[168:171]
    v_exp_f32 v210, v126
    v_mfma_f32_16x16x32_bf16 v[144:147], a[132:135], v[68:71], v[144:147]
    ds_read_b64_tr_b16 a[184:185], v250 offset:2048
    ds_read_b64_tr_b16 a[186:187], v250 offset:10240
    v_mfma_f32_16x16x32_bf16 v[144:147], a[136:139], v[72:75], v[144:147]
    v_exp_f32 v211, v127
    v_mfma_f32_16x16x32_bf16 v[144:147], a[140:143], v[76:79], v[144:147]
    ds_read_b64_tr_b16 a[188:189], v251 offset:2048
    v_cvt_pk_bf16_f32 v199, v210, v211
    v_mfma_f32_16x16x32_bf16 v[148:151], a[156:159], v[76:79], v[168:171]
    ds_read_b64_tr_b16 a[190:191], v251 offset:10240
    v_mov_b32 v233, v228
    v_mfma_f32_16x16x32_bf16 v[148:151], a[152:155], v[72:75], v[148:151]
    v_exp_f32 v208, v96
    v_mfma_f32_16x16x32_bf16 v[148:151], a[148:151], v[68:71], v[148:151]
    v_mfma_f32_16x16x32_bf16 v[148:151], a[144:147], v[64:67], v[148:151]
    v_exp_f32 v209, v97
    v_smfmac_f32_16x16x64_bf16 v[228:231], v[24:27], v[192:199], v235
    v_cvt_pk_bf16_f32 v176, v208, v209
    v_mfma_f32_16x16x32_bf16 v[156:159], a[144:147], v[80:83], v[172:175]
    v_exp_f32 v210, v98
    v_mfma_f32_16x16x32_bf16 v[156:159], a[148:151], v[84:87], v[156:159]
    v_mfma_f32_16x16x32_bf16 v[156:159], a[152:155], v[88:91], v[156:159]
    v_exp_f32 v211, v99
    v_mfma_f32_16x16x32_bf16 v[156:159], a[156:159], v[92:95], v[156:159]
    v_cvt_pk_bf16_f32 v177, v210, v211
    v_cmp_nle_f32 vcc, v228, v234
    v_mfma_f32_16x16x32_bf16 v[152:155], a[140:143], v[92:95], v[172:175]
    v_exp_f32 v208, v100
    v_mfma_f32_16x16x32_bf16 v[152:155], a[136:139], v[88:91], v[152:155]
    v_mfma_f32_16x16x32_bf16 v[152:155], a[132:135], v[84:87], v[152:155]
    v_exp_f32 v209, v101
    v_mfma_f32_16x16x32_bf16 v[152:155], a[128:131], v[80:83], v[152:155]
    s_waitcnt lgkmcnt(0)
    v_cvt_pk_bf16_f32 v178, v208, v209
    s_cbranch_vccnz L_slow0_s4
L_back0_s4:
    v_mfma_f32_16x16x32_bf16 a[64:67], a[192:195], v[200:203], a[64:67]
    v_exp_f32 v210, v102
    v_mfma_f32_16x16x32_bf16 a[64:67], a[160:163], v[192:195], a[64:67]
    ds_read_b128 a[128:131], v12 offset:0
    ds_read_b128 a[132:135], v13 offset:0
    v_mfma_f32_16x16x32_bf16 a[68:71], a[164:167], v[192:195], a[68:71]
    v_exp_f32 v211, v103
    v_mfma_f32_16x16x32_bf16 a[68:71], a[196:199], v[200:203], a[68:71]
    ds_read_b128 a[136:139], v14 offset:0
    v_cvt_pk_bf16_f32 v179, v210, v211
    v_mfma_f32_16x16x32_bf16 a[72:75], a[200:203], v[200:203], a[72:75]
    v_exp_f32 v208, v104
    v_mfma_f32_16x16x32_bf16 a[72:75], a[168:171], v[192:195], a[72:75]
    ds_read_b128 a[140:143], v15 offset:0
    ds_read_b128 a[144:147], v12 offset:8192
    v_mfma_f32_16x16x32_bf16 a[76:79], a[172:175], v[192:195], a[76:79]
    s_add_u32 s52, s52, 8192
    v_exp_f32 v209, v105
    v_mfma_f32_16x16x32_bf16 a[76:79], a[204:207], v[200:203], a[76:79]
    ds_read_b128 a[148:151], v13 offset:8192
    v_cvt_pk_bf16_f32 v180, v208, v209
    v_mfma_f32_16x16x32_bf16 a[80:83], a[208:211], v[200:203], a[80:83]
    s_add_u32 m0, s88, 32768
    v_exp_f32 v210, v106
    v_mfma_f32_16x16x32_bf16 a[80:83], a[176:179], v[192:195], a[80:83]
    buffer_load_dwordx4 v28, s[8:11], s52 offen offset:0 lds
    v_mfma_f32_16x16x32_bf16 a[84:87], a[180:183], v[192:195], a[84:87]
    v_exp_f32 v211, v107
    v_mfma_f32_16x16x32_bf16 a[84:87], a[212:215], v[200:203], a[84:87]
    ds_read_b128 a[152:155], v14 offset:8192
    v_cvt_pk_bf16_f32 v181, v210, v211
    v_mfma_f32_16x16x32_bf16 a[88:91], a[216:219], v[200:203], a[88:91]
    v_exp_f32 v208, v108
    v_mfma_f32_16x16x32_bf16 a[88:91], a[184:187], v[192:195], a[88:91]
    buffer_load_dwordx4 v29, s[8:11], s52 offen offset:1024 lds
    v_mfma_f32_16x16x32_bf16 a[92:95], a[188:191], v[192:195], a[92:95]
    v_exp_f32 v209, v109
    v_mfma_f32_16x16x32_bf16 a[92:95], a[220:223], v[200:203], a[92:95]
    ds_read_b128 a[156:159], v15 offset:8192
    v_cvt_pk_bf16_f32 v182, v208, v209
    v_mfma_f32_16x16x32_bf16 a[124:127], a[220:223], v[204:207], a[124:127]
    v_exp_f32 v210, v110
    v_mfma_f32_16x16x32_bf16 a[124:127], a[188:191], v[196:199], a[124:127]
    buffer_load_dwordx4 v30, s[12:15], s52 offen offset:2048 lds
    v_mfma_f32_16x16x32_bf16 a[120:123], a[184:187], v[196:199], a[120:123]
    v_exp_f32 v211, v111
    v_mfma_f32_16x16x32_bf16 a[120:123], a[216:219], v[204:207], a[120:123]
    v_cvt_pk_bf16_f32 v183, v210, v211
    v_mfma_f32_16x16x32_bf16 a[116:119], a[212:215], v[204:207], a[116:119]
    v_mov_b32 v232, v224
    v_mfma_f32_16x16x32_bf16 a[116:119], a[180:183], v[196:199], a[116:119]
    v_exp_f32 v208, v128
    v_mfma_f32_16x16x32_bf16 a[112:115], a[176:179], v[196:199], a[112:115]
    buffer_load_dwordx4 v31, s[12:15], s52 offen offset:3072 lds
    v_mfma_f32_16x16x32_bf16 a[112:115], a[208:211], v[204:207], a[112:115]
    v_exp_f32 v209, v129
    v_smfmac_f32_16x16x64_bf16 v[224:227], v[24:27], v[176:183], v235
    v_cvt_pk_bf16_f32 v184, v208, v209
    v_mfma_f32_16x16x32_bf16 a[108:111], a[204:207], v[204:207], a[108:111]
    v_exp_f32 v210, v130
    v_mfma_f32_16x16x32_bf16 a[108:111], a[172:175], v[196:199], a[108:111]
    v_mfma_f32_16x16x32_bf16 a[104:107], a[168:171], v[196:199], a[104:107]
    v_exp_f32 v211, v131
    v_mfma_f32_16x16x32_bf16 a[104:107], a[200:203], v[204:207], a[104:107]
    v_cvt_pk_bf16_f32 v185, v210, v211
    v_cmp_nle_f32 vcc, v224, v234
    v_mfma_f32_16x16x32_bf16 a[100:103], a[196:199], v[204:207], a[100:103]
    v_exp_f32 v208, v132
    v_mfma_f32_16x16x32_bf16 a[100:103], a[164:167], v[196:199], a[100:103]
    v_mfma_f32_16x16x32_bf16 a[96:99], a[160:163], v[196:199], a[96:99]
    v_exp_f32 v209, v133
    v_mfma_f32_16x16x32_bf16 a[96:99], a[192:195], v[204:207], a[96:99]
    s_waitcnt lgkmcnt(0)
    v_cvt_pk_bf16_f32 v186, v208, v209
    s_cbranch_vccnz L_slow1_s4
L_back1_s4:
    v_mfma_f32_16x16x32_bf16 v[112:115], a[128:131], v[64:67], v[168:171]
    v_exp_f32 v210, v134
    v_mfma_f32_16x16x32_bf16 v[112:115], a[132:135], v[68:71], v[112:115]
    ds_read_b64_tr_b16 a[192:193], v244 offset:18432
    ds_read_b64_tr_b16 a[194:195], v244 offset:26624
    v_mfma_f32_16x16x32_bf16 v[112:115], a[136:139], v[72:75], v[112:115]
    v_exp_f32 v211, v135
    v_mfma_f32_16x16x32_bf16 v[112:115], a[140:143], v[76:79], v[112:115]
    ds_read_b64_tr_b16 a[196:197], v245 offset:18432
    v_cvt_pk_bf16_f32 v187, v210, v211
    v_mfma_f32_16x16x32_bf16 v[116:119], a[156:159], v[76:79], v[168:171]
    v_exp_f32 v208, v136
    v_mfma_f32_16x16x32_bf16 v[116:119], a[152:155], v[72:75], v[116:119]
    ds_read_b64_tr_b16 a[198:199], v245 offset:26624
    ds_read_b64_tr_b16 a[200:201], v246 offset:18432
    v_mfma_f32_16x16x32_bf16 v[116:119], a[148:151], v[68:71], v[116:119]
    v_exp_f32 v209, v137
    v_mfma_f32_16x16x32_bf16 v[116:119], a[144:147], v[64:67], v[116:119]
    ds_read_b64_tr_b16 a[202:203], v246 offset:26624
    v_cvt_pk_bf16_f32 v188, v208, v209
    v_mfma_f32_16x16x32_bf16 v[124:127], a[144:147], v[80:83], v[172:175]
    v_exp_f32 v210, v138
    v_mfma_f32_16x16x32_bf16 v[124:127], a[148:151], v[84:87], v[124:127]
    ds_read_b64_tr_b16 a[204:205], v247 offset:18432
    ds_read_b64_tr_b16 a[206:207], v247 offset:26624
    v_mfma_f32_16x16x32_bf16 v[124:127], a[152:155], v[88:91], v[124:127]
    v_exp_f32 v211, v139
    v_mfma_f32_16x16x32_bf16 v[124:127], a[156:159], v[92:95], v[124:127]
    ds_read_b64_tr_b16 a[208:209], v248 offset:18432
    v_cvt_pk_bf16_f32 v189, v210, v211
    v_mfma_f32_16x16x32_bf16 v[120:123], a[140:143], v[92:95], v[172:175]
    v_exp_f32 v208, v140
    v_mfma_f32_16x16x32_bf16 v[120:123], a[136:139], v[88:91], v[120:123]
    ds_read_b64_tr_b16 a[210:211], v248 offset:26624
    ds_read_b64_tr_b16 a[212:213], v249 offset:18432
    v_mfma_f32_16x16x32_bf16 v[120:123], a[132:135], v[84:87], v[120:123]
    v_exp_f32 v209, v141
    v_mfma_f32_16x16x32_bf16 v[120:123], a[128:131], v[80:83], v[120:123]
    ds_read_b64_tr_b16 a[214:215], v249 offset:26624
    v_cvt_pk_bf16_f32 v190, v208, v209
    v_mfma_f32_16x16x32_bf16 v[96:99], a[128:131], v[32:35], v[160:163]
    v_exp_f32 v210, v142
    v_mfma_f32_16x16x32_bf16 v[96:99], a[132:135], v[36:39], v[96:99]
    ds_read_b64_tr_b16 a[216:217], v250 offset:18432
    ds_read_b64_tr_b16 a[218:219], v250 offset:26624
    v_mfma_f32_16x16x32_bf16 v[96:99], a[136:139], v[40:43], v[96:99]
    v_exp_f32 v211, v143
    v_mfma_f32_16x16x32_bf16 v[96:99], a[140:143], v[44:47], v[96:99]
    ds_read_b64_tr_b16 a[220:221], v251 offset:18432
    v_cvt_pk_bf16_f32 v191, v210, v211
    v_mfma_f32_16x16x32_bf16 v[100:103], a[156:159], v[44:47], v[160:163]
    ds_read_b64_tr_b16 a[222:223], v251 offset:26624
    v_mov_b32 v232, v224
    v_mfma_f32_16x16x32_bf16 v[100:103], a[152:155], v[40:43], v[100:103]
    v_exp_f32 v208, v144
    v_mfma_f32_16x16x32_bf16 v[100:103], a[148:151], v[36:39], v[100:103]
    v_mfma_f32_16x16x32_bf16 v[100:103], a[144:147], v[32:35], v[100:103]
    v_exp_f32 v209, v145
    v_smfmac_f32_16x16x64_bf16 v[224:227], v[24:27], v[184:191], v235
    v_cvt_pk_bf16_f32 v200, v208, v209
    v_mfma_f32_16x16x32_bf16 v[108:111], a[144:147], v[48:51], v[164:167]
    v_exp_f32 v210, v146
    v_mfma_f32_16x16x32_bf16 v[108:111], a[148:151], v[52:55], v[108:111]
    v_mfma_f32_16x16x32_bf16 v[108:111], a[152:155], v[56:59], v[108:111]
    v_exp_f32 v211, v147
    v_mfma_f32_16x16x32_bf16 v[108:111], a[156:159], v[60:63], v[108:111]
    v_cvt_pk_bf16_f32 v201, v210, v211
    v_cmp_nle_f32 vcc, v224, v234
    v_mfma_f32_16x16x32_bf16 v[104:107], a[140:143], v[60:63], v[164:167]
    v_exp_f32 v208, v148
    v_mfma_f32_16x16x32_bf16 v[104:107], a[136:139], v[56:59], v[104:107]
    v_mfma_f32_16x16x32_bf16 v[104:107], a[132:135], v[52:55], v[104:107]
    v_exp_f32 v209, v149
    v_mfma_f32_16x16x32_bf16 v[104:107], a[128:131], v[48:51], v[104:107]
    s_waitcnt lgkmcnt(0)
    v_cvt_pk_bf16_f32 v202, v208, v209
    s_cbranch_vccnz L_slow0_s5
L_back0_s5:
    v_mfma_f32_16x16x32_bf16 a[0:3], a[160:163], v[176:179], a[0:3]
    v_exp_f32 v210, v150
    v_mfma_f32_16x16x32_bf16 a[0:3], a[192:195], v[184:187], a[0:3]
    ds_read_b128 a[128:131], v12 offset:16384
    ds_read_b128 a[132:135], v13 offset:16384
    v_mfma_f32_16x16x32_bf16 a[4:7], a[196:199], v[184:187], a[4:7]
    v_exp_f32 v211, v151
    v_mfma_f32_16x16x32_bf16 a[4:7], a[164:167], v[176:179], a[4:7]
    ds_read_b128 a[136:139], v14 offset:16384
    v_cvt_pk_bf16_f32 v203, v210, v211
    v_mfma_f32_16x16x32_bf16 a[8:11], a[168:171], v[176:179], a[8:11]
    v_exp_f32 v208, v152
    v_mfma_f32_16x16x32_bf16 a[8:11], a[200:203], v[184:187], a[8:11]
    ds_read_b128 a[140:143], v15 offset:16384
    ds_read_b128 a[144:147], v12 offset:24576
    v_mfma_f32_16x16x32_bf16 a[12:15], a[204:207], v[184:187], a[12:15]
    s_add_u32 s52, s52, 8192
L_pad9:
    s_cbranch_execz L_pad13
    v_exp_f32 v209, v153
    v_mfma_f32_16x16x32_bf16 a[12:15], a[172:175], v[176:179], a[12:15]
    ds_read_b128 a[148:151], v13 offset:24576
    v_cvt_pk_bf16_f32 v204, v208, v209
    v_mfma_f32_16x16x32_bf16 a[16:19], a[176:179], v[176:179], a[16:19]
    s_add_u32 m0, s88, 49152
    v_exp_f32 v210, v154
    v_mfma_f32_16x16x32_bf16 a[16:19], a[208:211], v[184:187], a[16:19]
    buffer_load_dwordx4 v28, s[8:11], s52 offen offset:0 lds
    v_mfma_f32_16x16x32_bf16 a[20:23], a[212:215], v[184:187], a[20:23]
    v_exp_f32 v211, v155
    v_mfma_f32_16x16x32_bf16 a[20:23], a[180:183], v[176:179], a[20:23]
    ds_read_b128 a[152:155], v14 offset:24576
    v_cvt_pk_bf16_f32 v205, v210, v211
    v_mfma_f32_16x16x32_bf16 a[24:27], a[184:187], v[176:179], a[24:27]
    v_exp_f32 v208, v156
    v_mfma_f32_16x16x32_bf16 a[24:27], a[216:219], v[184:187], a[24:27]
    buffer_load_dwordx4 v29, s[8:11], s52 offen offset:1024 lds
    v_mfma_f32_16x16x32_bf16 a[28:31], a[220:223], v[184:187], a[28:31]
    v_exp_f32 v209, v157
    v_mfma_f32_16x16x32_bf16 a[28:31], a[188:191], v[176:179], a[28:31]
    ds_read_b128 a[156:159], v15 offset:24576
    v_cvt_pk_bf16_f32 v206, v208, v209
    v_mfma_f32_16x16x32_bf16 a[60:63], a[188:191], v[180:183], a[60:63]
    v_exp_f32 v210, v158
    v_mfma_f32_16x16x32_bf16 a[60:63], a[220:223], v[188:191], a[60:63]
    buffer_load_dwordx4 v30, s[12:15], s52 offen offset:2048 lds
    v_mfma_f32_16x16x32_bf16 a[56:59], a[216:219], v[188:191], a[56:59]
    v_exp_f32 v211, v159
    v_mfma_f32_16x16x32_bf16 a[56:59], a[184:187], v[180:183], a[56:59]
    v_cvt_pk_bf16_f32 v207, v210, v211
    v_mfma_f32_16x16x32_bf16 a[52:55], a[180:183], v[180:183], a[52:55]
    v_mov_b32 v233, v228
    v_mfma_f32_16x16x32_bf16 a[52:55], a[212:215], v[188:191], a[52:55]
    v_exp_f32 v208, v112
    v_mfma_f32_16x16x32_bf16 a[48:51], a[208:211], v[188:191], a[48:51]
    buffer_load_dwordx4 v31, s[12:15], s52 offen offset:3072 lds
    v_mfma_f32_16x16x32_bf16 a[48:51], a[176:179], v[180:183], a[48:51]
    v_exp_f32 v209, v113
    v_smfmac_f32_16x16x64_bf16 v[228:231], v[24:27], v[200:207], v235
    v_cvt_pk_bf16_f32 v192, v208, v209
    v_mfma_f32_16x16x32_bf16 a[44:47], a[172:175], v[180:183], a[44:47]
    v_exp_f32 v210, v114
    v_mfma_f32_16x16x32_bf16 a[44:47], a[204:207], v[188:191], a[44:47]
    v_mfma_f32_16x16x32_bf16 a[40:43], a[200:203], v[188:191], a[40:43]
    v_exp_f32 v211, v115
    v_mfma_f32_16x16x32_bf16 a[40:43], a[168:171], v[180:183], a[40:43]
    v_cvt_pk_bf16_f32 v193, v210, v211
    v_cmp_nle_f32 vcc, v228, v234
    v_mfma_f32_16x16x32_bf16 a[36:39], a[164:167], v[180:183], a[36:39]
    v_exp_f32 v208, v116
    v_mfma_f32_16x16x32_bf16 a[36:39], a[196:199], v[188:191], a[36:39]
    v_mfma_f32_16x16x32_bf16 a[32:35], a[192:195], v[188:191], a[32:35]
    v_exp_f32 v209, v117
    v_mfma_f32_16x16x32_bf16 a[32:35], a[160:163], v[180:183], a[32:35]
    s_waitcnt vmcnt(16) lgkmcnt(0)
    s_barrier
    v_cvt_pk_bf16_f32 v194, v208, v209
    s_cbranch_vccnz L_slow1_s5
L_back1_s5:
    v_mfma_f32_16x16x32_bf16 v[128:131], a[128:131], v[32:35], v[160:163]
    v_exp_f32 v210, v118
    v_mfma_f32_16x16x32_bf16 v[128:131], a[132:135], v[36:39], v[128:131]
    ds_read_b64_tr_b16 a[160:161], v244 offset:34816
    ds_read_b64_tr_b16 a[162:163], v244 offset:43008
    v_mfma_f32_16x16x32_bf16 v[128:131], a[136:139], v[40:43], v[128:131]
    v_exp_f32 v211, v119
    v_mfma_f32_16x16x32_bf16 v[128:131], a[140:143], v[44:47], v[128:131]
    ds_read_b64_tr_b16 a[164:165], v245 offset:34816
    v_cvt_pk_bf16_f32 v195, v210, v211
    v_mfma_f32_16x16x32_bf16 v[132:135], a[156:159], v[44:47], v[160:163]
    v_exp_f32 v208, v120
    v_mfma_f32_16x16x32_bf16 v[132:135], a[152:155], v[40:43], v[132:135]
    ds_read_b64_tr_b16 a[166:167], v245 offset:43008
    ds_read_b64_tr_b16 a[168:169], v246 offset:34816
    v_mfma_f32_16x16x32_bf16 v[132:135], a[148:151], v[36:39], v[132:135]
    v_exp_f32 v209, v121
    v_mfma_f32_16x16x32_bf16 v[132:135], a[144:147], v[32:35], v[132:135]
    ds_read_b64_tr_b16 a[170:171], v246 offset:43008
    v_cvt_pk_bf16_f32 v196, v208, v209
    v_mfma_f32_16x16x32_bf16 v[140:143], a[144:147], v[48:51], v[164:167]
    v_exp_f32 v210, v122
    v_mfma_f32_16x16x32_bf16 v[140:143], a[148:151], v[52:55], v[140:143]
    ds_read_b64_tr_b16 a[172:173], v247 offset:34816
    ds_read_b64_tr_b16 a[174:175], v247 offset:43008
    v_mfma_f32_16x16x32_bf16 v[140:143], a[152:155], v[56:59], v[140:143]
    v_exp_f32 v211, v123
    v_mfma_f32_16x16x32_bf16 v[140:143], a[156:159], v[60:63], v[140:143]
    ds_read_b64_tr_b16 a[176:177], v248 offset:34816
    v_cvt_pk_bf16_f32 v197, v210, v211
    v_mfma_f32_16x16x32_bf16 v[136:139], a[140:143], v[60:63], v[164:167]
    v_exp_f32 v208, v124
    v_mfma_f32_16x16x32_bf16 v[136:139], a[136:139], v[56:59], v[136:139]
    ds_read_b64_tr_b16 a[178:179], v248 offset:43008
    ds_read_b64_tr_b16 a[180:181], v249 offset:34816
    v_mfma_f32_16x16x32_bf16 v[136:139], a[132:135], v[52:55], v[136:139]
    v_exp_f32 v209, v125
    v_mfma_f32_16x16x32_bf16 v[136:139], a[128:131], v[48:51], v[136:139]
    ds_read_b64_tr_b16 a[182:183], v249 offset:43008
    v_cvt_pk_bf16_f32 v198, v208, v209
    v_mfma_f32_16x16x32_bf16 v[144:147], a[128:131], v[64:67], v[168:171]
    v_exp_f32 v210, v126
    v_mfma_f32_16x16x32_bf16 v[144:147], a[132:135], v[68:71], v[144:147]
    ds_read_b64_tr_b16 a[184:185], v250 offset:34816
    ds_read_b64_tr_b16 a[186:187], v250 offset:43008
    v_mfma_f32_16x16x32_bf16 v[144:147], a[136:139], v[72:75], v[144:147]
    v_exp_f32 v211, v127
    v_mfma_f32_16x16x32_bf16 v[144:147], a[140:143], v[76:79], v[144:147]
    ds_read_b64_tr_b16 a[188:189], v251 offset:34816
    v_cvt_pk_bf16_f32 v199, v210, v211
    v_mfma_f32_16x16x32_bf16 v[148:151], a[156:159], v[76:79], v[168:171]
    ds_read_b64_tr_b16 a[190:191], v251 offset:43008
    v_mov_b32 v233, v228
    v_mfma_f32_16x16x32_bf16 v[148:151], a[152:155], v[72:75], v[148:151]
    v_exp_f32 v208, v96
    v_mfma_f32_16x16x32_bf16 v[148:151], a[148:151], v[68:71], v[148:151]
    v_mfma_f32_16x16x32_bf16 v[148:151], a[144:147], v[64:67], v[148:151]
    v_exp_f32 v209, v97
    v_smfmac_f32_16x16x64_bf16 v[228:231], v[24:27], v[192:199], v235
    v_cvt_pk_bf16_f32 v176, v208, v209
    v_mfma_f32_16x16x32_bf16 v[156:159], a[144:147], v[80:83], v[172:175]
    v_exp_f32 v210, v98
    v_mfma_f32_16x16x32_bf16 v[156:159], a[148:151], v[84:87], v[156:159]
    v_mfma_f32_16x16x32_bf16 v[156:159], a[152:155], v[88:91], v[156:159]
    v_exp_f32 v211, v99
    v_mfma_f32_16x16x32_bf16 v[156:159], a[156:159], v[92:95], v[156:159]
    v_cvt_pk_bf16_f32 v177, v210, v211
    v_cmp_nle_f32 vcc, v228, v234
    v_mfma_f32_16x16x32_bf16 v[152:155], a[140:143], v[92:95], v[172:175]
    v_exp_f32 v208, v100
    v_mfma_f32_16x16x32_bf16 v[152:155], a[136:139], v[88:91], v[152:155]
    v_mfma_f32_16x16x32_bf16 v[152:155], a[132:135], v[84:87], v[152:155]
    v_exp_f32 v209, v101
    v_mfma_f32_16x16x32_bf16 v[152:155], a[128:131], v[80:83], v[152:155]
    s_waitcnt lgkmcnt(0)
    v_cvt_pk_bf16_f32 v178, v208, v209
    s_cbranch_vccnz L_slow0_s6
L_back0_s6:
    v_mfma_f32_16x16x32_bf16 a[64:67], a[192:195], v[200:203], a[64:67]
    v_exp_f32 v210, v102
    v_mfma_f32_16x16x32_bf16 a[64:67], a[160:163], v[192:195], a[64:67]
    ds_read_b128 a[128:131], v12 offset:32768
    ds_read_b128 a[132:135], v13 offset:32768
    v_mfma_f32_16x16x32_bf16 a[68:71], a[164:167], v[192:195], a[68:71]
    v_exp_f32 v211, v103
    v_mfma_f32_16x16x32_bf16 a[68:71], a[196:199], v[200:203], a[68:71]
    ds_read_b128 a[136:139], v14 offset:32768
    v_cvt_pk_bf16_f32 v179, v210, v211
    v_mfma_f32_16x16x32_bf16 a[72:75], a[200:203], v[200:203], a[72:75]
    v_exp_f32 v208, v104
    v_mfma_f32_16x16x32_bf16 a[72:75], a[168:171], v[192:195], a[72:75]
    ds_read_b128 a[140:143], v15 offset:32768
    ds_read_b128 a[144:147], v12 offset:40960
    v_mfma_f32_16x16x32_bf16 a[76:79], a[172:175], v[192:195], a[76:79]
    s_add_u32 s52, s52, 8192
    v_exp_f32 v209, v105
    v_mfma_f32_16x16x32_bf16 a[76:79], a[204:207], v[200:203], a[76:79]
    ds_read_b128 a[148:151], v13 offset:40960
    v_cvt_pk_bf16_f32 v180, v208, v209
    v_mfma_f32_16x16x32_bf16 a[80:83], a[208:211], v[200:203], a[80:83]
    s_add_u32 m0, s88, 65536
    v_exp_f32 v210, v106
    v_mfma_f32_16x16x32_bf16 a[80:83], a[176:179], v[192:195], a[80:83]
    buffer_load_dwordx4 v28, s[8:11], s52 offen offset:0 lds
    v_mfma_f32_16x16x32_bf16 a[84:87], a[180:183], v[192:195], a[84:87]
    v_exp_f32 v211, v107
    v_mfma_f32_16x16x32_bf16 a[84:87], a[212:215], v[200:203], a[84:87]
    ds_read_b128 a[152:155], v14 offset:40960
    v_cvt_pk_bf16_f32 v181, v210, v211
    v_mfma_f32_16x16x32_bf16 a[88:91], a[216:219], v[200:203], a[88:91]
    v_exp_f32 v208, v108
    v_mfma_f32_16x16x32_bf16 a[88:91], a[184:187], v[192:195], a[88:91]
    buffer_load_dwordx4 v29, s[8:11], s52 offen offset:1024 lds
    v_mfma_f32_16x16x32_bf16 a[92:95], a[188:191], v[192:195], a[92:95]
    v_exp_f32 v209, v109
    v_mfma_f32_16x16x32_bf16 a[92:95], a[220:223], v[200:203], a[92:95]
    ds_read_b128 a[156:159], v15 offset:40960
    v_cvt_pk_bf16_f32 v182, v208, v209
    v_mfma_f32_16x16x32_bf16 a[124:127], a[220:223], v[204:207], a[124:127]
    v_exp_f32 v210, v110
    v_mfma_f32_16x16x32_bf16 a[124:127], a[188:191], v[196:199], a[124:127]
    buffer_load_dwordx4 v30, s[12:15], s52 offen offset:2048 lds
    v_mfma_f32_16x16x32_bf16 a[120:123], a[184:187], v[196:199], a[120:123]
    v_exp_f32 v211, v111
    v_mfma_f32_16x16x32_bf16 a[120:123], a[216:219], v[204:207], a[120:123]
    v_cvt_pk_bf16_f32 v183, v210, v211
    v_mfma_f32_16x16x32_bf16 a[116:119], a[212:215], v[204:207], a[116:119]
    v_mov_b32 v232, v224
    v_mfma_f32_16x16x32_bf16 a[116:119], a[180:183], v[196:199], a[116:119]
    v_exp_f32 v208, v128
    v_mfma_f32_16x16x32_bf16 a[112:115], a[176:179], v[196:199], a[112:115]
    buffer_load_dwordx4 v31, s[12:15], s52 offen offset:3072 lds
    v_mfma_f32_16x16x32_bf16 a[112:115], a[208:211], v[204:207], a[112:115]
    v_exp_f32 v209, v129
    v_smfmac_f32_16x16x64_bf16 v[224:227], v[24:27], v[176:183], v235
    v_cvt_pk_bf16_f32 v184, v208, v209
    v_mfma_f32_16x16x32_bf16 a[108:111], a[204:207], v[204:207], a[108:111]
    v_exp_f32 v210, v130
    v_mfma_f32_16x16x32_bf16 a[108:111], a[172:175], v[196:199], a[108:111]
    v_mfma_f32_16x16x32_bf16 a[104:107], a[168:171], v[196:199], a[104:107]
    v_exp_f32 v211, v131
    v_mfma_f32_16x16x32_bf16 a[104:107], a[200:203], v[204:207], a[104:107]
    v_cvt_pk_bf16_f32 v185, v210, v211
    v_cmp_nle_f32 vcc, v224, v234
    v_mfma_f32_16x16x32_bf16 a[100:103], a[196:199], v[204:207], a[100:103]
    v_exp_f32 v208, v132
    v_mfma_f32_16x16x32_bf16 a[100:103], a[164:167], v[196:199], a[100:103]
    v_mfma_f32_16x16x32_bf16 a[96:99], a[160:163], v[196:199], a[96:99]
    v_exp_f32 v209, v133
    v_mfma_f32_16x16x32_bf16 a[96:99], a[192:195], v[204:207], a[96:99]
    s_waitcnt lgkmcnt(0)
    v_cvt_pk_bf16_f32 v186, v208, v209
    s_cbranch_vccnz L_slow1_s6
L_back1_s6:
    v_mfma_f32_16x16x32_bf16 v[112:115], a[128:131], v[64:67], v[168:171]
    v_exp_f32 v210, v134
    v_mfma_f32_16x16x32_bf16 v[112:115], a[132:135], v[68:71], v[112:115]
    ds_read_b64_tr_b16 a[192:193], v244 offset:51200
    ds_read_b64_tr_b16 a[194:195], v244 offset:59392
    v_mfma_f32_16x16x32_bf16 v[112:115], a[136:139], v[72:75], v[112:115]
    v_exp_f32 v211, v135
    v_mfma_f32_16x16x32_bf16 v[112:115], a[140:143], v[76:79], v[112:115]
    ds_read_b64_tr_b16 a[196:197], v245 offset:51200
    v_cvt_pk_bf16_f32 v187, v210, v211
    v_mfma_f32_16x16x32_bf16 v[116:119], a[156:159], v[76:79], v[168:171]
    v_exp_f32 v208, v136
    v_mfma_f32_16x16x32_bf16 v[116:119], a[152:155], v[72:75], v[116:119]
    ds_read_b64_tr_b16 a[198:199], v245 offset:59392
    ds_read_b64_tr_b16 a[200:201], v246 offset:51200
    v_mfma_f32_16x16x32_bf16 v[116:119], a[148:151], v[68:71], v[116:119]
    v_exp_f32 v209, v137
    v_mfma_f32_16x16x32_bf16 v[116:119], a[144:147], v[64:67], v[116:119]
    ds_read_b64_tr_b16 a[202:203], v246 offset:59392
    v_cvt_pk_bf16_f32 v188, v208, v209
    v_mfma_f32_16x16x32_bf16 v[124:127], a[144:147], v[80:83], v[172:175]
    v_exp_f32 v210, v138
    v_mfma_f32_16x16x32_bf16 v[124:127], a[148:151], v[84:87], v[124:127]
    ds_read_b64_tr_b16 a[204:205], v247 offset:51200
    ds_read_b64_tr_b16 a[206:207], v247 offset:59392
    v_mfma_f32_16x16x32_bf16 v[124:127], a[152:155], v[88:91], v[124:127]
    v_exp_f32 v211, v139
    v_mfma_f32_16x16x32_bf16 v[124:127], a[156:159], v[92:95], v[124:127]
    ds_read_b64_tr_b16 a[208:209], v248 offset:51200
    v_cvt_pk_bf16_f32 v189, v210, v211
    v_mfma_f32_16x16x32_bf16 v[120:123], a[140:143], v[92:95], v[172:175]
    v_exp_f32 v208, v140
    v_mfma_f32_16x16x32_bf16 v[120:123], a[136:139], v[88:91], v[120:123]
    ds_read_b64_tr_b16 a[210:211], v248 offset:59392
    ds_read_b64_tr_b16 a[212:213], v249 offset:51200
    v_mfma_f32_16x16x32_bf16 v[120:123], a[132:135], v[84:87], v[120:123]
    v_exp_f32 v209, v141
    v_mfma_f32_16x16x32_bf16 v[120:123], a[128:131], v[80:83], v[120:123]
    ds_read_b64_tr_b16 a[214:215], v249 offset:59392
    v_cvt_pk_bf16_f32 v190, v208, v209
    v_mfma_f32_16x16x32_bf16 v[96:99], a[128:131], v[32:35], v[160:163]
    v_exp_f32 v210, v142
    v_mfma_f32_16x16x32_bf16 v[96:99], a[132:135], v[36:39], v[96:99]
    ds_read_b64_tr_b16 a[216:217], v250 offset:51200
    ds_read_b64_tr_b16 a[218:219], v250 offset:59392
    v_mfma_f32_16x16x32_bf16 v[96:99], a[136:139], v[40:43], v[96:99]
    v_exp_f32 v211, v143
    v_mfma_f32_16x16x32_bf16 v[96:99], a[140:143], v[44:47], v[96:99]
    ds_read_b64_tr_b16 a[220:221], v251 offset:51200
    v_cvt_pk_bf16_f32 v191, v210, v211
    v_mfma_f32_16x16x32_bf16 v[100:103], a[156:159], v[44:47], v[160:163]
    ds_read_b64_tr_b16 a[222:223], v251 offset:59392
    v_mov_b32 v232, v224
    v_mfma_f32_16x16x32_bf16 v[100:103], a[152:155], v[40:43], v[100:103]
    v_exp_f32 v208, v144
    v_mfma_f32_16x16x32_bf16 v[100:103], a[148:151], v[36:39], v[100:103]
    v_mfma_f32_16x16x32_bf16 v[100:103], a[144:147], v[32:35], v[100:103]
    v_exp_f32 v209, v145
    v_smfmac_f32_16x16x64_bf16 v[224:227], v[24:27], v[184:191], v235
    v_cvt_pk_bf16_f32 v200, v208, v209
    v_mfma_f32_16x16x32_bf16 v[108:111], a[144:147], v[48:51], v[164:167]
    v_exp_f32 v210, v146
    v_mfma_f32_16x16x32_bf16 v[108:111], a[148:151], v[52:55], v[108:111]
    v_mfma_f32_16x16x32_bf16 v[108:111], a[152:155], v[56:59], v[108:111]
    v_exp_f32 v211, v147
    v_mfma_f32_16x16x32_bf16 v[108:111], a[156:159], v[60:63], v[108:111]
    v_cvt_pk_bf16_f32 v201, v210, v211
    v_cmp_nle_f32 vcc, v224, v234
    v_mfma_f32_16x16x32_bf16 v[104:107], a[140:143], v[60:63], v[164:167]
    v_exp_f32 v208, v148
    v_mfma_f32_16x16x32_bf16 v[104:107], a[136:139], v[56:59], v[104:107]
    v_mfma_f32_16x16x32_bf16 v[104:107], a[132:135], v[52:55], v[104:107]
    v_exp_f32 v209, v149
    v_mfma_f32_16x16x32_bf16 v[104:107], a[128:131], v[48:51], v[104:107]
    s_waitcnt lgkmcnt(0)
    v_cvt_pk_bf16_f32 v202, v208, v209
    s_cbranch_vccnz L_slow0_s7
L_back0_s7:
    v_mfma_f32_16x16x32_bf16 a[0:3], a[160:163], v[176:179], a[0:3]
    v_exp_f32 v210, v150
    v_mfma_f32_16x16x32_bf16 a[0:3], a[192:195], v[184:187], a[0:3]
    ds_read_b128 a[128:131], v12 offset:49152
    ds_read_b128 a[132:135], v13 offset:49152
    v_mfma_f32_16x16x32_bf16 a[4:7], a[196:199], v[184:187], a[4:7]
    v_exp_f32 v211, v151
    v_mfma_f32_16x16x32_bf16 a[4:7], a[164:167], v[176:179], a[4:7]
    ds_read_b128 a[136:139], v14 offset:49152
    v_cvt_pk_bf16_f32 v203, v210, v211
    v_mfma_f32_16x16x32_bf16 a[8:11], a[168:171], v[176:179], a[8:11]
    v_exp_f32 v208, v152
    v_mfma_f32_16x16x32_bf16 a[8:11], a[200:203], v[184:187], a[8:11]
    ds_read_b128 a[140:143], v15 offset:49152
    ds_read_b128 a[144:147], v12 offset:57344
    v_mfma_f32_16x16x32_bf16 a[12:15], a[204:207], v[184:187], a[12:15]
    s_add_u32 s52, s52, 8192
    v_exp_f32 v209, v153
    v_mfma_f32_16x16x32_bf16 a[12:15], a[172:175], v[176:179], a[12:15]
    ds_read_b128 a[148:151], v13 offset:57344
    v_cvt_pk_bf16_f32 v204, v208, v209
    v_mfma_f32_16x16x32_bf16 a[16:19], a[176:179], v[176:179], a[16:19]
    s_add_u32 m0, s88, 81920
    v_exp_f32 v210, v154
    v_mfma_f32_16x16x32_bf16 a[16:19], a[208:211], v[184:187], a[16:19]
    buffer_load_dwordx4 v28, s[8:11], s52 offen offset:0 lds
    v_mfma_f32_16x16x32_bf16 a[20:23], a[212:215], v[184:187], a[20:23]
    v_exp_f32 v211, v155
    v_mfma_f32_16x16x32_bf16 a[20:23], a[180:183], v[176:179], a[20:23]
    ds_read_b128 a[152:155], v14 offset:57344
    v_cvt_pk_bf16_f32 v205, v210, v211
    v_mfma_f32_16x16x32_bf16 a[24:27], a[184:187], v[176:179], a[24:27]
    v_exp_f32 v208, v156
    v_mfma_f32_16x16x32_bf16 a[24:27], a[216:219], v[184:187], a[24:27]
    buffer_load_dwordx4 v29, s[8:11], s52 offen offset:1024 lds
    v_mfma_f32_16x16x32_bf16 a[28:31], a[220:223], v[184:187], a[28:31]
    v_exp_f32 v209, v157
    v_mfma_f32_16x16x32_bf16 a[28:31], a[188:191], v[176:179], a[28:31]
    ds_read_b128 a[156:159], v15 offset:57344
    v_cvt_pk_bf16_f32 v206, v208, v209
    v_mfma_f32_16x16x32_bf16 a[60:63], a[188:191], v[180:183], a[60:63]
    v_exp_f32 v210, v158
    v_mfma_f32_16x16x32_bf16 a[60:63], a[220:223], v[188:191], a[60:63]
    buffer_load_dwordx4 v30, s[12:15], s52 offen offset:2048 lds
    v_mfma_f32_16x16x32_bf16 a[56:59], a[216:219], v[188:191], a[56:59]
    v_exp_f32 v211, v159
    v_mfma_f32_16x16x32_bf16 a[56:59], a[184:187], v[180:183], a[56:59]
    v_cvt_pk_bf16_f32 v207, v210, v211
    v_mfma_f32_16x16x32_bf16 a[52:55], a[180:183], v[180:183], a[52:55]
    v_mov_b32 v233, v228
    v_mfma_f32_16x16x32_bf16 a[52:55], a[212:215], v[188:191], a[52:55]
    v_exp_f32 v208, v112
    v_mfma_f32_16x16x32_bf16 a[48:51], a[208:211], v[188:191], a[48:51]
    buffer_load_dwordx4 v31, s[12:15], s52 offen offset:3072 lds
    v_mfma_f32_16x16x32_bf16 a[48:51], a[176:179], v[180:183], a[48:51]
    v_exp_f32 v209, v113
    v_smfmac_f32_16x16x64_bf16 v[228:231], v[24:27], v[200:207], v235
    v_cvt_pk_bf16_f32 v192, v208, v209
    v_mfma_f32_16x16x32_bf16 a[44:47], a[172:175], v[180:183], a[44:47]
    v_exp_f32 v210, v114
    v_mfma_f32_16x16x32_bf16 a[44:47], a[204:207], v[188:191], a[44:47]
    v_mfma_f32_16x16x32_bf16 a[40:43], a[200:203], v[188:191], a[40:43]
    s_sub_u32 s55, s55, 1
    v_exp_f32 v211, v115
    v_mfma_f32_16x16x32_bf16 a[40:43], a[168:171], v[180:183], a[40:43]
    v_cvt_pk_bf16_f32 v193, v210, v211
    v_cmp_nle_f32 vcc, v228, v234
    v_mfma_f32_16x16x32_bf16 a[36:39], a[164:167], v[180:183], a[36:39]
    s_cmp_lg_u32 s55, 0
    v_exp_f32 v208, v116
    v_mfma_f32_16x16x32_bf16 a[36:39], a[196:199], v[188:191], a[36:39]
    v_mfma_f32_16x16x32_bf16 a[32:35], a[192:195], v[188:191], a[32:35]
    v_exp_f32 v209, v117
    v_mfma_f32_16x16x32_bf16 a[32:35], a[160:163], v[180:183], a[32:35]
    s_waitcnt vmcnt(16) lgkmcnt(0)
    s_barrier
    v_cvt_pk_bf16_f32 v194, v208, v209
    s_cbranch_vccnz L_slow1_s7
L_back1_s7:
    s_cbranch_scc1 L_attn
.p2align 3
    v_mfma_f32_16x16x32_bf16 v[128:131], a[128:131], v[32:35], v[160:163]
    v_exp_f32 v210, v118
    v_mfma_f32_16x16x32_bf16 v[128:131], a[132:135], v[36:39], v[128:131]
    ds_read_b64_tr_b16 a[160:161], v16 offset:2048
    ds_read_b64_tr_b16 a[162:163], v16 offset:10240
    v_mfma_f32_16x16x32_bf16 v[128:131], a[136:139], v[40:43], v[128:131]
    s_lshr_b32 s3, s2, 3
    s_lshl_b32 s3, s3, 2
    s_add_u32 s3, s3, s6
    v_exp_f32 v211, v119
    v_mfma_f32_16x16x32_bf16 v[128:131], a[140:143], v[44:47], v[128:131]
    ds_read_b64_tr_b16 a[164:165], v17 offset:2048
    v_cvt_pk_bf16_f32 v195, v210, v211
    v_mfma_f32_16x16x32_bf16 v[132:135], a[156:159], v[44:47], v[160:163]
    s_lshr_b32 s7, s3, 4
    s_mul_i32 s7, s7, 753664
    s_and_b32 s3, s3, 15
    v_exp_f32 v208, v120
    v_mfma_f32_16x16x32_bf16 v[132:135], a[152:155], v[40:43], v[132:135]
    ds_read_b64_tr_b16 a[166:167], v17 offset:10240
    ds_read_b64_tr_b16 a[168:169], v18 offset:2048
    v_mfma_f32_16x16x32_bf16 v[132:135], a[148:151], v[36:39], v[132:135]
    s_lshl_b32 s3, s3, 13
    s_add_u32 s3, s3, s7
    s_bfe_u32 s7, s2, 0x20001
    v_exp_f32 v209, v121
    v_mfma_f32_16x16x32_bf16 v[132:135], a[144:147], v[32:35], v[132:135]
    ds_read_b64_tr_b16 a[170:171], v18 offset:10240
    v_cvt_pk_bf16_f32 v196, v208, v209
    v_mfma_f32_16x16x32_bf16 v[140:143], a[144:147], v[48:51], v[164:167]
    s_lshl_b32 s7, s7, 17
    s_add_u32 s3, s3, s7
    s_add_u32 s58, s3, 26509312
    v_exp_f32 v210, v122
    v_mfma_f32_16x16x32_bf16 v[140:143], a[148:151], v[52:55], v[140:143]
    ds_read_b64_tr_b16 a[172:173], v19 offset:2048
    ds_read_b64_tr_b16 a[174:175], v19 offset:10240
    v_mfma_f32_16x16x32_bf16 v[140:143], a[152:155], v[56:59], v[140:143]
    v_exp_f32 v211, v123
    v_mfma_f32_16x16x32_bf16 v[140:143], a[156:159], v[60:63], v[140:143]
    ds_read_b64_tr_b16 a[176:177], v20 offset:2048
    v_cvt_pk_bf16_f32 v197, v210, v211
    v_mfma_f32_16x16x32_bf16 v[136:139], a[140:143], v[60:63], v[164:167]
    v_exp_f32 v208, v124
    v_mfma_f32_16x16x32_bf16 v[136:139], a[136:139], v[56:59], v[136:139]
    ds_read_b64_tr_b16 a[178:179], v20 offset:10240
    ds_read_b64_tr_b16 a[180:181], v21 offset:2048
    v_mfma_f32_16x16x32_bf16 v[136:139], a[132:135], v[52:55], v[136:139]
    v_exp_f32 v209, v125
    v_mfma_f32_16x16x32_bf16 v[136:139], a[128:131], v[48:51], v[136:139]
    ds_read_b64_tr_b16 a[182:183], v21 offset:10240
    v_cvt_pk_bf16_f32 v198, v208, v209
    v_mfma_f32_16x16x32_bf16 v[144:147], a[128:131], v[64:67], v[168:171]
    v_exp_f32 v210, v126
    v_mfma_f32_16x16x32_bf16 v[144:147], a[132:135], v[68:71], v[144:147]
    ds_read_b64_tr_b16 a[184:185], v22 offset:2048
    ds_read_b64_tr_b16 a[186:187], v22 offset:10240
    v_mfma_f32_16x16x32_bf16 v[144:147], a[136:139], v[72:75], v[144:147]
    v_exp_f32 v211, v127
    v_mfma_f32_16x16x32_bf16 v[144:147], a[140:143], v[76:79], v[144:147]
    ds_read_b64_tr_b16 a[188:189], v23 offset:2048
    v_cvt_pk_bf16_f32 v199, v210, v211
    v_mfma_f32_16x16x32_bf16 v[148:151], a[156:159], v[76:79], v[168:171]
    ds_read_b64_tr_b16 a[190:191], v23 offset:10240
    v_mov_b32 v233, v228
    v_mfma_f32_16x16x32_bf16 v[148:151], a[152:155], v[72:75], v[148:151]
    v_exp_f32 v208, v96
    v_mfma_f32_16x16x32_bf16 v[148:151], a[148:151], v[68:71], v[148:151]
    v_lshlrev_b32 v4, 7, v1
    v_mfma_f32_16x16x32_bf16 v[148:151], a[144:147], v[64:67], v[148:151]
    v_exp_f32 v209, v97
    v_smfmac_f32_16x16x64_bf16 v[228:231], v[24:27], v[192:199], v235
    v_cvt_pk_bf16_f32 v176, v208, v209
    v_mfma_f32_16x16x32_bf16 v[156:159], a[144:147], v[80:83], v[172:175]
    v_exp_f32 v210, v98
    v_mfma_f32_16x16x32_bf16 v[156:159], a[148:151], v[84:87], v[156:159]
    v_mfma_f32_16x16x32_bf16 v[156:159], a[152:155], v[88:91], v[156:159]
    v_exp_f32 v211, v99
    v_mfma_f32_16x16x32_bf16 v[156:159], a[156:159], v[92:95], v[156:159]
    v_cvt_pk_bf16_f32 v177, v210, v211
    v_cmp_nle_f32 vcc, v228, v234
    v_mfma_f32_16x16x32_bf16 v[152:155], a[140:143], v[92:95], v[172:175]
    v_exp_f32 v208, v100
    v_mfma_f32_16x16x32_bf16 v[152:155], a[136:139], v[88:91], v[152:155]
    v_mfma_f32_16x16x32_bf16 v[152:155], a[132:135], v[84:87], v[152:155]
    v_exp_f32 v209, v101
    v_mfma_f32_16x16x32_bf16 v[152:155], a[128:131], v[80:83], v[152:155]
    s_waitcnt lgkmcnt(0)
    v_cvt_pk_bf16_f32 v178, v208, v209
    s_cbranch_vccnz L_slow0_t0
L_back0_t0:
    v_mfma_f32_16x16x32_bf16 a[64:67], a[192:195], v[200:203], a[64:67]
    v_exp_f32 v210, v102
    v_mfma_f32_16x16x32_bf16 a[64:67], a[160:163], v[192:195], a[64:67]
    ds_read_b128 a[128:131], v8 offset:0
    ds_read_b128 a[132:135], v9 offset:0
    v_mfma_f32_16x16x32_bf16 a[68:71], a[164:167], v[192:195], a[68:71]
    v_exp_f32 v211, v103
    v_mfma_f32_16x16x32_bf16 a[68:71], a[196:199], v[200:203], a[68:71]
    ds_read_b128 a[136:139], v10 offset:0
    v_cvt_pk_bf16_f32 v179, v210, v211
    v_mfma_f32_16x16x32_bf16 a[72:75], a[200:203], v[200:203], a[72:75]
    v_exp_f32 v208, v104
    v_mfma_f32_16x16x32_bf16 a[72:75], a[168:171], v[192:195], a[72:75]
    ds_read_b128 a[140:143], v11 offset:0
    ds_read_b128 a[144:147], v8 offset:8192
    v_mfma_f32_16x16x32_bf16 a[76:79], a[172:175], v[192:195], a[76:79]
    s_add_u32 s52, s52, 8192
    v_exp_f32 v209, v105
    v_mfma_f32_16x16x32_bf16 a[76:79], a[204:207], v[200:203], a[76:79]
    ds_read_b128 a[148:151], v9 offset:8192
    v_cvt_pk_bf16_f32 v180, v208, v209
    v_mfma_f32_16x16x32_bf16 a[80:83], a[208:211], v[200:203], a[80:83]
    s_add_u32 m0, s88, 98304
    v_exp_f32 v210, v106
    v_mfma_f32_16x16x32_bf16 a[80:83], a[176:179], v[192:195], a[80:83]
    buffer_load_dwordx4 v30, s[12:15], s52 offen offset:2048 lds
    v_mfma_f32_16x16x32_bf16 a[84:87], a[180:183], v[192:195], a[84:87]
    v_exp_f32 v211, v107
    v_mfma_f32_16x16x32_bf16 a[84:87], a[212:215], v[200:203], a[84:87]
    ds_read_b128 a[152:155], v10 offset:8192
    v_cvt_pk_bf16_f32 v181, v210, v211
    v_mfma_f32_16x16x32_bf16 a[88:91], a[216:219], v[200:203], a[88:91]
    v_exp_f32 v208, v108
    v_mfma_f32_16x16x32_bf16 a[88:91], a[184:187], v[192:195], a[88:91]
    buffer_load_dwordx4 v31, s[12:15], s52 offen offset:3072 lds
    v_mfma_f32_16x16x32_bf16 a[92:95], a[188:191], v[192:195], a[92:95]
    v_exp_f32 v209, v109
    v_mfma_f32_16x16x32_bf16 a[92:95], a[220:223], v[200:203], a[92:95]
    ds_read_b128 a[156:159], v11 offset:8192
    v_cvt_pk_bf16_f32 v182, v208, v209
    v_mfma_f32_16x16x32_bf16 a[124:127], a[220:223], v[204:207], a[124:127]
    v_exp_f32 v210, v110
    v_mfma_f32_16x16x32_bf16 a[124:127], a[188:191], v[196:199], a[124:127]
    v_mfma_f32_16x16x32_bf16 a[120:123], a[184:187], v[196:199], a[120:123]
    v_exp_f32 v211, v111
    v_mfma_f32_16x16x32_bf16 a[120:123], a[216:219], v[204:207], a[120:123]
    v_cvt_pk_bf16_f32 v183, v210, v211
    v_mfma_f32_16x16x32_bf16 a[116:119], a[212:215], v[204:207], a[116:119]
    v_mov_b32 v232, v224
    v_mfma_f32_16x16x32_bf16 a[116:119], a[180:183], v[196:199], a[116:119]
    v_exp_f32 v208, v128
    v_mfma_f32_16x16x32_bf16 a[112:115], a[176:179], v[196:199], a[112:115]
    v_mfma_f32_16x16x32_bf16 a[112:115], a[208:211], v[204:207], a[112:115]
    v_exp_f32 v209, v129
    v_smfmac_f32_16x16x64_bf16 v[224:227], v[24:27], v[176:183], v235
    v_cvt_pk_bf16_f32 v184, v208, v209
    v_mfma_f32_16x16x32_bf16 a[108:111], a[204:207], v[204:207], a[108:111]
    v_exp_f32 v210, v130
    v_mfma_f32_16x16x32_bf16 a[108:111], a[172:175], v[196:199], a[108:111]
    v_mfma_f32_16x16x32_bf16 a[104:107], a[168:171], v[196:199], a[104:107]
    v_exp_f32 v211, v131
    v_mfma_f32_16x16x32_bf16 a[104:107], a[200:203], v[204:207], a[104:107]
    v_cvt_pk_bf16_f32 v185, v210, v211
    v_cmp_nle_f32 vcc, v224, v234
    v_mfma_f32_16x16x32_bf16 a[100:103], a[196:199], v[204:207], a[100:103]
    v_exp_f32 v208, v132
    v_mfma_f32_16x16x32_bf16 a[100:103], a[164:167], v[196:199], a[100:103]
    v_mfma_f32_16x16x32_bf16 a[96:99], a[160:163], v[196:199], a[96:99]
    v_exp_f32 v209, v133
    v_mfma_f32_16x16x32_bf16 a[96:99], a[192:195], v[204:207], a[96:99]
    s_waitcnt lgkmcnt(0)
    v_cvt_pk_bf16_f32 v186, v208, v209
    s_cbranch_vccnz L_slow1_t0
L_back1_t0:
    v_mfma_f32_16x16x32_bf16 v[112:115], a[128:131], v[64:67], v[168:171]
    v_exp_f32 v210, v134
    v_mfma_f32_16x16x32_bf16 v[112:115], a[132:135], v[68:71], v[112:115]
    ds_read_b64_tr_b16 a[192:193], v16 offset:18432
    ds_read_b64_tr_b16 a[194:195], v16 offset:26624
    v_mfma_f32_16x16x32_bf16 v[112:115], a[136:139], v[72:75], v[112:115]
    v_exp_f32 v211, v135
    v_mfma_f32_16x16x32_bf16 v[112:115], a[140:143], v[76:79], v[112:115]
    ds_read_b64_tr_b16 a[196:197], v17 offset:18432
    v_cvt_pk_bf16_f32 v187, v210, v211
    v_mfma_f32_16x16x32_bf16 v[116:119], a[156:159], v[76:79], v[168:171]
    v_exp_f32 v208, v136
    v_mfma_f32_16x16x32_bf16 v[116:119], a[152:155], v[72:75], v[116:119]
    ds_read_b64_tr_b16 a[198:199], v17 offset:26624
    ds_read_b64_tr_b16 a[200:201], v18 offset:18432
    v_mfma_f32_16x16x32_bf16 v[116:119], a[148:151], v[68:71], v[116:119]
    v_exp_f32 v209, v137
    v_mfma_f32_16x16x32_bf16 v[116:119], a[144:147], v[64:67], v[116:119]
    ds_read_b64_tr_b16 a[202:203], v18 offset:26624
    v_cvt_pk_bf16_f32 v188, v208, v209
    v_mfma_f32_16x16x32_bf16 v[124:127], a[144:147], v[80:83], v[172:175]
    v_exp_f32 v210, v138
    v_mfma_f32_16x16x32_bf16 v[124:127], a[148:151], v[84:87], v[124:127]
    ds_read_b64_tr_b16 a[204:205], v19 offset:18432
    ds_read_b64_tr_b16 a[206:207], v19 offset:26624
    v_mfma_f32_16x16x32_bf16 v[124:127], a[152:155], v[88:91], v[124:127]
    v_exp_f32 v211, v139
    v_mfma_f32_16x16x32_bf16 v[124:127], a[156:159], v[92:95], v[124:127]
    ds_read_b64_tr_b16 a[208:209], v20 offset:18432
    v_cvt_pk_bf16_f32 v189, v210, v211
    v_mfma_f32_16x16x32_bf16 v[120:123], a[140:143], v[92:95], v[172:175]
    v_exp_f32 v208, v140
    v_mfma_f32_16x16x32_bf16 v[120:123], a[136:139], v[88:91], v[120:123]
    ds_read_b64_tr_b16 a[210:211], v20 offset:26624
    ds_read_b64_tr_b16 a[212:213], v21 offset:18432
    v_mfma_f32_16x16x32_bf16 v[120:123], a[132:135], v[84:87], v[120:123]
    v_exp_f32 v209, v141
    v_mfma_f32_16x16x32_bf16 v[120:123], a[128:131], v[80:83], v[120:123]
    ds_read_b64_tr_b16 a[214:215], v21 offset:26624
    v_cvt_pk_bf16_f32 v190, v208, v209
    v_mfma_f32_16x16x32_bf16 v[96:99], a[128:131], v[32:35], v[160:163]
    v_exp_f32 v210, v142
    v_mfma_f32_16x16x32_bf16 v[96:99], a[132:135], v[36:39], v[96:99]
    ds_read_b64_tr_b16 a[216:217], v22 offset:18432
    ds_read_b64_tr_b16 a[218:219], v22 offset:26624
    v_mfma_f32_16x16x32_bf16 v[96:99], a[136:139], v[40:43], v[96:99]
    v_exp_f32 v211, v143
    v_mfma_f32_16x16x32_bf16 v[96:99], a[140:143], v[44:47], v[96:99]
    ds_read_b64_tr_b16 a[220:221], v23 offset:18432
    v_cvt_pk_bf16_f32 v191, v210, v211
    v_mfma_f32_16x16x32_bf16 v[100:103], a[156:159], v[44:47], v[160:163]
    ds_read_b64_tr_b16 a[222:223], v23 offset:26624
    v_mov_b32 v232, v224
    v_mfma_f32_16x16x32_bf16 v[100:103], a[152:155], v[40:43], v[100:103]
    v_exp_f32 v208, v144
    v_mfma_f32_16x16x32_bf16 v[100:103], a[148:151], v[36:39], v[100:103]
    v_mfma_f32_16x16x32_bf16 v[100:103], a[144:147], v[32:35], v[100:103]
    v_exp_f32 v209, v145
    v_smfmac_f32_16x16x64_bf16 v[224:227], v[24:27], v[184:191], v235
    v_cvt_pk_bf16_f32 v200, v208, v209
    v_mfma_f32_16x16x32_bf16 v[108:111], a[144:147], v[48:51], v[164:167]
    v_exp_f32 v210, v146
    v_mfma_f32_16x16x32_bf16 v[108:111], a[148:151], v[52:55], v[108:111]
    v_mfma_f32_16x16x32_bf16 v[108:111], a[152:155], v[56:59], v[108:111]
L_pad10:
    s_cbranch_execz L_pad14
    v_exp_f32 v211, v147
    v_mfma_f32_16x16x32_bf16 v[108:111], a[156:159], v[60:63], v[108:111]
    v_cvt_pk_bf16_f32 v201, v210, v211
    v_cmp_nle_f32 vcc, v224, v234
    v_mfma_f32_16x16x32_bf16 v[104:107], a[140:143], v[60:63], v[164:167]
    v_exp_f32 v208, v148
    v_mfma_f32_16x16x32_bf16 v[104:107], a[136:139], v[56:59], v[104:107]
    v_mfma_f32_16x16x32_bf16 v[104:107], a[132:135], v[52:55], v[104:107]
    v_exp_f32 v209, v149
    v_mfma_f32_16x16x32_bf16 v[104:107], a[128:131], v[48:51], v[104:107]
    s_waitcnt lgkmcnt(0)
    v_cvt_pk_bf16_f32 v202, v208, v209
    s_cbranch_vccnz L_slow0_t1
L_back0_t1:
    v_mfma_f32_16x16x32_bf16 a[0:3], a[160:163], v[176:179], a[0:3]
    v_exp_f32 v210, v150
    v_mfma_f32_16x16x32_bf16 a[0:3], a[192:195], v[184:187], a[0:3]
    ds_read_b128 a[128:131], v8 offset:16384
    ds_read_b128 a[132:135], v9 offset:16384
    v_mfma_f32_16x16x32_bf16 a[4:7], a[196:199], v[184:187], a[4:7]
    v_exp_f32 v211, v151
    v_mfma_f32_16x16x32_bf16 a[4:7], a[164:167], v[176:179], a[4:7]
    ds_read_b128 a[136:139], v10 offset:16384
    v_cvt_pk_bf16_f32 v203, v210, v211
    v_mfma_f32_16x16x32_bf16 a[8:11], a[168:171], v[176:179], a[8:11]
    v_exp_f32 v208, v152
    v_mfma_f32_16x16x32_bf16 a[8:11], a[200:203], v[184:187], a[8:11]
    ds_read_b128 a[140:143], v11 offset:16384
    ds_read_b128 a[144:147], v8 offset:24576
    v_mfma_f32_16x16x32_bf16 a[12:15], a[204:207], v[184:187], a[12:15]
    s_add_u32 s52, s52, 8192
    v_exp_f32 v209, v153
    v_mfma_f32_16x16x32_bf16 a[12:15], a[172:175], v[176:179], a[12:15]
    ds_read_b128 a[148:151], v9 offset:24576
    v_cvt_pk_bf16_f32 v204, v208, v209
    v_mfma_f32_16x16x32_bf16 a[16:19], a[176:179], v[176:179], a[16:19]
    s_add_u32 m0, s88, 114688
    v_exp_f32 v210, v154
    v_mfma_f32_16x16x32_bf16 a[16:19], a[208:211], v[184:187], a[16:19]
    buffer_load_dwordx4 v30, s[12:15], s52 offen offset:2048 lds
    v_mfma_f32_16x16x32_bf16 a[20:23], a[212:215], v[184:187], a[20:23]
    v_exp_f32 v211, v155
    v_mfma_f32_16x16x32_bf16 a[20:23], a[180:183], v[176:179], a[20:23]
    ds_read_b128 a[152:155], v10 offset:24576
    v_cvt_pk_bf16_f32 v205, v210, v211
    v_mfma_f32_16x16x32_bf16 a[24:27], a[184:187], v[176:179], a[24:27]
    v_exp_f32 v208, v156
    v_mfma_f32_16x16x32_bf16 a[24:27], a[216:219], v[184:187], a[24:27]
    buffer_load_dwordx4 v31, s[12:15], s52 offen offset:3072 lds
    v_mfma_f32_16x16x32_bf16 a[28:31], a[220:223], v[184:187], a[28:31]
    v_exp_f32 v209, v157
    v_mfma_f32_16x16x32_bf16 a[28:31], a[188:191], v[176:179], a[28:31]
    ds_read_b128 a[156:159], v11 offset:24576
    v_cvt_pk_bf16_f32 v206, v208, v209
    v_mfma_f32_16x16x32_bf16 a[60:63], a[188:191], v[180:183], a[60:63]
    v_exp_f32 v210, v158
    v_mfma_f32_16x16x32_bf16 a[60:63], a[220:223], v[188:191], a[60:63]
    v_mfma_f32_16x16x32_bf16 a[56:59], a[216:219], v[188:191], a[56:59]
    v_exp_f32 v211, v159
    v_mfma_f32_16x16x32_bf16 a[56:59], a[184:187], v[180:183], a[56:59]
    v_cvt_pk_bf16_f32 v207, v210, v211
    v_mfma_f32_16x16x32_bf16 a[52:55], a[180:183], v[180:183], a[52:55]
    v_mov_b32 v233, v228
    v_mfma_f32_16x16x32_bf16 a[52:55], a[212:215], v[188:191], a[52:55]
    v_exp_f32 v208, v112
    v_mfma_f32_16x16x32_bf16 a[48:51], a[208:211], v[188:191], a[48:51]
    v_mfma_f32_16x16x32_bf16 a[48:51], a[176:179], v[180:183], a[48:51]
    v_exp_f32 v209, v113
    v_smfmac_f32_16x16x64_bf16 v[228:231], v[24:27], v[200:207], v235
    v_cvt_pk_bf16_f32 v192, v208, v209
    v_mfma_f32_16x16x32_bf16 a[44:47], a[172:175], v[180:183], a[44:47]
    v_exp_f32 v210, v114
    v_mfma_f32_16x16x32_bf16 a[44:47], a[204:207], v[188:191], a[44:47]
    v_mfma_f32_16x16x32_bf16 a[40:43], a[200:203], v[188:191], a[40:43]
    v_exp_f32 v211, v115
    v_mfma_f32_16x16x32_bf16 a[40:43], a[168:171], v[180:183], a[40:43]
    v_cvt_pk_bf16_f32 v193, v210, v211
    v_cmp_nle_f32 vcc, v228, v234
    v_mfma_f32_16x16x32_bf16 a[36:39], a[164:167], v[180:183], a[36:39]
    v_exp_f32 v208, v116
    v_mfma_f32_16x16x32_bf16 a[36:39], a[196:199], v[188:191], a[36:39]
    v_mfma_f32_16x16x32_bf16 a[32:35], a[192:195], v[188:191], a[32:35]
    v_exp_f32 v209, v117
    v_mfma_f32_16x16x32_bf16 a[32:35], a[160:163], v[180:183], a[32:35]
    s_waitcnt vmcnt(12) lgkmcnt(0)
    s_barrier
    v_cvt_pk_bf16_f32 v194, v208, v209
    s_cbranch_vccnz L_slow1_t1
L_back1_t1:
    v_mfma_f32_16x16x32_bf16 v[128:131], a[128:131], v[32:35], v[160:163]
    v_exp_f32 v210, v118
    v_mfma_f32_16x16x32_bf16 v[128:131], a[132:135], v[36:39], v[128:131]
    ds_read_b64_tr_b16 a[160:161], v16 offset:34816
    ds_read_b64_tr_b16 a[162:163], v16 offset:43008
    v_mfma_f32_16x16x32_bf16 v[128:131], a[136:139], v[40:43], v[128:131]
    s_lshl_b32 s3, s89, 2
    s_add_u32 s3, s3, s6
    v_exp_f32 v211, v119
    v_mfma_f32_16x16x32_bf16 v[128:131], a[140:143], v[44:47], v[128:131]
    ds_read_b64_tr_b16 a[164:165], v17 offset:34816
    v_cvt_pk_bf16_f32 v195, v210, v211
    v_mfma_f32_16x16x32_bf16 v[132:135], a[156:159], v[44:47], v[160:163]
    s_mul_i32 s3, s3, 116736
    s_bfe_u32 s7, s2, 0x20001
    v_exp_f32 v208, v120
    v_mfma_f32_16x16x32_bf16 v[132:135], a[152:155], v[40:43], v[132:135]
    ds_read_b64_tr_b16 a[166:167], v17 offset:43008
    ds_read_b64_tr_b16 a[168:169], v18 offset:34816
    v_mfma_f32_16x16x32_bf16 v[132:135], a[148:151], v[36:39], v[132:135]
    s_mul_i32 s7, s7, 14336
    s_add_u32 s3, s3, s7
    v_exp_f32 v209, v121
    v_mfma_f32_16x16x32_bf16 v[132:135], a[144:147], v[32:35], v[132:135]
    ds_read_b64_tr_b16 a[170:171], v18 offset:43008
    v_cvt_pk_bf16_f32 v196, v208, v209
    v_mfma_f32_16x16x32_bf16 v[140:143], a[144:147], v[48:51], v[164:167]
    s_add_u32 s56, s3, 17824768
    s_add_u32 s57, s56, 57344
    v_exp_f32 v210, v122
    v_mfma_f32_16x16x32_bf16 v[140:143], a[148:151], v[52:55], v[140:143]
    ds_read_b64_tr_b16 a[172:173], v19 offset:34816
    ds_read_b64_tr_b16 a[174:175], v19 offset:43008
    v_mfma_f32_16x16x32_bf16 v[140:143], a[152:155], v[56:59], v[140:143]
    s_lshl_b32 s3, s90, 1
    s_lshr_b32 s7, s6, 1
    v_exp_f32 v211, v123
    v_mfma_f32_16x16x32_bf16 v[140:143], a[156:159], v[60:63], v[140:143]
    ds_read_b64_tr_b16 a[176:177], v20 offset:34816
    v_cvt_pk_bf16_f32 v197, v210, v211
    v_mfma_f32_16x16x32_bf16 v[136:139], a[140:143], v[60:63], v[164:167]
    s_add_u32 s3, s3, s7
    s_mul_i32 s3, s3, 753664
    v_exp_f32 v208, v124
    v_mfma_f32_16x16x32_bf16 v[136:139], a[136:139], v[56:59], v[136:139]
    ds_read_b64_tr_b16 a[178:179], v20 offset:43008
    ds_read_b64_tr_b16 a[180:181], v21 offset:34816
    v_mfma_f32_16x16x32_bf16 v[136:139], a[132:135], v[52:55], v[136:139]
    s_bfe_u32 s7, s2, 0x20001
    s_mul_i32 s7, s7, 57344
    v_exp_f32 v209, v125
    v_mfma_f32_16x16x32_bf16 v[136:139], a[128:131], v[48:51], v[136:139]
    ds_read_b64_tr_b16 a[182:183], v21 offset:43008
    v_cvt_pk_bf16_f32 v198, v208, v209
    v_mfma_f32_16x16x32_bf16 v[144:147], a[128:131], v[64:67], v[168:171]
    s_add_u32 s3, s3, s7
    s_and_b32 s7, s6, 1
    v_exp_f32 v210, v126
    v_mfma_f32_16x16x32_bf16 v[144:147], a[132:135], v[68:71], v[144:147]
    ds_read_b64_tr_b16 a[184:185], v22 offset:34816
    ds_read_b64_tr_b16 a[186:187], v22 offset:43008
    v_mfma_f32_16x16x32_bf16 v[144:147], a[136:139], v[72:75], v[144:147]
    s_lshl_b32 s7, s7, 11
    s_add_u32 s3, s3, s7
    v_exp_f32 v211, v127
    v_mfma_f32_16x16x32_bf16 v[144:147], a[140:143], v[76:79], v[144:147]
    ds_read_b64_tr_b16 a[188:189], v23 offset:34816
    v_cvt_pk_bf16_f32 v199, v210, v211
    v_mfma_f32_16x16x32_bf16 v[148:151], a[156:159], v[76:79], v[168:171]
    s_add_u32 s61, s3, 26273792
    ds_read_b64_tr_b16 a[190:191], v23 offset:43008
    v_mov_b32 v233, v228
    v_mfma_f32_16x16x32_bf16 v[148:151], a[152:155], v[72:75], v[148:151]
    v_exp_f32 v208, v96
    v_mfma_f32_16x16x32_bf16 v[148:151], a[148:151], v[68:71], v[148:151]
    buffer_load_dword v6, off, s[48:51], 0 sc1
    v_mfma_f32_16x16x32_bf16 v[148:151], a[144:147], v[64:67], v[148:151]
    v_exp_f32 v209, v97
    v_smfmac_f32_16x16x64_bf16 v[228:231], v[24:27], v[192:199], v235
    v_cvt_pk_bf16_f32 v176, v208, v209
    v_mfma_f32_16x16x32_bf16 v[156:159], a[144:147], v[80:83], v[172:175]
    v_exp_f32 v210, v98
    v_mfma_f32_16x16x32_bf16 v[156:159], a[148:151], v[84:87], v[156:159]
    v_mfma_f32_16x16x32_bf16 v[156:159], a[152:155], v[88:91], v[156:159]
    v_exp_f32 v211, v99
    v_mfma_f32_16x16x32_bf16 v[156:159], a[156:159], v[92:95], v[156:159]
    v_cvt_pk_bf16_f32 v177, v210, v211
    v_cmp_nle_f32 vcc, v228, v234
    v_mfma_f32_16x16x32_bf16 v[152:155], a[140:143], v[92:95], v[172:175]
    v_exp_f32 v208, v100
    v_mfma_f32_16x16x32_bf16 v[152:155], a[136:139], v[88:91], v[152:155]
    v_mfma_f32_16x16x32_bf16 v[152:155], a[132:135], v[84:87], v[152:155]
    v_exp_f32 v209, v101
    v_mfma_f32_16x16x32_bf16 v[152:155], a[128:131], v[80:83], v[152:155]
    s_waitcnt lgkmcnt(0)
    v_cvt_pk_bf16_f32 v178, v208, v209
    s_cbranch_vccnz L_slow0_t2
L_back0_t2:
    v_mfma_f32_16x16x32_bf16 a[64:67], a[192:195], v[200:203], a[64:67]
    v_exp_f32 v210, v102
    v_mfma_f32_16x16x32_bf16 a[64:67], a[160:163], v[192:195], a[64:67]
    ds_read_b128 a[128:131], v8 offset:32768
    ds_read_b128 a[132:135], v9 offset:32768
    v_mfma_f32_16x16x32_bf16 a[68:71], a[164:167], v[192:195], a[68:71]
    v_exp_f32 v211, v103
    v_mfma_f32_16x16x32_bf16 a[68:71], a[196:199], v[200:203], a[68:71]
    ds_read_b128 a[136:139], v10 offset:32768
    v_cvt_pk_bf16_f32 v179, v210, v211
    v_mfma_f32_16x16x32_bf16 a[72:75], a[200:203], v[200:203], a[72:75]
    v_exp_f32 v208, v104
    v_mfma_f32_16x16x32_bf16 a[72:75], a[168:171], v[192:195], a[72:75]
    ds_read_b128 a[140:143], v11 offset:32768
    ds_read_b128 a[144:147], v8 offset:40960
    v_mfma_f32_16x16x32_bf16 a[76:79], a[172:175], v[192:195], a[76:79]
    v_exp_f32 v209, v105
    v_mfma_f32_16x16x32_bf16 a[76:79], a[204:207], v[200:203], a[76:79]
    ds_read_b128 a[148:151], v9 offset:40960
    v_cvt_pk_bf16_f32 v180, v208, v209
    v_mfma_f32_16x16x32_bf16 a[80:83], a[208:211], v[200:203], a[80:83]
    v_exp_f32 v210, v106
    v_mfma_f32_16x16x32_bf16 a[80:83], a[176:179], v[192:195], a[80:83]
    v_mfma_f32_16x16x32_bf16 a[84:87], a[180:183], v[192:195], a[84:87]
    v_exp_f32 v211, v107
    v_mfma_f32_16x16x32_bf16 a[84:87], a[212:215], v[200:203], a[84:87]
    ds_read_b128 a[152:155], v10 offset:40960
    v_cvt_pk_bf16_f32 v181, v210, v211
    v_mfma_f32_16x16x32_bf16 a[88:91], a[216:219], v[200:203], a[88:91]
    v_exp_f32 v208, v108
    v_mfma_f32_16x16x32_bf16 a[88:91], a[184:187], v[192:195], a[88:91]
    v_mfma_f32_16x16x32_bf16 a[92:95], a[188:191], v[192:195], a[92:95]
    v_exp_f32 v209, v109
    v_mfma_f32_16x16x32_bf16 a[92:95], a[220:223], v[200:203], a[92:95]
    ds_read_b128 a[156:159], v11 offset:40960
    v_cvt_pk_bf16_f32 v182, v208, v209
    v_mfma_f32_16x16x32_bf16 a[124:127], a[220:223], v[204:207], a[124:127]
    v_exp_f32 v210, v110
    v_mfma_f32_16x16x32_bf16 a[124:127], a[188:191], v[196:199], a[124:127]
    v_mfma_f32_16x16x32_bf16 a[120:123], a[184:187], v[196:199], a[120:123]
    v_exp_f32 v211, v111
    v_mfma_f32_16x16x32_bf16 a[120:123], a[216:219], v[204:207], a[120:123]
    v_cvt_pk_bf16_f32 v183, v210, v211
    v_mfma_f32_16x16x32_bf16 a[116:119], a[212:215], v[204:207], a[116:119]
    v_mov_b32 v232, v224
    v_mfma_f32_16x16x32_bf16 a[116:119], a[180:183], v[196:199], a[116:119]
    v_exp_f32 v208, v128
    v_mfma_f32_16x16x32_bf16 a[112:115], a[176:179], v[196:199], a[112:115]
    v_mfma_f32_16x16x32_bf16 a[112:115], a[208:211], v[204:207], a[112:115]
    v_exp_f32 v209, v129
    v_smfmac_f32_16x16x64_bf16 v[224:227], v[24:27], v[176:183], v235
    v_cvt_pk_bf16_f32 v184, v208, v209
    v_mfma_f32_16x16x32_bf16 a[108:111], a[204:207], v[204:207], a[108:111]
    v_exp_f32 v210, v130
    v_mfma_f32_16x16x32_bf16 a[108:111], a[172:175], v[196:199], a[108:111]
    v_mfma_f32_16x16x32_bf16 a[104:107], a[168:171], v[196:199], a[104:107]
    v_exp_f32 v211, v131
    v_mfma_f32_16x16x32_bf16 a[104:107], a[200:203], v[204:207], a[104:107]
    v_cvt_pk_bf16_f32 v185, v210, v211
    v_cmp_nle_f32 vcc, v224, v234
    v_mfma_f32_16x16x32_bf16 a[100:103], a[196:199], v[204:207], a[100:103]
    v_exp_f32 v208, v132
    v_mfma_f32_16x16x32_bf16 a[100:103], a[164:167], v[196:199], a[100:103]
    v_mfma_f32_16x16x32_bf16 a[96:99], a[160:163], v[196:199], a[96:99]
    v_exp_f32 v209, v133
    v_mfma_f32_16x16x32_bf16 a[96:99], a[192:195], v[204:207], a[96:99]
    s_waitcnt lgkmcnt(0)
    v_cvt_pk_bf16_f32 v186, v208, v209
    s_cbranch_vccnz L_slow1_t2
L_back1_t2:
    v_mfma_f32_16x16x32_bf16 v[112:115], a[128:131], v[64:67], v[168:171]
    v_exp_f32 v210, v134
    v_mfma_f32_16x16x32_bf16 v[112:115], a[132:135], v[68:71], v[112:115]
    ds_read_b64_tr_b16 a[192:193], v16 offset:51200
    ds_read_b64_tr_b16 a[194:195], v16 offset:59392
    v_mfma_f32_16x16x32_bf16 v[112:115], a[136:139], v[72:75], v[112:115]
    v_exp_f32 v211, v135
    v_mfma_f32_16x16x32_bf16 v[112:115], a[140:143], v[76:79], v[112:115]
    ds_read_b64_tr_b16 a[196:197], v17 offset:51200
    v_cvt_pk_bf16_f32 v187, v210, v211
    v_mfma_f32_16x16x32_bf16 v[116:119], a[156:159], v[76:79], v[168:171]
    v_exp_f32 v208, v136
    v_mfma_f32_16x16x32_bf16 v[116:119], a[152:155], v[72:75], v[116:119]
    ds_read_b64_tr_b16 a[198:199], v17 offset:59392
    ds_read_b64_tr_b16 a[200:201], v18 offset:51200
    v_mfma_f32_16x16x32_bf16 v[116:119], a[148:151], v[68:71], v[116:119]
    v_exp_f32 v209, v137
    v_mfma_f32_16x16x32_bf16 v[116:119], a[144:147], v[64:67], v[116:119]
    ds_read_b64_tr_b16 a[202:203], v18 offset:59392
    v_cvt_pk_bf16_f32 v188, v208, v209
    v_mfma_f32_16x16x32_bf16 v[124:127], a[144:147], v[80:83], v[172:175]
    v_exp_f32 v210, v138
    v_mfma_f32_16x16x32_bf16 v[124:127], a[148:151], v[84:87], v[124:127]
    ds_read_b64_tr_b16 a[204:205], v19 offset:51200
    ds_read_b64_tr_b16 a[206:207], v19 offset:59392
    v_mfma_f32_16x16x32_bf16 v[124:127], a[152:155], v[88:91], v[124:127]
    v_exp_f32 v211, v139
    v_mfma_f32_16x16x32_bf16 v[124:127], a[156:159], v[92:95], v[124:127]
    ds_read_b64_tr_b16 a[208:209], v20 offset:51200
    v_cvt_pk_bf16_f32 v189, v210, v211
    v_mfma_f32_16x16x32_bf16 v[120:123], a[140:143], v[92:95], v[172:175]
    v_exp_f32 v208, v140
    v_mfma_f32_16x16x32_bf16 v[120:123], a[136:139], v[88:91], v[120:123]
    ds_read_b64_tr_b16 a[210:211], v20 offset:59392
    ds_read_b64_tr_b16 a[212:213], v21 offset:51200
    v_mfma_f32_16x16x32_bf16 v[120:123], a[132:135], v[84:87], v[120:123]
    v_exp_f32 v209, v141
    v_mfma_f32_16x16x32_bf16 v[120:123], a[128:131], v[80:83], v[120:123]
    ds_read_b64_tr_b16 a[214:215], v21 offset:59392
    v_cvt_pk_bf16_f32 v190, v208, v209
    v_mfma_f32_16x16x32_bf16 v[96:99], a[128:131], v[32:35], v[160:163]
    v_exp_f32 v210, v142
    v_mfma_f32_16x16x32_bf16 v[96:99], a[132:135], v[36:39], v[96:99]
    ds_read_b64_tr_b16 a[216:217], v22 offset:51200
    ds_read_b64_tr_b16 a[218:219], v22 offset:59392
    v_mfma_f32_16x16x32_bf16 v[96:99], a[136:139], v[40:43], v[96:99]
    v_exp_f32 v211, v143
    v_mfma_f32_16x16x32_bf16 v[96:99], a[140:143], v[44:47], v[96:99]
    ds_read_b64_tr_b16 a[220:221], v23 offset:51200
    v_cvt_pk_bf16_f32 v191, v210, v211
    v_mfma_f32_16x16x32_bf16 v[100:103], a[156:159], v[44:47], v[160:163]
    ds_read_b64_tr_b16 a[222:223], v23 offset:59392
    v_mov_b32 v232, v224
    v_mfma_f32_16x16x32_bf16 v[100:103], a[152:155], v[40:43], v[100:103]
    v_exp_f32 v208, v144
    v_mfma_f32_16x16x32_bf16 v[100:103], a[148:151], v[36:39], v[100:103]
    v_mfma_f32_16x16x32_bf16 v[100:103], a[144:147], v[32:35], v[100:103]
    v_exp_f32 v209, v145
    v_smfmac_f32_16x16x64_bf16 v[224:227], v[24:27], v[184:191], v235
    v_cvt_pk_bf16_f32 v200, v208, v209
    v_mfma_f32_16x16x32_bf16 v[108:111], a[144:147], v[48:51], v[164:167]
    v_exp_f32 v210, v146
    v_mfma_f32_16x16x32_bf16 v[108:111], a[148:151], v[52:55], v[108:111]
    v_mfma_f32_16x16x32_bf16 v[108:111], a[152:155], v[56:59], v[108:111]
    v_exp_f32 v211, v147
    v_mfma_f32_16x16x32_bf16 v[108:111], a[156:159], v[60:63], v[108:111]
    v_cvt_pk_bf16_f32 v201, v210, v211
    v_cmp_nle_f32 vcc, v224, v234
    v_mfma_f32_16x16x32_bf16 v[104:107], a[140:143], v[60:63], v[164:167]
    v_exp_f32 v208, v148
    v_mfma_f32_16x16x32_bf16 v[104:107], a[136:139], v[56:59], v[104:107]
    v_mfma_f32_16x16x32_bf16 v[104:107], a[132:135], v[52:55], v[104:107]
    v_exp_f32 v209, v149
    v_mfma_f32_16x16x32_bf16 v[104:107], a[128:131], v[48:51], v[104:107]
    s_waitcnt lgkmcnt(0)
    v_cvt_pk_bf16_f32 v202, v208, v209
    s_cbranch_vccnz L_slow0_t3
L_back0_t3:
    v_mfma_f32_16x16x32_bf16 a[0:3], a[160:163], v[176:179], a[0:3]
    v_exp_f32 v210, v150
    v_mfma_f32_16x16x32_bf16 a[0:3], a[192:195], v[184:187], a[0:3]
    ds_read_b128 a[128:131], v8 offset:49152
    ds_read_b128 a[132:135], v9 offset:49152
    v_mfma_f32_16x16x32_bf16 a[4:7], a[196:199], v[184:187], a[4:7]
    v_exp_f32 v211, v151
    v_mfma_f32_16x16x32_bf16 a[4:7], a[164:167], v[176:179], a[4:7]
    ds_read_b128 a[136:139], v10 offset:49152
    v_cvt_pk_bf16_f32 v203, v210, v211
    v_mfma_f32_16x16x32_bf16 a[8:11], a[168:171], v[176:179], a[8:11]
    v_exp_f32 v208, v152
    v_mfma_f32_16x16x32_bf16 a[8:11], a[200:203], v[184:187], a[8:11]
    ds_read_b128 a[140:143], v11 offset:49152
    ds_read_b128 a[144:147], v8 offset:57344
    v_mfma_f32_16x16x32_bf16 a[12:15], a[204:207], v[184:187], a[12:15]
    v_exp_f32 v209, v153
    v_mfma_f32_16x16x32_bf16 a[12:15], a[172:175], v[176:179], a[12:15]
    ds_read_b128 a[148:151], v9 offset:57344
    v_cvt_pk_bf16_f32 v204, v208, v209
    v_mfma_f32_16x16x32_bf16 a[16:19], a[176:179], v[176:179], a[16:19]
    v_exp_f32 v210, v154
    v_mfma_f32_16x16x32_bf16 a[16:19], a[208:211], v[184:187], a[16:19]
    v_mfma_f32_16x16x32_bf16 a[20:23], a[212:215], v[184:187], a[20:23]
    v_exp_f32 v211, v155
    v_mfma_f32_16x16x32_bf16 a[20:23], a[180:183], v[176:179], a[20:23]
    ds_read_b128 a[152:155], v10 offset:57344
    v_cvt_pk_bf16_f32 v205, v210, v211
    v_mfma_f32_16x16x32_bf16 a[24:27], a[184:187], v[176:179], a[24:27]
    v_exp_f32 v208, v156
    v_mfma_f32_16x16x32_bf16 a[24:27], a[216:219], v[184:187], a[24:27]
    v_mfma_f32_16x16x32_bf16 a[28:31], a[220:223], v[184:187], a[28:31]
    v_exp_f32 v209, v157
    v_mfma_f32_16x16x32_bf16 a[28:31], a[188:191], v[176:179], a[28:31]
    ds_read_b128 a[156:159], v11 offset:57344
    v_cvt_pk_bf16_f32 v206, v208, v209
    v_mfma_f32_16x16x32_bf16 a[60:63], a[188:191], v[180:183], a[60:63]
    v_exp_f32 v210, v158
    v_mfma_f32_16x16x32_bf16 a[60:63], a[220:223], v[188:191], a[60:63]
    v_mfma_f32_16x16x32_bf16 a[56:59], a[216:219], v[188:191], a[56:59]
    v_exp_f32 v211, v159
    v_mfma_f32_16x16x32_bf16 a[56:59], a[184:187], v[180:183], a[56:59]
    v_cvt_pk_bf16_f32 v207, v210, v211
    v_mfma_f32_16x16x32_bf16 a[52:55], a[180:183], v[180:183], a[52:55]
    v_mov_b32 v233, v228
    v_mfma_f32_16x16x32_bf16 a[52:55], a[212:215], v[188:191], a[52:55]
    v_exp_f32 v208, v112
    v_mfma_f32_16x16x32_bf16 a[48:51], a[208:211], v[188:191], a[48:51]
    v_mfma_f32_16x16x32_bf16 a[48:51], a[176:179], v[180:183], a[48:51]
    v_exp_f32 v209, v113
    v_smfmac_f32_16x16x64_bf16 v[228:231], v[24:27], v[200:207], v235
    v_cvt_pk_bf16_f32 v192, v208, v209
    v_mfma_f32_16x16x32_bf16 a[44:47], a[172:175], v[180:183], a[44:47]
    v_exp_f32 v210, v114
    v_mfma_f32_16x16x32_bf16 a[44:47], a[204:207], v[188:191], a[44:47]
    v_mfma_f32_16x16x32_bf16 a[40:43], a[200:203], v[188:191], a[40:43]
    v_exp_f32 v211, v115
    v_mfma_f32_16x16x32_bf16 a[40:43], a[168:171], v[180:183], a[40:43]
    v_cvt_pk_bf16_f32 v193, v210, v211
    v_cmp_nle_f32 vcc, v228, v234
    v_mfma_f32_16x16x32_bf16 a[36:39], a[164:167], v[180:183], a[36:39]
    v_exp_f32 v208, v116
    v_mfma_f32_16x16x32_bf16 a[36:39], a[196:199], v[188:191], a[36:39]
    v_mfma_f32_16x16x32_bf16 a[32:35], a[192:195], v[188:191], a[32:35]
    v_exp_f32 v209, v117
    v_mfma_f32_16x16x32_bf16 a[32:35], a[160:163], v[180:183], a[32:35]
    s_waitcnt vmcnt(0) lgkmcnt(0)
    s_barrier
    v_cvt_pk_bf16_f32 v194, v208, v209
    s_cbranch_vccnz L_slow1_t3
L_back1_t3:
    v_mfma_f32_16x16x32_bf16 v[128:131], a[128:131], v[32:35], v[160:163]
    v_exp_f32 v210, v118
    v_mfma_f32_16x16x32_bf16 v[128:131], a[132:135], v[36:39], v[128:131]
    ds_read_b64_tr_b16 a[160:161], v244 offset:2048
    ds_read_b64_tr_b16 a[162:163], v244 offset:10240
    v_mfma_f32_16x16x32_bf16 v[128:131], a[136:139], v[40:43], v[128:131]
    v_exp_f32 v211, v119
    v_mfma_f32_16x16x32_bf16 v[128:131], a[140:143], v[44:47], v[128:131]
    ds_read_b64_tr_b16 a[164:165], v245 offset:2048
    v_cvt_pk_bf16_f32 v195, v210, v211
    v_mfma_f32_16x16x32_bf16 v[132:135], a[156:159], v[44:47], v[160:163]
    v_exp_f32 v208, v120
    v_mfma_f32_16x16x32_bf16 v[132:135], a[152:155], v[40:43], v[132:135]
    ds_read_b64_tr_b16 a[166:167], v245 offset:10240
    ds_read_b64_tr_b16 a[168:169], v246 offset:2048
    v_mfma_f32_16x16x32_bf16 v[132:135], a[148:151], v[36:39], v[132:135]
    v_exp_f32 v209, v121
    v_mfma_f32_16x16x32_bf16 v[132:135], a[144:147], v[32:35], v[132:135]
    ds_read_b64_tr_b16 a[170:171], v246 offset:10240
    v_cvt_pk_bf16_f32 v196, v208, v209
    v_mfma_f32_16x16x32_bf16 v[140:143], a[144:147], v[48:51], v[164:167]
    v_exp_f32 v210, v122
    v_mfma_f32_16x16x32_bf16 v[140:143], a[148:151], v[52:55], v[140:143]
    ds_read_b64_tr_b16 a[172:173], v247 offset:2048
    ds_read_b64_tr_b16 a[174:175], v247 offset:10240
    v_mfma_f32_16x16x32_bf16 v[140:143], a[152:155], v[56:59], v[140:143]
    v_exp_f32 v211, v123
    v_mfma_f32_16x16x32_bf16 v[140:143], a[156:159], v[60:63], v[140:143]
    ds_read_b64_tr_b16 a[176:177], v248 offset:2048
    v_cvt_pk_bf16_f32 v197, v210, v211
    v_mfma_f32_16x16x32_bf16 v[136:139], a[140:143], v[60:63], v[164:167]
    v_exp_f32 v208, v124
    v_mfma_f32_16x16x32_bf16 v[136:139], a[136:139], v[56:59], v[136:139]
    ds_read_b64_tr_b16 a[178:179], v248 offset:10240
    ds_read_b64_tr_b16 a[180:181], v249 offset:2048
    v_mfma_f32_16x16x32_bf16 v[136:139], a[132:135], v[52:55], v[136:139]
    v_exp_f32 v209, v125
    v_mfma_f32_16x16x32_bf16 v[136:139], a[128:131], v[48:51], v[136:139]
    ds_read_b64_tr_b16 a[182:183], v249 offset:10240
    v_cvt_pk_bf16_f32 v198, v208, v209
    v_cmp_gt_u32 vcc, 0x100, v6
    v_mfma_f32_16x16x32_bf16 v[144:147], a[128:131], v[64:67], v[168:171]
    v_exp_f32 v210, v126
    v_mfma_f32_16x16x32_bf16 v[144:147], a[132:135], v[68:71], v[144:147]
    ds_read_b64_tr_b16 a[184:185], v250 offset:2048
    ds_read_b64_tr_b16 a[186:187], v250 offset:10240
    v_mfma_f32_16x16x32_bf16 v[144:147], a[136:139], v[72:75], v[144:147]
    v_exp_f32 v211, v127
    v_mfma_f32_16x16x32_bf16 v[144:147], a[140:143], v[76:79], v[144:147]
    ds_read_b64_tr_b16 a[188:189], v251 offset:2048
    v_cvt_pk_bf16_f32 v199, v210, v211
    s_cbranch_vccnz L_pollall
L_pollall_ok:
    v_mfma_f32_16x16x32_bf16 v[148:151], a[156:159], v[76:79], v[168:171]
    ds_read_b64_tr_b16 a[190:191], v251 offset:10240
    v_mov_b32 v233, v228
    v_mfma_f32_16x16x32_bf16 v[148:151], a[152:155], v[72:75], v[148:151]
    s_add_u32 m0, s88, 0
    s_add_u32 s56, s56, 1024
    v_exp_f32 v208, v96
    v_mfma_f32_16x16x32_bf16 v[148:151], a[148:151], v[68:71], v[148:151]
    buffer_load_dwordx4 v7, s[16:19], s56 offen sc1 lds
    v_mfma_f32_16x16x32_bf16 v[148:151], a[144:147], v[64:67], v[148:151]
    v_exp_f32 v209, v97
    v_smfmac_f32_16x16x64_bf16 v[228:231], v[24:27], v[192:199], v235
    v_cvt_pk_bf16_f32 v176, v208, v209
    v_mfma_f32_16x16x32_bf16 v[156:159], a[144:147], v[80:83], v[172:175]
    s_add_u32 s57, s57, 1024
    v_exp_f32 v210, v98
    v_mfma_f32_16x16x32_bf16 v[156:159], a[148:151], v[84:87], v[156:159]
    buffer_load_dwordx4 v7, s[16:19], s57 offen offset:1024 sc1 lds
    v_mfma_f32_16x16x32_bf16 v[156:159], a[152:155], v[88:91], v[156:159]
    v_exp_f32 v211, v99
    v_mfma_f32_16x16x32_bf16 v[156:159], a[156:159], v[92:95], v[156:159]
    v_cvt_pk_bf16_f32 v177, v210, v211
    v_cmp_nle_f32 vcc, v228, v234
    v_mfma_f32_16x16x32_bf16 v[152:155], a[140:143], v[92:95], v[172:175]
    s_add_u32 s61, s61, 4096
    v_exp_f32 v208, v100
    v_mfma_f32_16x16x32_bf16 v[152:155], a[136:139], v[88:91], v[152:155]
    buffer_load_dwordx4 v7, s[16:19], s61 offen offset:2048 sc1 lds
    v_mfma_f32_16x16x32_bf16 v[152:155], a[132:135], v[84:87], v[152:155]
    v_exp_f32 v209, v101
    v_mfma_f32_16x16x32_bf16 v[152:155], a[128:131], v[80:83], v[152:155]
    s_waitcnt lgkmcnt(0)
    v_cvt_pk_bf16_f32 v178, v208, v209
    s_cbranch_vccnz L_slow0_t4
L_back0_t4:
    v_mfma_f32_16x16x32_bf16 a[64:67], a[192:195], v[200:203], a[64:67]
    v_exp_f32 v210, v102
    v_mfma_f32_16x16x32_bf16 a[64:67], a[160:163], v[192:195], a[64:67]
    ds_read_b128 a[128:131], v12 offset:0
    ds_read_b128 a[132:135], v13 offset:0
    v_mfma_f32_16x16x32_bf16 a[68:71], a[164:167], v[192:195], a[68:71]
    v_exp_f32 v211, v103
    v_mfma_f32_16x16x32_bf16 a[68:71], a[196:199], v[200:203], a[68:71]
    ds_read_b128 a[136:139], v14 offset:0
    v_cvt_pk_bf16_f32 v179, v210, v211
    v_mfma_f32_16x16x32_bf16 a[72:75], a[200:203], v[200:203], a[72:75]
    v_exp_f32 v208, v104
    v_mfma_f32_16x16x32_bf16 a[72:75], a[168:171], v[192:195], a[72:75]
    ds_read_b128 a[140:143], v15 offset:0
    ds_read_b128 a[144:147], v12 offset:8192
    v_mfma_f32_16x16x32_bf16 a[76:79], a[172:175], v[192:195], a[76:79]
    v_exp_f32 v209, v105
    v_mfma_f32_16x16x32_bf16 a[76:79], a[204:207], v[200:203], a[76:79]
    ds_read_b128 a[148:151], v13 offset:8192
    v_cvt_pk_bf16_f32 v180, v208, v209
    v_mfma_f32_16x16x32_bf16 a[80:83], a[208:211], v[200:203], a[80:83]
    v_exp_f32 v210, v106
    v_mfma_f32_16x16x32_bf16 a[80:83], a[176:179], v[192:195], a[80:83]
    buffer_load_dwordx4 v7, s[16:19], s61 offen offset:3072 sc1 lds
    v_mfma_f32_16x16x32_bf16 a[84:87], a[180:183], v[192:195], a[84:87]
    v_exp_f32 v211, v107
    v_mfma_f32_16x16x32_bf16 a[84:87], a[212:215], v[200:203], a[84:87]
    ds_read_b128 a[152:155], v14 offset:8192
    v_cvt_pk_bf16_f32 v181, v210, v211
    v_mfma_f32_16x16x32_bf16 a[88:91], a[216:219], v[200:203], a[88:91]
    s_add_u32 m0, s88, 16384
    s_add_u32 s56, s56, 1024
    v_exp_f32 v208, v108
    v_mfma_f32_16x16x32_bf16 a[88:91], a[184:187], v[192:195], a[88:91]
    buffer_load_dwordx4 v7, s[16:19], s56 offen sc1 lds
    v_mfma_f32_16x16x32_bf16 a[92:95], a[188:191], v[192:195], a[92:95]
    v_exp_f32 v209, v109
    v_mfma_f32_16x16x32_bf16 a[92:95], a[220:223], v[200:203], a[92:95]
    ds_read_b128 a[156:159], v15 offset:8192
    v_cvt_pk_bf16_f32 v182, v208, v209
    v_mfma_f32_16x16x32_bf16 a[124:127], a[220:223], v[204:207], a[124:127]
    s_add_u32 s57, s57, 1024
    v_exp_f32 v210, v110
    v_mfma_f32_16x16x32_bf16 a[124:127], a[188:191], v[196:199], a[124:127]
    buffer_load_dwordx4 v7, s[16:19], s57 offen offset:1024 sc1 lds
    v_mfma_f32_16x16x32_bf16 a[120:123], a[184:187], v[196:199], a[120:123]
    v_exp_f32 v211, v111
    v_mfma_f32_16x16x32_bf16 a[120:123], a[216:219], v[204:207], a[120:123]
    v_cvt_pk_bf16_f32 v183, v210, v211
    v_mfma_f32_16x16x32_bf16 a[116:119], a[212:215], v[204:207], a[116:119]
    v_mov_b32 v232, v224
    v_mfma_f32_16x16x32_bf16 a[116:119], a[180:183], v[196:199], a[116:119]
    s_add_u32 s61, s61, 4096
    v_exp_f32 v208, v128
    v_mfma_f32_16x16x32_bf16 a[112:115], a[176:179], v[196:199], a[112:115]
    buffer_load_dwordx4 v7, s[16:19], s61 offen offset:2048 sc1 lds
    v_mfma_f32_16x16x32_bf16 a[112:115], a[208:211], v[204:207], a[112:115]
    v_exp_f32 v209, v129
    v_smfmac_f32_16x16x64_bf16 v[224:227], v[24:27], v[176:183], v235
    v_cvt_pk_bf16_f32 v184, v208, v209
    v_mfma_f32_16x16x32_bf16 a[108:111], a[204:207], v[204:207], a[108:111]
    v_exp_f32 v210, v130
    v_mfma_f32_16x16x32_bf16 a[108:111], a[172:175], v[196:199], a[108:111]
    buffer_load_dwordx4 v7, s[16:19], s61 offen offset:3072 sc1 lds
    v_mfma_f32_16x16x32_bf16 a[104:107], a[168:171], v[196:199], a[104:107]
    v_exp_f32 v211, v131
    v_mfma_f32_16x16x32_bf16 a[104:107], a[200:203], v[204:207], a[104:107]
    v_cvt_pk_bf16_f32 v185, v210, v211
    v_cmp_nle_f32 vcc, v224, v234
    v_mfma_f32_16x16x32_bf16 a[100:103], a[196:199], v[204:207], a[100:103]
    v_exp_f32 v208, v132
    v_mfma_f32_16x16x32_bf16 a[100:103], a[164:167], v[196:199], a[100:103]
    buffer_load_dword v5, v4, s[16:19], s58 offen sc1
    v_mfma_f32_16x16x32_bf16 a[96:99], a[160:163], v[196:199], a[96:99]
    v_exp_f32 v209, v133
    v_mfma_f32_16x16x32_bf16 a[96:99], a[192:195], v[204:207], a[96:99]
    s_waitcnt lgkmcnt(0)
    v_cvt_pk_bf16_f32 v186, v208, v209
    s_cbranch_vccnz L_slow1_t4
L_back1_t4:
    v_mfma_f32_16x16x32_bf16 v[112:115], a[128:131], v[64:67], v[168:171]
    v_exp_f32 v210, v134
    v_mfma_f32_16x16x32_bf16 v[112:115], a[132:135], v[68:71], v[112:115]
    ds_read_b64_tr_b16 a[192:193], v244 offset:18432
    ds_read_b64_tr_b16 a[194:195], v244 offset:26624
    v_mfma_f32_16x16x32_bf16 v[112:115], a[136:139], v[72:75], v[112:115]
    v_exp_f32 v211, v135
    v_mfma_f32_16x16x32_bf16 v[112:115], a[140:143], v[76:79], v[112:115]
    ds_read_b64_tr_b16 a[196:197], v245 offset:18432
    v_cvt_pk_bf16_f32 v187, v210, v211
    v_mfma_f32_16x16x32_bf16 v[116:119], a[156:159], v[76:79], v[168:171]
    v_exp_f32 v208, v136
    v_mfma_f32_16x16x32_bf16 v[116:119], a[152:155], v[72:75], v[116:119]
    ds_read_b64_tr_b16 a[198:199], v245 offset:26624
    ds_read_b64_tr_b16 a[200:201], v246 offset:18432
    v_mfma_f32_16x16x32_bf16 v[116:119], a[148:151], v[68:71], v[116:119]
    v_exp_f32 v209, v137
    v_mfma_f32_16x16x32_bf16 v[116:119], a[144:147], v[64:67], v[116:119]
    ds_read_b64_tr_b16 a[202:203], v246 offset:26624
    v_cvt_pk_bf16_f32 v188, v208, v209
    v_mfma_f32_16x16x32_bf16 v[124:127], a[144:147], v[80:83], v[172:175]
    v_exp_f32 v210, v138
    v_mfma_f32_16x16x32_bf16 v[124:127], a[148:151], v[84:87], v[124:127]
    ds_read_b64_tr_b16 a[204:205], v247 offset:18432
    ds_read_b64_tr_b16 a[206:207], v247 offset:26624
    v_mfma_f32_16x16x32_bf16 v[124:127], a[152:155], v[88:91], v[124:127]
    v_exp_f32 v211, v139
    v_mfma_f32_16x16x32_bf16 v[124:127], a[156:159], v[92:95], v[124:127]
    ds_read_b64_tr_b16 a[208:209], v248 offset:18432
    v_cvt_pk_bf16_f32 v189, v210, v211
L_pad11:
    s_cbranch_execz L_pad15
    v_mfma_f32_16x16x32_bf16 v[120:123], a[140:143], v[92:95], v[172:175]
    v_exp_f32 v208, v140
    v_mfma_f32_16x16x32_bf16 v[120:123], a[136:139], v[88:91], v[120:123]
    ds_read_b64_tr_b16 a[210:211], v248 offset:26624
    ds_read_b64_tr_b16 a[212:213], v249 offset:18432
    v_mfma_f32_16x16x32_bf16 v[120:123], a[132:135], v[84:87], v[120:123]
    v_exp_f32 v209, v141
    v_mfma_f32_16x16x32_bf16 v[120:123], a[128:131], v[80:83], v[120:123]
    ds_read_b64_tr_b16 a[214:215], v249 offset:26624
    v_cvt_pk_bf16_f32 v190, v208, v209
    v_mfma_f32_16x16x32_bf16 v[96:99], a[128:131], v[32:35], v[160:163]
    v_exp_f32 v210, v142
    v_mfma_f32_16x16x32_bf16 v[96:99], a[132:135], v[36:39], v[96:99]
    ds_read_b64_tr_b16 a[216:217], v250 offset:18432
    ds_read_b64_tr_b16 a[218:219], v250 offset:26624
    v_mfma_f32_16x16x32_bf16 v[96:99], a[136:139], v[40:43], v[96:99]
    v_exp_f32 v211, v143
    v_mfma_f32_16x16x32_bf16 v[96:99], a[140:143], v[44:47], v[96:99]
    ds_read_b64_tr_b16 a[220:221], v251 offset:18432
    v_cvt_pk_bf16_f32 v191, v210, v211
    v_mfma_f32_16x16x32_bf16 v[100:103], a[156:159], v[44:47], v[160:163]
    ds_read_b64_tr_b16 a[222:223], v251 offset:26624
    v_mov_b32 v232, v224
    v_mfma_f32_16x16x32_bf16 v[100:103], a[152:155], v[40:43], v[100:103]
    s_add_u32 m0, s88, 32768
    s_add_u32 s56, s56, 1024
    v_exp_f32 v208, v144
    v_mfma_f32_16x16x32_bf16 v[100:103], a[148:151], v[36:39], v[100:103]
    buffer_load_dwordx4 v7, s[16:19], s56 offen sc1 lds
    v_mfma_f32_16x16x32_bf16 v[100:103], a[144:147], v[32:35], v[100:103]
    v_exp_f32 v209, v145
    v_smfmac_f32_16x16x64_bf16 v[224:227], v[24:27], v[184:191], v235
    v_cvt_pk_bf16_f32 v200, v208, v209
    v_mfma_f32_16x16x32_bf16 v[108:111], a[144:147], v[48:51], v[164:167]
    s_add_u32 s57, s57, 1024
    v_exp_f32 v210, v146
    v_mfma_f32_16x16x32_bf16 v[108:111], a[148:151], v[52:55], v[108:111]
    buffer_load_dwordx4 v7, s[16:19], s57 offen offset:1024 sc1 lds
    v_mfma_f32_16x16x32_bf16 v[108:111], a[152:155], v[56:59], v[108:111]
    v_exp_f32 v211, v147
    v_mfma_f32_16x16x32_bf16 v[108:111], a[156:159], v[60:63], v[108:111]
    v_cvt_pk_bf16_f32 v201, v210, v211
    v_cmp_nle_f32 vcc, v224, v234
    v_mfma_f32_16x16x32_bf16 v[104:107], a[140:143], v[60:63], v[164:167]
    s_add_u32 s61, s61, 4096
    v_exp_f32 v208, v148
    v_mfma_f32_16x16x32_bf16 v[104:107], a[136:139], v[56:59], v[104:107]
    buffer_load_dwordx4 v7, s[16:19], s61 offen offset:2048 sc1 lds
    v_mfma_f32_16x16x32_bf16 v[104:107], a[132:135], v[52:55], v[104:107]
    v_exp_f32 v209, v149
    v_mfma_f32_16x16x32_bf16 v[104:107], a[128:131], v[48:51], v[104:107]
    s_waitcnt lgkmcnt(0)
    v_cvt_pk_bf16_f32 v202, v208, v209
    s_cbranch_vccnz L_slow0_t5
L_back0_t5:
    v_mfma_f32_16x16x32_bf16 a[0:3], a[160:163], v[176:179], a[0:3]
    v_exp_f32 v210, v150
    v_mfma_f32_16x16x32_bf16 a[0:3], a[192:195], v[184:187], a[0:3]
    ds_read_b128 a[128:131], v12 offset:16384
    ds_read_b128 a[132:135], v13 offset:16384
    v_mfma_f32_16x16x32_bf16 a[4:7], a[196:199], v[184:187], a[4:7]
    v_exp_f32 v211, v151
    v_mfma_f32_16x16x32_bf16 a[4:7], a[164:167], v[176:179], a[4:7]
    ds_read_b128 a[136:139], v14 offset:16384
    v_cvt_pk_bf16_f32 v203, v210, v211
    v_mfma_f32_16x16x32_bf16 a[8:11], a[168:171], v[176:179], a[8:11]
    v_exp_f32 v208, v152
    v_mfma_f32_16x16x32_bf16 a[8:11], a[200:203], v[184:187], a[8:11]
    ds_read_b128 a[140:143], v15 offset:16384
    ds_read_b128 a[144:147], v12 offset:24576
    v_mfma_f32_16x16x32_bf16 a[12:15], a[204:207], v[184:187], a[12:15]
    v_exp_f32 v209, v153
    v_mfma_f32_16x16x32_bf16 a[12:15], a[172:175], v[176:179], a[12:15]
    ds_read_b128 a[148:151], v13 offset:24576
    v_cvt_pk_bf16_f32 v204, v208, v209
    v_mfma_f32_16x16x32_bf16 a[16:19], a[176:179], v[176:179], a[16:19]
    v_exp_f32 v210, v154
    v_mfma_f32_16x16x32_bf16 a[16:19], a[208:211], v[184:187], a[16:19]
    buffer_load_dwordx4 v7, s[16:19], s61 offen offset:3072 sc1 lds
    v_mfma_f32_16x16x32_bf16 a[20:23], a[212:215], v[184:187], a[20:23]
    v_exp_f32 v211, v155
    v_mfma_f32_16x16x32_bf16 a[20:23], a[180:183], v[176:179], a[20:23]
    ds_read_b128 a[152:155], v14 offset:24576
    v_cvt_pk_bf16_f32 v205, v210, v211
    v_mfma_f32_16x16x32_bf16 a[24:27], a[184:187], v[176:179], a[24:27]
    s_add_u32 m0, s88, 49152
    s_add_u32 s56, s56, 1024
    v_exp_f32 v208, v156
    v_mfma_f32_16x16x32_bf16 a[24:27], a[216:219], v[184:187], a[24:27]
    buffer_load_dwordx4 v7, s[16:19], s56 offen sc1 lds
    v_mfma_f32_16x16x32_bf16 a[28:31], a[220:223], v[184:187], a[28:31]
    v_exp_f32 v209, v157
    v_mfma_f32_16x16x32_bf16 a[28:31], a[188:191], v[176:179], a[28:31]
    ds_read_b128 a[156:159], v15 offset:24576
    v_cvt_pk_bf16_f32 v206, v208, v209
    v_mfma_f32_16x16x32_bf16 a[60:63], a[188:191], v[180:183], a[60:63]
    s_add_u32 s57, s57, 1024
    v_exp_f32 v210, v158
    v_mfma_f32_16x16x32_bf16 a[60:63], a[220:223], v[188:191], a[60:63]
    buffer_load_dwordx4 v7, s[16:19], s57 offen offset:1024 sc1 lds
    v_mfma_f32_16x16x32_bf16 a[56:59], a[216:219], v[188:191], a[56:59]
    v_exp_f32 v211, v159
    v_mfma_f32_16x16x32_bf16 a[56:59], a[184:187], v[180:183], a[56:59]
    v_cvt_pk_bf16_f32 v207, v210, v211
    v_mfma_f32_16x16x32_bf16 a[52:55], a[180:183], v[180:183], a[52:55]
    v_mov_b32 v233, v228
    v_mfma_f32_16x16x32_bf16 a[52:55], a[212:215], v[188:191], a[52:55]
    s_add_u32 s61, s61, 4096
    v_exp_f32 v208, v112
    v_mfma_f32_16x16x32_bf16 a[48:51], a[208:211], v[188:191], a[48:51]
    buffer_load_dwordx4 v7, s[16:19], s61 offen offset:2048 sc1 lds
    v_mfma_f32_16x16x32_bf16 a[48:51], a[176:179], v[180:183], a[48:51]
    v_exp_f32 v209, v113
    v_smfmac_f32_16x16x64_bf16 v[228:231], v[24:27], v[200:207], v235
    v_cvt_pk_bf16_f32 v192, v208, v209
    v_mfma_f32_16x16x32_bf16 a[44:47], a[172:175], v[180:183], a[44:47]
    v_exp_f32 v210, v114
    v_mfma_f32_16x16x32_bf16 a[44:47], a[204:207], v[188:191], a[44:47]
    buffer_load_dwordx4 v7, s[16:19], s61 offen offset:3072 sc1 lds
    v_mfma_f32_16x16x32_bf16 a[40:43], a[200:203], v[188:191], a[40:43]
    v_exp_f32 v211, v115
    v_mfma_f32_16x16x32_bf16 a[40:43], a[168:171], v[180:183], a[40:43]
    v_cvt_pk_bf16_f32 v193, v210, v211
    v_cmp_nle_f32 vcc, v228, v234
    v_mfma_f32_16x16x32_bf16 a[36:39], a[164:167], v[180:183], a[36:39]
    v_exp_f32 v208, v116
    v_mfma_f32_16x16x32_bf16 a[36:39], a[196:199], v[188:191], a[36:39]
    v_mfma_f32_16x16x32_bf16 a[32:35], a[192:195], v[188:191], a[32:35]
    v_exp_f32 v209, v117
    v_mfma_f32_16x16x32_bf16 a[32:35], a[160:163], v[180:183], a[32:35]
    s_waitcnt vmcnt(63) lgkmcnt(0)
    s_barrier
    v_cvt_pk_bf16_f32 v194, v208, v209
    s_cbranch_vccnz L_slow1_t5
L_back1_t5:
    v_mfma_f32_16x16x32_bf16 v[128:131], a[128:131], v[32:35], v[160:163]
    v_exp_f32 v210, v118
    v_mfma_f32_16x16x32_bf16 v[128:131], a[132:135], v[36:39], v[128:131]
    ds_read_b64_tr_b16 a[160:161], v244 offset:34816
    ds_read_b64_tr_b16 a[162:163], v244 offset:43008
    v_mfma_f32_16x16x32_bf16 v[128:131], a[136:139], v[40:43], v[128:131]
    v_exp_f32 v211, v119
    v_mfma_f32_16x16x32_bf16 v[128:131], a[140:143], v[44:47], v[128:131]
    ds_read_b64_tr_b16 a[164:165], v245 offset:34816
    v_cvt_pk_bf16_f32 v195, v210, v211
    v_mfma_f32_16x16x32_bf16 v[132:135], a[156:159], v[44:47], v[160:163]
    v_exp_f32 v208, v120
    v_mfma_f32_16x16x32_bf16 v[132:135], a[152:155], v[40:43], v[132:135]
    ds_read_b64_tr_b16 a[166:167], v245 offset:43008
    ds_read_b64_tr_b16 a[168:169], v246 offset:34816
    v_mfma_f32_16x16x32_bf16 v[132:135], a[148:151], v[36:39], v[132:135]
    v_exp_f32 v209, v121
    v_mfma_f32_16x16x32_bf16 v[132:135], a[144:147], v[32:35], v[132:135]
    ds_read_b64_tr_b16 a[170:171], v246 offset:43008
    v_cvt_pk_bf16_f32 v196, v208, v209
    v_mfma_f32_16x16x32_bf16 v[140:143], a[144:147], v[48:51], v[164:167]
    v_exp_f32 v210, v122
    v_mfma_f32_16x16x32_bf16 v[140:143], a[148:151], v[52:55], v[140:143]
    ds_read_b64_tr_b16 a[172:173], v247 offset:34816
    ds_read_b64_tr_b16 a[174:175], v247 offset:43008
    v_mfma_f32_16x16x32_bf16 v[140:143], a[152:155], v[56:59], v[140:143]
    v_exp_f32 v211, v123
    v_mfma_f32_16x16x32_bf16 v[140:143], a[156:159], v[60:63], v[140:143]
    ds_read_b64_tr_b16 a[176:177], v248 offset:34816
    v_cvt_pk_bf16_f32 v197, v210, v211
    v_mfma_f32_16x16x32_bf16 v[136:139], a[140:143], v[60:63], v[164:167]
    v_exp_f32 v208, v124
    v_mfma_f32_16x16x32_bf16 v[136:139], a[136:139], v[56:59], v[136:139]
    ds_read_b64_tr_b16 a[178:179], v248 offset:43008
    ds_read_b64_tr_b16 a[180:181], v249 offset:34816
    v_mfma_f32_16x16x32_bf16 v[136:139], a[132:135], v[52:55], v[136:139]
    v_exp_f32 v209, v125
    v_mfma_f32_16x16x32_bf16 v[136:139], a[128:131], v[48:51], v[136:139]
    ds_read_b64_tr_b16 a[182:183], v249 offset:43008
    v_cvt_pk_bf16_f32 v198, v208, v209
    v_mfma_f32_16x16x32_bf16 v[144:147], a[128:131], v[64:67], v[168:171]
    v_exp_f32 v210, v126
    v_mfma_f32_16x16x32_bf16 v[144:147], a[132:135], v[68:71], v[144:147]
    ds_read_b64_tr_b16 a[184:185], v250 offset:34816
    ds_read_b64_tr_b16 a[186:187], v250 offset:43008
    v_mfma_f32_16x16x32_bf16 v[144:147], a[136:139], v[72:75], v[144:147]
    v_exp_f32 v211, v127
    v_mfma_f32_16x16x32_bf16 v[144:147], a[140:143], v[76:79], v[144:147]
    ds_read_b64_tr_b16 a[188:189], v251 offset:34816
    v_cvt_pk_bf16_f32 v199, v210, v211
    v_mfma_f32_16x16x32_bf16 v[148:151], a[156:159], v[76:79], v[168:171]
    ds_read_b64_tr_b16 a[190:191], v251 offset:43008
    v_mov_b32 v233, v228
    v_mfma_f32_16x16x32_bf16 v[148:151], a[152:155], v[72:75], v[148:151]
    s_add_u32 m0, s88, 131072
    s_add_u32 s56, s56, 1024
    v_exp_f32 v208, v96
    v_mfma_f32_16x16x32_bf16 v[148:151], a[148:151], v[68:71], v[148:151]
    buffer_load_dwordx4 v7, s[16:19], s56 offen sc1 lds
    v_mfma_f32_16x16x32_bf16 v[148:151], a[144:147], v[64:67], v[148:151]
    v_exp_f32 v209, v97
    v_smfmac_f32_16x16x64_bf16 v[228:231], v[24:27], v[192:199], v235
    v_cvt_pk_bf16_f32 v176, v208, v209
    v_mfma_f32_16x16x32_bf16 v[156:159], a[144:147], v[80:83], v[172:175]
    s_add_u32 s57, s57, 1024
    v_exp_f32 v210, v98
    v_mfma_f32_16x16x32_bf16 v[156:159], a[148:151], v[84:87], v[156:159]
    buffer_load_dwordx4 v7, s[16:19], s57 offen offset:1024 sc1 lds
    v_mfma_f32_16x16x32_bf16 v[156:159], a[152:155], v[88:91], v[156:159]
    v_exp_f32 v211, v99
    v_mfma_f32_16x16x32_bf16 v[156:159], a[156:159], v[92:95], v[156:159]
    v_cvt_pk_bf16_f32 v177, v210, v211
    v_cmp_nle_f32 vcc, v228, v234
    v_mfma_f32_16x16x32_bf16 v[152:155], a[140:143], v[92:95], v[172:175]
    s_add_u32 s61, s61, 4096
    v_exp_f32 v208, v100
    v_mfma_f32_16x16x32_bf16 v[152:155], a[136:139], v[88:91], v[152:155]
    buffer_load_dwordx4 v7, s[16:19], s61 offen offset:2048 sc1 lds
    v_mfma_f32_16x16x32_bf16 v[152:155], a[132:135], v[84:87], v[152:155]
    v_exp_f32 v209, v101
    v_mfma_f32_16x16x32_bf16 v[152:155], a[128:131], v[80:83], v[152:155]
    s_waitcnt lgkmcnt(0)
    v_cvt_pk_bf16_f32 v178, v208, v209
    s_cbranch_vccnz L_slow0_t6
L_back0_t6:
    v_mfma_f32_16x16x32_bf16 a[64:67], a[192:195], v[200:203], a[64:67]
    v_exp_f32 v210, v102
    v_mfma_f32_16x16x32_bf16 a[64:67], a[160:163], v[192:195], a[64:67]
    ds_read_b128 a[128:131], v12 offset:32768
    ds_read_b128 a[132:135], v13 offset:32768
    v_mfma_f32_16x16x32_bf16 a[68:71], a[164:167], v[192:195], a[68:71]
    v_exp_f32 v211, v103
    v_mfma_f32_16x16x32_bf16 a[68:71], a[196:199], v[200:203], a[68:71]
    ds_read_b128 a[136:139], v14 offset:32768
    v_cvt_pk_bf16_f32 v179, v210, v211
    v_mfma_f32_16x16x32_bf16 a[72:75], a[200:203], v[200:203], a[72:75]
    v_exp_f32 v208, v104
    v_mfma_f32_16x16x32_bf16 a[72:75], a[168:171], v[192:195], a[72:75]
    ds_read_b128 a[140:143], v15 offset:32768
    ds_read_b128 a[144:147], v12 offset:40960
    v_mfma_f32_16x16x32_bf16 a[76:79], a[172:175], v[192:195], a[76:79]
    v_exp_f32 v209, v105
    v_mfma_f32_16x16x32_bf16 a[76:79], a[204:207], v[200:203], a[76:79]
    ds_read_b128 a[148:151], v13 offset:40960
    v_cvt_pk_bf16_f32 v180, v208, v209
    v_mfma_f32_16x16x32_bf16 a[80:83], a[208:211], v[200:203], a[80:83]
    v_exp_f32 v210, v106
    v_mfma_f32_16x16x32_bf16 a[80:83], a[176:179], v[192:195], a[80:83]
    buffer_load_dwordx4 v7, s[16:19], s61 offen offset:3072 sc1 lds
    v_mfma_f32_16x16x32_bf16 a[84:87], a[180:183], v[192:195], a[84:87]
    v_exp_f32 v211, v107
    v_mfma_f32_16x16x32_bf16 a[84:87], a[212:215], v[200:203], a[84:87]
    ds_read_b128 a[152:155], v14 offset:40960
    v_cvt_pk_bf16_f32 v181, v210, v211
    v_mfma_f32_16x16x32_bf16 a[88:91], a[216:219], v[200:203], a[88:91]
    s_add_u32 m0, s88, 147456
    s_add_u32 s56, s56, 1024
    v_exp_f32 v208, v108
    v_mfma_f32_16x16x32_bf16 a[88:91], a[184:187], v[192:195], a[88:91]
    buffer_load_dwordx4 v7, s[16:19], s56 offen sc1 lds
    v_mfma_f32_16x16x32_bf16 a[92:95], a[188:191], v[192:195], a[92:95]
    v_exp_f32 v209, v109
    v_mfma_f32_16x16x32_bf16 a[92:95], a[220:223], v[200:203], a[92:95]
    ds_read_b128 a[156:159], v15 offset:40960
    v_cvt_pk_bf16_f32 v182, v208, v209
    v_mfma_f32_16x16x32_bf16 a[124:127], a[220:223], v[204:207], a[124:127]
    s_add_u32 s57, s57, 1024
    v_exp_f32 v210, v110
    v_mfma_f32_16x16x32_bf16 a[124:127], a[188:191], v[196:199], a[124:127]
    buffer_load_dwordx4 v7, s[16:19], s57 offen offset:1024 sc1 lds
    v_mfma_f32_16x16x32_bf16 a[120:123], a[184:187], v[196:199], a[120:123]
    v_exp_f32 v211, v111
    v_mfma_f32_16x16x32_bf16 a[120:123], a[216:219], v[204:207], a[120:123]
    v_cvt_pk_bf16_f32 v183, v210, v211
    v_mfma_f32_16x16x32_bf16 a[116:119], a[212:215], v[204:207], a[116:119]
    v_mov_b32 v232, v224
    v_mfma_f32_16x16x32_bf16 a[116:119], a[180:183], v[196:199], a[116:119]
    s_add_u32 s61, s61, 4096
    v_exp_f32 v208, v128
    v_mfma_f32_16x16x32_bf16 a[112:115], a[176:179], v[196:199], a[112:115]
    buffer_load_dwordx4 v7, s[16:19], s61 offen offset:2048 sc1 lds
    v_mfma_f32_16x16x32_bf16 a[112:115], a[208:211], v[204:207], a[112:115]
    v_exp_f32 v209, v129
    v_smfmac_f32_16x16x64_bf16 v[224:227], v[24:27], v[176:183], v235
    v_cvt_pk_bf16_f32 v184, v208, v209
    v_mfma_f32_16x16x32_bf16 a[108:111], a[204:207], v[204:207], a[108:111]
    v_exp_f32 v210, v130
    v_mfma_f32_16x16x32_bf16 a[108:111], a[172:175], v[196:199], a[108:111]
    buffer_load_dwordx4 v7, s[16:19], s61 offen offset:3072 sc1 lds
    v_mfma_f32_16x16x32_bf16 a[104:107], a[168:171], v[196:199], a[104:107]
    v_exp_f32 v211, v131
    v_mfma_f32_16x16x32_bf16 a[104:107], a[200:203], v[204:207], a[104:107]
    v_cvt_pk_bf16_f32 v185, v210, v211
    v_cmp_nle_f32 vcc, v224, v234
    v_mfma_f32_16x16x32_bf16 a[100:103], a[196:199], v[204:207], a[100:103]
    v_exp_f32 v208, v132
    v_mfma_f32_16x16x32_bf16 a[100:103], a[164:167], v[196:199], a[100:103]
    v_mfma_f32_16x16x32_bf16 a[96:99], a[160:163], v[196:199], a[96:99]
    v_exp_f32 v209, v133
    v_mfma_f32_16x16x32_bf16 a[96:99], a[192:195], v[204:207], a[96:99]
    s_waitcnt lgkmcnt(0)
    v_cvt_pk_bf16_f32 v186, v208, v209
    s_cbranch_vccnz L_slow1_t6
L_back1_t6:
    v_mfma_f32_16x16x32_bf16 a[0:3], a[160:163], v[176:179], a[0:3]
    v_exp_f32 v210, v134
    ds_read_b64_tr_b16 a[192:193], v244 offset:51200
    ds_read_b64_tr_b16 a[194:195], v244 offset:59392
    v_mfma_f32_16x16x32_bf16 a[4:7], a[164:167], v[176:179], a[4:7]
    v_exp_f32 v211, v135
    ds_read_b64_tr_b16 a[196:197], v245 offset:51200
    v_cvt_pk_bf16_f32 v187, v210, v211
    v_mfma_f32_16x16x32_bf16 a[8:11], a[168:171], v[176:179], a[8:11]
    v_exp_f32 v208, v136
    ds_read_b64_tr_b16 a[198:199], v245 offset:59392
    ds_read_b64_tr_b16 a[200:201], v246 offset:51200
    v_mfma_f32_16x16x32_bf16 a[12:15], a[172:175], v[176:179], a[12:15]
    v_exp_f32 v209, v137
    ds_read_b64_tr_b16 a[202:203], v246 offset:59392
    v_cvt_pk_bf16_f32 v188, v208, v209
    v_mfma_f32_16x16x32_bf16 a[16:19], a[176:179], v[176:179], a[16:19]
    v_exp_f32 v210, v138
    ds_read_b64_tr_b16 a[204:205], v247 offset:51200
    ds_read_b64_tr_b16 a[206:207], v247 offset:59392
    v_mfma_f32_16x16x32_bf16 a[20:23], a[180:183], v[176:179], a[20:23]
    v_exp_f32 v211, v139
    ds_read_b64_tr_b16 a[208:209], v248 offset:51200
    v_cvt_pk_bf16_f32 v189, v210, v211
    v_mfma_f32_16x16x32_bf16 a[24:27], a[184:187], v[176:179], a[24:27]
    v_exp_f32 v208, v140
    ds_read_b64_tr_b16 a[210:211], v248 offset:59392
    ds_read_b64_tr_b16 a[212:213], v249 offset:51200
    v_mfma_f32_16x16x32_bf16 a[28:31], a[188:191], v[176:179], a[28:31]
    v_exp_f32 v209, v141
    ds_read_b64_tr_b16 a[214:215], v249 offset:59392
    v_cvt_pk_bf16_f32 v190, v208, v209
    v_mfma_f32_16x16x32_bf16 a[60:63], a[188:191], v[180:183], a[60:63]
    v_exp_f32 v210, v142
    ds_read_b64_tr_b16 a[216:217], v250 offset:51200
    ds_read_b64_tr_b16 a[218:219], v250 offset:59392
    v_mfma_f32_16x16x32_bf16 a[56:59], a[184:187], v[180:183], a[56:59]
    v_exp_f32 v211, v143
    ds_read_b64_tr_b16 a[220:221], v251 offset:51200
    v_cvt_pk_bf16_f32 v191, v210, v211
    v_mfma_f32_16x16x32_bf16 a[52:55], a[180:183], v[180:183], a[52:55]
    ds_read_b64_tr_b16 a[222:223], v251 offset:59392
    v_mov_b32 v232, v224
    s_add_u32 m0, s88, 65536
    s_add_u32 s56, s56, 1024
    v_exp_f32 v208, v144
    v_mfma_f32_16x16x32_bf16 a[48:51], a[176:179], v[180:183], a[48:51]
    buffer_load_dwordx4 v7, s[16:19], s56 offen sc1 lds
    v_exp_f32 v209, v145
    v_smfmac_f32_16x16x64_bf16 v[224:227], v[24:27], v[184:191], v235
    v_cvt_pk_bf16_f32 v200, v208, v209
    s_add_u32 s57, s57, 1024
    s_nop 3
    v_exp_f32 v210, v146
    v_mfma_f32_16x16x32_bf16 a[44:47], a[172:175], v[180:183], a[44:47]
    buffer_load_dwordx4 v7, s[16:19], s57 offen offset:1024 sc1 lds
    v_exp_f32 v211, v147
    v_mfma_f32_16x16x32_bf16 a[40:43], a[168:171], v[180:183], a[40:43]
    v_cvt_pk_bf16_f32 v201, v210, v211
    v_cmp_nle_f32 vcc, v224, v234
    s_add_u32 s61, s61, 4096
    v_exp_f32 v208, v148
    v_mfma_f32_16x16x32_bf16 a[36:39], a[164:167], v[180:183], a[36:39]
    buffer_load_dwordx4 v7, s[16:19], s61 offen offset:2048 sc1 lds
    v_mfma_f32_16x16x32_bf16 a[32:35], a[160:163], v[180:183], a[32:35]
    v_exp_f32 v209, v149
    s_waitcnt lgkmcnt(0)
    v_cvt_pk_bf16_f32 v202, v208, v209
    s_cbranch_vccnz L_slow0_t7
L_back0_t7:
    v_exp_f32 v210, v150
    v_mfma_f32_16x16x32_bf16 a[0:3], a[192:195], v[184:187], a[0:3]
    v_mfma_f32_16x16x32_bf16 a[4:7], a[196:199], v[184:187], a[4:7]
    v_exp_f32 v211, v151
    s_nop 0
    v_cvt_pk_bf16_f32 v203, v210, v211
    v_exp_f32 v208, v152
    v_mfma_f32_16x16x32_bf16 a[8:11], a[200:203], v[184:187], a[8:11]
    v_mfma_f32_16x16x32_bf16 a[12:15], a[204:207], v[184:187], a[12:15]
    v_exp_f32 v209, v153
    s_nop 0
    v_cvt_pk_bf16_f32 v204, v208, v209
    v_exp_f32 v210, v154
    v_mfma_f32_16x16x32_bf16 a[16:19], a[208:211], v[184:187], a[16:19]
    buffer_load_dwordx4 v7, s[16:19], s61 offen offset:3072 sc1 lds
    v_mfma_f32_16x16x32_bf16 a[20:23], a[212:215], v[184:187], a[20:23]
    v_exp_f32 v211, v155
    s_nop 0
    v_cvt_pk_bf16_f32 v205, v210, v211
    s_add_u32 m0, s88, 81920
    s_add_u32 s56, s56, 1024
    v_exp_f32 v208, v156
    v_mfma_f32_16x16x32_bf16 a[24:27], a[216:219], v[184:187], a[24:27]
    buffer_load_dwordx4 v7, s[16:19], s56 offen sc1 lds
    v_mfma_f32_16x16x32_bf16 a[28:31], a[220:223], v[184:187], a[28:31]
    v_exp_f32 v209, v157
    s_nop 0
    v_cvt_pk_bf16_f32 v206, v208, v209
    s_add_u32 s57, s57, 1024
    v_exp_f32 v210, v158
    v_mfma_f32_16x16x32_bf16 a[60:63], a[220:223], v[188:191], a[60:63]
    buffer_load_dwordx4 v7, s[16:19], s57 offen offset:1024 sc1 lds
    v_mfma_f32_16x16x32_bf16 a[56:59], a[216:219], v[188:191], a[56:59]
    v_exp_f32 v211, v159
    s_nop 0
    v_cvt_pk_bf16_f32 v207, v210, v211
    v_mov_b32 v233, v228
    v_mfma_f32_16x16x32_bf16 a[52:55], a[212:215], v[188:191], a[52:55]
    s_add_u32 s61, s61, 4096
    v_mfma_f32_16x16x32_bf16 a[48:51], a[208:211], v[188:191], a[48:51]
    buffer_load_dwordx4 v7, s[16:19], s61 offen offset:2048 sc1 lds
    v_smfmac_f32_16x16x64_bf16 v[228:231], v[24:27], v[200:207], v235
    v_mfma_f32_16x16x32_bf16 a[44:47], a[204:207], v[188:191], a[44:47]
    buffer_load_dwordx4 v7, s[16:19], s61 offen offset:3072 sc1 lds
    v_mfma_f32_16x16x32_bf16 a[40:43], a[200:203], v[188:191], a[40:43]
    v_mfma_f32_16x16x32_bf16 a[36:39], a[196:199], v[188:191], a[36:39]
    s_nop 6
    v_mfma_f32_16x16x32_bf16 a[32:35], a[192:195], v[188:191], a[32:35]
    v_cmp_nle_f32 vcc, v228, v234
    s_cbranch_vccnz L_slow1_t7
L_back1_t7:
    s_lshl_b32 s3, s5, 4
    s_lshl_b32 s7, s6, 2
    s_add_u32 s3, s3, s7
    s_mul_i32 s3, s3, 136192
    s_lshl_b32 s7, s4, 12
    s_add_u32 s52, s3, s7
    v_mov_b32 v212, v224
    v_mov_b32 v213, v228
    s_nop 0
    v_permlane16_swap_b32 v224, v212
    v_permlane16_swap_b32 v228, v213
    v_add_f32 v214, v224, v212
    v_add_f32 v215, v224, v212
    v_add_f32 v216, v228, v213
    v_add_f32 v217, v228, v213
    s_nop 0
    v_permlane32_swap_b32 v214, v215
    v_permlane32_swap_b32 v216, v217
    v_rcp_f32 v240, v214
    v_rcp_f32 v241, v214
    v_rcp_f32 v242, v215
    v_rcp_f32 v243, v215
    v_rcp_f32 v244, v216
    v_rcp_f32 v245, v216
    v_rcp_f32 v246, v217
    v_rcp_f32 v247, v217
    v_mfma_f32_16x16x32_bf16 a[64:67], a[192:195], v[200:203], a[64:67]
    v_accvgpr_read_b32 v128, a0
    v_accvgpr_read_b32 v129, a1
    v_accvgpr_read_b32 v130, a2
    v_accvgpr_read_b32 v131, a3
    v_mfma_f32_16x16x32_bf16 a[68:71], a[196:199], v[200:203], a[68:71]
    v_accvgpr_read_b32 v132, a4
    v_accvgpr_read_b32 v133, a5
    v_accvgpr_read_b32 v134, a6
    v_accvgpr_read_b32 v135, a7
    v_mfma_f32_16x16x32_bf16 a[72:75], a[200:203], v[200:203], a[72:75]
    v_accvgpr_read_b32 v136, a8
    v_accvgpr_read_b32 v137, a9
    v_accvgpr_read_b32 v138, a10
    v_accvgpr_read_b32 v139, a11
    v_mfma_f32_16x16x32_bf16 a[76:79], a[204:207], v[200:203], a[76:79]
    v_accvgpr_read_b32 v140, a12
    v_accvgpr_read_b32 v141, a13
    v_accvgpr_read_b32 v142, a14
    v_accvgpr_read_b32 v143, a15
    v_mfma_f32_16x16x32_bf16 a[80:83], a[208:211], v[200:203], a[80:83]
    v_accvgpr_read_b32 v144, a16
    v_accvgpr_read_b32 v145, a17
    v_accvgpr_read_b32 v146, a18
    v_accvgpr_read_b32 v147, a19
    v_mfma_f32_16x16x32_bf16 a[84:87], a[212:215], v[200:203], a[84:87]
    v_accvgpr_read_b32 v148, a20
    v_accvgpr_read_b32 v149, a21
    v_accvgpr_read_b32 v150, a22
    v_accvgpr_read_b32 v151, a23
    v_mfma_f32_16x16x32_bf16 a[88:91], a[216:219], v[200:203], a[88:91]
    v_accvgpr_read_b32 v152, a24
    v_accvgpr_read_b32 v153, a25
    v_accvgpr_read_b32 v154, a26
    v_accvgpr_read_b32 v155, a27
    v_mfma_f32_16x16x32_bf16 a[92:95], a[220:223], v[200:203], a[92:95]
    v_accvgpr_read_b32 v156, a28
    v_accvgpr_read_b32 v157, a29
    v_accvgpr_read_b32 v158, a30
    v_accvgpr_read_b32 v159, a31
    v_pk_mul_f32 v[128:129], v[128:129], v[240:241]
    v_pk_mul_f32 v[130:131], v[130:131], v[240:241]
    v_pk_mul_f32 v[132:133], v[132:133], v[240:241]
    v_pk_mul_f32 v[134:135], v[134:135], v[240:241]
    v_cvt_pk_bf16_f32 v160, v128, v129
    v_cvt_pk_bf16_f32 v161, v130, v131
    v_cvt_pk_bf16_f32 v162, v132, v133
    v_cvt_pk_bf16_f32 v163, v134, v135
    buffer_store_dwordx4 v[160:163], v7, s[16:19], s52 offen offset:0 sc1
    v_pk_mul_f32 v[136:137], v[136:137], v[240:241]
    v_pk_mul_f32 v[138:139], v[138:139], v[240:241]
    v_pk_mul_f32 v[140:141], v[140:141], v[240:241]
    v_pk_mul_f32 v[142:143], v[142:143], v[240:241]
    v_cvt_pk_bf16_f32 v164, v136, v137
    v_cvt_pk_bf16_f32 v165, v138, v139
    v_cvt_pk_bf16_f32 v166, v140, v141
    v_cvt_pk_bf16_f32 v167, v142, v143
    buffer_store_dwordx4 v[164:167], v7, s[16:19], s52 offen offset:1024 sc1
    v_pk_mul_f32 v[144:145], v[144:145], v[240:241]
    v_pk_mul_f32 v[146:147], v[146:147], v[240:241]
    v_pk_mul_f32 v[148:149], v[148:149], v[240:241]
    v_pk_mul_f32 v[150:151], v[150:151], v[240:241]
    v_cvt_pk_bf16_f32 v168, v144, v145
    v_cvt_pk_bf16_f32 v169, v146, v147
    v_cvt_pk_bf16_f32 v170, v148, v149
    v_cvt_pk_bf16_f32 v171, v150, v151
    buffer_store_dwordx4 v[168:171], v7, s[16:19], s52 offen offset:2048 sc1
    v_pk_mul_f32 v[152:153], v[152:153], v[240:241]
    v_pk_mul_f32 v[154:155], v[154:155], v[240:241]
    v_pk_mul_f32 v[156:157], v[156:157], v[240:241]
    v_pk_mul_f32 v[158:159], v[158:159], v[240:241]
    v_cvt_pk_bf16_f32 v172, v152, v153
    v_cvt_pk_bf16_f32 v173, v154, v155
    v_cvt_pk_bf16_f32 v174, v156, v157
    v_cvt_pk_bf16_f32 v175, v158, v159
    buffer_store_dwordx4 v[172:175], v7, s[16:19], s52 offen offset:3072 sc1
    s_add_u32 s52, s52, 136192
    v_mfma_f32_16x16x32_bf16 a[96:99], a[192:195], v[204:207], a[96:99]
    v_accvgpr_read_b32 v128, a32
    v_accvgpr_read_b32 v129, a33
    v_accvgpr_read_b32 v130, a34
    v_accvgpr_read_b32 v131, a35
    v_mfma_f32_16x16x32_bf16 a[100:103], a[196:199], v[204:207], a[100:103]
    v_accvgpr_read_b32 v132, a36
    v_accvgpr_read_b32 v133, a37
    v_accvgpr_read_b32 v134, a38
    v_accvgpr_read_b32 v135, a39
    v_mfma_f32_16x16x32_bf16 a[104:107], a[200:203], v[204:207], a[104:107]
    v_accvgpr_read_b32 v136, a40
    v_accvgpr_read_b32 v137, a41
    v_accvgpr_read_b32 v138, a42
    v_accvgpr_read_b32 v139, a43
    v_mfma_f32_16x16x32_bf16 a[108:111], a[204:207], v[204:207], a[108:111]
    v_accvgpr_read_b32 v140, a44
    v_accvgpr_read_b32 v141, a45
    v_accvgpr_read_b32 v142, a46
    v_accvgpr_read_b32 v143, a47
    v_mfma_f32_16x16x32_bf16 a[112:115], a[208:211], v[204:207], a[112:115]
    v_accvgpr_read_b32 v144, a48
    v_accvgpr_read_b32 v145, a49
    v_accvgpr_read_b32 v146, a50
    v_accvgpr_read_b32 v147, a51
    v_mfma_f32_16x16x32_bf16 a[116:119], a[212:215], v[204:207], a[116:119]
    v_accvgpr_read_b32 v148, a52
    v_accvgpr_read_b32 v149, a53
    v_accvgpr_read_b32 v150, a54
    v_accvgpr_read_b32 v151, a55
    v_mfma_f32_16x16x32_bf16 a[120:123], a[216:219], v[204:207], a[120:123]
    v_accvgpr_read_b32 v152, a56
    v_accvgpr_read_b32 v153, a57
    v_accvgpr_read_b32 v154, a58
    v_accvgpr_read_b32 v155, a59
    v_mfma_f32_16x16x32_bf16 a[124:127], a[220:223], v[204:207], a[124:127]
    v_accvgpr_read_b32 v156, a60
    v_accvgpr_read_b32 v157, a61
    v_accvgpr_read_b32 v158, a62
    v_accvgpr_read_b32 v159, a63
    v_pk_mul_f32 v[128:129], v[128:129], v[242:243]
    v_pk_mul_f32 v[130:131], v[130:131], v[242:243]
    v_pk_mul_f32 v[132:133], v[132:133], v[242:243]
    v_pk_mul_f32 v[134:135], v[134:135], v[242:243]
    v_cvt_pk_bf16_f32 v160, v128, v129
    v_cvt_pk_bf16_f32 v161, v130, v131
    v_cvt_pk_bf16_f32 v162, v132, v133
    v_cvt_pk_bf16_f32 v163, v134, v135
    buffer_store_dwordx4 v[160:163], v7, s[16:19], s52 offen offset:0 sc1
    v_pk_mul_f32 v[136:137], v[136:137], v[242:243]
    v_pk_mul_f32 v[138:139], v[138:139], v[242:243]
    v_pk_mul_f32 v[140:141], v[140:141], v[242:243]
    v_pk_mul_f32 v[142:143], v[142:143], v[242:243]
    v_cvt_pk_bf16_f32 v164, v136, v137
    v_cvt_pk_bf16_f32 v165, v138, v139
    v_cvt_pk_bf16_f32 v166, v140, v141
    v_cvt_pk_bf16_f32 v167, v142, v143
    buffer_store_dwordx4 v[164:167], v7, s[16:19], s52 offen offset:1024 sc1
    v_pk_mul_f32 v[144:145], v[144:145], v[242:243]
    v_pk_mul_f32 v[146:147], v[146:147], v[242:243]
    v_pk_mul_f32 v[148:149], v[148:149], v[242:243]
    v_pk_mul_f32 v[150:151], v[150:151], v[242:243]
    v_cvt_pk_bf16_f32 v168, v144, v145
    v_cvt_pk_bf16_f32 v169, v146, v147
L_pad12:
    s_cbranch_execz L_warmret
    v_cvt_pk_bf16_f32 v170, v148, v149
    v_cvt_pk_bf16_f32 v171, v150, v151
    buffer_store_dwordx4 v[168:171], v7, s[16:19], s52 offen offset:2048 sc1
    v_pk_mul_f32 v[152:153], v[152:153], v[242:243]
    v_pk_mul_f32 v[154:155], v[154:155], v[242:243]
    v_pk_mul_f32 v[156:157], v[156:157], v[242:243]
    v_pk_mul_f32 v[158:159], v[158:159], v[242:243]
    v_cvt_pk_bf16_f32 v172, v152, v153
    v_cvt_pk_bf16_f32 v173, v154, v155
    v_cvt_pk_bf16_f32 v174, v156, v157
    v_cvt_pk_bf16_f32 v175, v158, v159
    buffer_store_dwordx4 v[172:175], v7, s[16:19], s52 offen offset:3072 sc1
    s_add_u32 s52, s52, 136192
    v_accvgpr_read_b32 v128, a64
    v_accvgpr_read_b32 v129, a65
    v_accvgpr_read_b32 v130, a66
    v_accvgpr_read_b32 v131, a67
    v_accvgpr_read_b32 v132, a68
    v_accvgpr_read_b32 v133, a69
    v_accvgpr_read_b32 v134, a70
    v_accvgpr_read_b32 v135, a71
    v_accvgpr_read_b32 v136, a72
    v_accvgpr_read_b32 v137, a73
    v_accvgpr_read_b32 v138, a74
    v_accvgpr_read_b32 v139, a75
    v_accvgpr_read_b32 v140, a76
    v_accvgpr_read_b32 v141, a77
    v_accvgpr_read_b32 v142, a78
    v_accvgpr_read_b32 v143, a79
    v_accvgpr_read_b32 v144, a80
    v_accvgpr_read_b32 v145, a81
    v_accvgpr_read_b32 v146, a82
    v_accvgpr_read_b32 v147, a83
    v_accvgpr_read_b32 v148, a84
    v_accvgpr_read_b32 v149, a85
    v_accvgpr_read_b32 v150, a86
    v_accvgpr_read_b32 v151, a87
    v_accvgpr_read_b32 v152, a88
    v_accvgpr_read_b32 v153, a89
    v_accvgpr_read_b32 v154, a90
    v_accvgpr_read_b32 v155, a91
    v_accvgpr_read_b32 v156, a92
    v_accvgpr_read_b32 v157, a93
    v_accvgpr_read_b32 v158, a94
    v_accvgpr_read_b32 v159, a95
    v_pk_mul_f32 v[128:129], v[128:129], v[244:245]
    v_pk_mul_f32 v[130:131], v[130:131], v[244:245]
    v_pk_mul_f32 v[132:133], v[132:133], v[244:245]
    v_pk_mul_f32 v[134:135], v[134:135], v[244:245]
    v_cvt_pk_bf16_f32 v160, v128, v129
    v_cvt_pk_bf16_f32 v161, v130, v131
    v_cvt_pk_bf16_f32 v162, v132, v133
    v_cvt_pk_bf16_f32 v163, v134, v135
    buffer_store_dwordx4 v[160:163], v7, s[16:19], s52 offen offset:0 sc1
    v_pk_mul_f32 v[136:137], v[136:137], v[244:245]
    v_pk_mul_f32 v[138:139], v[138:139], v[244:245]
    v_pk_mul_f32 v[140:141], v[140:141], v[244:245]
    v_pk_mul_f32 v[142:143], v[142:143], v[244:245]
    v_cvt_pk_bf16_f32 v164, v136, v137
    v_cvt_pk_bf16_f32 v165, v138, v139
    v_cvt_pk_bf16_f32 v166, v140, v141
    v_cvt_pk_bf16_f32 v167, v142, v143
    buffer_store_dwordx4 v[164:167], v7, s[16:19], s52 offen offset:1024 sc1
    v_pk_mul_f32 v[144:145], v[144:145], v[244:245]
    v_pk_mul_f32 v[146:147], v[146:147], v[244:245]
    v_pk_mul_f32 v[148:149], v[148:149], v[244:245]
    v_pk_mul_f32 v[150:151], v[150:151], v[244:245]
    v_cvt_pk_bf16_f32 v168, v144, v145
    v_cvt_pk_bf16_f32 v169, v146, v147
    v_cvt_pk_bf16_f32 v170, v148, v149
    v_cvt_pk_bf16_f32 v171, v150, v151
    buffer_store_dwordx4 v[168:171], v7, s[16:19], s52 offen offset:2048 sc1
    v_pk_mul_f32 v[152:153], v[152:153], v[244:245]
    v_pk_mul_f32 v[154:155], v[154:155], v[244:245]
    v_pk_mul_f32 v[156:157], v[156:157], v[244:245]
    v_pk_mul_f32 v[158:159], v[158:159], v[244:245]
    v_cvt_pk_bf16_f32 v172, v152, v153
    v_cvt_pk_bf16_f32 v173, v154, v155
    v_cvt_pk_bf16_f32 v174, v156, v157
    v_cvt_pk_bf16_f32 v175, v158, v159
    buffer_store_dwordx4 v[172:175], v7, s[16:19], s52 offen offset:3072 sc1
    s_add_u32 s52, s52, 136192
    v_accvgpr_read_b32 v128, a96
    v_accvgpr_read_b32 v129, a97
    v_accvgpr_read_b32 v130, a98
    v_accvgpr_read_b32 v131, a99
    v_accvgpr_read_b32 v132, a100
    v_accvgpr_read_b32 v133, a101
    v_accvgpr_read_b32 v134, a102
    v_accvgpr_read_b32 v135, a103
    v_accvgpr_read_b32 v136, a104
    v_accvgpr_read_b32 v137, a105
    v_accvgpr_read_b32 v138, a106
    v_accvgpr_read_b32 v139, a107
    v_accvgpr_read_b32 v140, a108
    v_accvgpr_read_b32 v141, a109
    v_accvgpr_read_b32 v142, a110
    v_accvgpr_read_b32 v143, a111
    v_accvgpr_read_b32 v144, a112
    v_accvgpr_read_b32 v145, a113
    v_accvgpr_read_b32 v146, a114
    v_accvgpr_read_b32 v147, a115
    v_accvgpr_read_b32 v148, a116
    v_accvgpr_read_b32 v149, a117
    v_accvgpr_read_b32 v150, a118
    v_accvgpr_read_b32 v151, a119
    v_accvgpr_read_b32 v152, a120
    v_accvgpr_read_b32 v153, a121
    v_accvgpr_read_b32 v154, a122
    v_accvgpr_read_b32 v155, a123
    v_accvgpr_read_b32 v156, a124
    v_accvgpr_read_b32 v157, a125
    v_accvgpr_read_b32 v158, a126
    v_accvgpr_read_b32 v159, a127
    v_pk_mul_f32 v[128:129], v[128:129], v[246:247]
    v_pk_mul_f32 v[130:131], v[130:131], v[246:247]
    v_pk_mul_f32 v[132:133], v[132:133], v[246:247]
    v_pk_mul_f32 v[134:135], v[134:135], v[246:247]
    v_cvt_pk_bf16_f32 v160, v128, v129
    v_cvt_pk_bf16_f32 v161, v130, v131
    v_cvt_pk_bf16_f32 v162, v132, v133
    v_cvt_pk_bf16_f32 v163, v134, v135
    buffer_store_dwordx4 v[160:163], v7, s[16:19], s52 offen offset:0 sc1
    v_pk_mul_f32 v[136:137], v[136:137], v[246:247]
    v_pk_mul_f32 v[138:139], v[138:139], v[246:247]
    v_pk_mul_f32 v[140:141], v[140:141], v[246:247]
    v_pk_mul_f32 v[142:143], v[142:143], v[246:247]
    v_cvt_pk_bf16_f32 v164, v136, v137
    v_cvt_pk_bf16_f32 v165, v138, v139
    v_cvt_pk_bf16_f32 v166, v140, v141
    v_cvt_pk_bf16_f32 v167, v142, v143
    buffer_store_dwordx4 v[164:167], v7, s[16:19], s52 offen offset:1024 sc1
    v_pk_mul_f32 v[144:145], v[144:145], v[246:247]
    v_pk_mul_f32 v[146:147], v[146:147], v[246:247]
    v_pk_mul_f32 v[148:149], v[148:149], v[246:247]
    v_pk_mul_f32 v[150:151], v[150:151], v[246:247]
    v_cvt_pk_bf16_f32 v168, v144, v145
    v_cvt_pk_bf16_f32 v169, v146, v147
    v_cvt_pk_bf16_f32 v170, v148, v149
    v_cvt_pk_bf16_f32 v171, v150, v151
    buffer_store_dwordx4 v[168:171], v7, s[16:19], s52 offen offset:2048 sc1
    v_pk_mul_f32 v[152:153], v[152:153], v[246:247]
    v_pk_mul_f32 v[154:155], v[154:155], v[246:247]
    v_pk_mul_f32 v[156:157], v[156:157], v[246:247]
    v_pk_mul_f32 v[158:159], v[158:159], v[246:247]
    v_cvt_pk_bf16_f32 v172, v152, v153
    v_cvt_pk_bf16_f32 v173, v154, v155
    v_cvt_pk_bf16_f32 v174, v156, v157
    v_cvt_pk_bf16_f32 v175, v158, v159
    buffer_store_dwordx4 v[172:175], v7, s[16:19], s52 offen offset:3072 sc1
    s_add_u32 s52, s52, 136192
    s_lshr_b32 s7, s6, 1
    s_lshl_b32 s58, s7, 13
    s_and_b32 s7, s6, 1
    s_lshl_b32 s7, s7, 13
    s_add_u32 s7, s7, 2048
    v_add_u32 v20, s7, v7
    v_add_u32 v21, 65536, v20
    v_add_u32 v22, 131072, v20
    s_bfe_u32 s3, s2, 0x20001
    s_add_u32 s3, s3, 0
    s_and_b32 s7, s3, 1
    s_and_b32 s3, s3, 2
    s_lshl_b32 s3, s3, 11
    s_lshl_b32 s7, s7, 10
    s_add_u32 s3, s3, s7
    s_add_u32 s3, s3, s58
    v_add_u32 v8, s3, v7
    v_add_u32 v12, 65536, v8
    v_add_u32 v16, 131072, v8
    s_bfe_u32 s3, s2, 0x20001
    s_add_u32 s3, s3, 1
    s_and_b32 s7, s3, 1
    s_and_b32 s3, s3, 2
    s_lshl_b32 s3, s3, 11
    s_lshl_b32 s7, s7, 10
    s_add_u32 s3, s3, s7
    s_add_u32 s3, s3, s58
    v_add_u32 v9, s3, v7
    v_add_u32 v13, 65536, v9
    v_add_u32 v17, 131072, v9
    s_bfe_u32 s3, s2, 0x20001
    s_add_u32 s3, s3, 2
    s_and_b32 s7, s3, 1
    s_and_b32 s3, s3, 2
    s_lshl_b32 s3, s3, 11
    s_lshl_b32 s7, s7, 10
    s_add_u32 s3, s3, s7
    s_add_u32 s3, s3, s58
    v_add_u32 v10, s3, v7
    v_add_u32 v14, 65536, v10
    v_add_u32 v18, 131072, v10
    s_bfe_u32 s3, s2, 0x20001
    s_add_u32 s3, s3, 3
    s_and_b32 s7, s3, 1
    s_and_b32 s3, s3, 2
    s_lshl_b32 s3, s3, 11
    s_lshl_b32 s7, s7, 10
    s_add_u32 s3, s3, s7
    s_add_u32 s3, s3, s58
    v_add_u32 v11, s3, v7
    v_add_u32 v15, 65536, v11
    v_add_u32 v19, 131072, v11
    s_waitcnt vmcnt(36)
    s_barrier
    ds_read_b128 a[192:195], v20 offset:0
    ds_read_b128 a[224:227], v8 offset:0
    ds_read_b128 a[196:199], v20 offset:1024
    ds_read_b128 a[228:231], v9 offset:0
    ds_read_b128 a[200:203], v20 offset:4096
    ds_read_b128 a[232:235], v10 offset:0
    ds_read_b128 a[204:207], v20 offset:5120
    ds_read_b128 a[236:239], v11 offset:0
    s_mov_b32 s20, s96
    s_mov_b32 s21, s97
    s_mov_b32 s22, 2097152
    s_mov_b32 s23, 0x20000
    v_lshlrev_b32 v5, 5, v3
    v_lshl_add_u32 v23, v2, 10, v5
    s_lshl_b32 s3, s89, 17
    s_lshl_b32 s7, s58, 3
    s_add_u32 s3, s3, s7
    s_bfe_u32 s7, s2, 0x20001
    s_lshl_b32 s7, s7, 14
    s_add_u32 s3, s3, s7
    s_lshl_b32 s7, s90, 8
    s_add_u32 s3, s3, s7
    s_and_b32 s7, s6, 1
    s_lshl_b32 s7, s7, 7
    s_add_u32 s53, s3, s7
    s_add_u32 s32, s16, s94
    s_addc_u32 s33, s17, 0
    s_mov_b32 s34, 4
    s_lshl_b32 s3, s89, 10
    s_lshr_b32 s7, s58, 4
    s_add_u32 s3, s3, s7
    s_bfe_u32 s7, s2, 0x20001
    s_lshl_b32 s7, s7, 7
    s_add_u32 s3, s3, s7
    s_add_u32 s3, s3, 26214400
    s_add_u32 s28, s16, s3
    s_addc_u32 s29, s17, 0
    s_mov_b32 s30, 32
    s_lshl_b32 s3, s54, 10
    s_add_u32 s3, s3, 49283072
    s_add_u32 s40, s16, s3
    s_addc_u32 s41, s17, 0
    s_mov_b32 s42, 512
    s_bfe_u32 s7, s2, 0x20001
    s_lshl_b32 s7, s7, 7
    s_add_u32 s36, s40, s7
    s_addc_u32 s37, s41, 0
    s_mov_b32 s38, 4
    v_lshlrev_b32 v4, 2, v1
    v_cmp_gt_u32 vcc, 8, v1
    v_mov_b32 v223, 1
    s_nop 0
    v_cndmask_b32 v6, 0, 1, vcc
    s_waitcnt lgkmcnt(0)
.p2align 3
    v_mfma_f32_16x16x32_bf16 a[128:131], a[192:195], a[224:227], 0
    ds_read_b128 a[208:211], v20 offset:16384
    v_mfma_f32_16x16x32_bf16 a[132:135], a[192:195], a[228:231], 0
    s_add_u32 m0, s88, 98304
    s_add_u32 s56, s56, 1024
    ds_read_b128 a[240:243], v8 offset:16384
    v_mfma_f32_16x16x32_bf16 a[136:139], a[192:195], a[232:235], 0
    buffer_load_dwordx4 v7, s[16:19], s56 offen sc1 lds
    v_mfma_f32_16x16x32_bf16 a[140:143], a[192:195], a[236:239], 0
    ds_read_b128 a[212:215], v20 offset:17408
    v_mfma_f32_16x16x32_bf16 a[156:159], a[196:199], a[236:239], 0
    ds_read_b128 a[244:247], v9 offset:16384
    v_mfma_f32_16x16x32_bf16 a[152:155], a[196:199], a[232:235], 0
    s_add_u32 s57, s57, 1024
    ds_read_b128 a[216:219], v20 offset:20480
    v_mfma_f32_16x16x32_bf16 a[148:151], a[196:199], a[228:231], 0
    buffer_load_dwordx4 v7, s[16:19], s57 offen offset:1024 sc1 lds
    v_mfma_f32_16x16x32_bf16 a[144:147], a[196:199], a[224:227], 0
    ds_read_b128 a[248:251], v10 offset:16384
    v_mfma_f32_16x16x32_bf16 a[160:163], a[200:203], a[224:227], 0
    ds_read_b128 a[220:223], v20 offset:21504
    v_mfma_f32_16x16x32_bf16 a[164:167], a[200:203], a[228:231], 0
    s_add_u32 s61, s61, 4096
    ds_read_b128 a[252:255], v11 offset:16384
    v_mfma_f32_16x16x32_bf16 a[168:171], a[200:203], a[232:235], 0
    buffer_load_dwordx4 v7, s[16:19], s61 offen offset:2048 sc1 lds
    v_mfma_f32_16x16x32_bf16 a[172:175], a[200:203], a[236:239], 0
    v_mfma_f32_16x16x32_bf16 a[188:191], a[204:207], a[236:239], 0
    v_mfma_f32_16x16x32_bf16 a[184:187], a[204:207], a[232:235], 0
    v_mfma_f32_16x16x32_bf16 a[180:183], a[204:207], a[228:231], 0
    buffer_load_dwordx4 v7, s[16:19], s61 offen offset:3072 sc1 lds
    v_mfma_f32_16x16x32_bf16 a[176:179], a[204:207], a[224:227], 0
    s_waitcnt vmcnt(4)
    buffer_store_dword v223, v7, s[32:35], 0 offen sc1
    s_waitcnt lgkmcnt(0)
    v_mfma_f32_16x16x32_bf16 a[128:131], a[208:211], a[240:243], a[128:131]
    ds_read_b128 a[192:195], v20 offset:32768
    v_mfma_f32_16x16x32_bf16 a[132:135], a[208:211], a[244:247], a[132:135]
    s_add_u32 m0, s88, 114688
    s_add_u32 s56, s56, 1024
    ds_read_b128 a[224:227], v8 offset:32768
    v_mfma_f32_16x16x32_bf16 a[136:139], a[208:211], a[248:251], a[136:139]
    buffer_load_dwordx4 v7, s[16:19], s56 offen sc1 lds
    v_mfma_f32_16x16x32_bf16 a[140:143], a[208:211], a[252:255], a[140:143]
    ds_read_b128 a[196:199], v20 offset:33792
    v_mfma_f32_16x16x32_bf16 a[156:159], a[212:215], a[252:255], a[156:159]
    ds_read_b128 a[228:231], v9 offset:32768
    v_mfma_f32_16x16x32_bf16 a[152:155], a[212:215], a[248:251], a[152:155]
    s_add_u32 s57, s57, 1024
    ds_read_b128 a[200:203], v20 offset:36864
    v_mfma_f32_16x16x32_bf16 a[148:151], a[212:215], a[244:247], a[148:151]
    buffer_load_dwordx4 v7, s[16:19], s57 offen offset:1024 sc1 lds
    v_mfma_f32_16x16x32_bf16 a[144:147], a[212:215], a[240:243], a[144:147]
    ds_read_b128 a[232:235], v10 offset:32768
    v_mfma_f32_16x16x32_bf16 a[160:163], a[216:219], a[240:243], a[160:163]
    ds_read_b128 a[204:207], v20 offset:37888
    v_mfma_f32_16x16x32_bf16 a[164:167], a[216:219], a[244:247], a[164:167]
    s_add_u32 s61, s61, 4096
    ds_read_b128 a[236:239], v11 offset:32768
    v_mfma_f32_16x16x32_bf16 a[168:171], a[216:219], a[248:251], a[168:171]
    buffer_load_dwordx4 v7, s[16:19], s61 offen offset:2048 sc1 lds
    v_mfma_f32_16x16x32_bf16 a[172:175], a[216:219], a[252:255], a[172:175]
    v_mfma_f32_16x16x32_bf16 a[188:191], a[220:223], a[252:255], a[188:191]
    v_mfma_f32_16x16x32_bf16 a[184:187], a[220:223], a[248:251], a[184:187]
    v_mfma_f32_16x16x32_bf16 a[180:183], a[220:223], a[244:247], a[180:183]
    buffer_load_dwordx4 v7, s[16:19], s61 offen offset:3072 sc1 lds
    v_mfma_f32_16x16x32_bf16 a[176:179], a[220:223], a[240:243], a[176:179]
    s_waitcnt vmcnt(37) lgkmcnt(0)
    s_barrier
    v_mfma_f32_16x16x32_bf16 a[128:131], a[192:195], a[224:227], a[128:131]
    ds_read_b128 a[208:211], v20 offset:49152
    v_mfma_f32_16x16x32_bf16 a[132:135], a[192:195], a[228:231], a[132:135]
    s_add_u32 m0, s88, 0
    s_add_u32 s56, s56, 1024
    ds_read_b128 a[240:243], v8 offset:49152
    v_mfma_f32_16x16x32_bf16 a[136:139], a[192:195], a[232:235], a[136:139]
    buffer_load_dwordx4 v7, s[16:19], s56 offen sc1 lds
    v_mfma_f32_16x16x32_bf16 a[140:143], a[192:195], a[236:239], a[140:143]
    ds_read_b128 a[212:215], v20 offset:50176
    v_mfma_f32_16x16x32_bf16 a[156:159], a[196:199], a[236:239], a[156:159]
    ds_read_b128 a[244:247], v9 offset:49152
    v_mfma_f32_16x16x32_bf16 a[152:155], a[196:199], a[232:235], a[152:155]
    s_add_u32 s57, s57, 1024
    ds_read_b128 a[216:219], v20 offset:53248
    v_mfma_f32_16x16x32_bf16 a[148:151], a[196:199], a[228:231], a[148:151]
    buffer_load_dwordx4 v7, s[16:19], s57 offen offset:1024 sc1 lds
    v_mfma_f32_16x16x32_bf16 a[144:147], a[196:199], a[224:227], a[144:147]
    ds_read_b128 a[248:251], v10 offset:49152
    v_mfma_f32_16x16x32_bf16 a[160:163], a[200:203], a[224:227], a[160:163]
    ds_read_b128 a[220:223], v20 offset:54272
    v_mfma_f32_16x16x32_bf16 a[164:167], a[200:203], a[228:231], a[164:167]
    s_add_u32 s61, s61, 4096
    ds_read_b128 a[252:255], v11 offset:49152
    v_mfma_f32_16x16x32_bf16 a[168:171], a[200:203], a[232:235], a[168:171]
    buffer_load_dwordx4 v7, s[16:19], s61 offen offset:2048 sc1 lds
    v_mfma_f32_16x16x32_bf16 a[172:175], a[200:203], a[236:239], a[172:175]
    v_mfma_f32_16x16x32_bf16 a[188:191], a[204:207], a[236:239], a[188:191]
    v_mfma_f32_16x16x32_bf16 a[184:187], a[204:207], a[232:235], a[184:187]
    v_mfma_f32_16x16x32_bf16 a[180:183], a[204:207], a[228:231], a[180:183]
    buffer_load_dwordx4 v7, s[16:19], s61 offen offset:3072 sc1 lds
    v_mfma_f32_16x16x32_bf16 a[176:179], a[204:207], a[224:227], a[176:179]
    s_waitcnt lgkmcnt(0)
    v_mfma_f32_16x16x32_bf16 a[128:131], a[208:211], a[240:243], a[128:131]
    ds_read_b128 a[192:195], v22 offset:0
    v_mfma_f32_16x16x32_bf16 a[132:135], a[208:211], a[244:247], a[132:135]
    s_add_u32 m0, s88, 16384
    s_add_u32 s56, s56, 1024
    ds_read_b128 a[224:227], v16 offset:0
    v_mfma_f32_16x16x32_bf16 a[136:139], a[208:211], a[248:251], a[136:139]
    buffer_load_dwordx4 v7, s[16:19], s56 offen sc1 lds
    v_mfma_f32_16x16x32_bf16 a[140:143], a[208:211], a[252:255], a[140:143]
    ds_read_b128 a[196:199], v22 offset:1024
    v_mfma_f32_16x16x32_bf16 a[156:159], a[212:215], a[252:255], a[156:159]
    ds_read_b128 a[228:231], v17 offset:0
    v_mfma_f32_16x16x32_bf16 a[152:155], a[212:215], a[248:251], a[152:155]
    s_add_u32 s57, s57, 1024
    ds_read_b128 a[200:203], v22 offset:4096
    v_mfma_f32_16x16x32_bf16 a[148:151], a[212:215], a[244:247], a[148:151]
    buffer_load_dwordx4 v7, s[16:19], s57 offen offset:1024 sc1 lds
    v_mfma_f32_16x16x32_bf16 a[144:147], a[212:215], a[240:243], a[144:147]
    ds_read_b128 a[232:235], v18 offset:0
    v_mfma_f32_16x16x32_bf16 a[160:163], a[216:219], a[240:243], a[160:163]
    ds_read_b128 a[204:207], v22 offset:5120
    v_mfma_f32_16x16x32_bf16 a[164:167], a[216:219], a[244:247], a[164:167]
    s_add_u32 s61, s61, 4096
    ds_read_b128 a[236:239], v19 offset:0
    v_mfma_f32_16x16x32_bf16 a[168:171], a[216:219], a[248:251], a[168:171]
    buffer_load_dwordx4 v7, s[16:19], s61 offen offset:2048 sc1 lds
    v_mfma_f32_16x16x32_bf16 a[172:175], a[216:219], a[252:255], a[172:175]
    v_mfma_f32_16x16x32_bf16 a[188:191], a[220:223], a[252:255], a[188:191]
    v_mfma_f32_16x16x32_bf16 a[184:187], a[220:223], a[248:251], a[184:187]
    v_mfma_f32_16x16x32_bf16 a[180:183], a[220:223], a[244:247], a[180:183]
    buffer_load_dwordx4 v7, s[16:19], s61 offen offset:3072 sc1 lds
    v_mfma_f32_16x16x32_bf16 a[176:179], a[220:223], a[240:243], a[176:179]
    s_waitcnt vmcnt(37) lgkmcnt(0)
    s_barrier
    v_mfma_f32_16x16x32_bf16 a[128:131], a[192:195], a[224:227], a[128:131]
    ds_read_b128 a[208:211], v22 offset:16384
    v_lshrrev_b32 v86, 2, v2
    v_mfma_f32_16x16x32_bf16 a[132:135], a[192:195], a[228:231], a[132:135]
    s_add_u32 m0, s88, 32768
    s_add_u32 s56, s56, 1024
    ds_read_b128 a[240:243], v16 offset:16384
    v_cmp_eq_u32 vcc, v86, v3
    v_mfma_f32_16x16x32_bf16 a[136:139], a[192:195], a[232:235], a[136:139]
    buffer_load_dwordx4 v7, s[16:19], s56 offen sc1 lds
    v_and_b32 v86, 1, v1
    v_mfma_f32_16x16x32_bf16 a[140:143], a[192:195], a[236:239], a[140:143]
    ds_read_b128 a[212:215], v22 offset:17408
    v_lshlrev_b32 v86, 4, v86
    v_mfma_f32_16x16x32_bf16 a[156:159], a[196:199], a[236:239], a[156:159]
    ds_read_b128 a[244:247], v17 offset:16384
    v_mov_b32 v87, 0x3f80
    v_mfma_f32_16x16x32_bf16 a[152:155], a[196:199], a[232:235], a[152:155]
    s_add_u32 s57, s57, 1024
    ds_read_b128 a[216:219], v22 offset:20480
    v_lshlrev_b32 v86, v86, v87
    v_mfma_f32_16x16x32_bf16 a[148:151], a[196:199], a[228:231], a[148:151]
    buffer_load_dwordx4 v7, s[16:19], s57 offen offset:1024 sc1 lds
    v_cndmask_b32 v86, 0, v86, vcc
    v_mfma_f32_16x16x32_bf16 a[144:147], a[196:199], a[224:227], a[144:147]
    ds_read_b128 a[248:251], v18 offset:16384
    v_and_b32 v87, 2, v1
    v_mfma_f32_16x16x32_bf16 a[160:163], a[200:203], a[224:227], a[160:163]
    ds_read_b128 a[220:223], v22 offset:21504
    v_cmp_eq_u32 vcc, 0, v87
    v_mfma_f32_16x16x32_bf16 a[164:167], a[200:203], a[228:231], a[164:167]
    s_add_u32 s61, s61, 4096
    ds_read_b128 a[252:255], v19 offset:16384
    v_mov_b32 v80, 0
    v_mfma_f32_16x16x32_bf16 a[168:171], a[200:203], a[232:235], a[168:171]
    buffer_load_dwordx4 v7, s[16:19], s61 offen offset:2048 sc1 lds
    v_mov_b32 v81, 0
    v_mfma_f32_16x16x32_bf16 a[172:175], a[200:203], a[236:239], a[172:175]
    v_cndmask_b32 v82, 0, v86, vcc
    v_mfma_f32_16x16x32_bf16 a[188:191], a[204:207], a[236:239], a[188:191]
    v_xor_b32 v83, v82, v86
    v_mfma_f32_16x16x32_bf16 a[184:187], a[204:207], a[232:235], a[184:187]
    v_mov_b32 v84, 0
    v_mfma_f32_16x16x32_bf16 a[180:183], a[204:207], a[228:231], a[180:183]
    buffer_load_dwordx4 v7, s[16:19], s61 offen offset:3072 sc1 lds
    v_mov_b32 v85, 0
    v_mfma_f32_16x16x32_bf16 a[176:179], a[204:207], a[224:227], a[176:179]
    s_waitcnt lgkmcnt(0)
    v_mfma_f32_16x16x32_bf16 a[128:131], a[208:211], a[240:243], a[128:131]
    ds_read_b128 a[192:195], v21 offset:0
    v_mfma_f32_16x16x32_bf16 a[132:135], a[208:211], a[244:247], a[132:135]
    s_add_u32 m0, s88, 49152
    s_add_u32 s56, s56, 1024
    ds_read_b128 a[224:227], v12 offset:0
    v_mfma_f32_16x16x32_bf16 a[136:139], a[208:211], a[248:251], a[136:139]
    buffer_load_dwordx4 v7, s[16:19], s56 offen sc1 lds
    v_mfma_f32_16x16x32_bf16 a[140:143], a[208:211], a[252:255], a[140:143]
    ds_read_b128 a[196:199], v21 offset:1024
    v_mfma_f32_16x16x32_bf16 a[156:159], a[212:215], a[252:255], a[156:159]
    ds_read_b128 a[228:231], v13 offset:0
    v_mfma_f32_16x16x32_bf16 a[152:155], a[212:215], a[248:251], a[152:155]
    s_add_u32 s57, s57, 1024
    ds_read_b128 a[200:203], v21 offset:4096
    v_mfma_f32_16x16x32_bf16 a[148:151], a[212:215], a[244:247], a[148:151]
    buffer_load_dwordx4 v7, s[16:19], s57 offen offset:1024 sc1 lds
    v_mfma_f32_16x16x32_bf16 a[144:147], a[212:215], a[240:243], a[144:147]
    ds_read_b128 a[232:235], v14 offset:0
    v_mfma_f32_16x16x32_bf16 a[160:163], a[216:219], a[240:243], a[160:163]
    ds_read_b128 a[204:207], v21 offset:5120
    v_mfma_f32_16x16x32_bf16 a[164:167], a[216:219], a[244:247], a[164:167]
    s_add_u32 s61, s61, 4096
    ds_read_b128 a[236:239], v15 offset:0
    v_mfma_f32_16x16x32_bf16 a[168:171], a[216:219], a[248:251], a[168:171]
    buffer_load_dwordx4 v7, s[16:19], s61 offen offset:2048 sc1 lds
    v_mfma_f32_16x16x32_bf16 a[172:175], a[216:219], a[252:255], a[172:175]
    v_mfma_f32_16x16x32_bf16 a[188:191], a[220:223], a[252:255], a[188:191]
    v_mfma_f32_16x16x32_bf16 a[184:187], a[220:223], a[248:251], a[184:187]
    v_mfma_f32_16x16x32_bf16 a[180:183], a[220:223], a[244:247], a[180:183]
    buffer_load_dwordx4 v7, s[16:19], s61 offen offset:3072 sc1 lds
    v_mfma_f32_16x16x32_bf16 a[176:179], a[220:223], a[240:243], a[176:179]
    s_waitcnt vmcnt(21) lgkmcnt(0)
    s_barrier
    v_mfma_f32_16x16x32_bf16 a[128:131], a[192:195], a[224:227], a[128:131]
    ds_read_b128 a[208:211], v21 offset:16384
    v_mfma_f32_16x16x32_bf16 a[132:135], a[192:195], a[228:231], a[132:135]
    s_lshl_b32 s3, s90, 1
    s_lshr_b32 s7, s6, 1
    s_add_u32 s3, s3, s7
    s_mul_i32 s3, s3, 753664
    s_bfe_u32 s7, s2, 0x20001
    s_mul_i32 s7, s7, 131072
    s_add_u32 s3, s3, s7
    s_and_b32 s7, s6, 1
    s_lshl_b32 s7, s7, 11
    s_add_u32 s3, s3, s7
    s_add_u32 s61, s3, 26503168
    s_add_u32 m0, s88, 131072
    s_add_u32 s61, s61, 4096
    ds_read_b128 a[240:243], v12 offset:16384
    v_mfma_f32_16x16x32_bf16 a[136:139], a[192:195], a[232:235], a[136:139]
    buffer_load_dwordx4 v7, s[16:19], s61 offen offset:2048 sc1 lds
    v_mfma_f32_16x16x32_bf16 a[140:143], a[192:195], a[236:239], a[140:143]
    ds_read_b128 a[212:215], v21 offset:17408
    v_mfma_f32_16x16x32_bf16 a[156:159], a[196:199], a[236:239], a[156:159]
    ds_read_b128 a[244:247], v13 offset:16384
    v_mfma_f32_16x16x32_bf16 a[152:155], a[196:199], a[232:235], a[152:155]
    ds_read_b128 a[216:219], v21 offset:20480
    v_mfma_f32_16x16x32_bf16 a[148:151], a[196:199], a[228:231], a[148:151]
    buffer_load_dwordx4 v7, s[16:19], s61 offen offset:3072 sc1 lds
    v_mfma_f32_16x16x32_bf16 a[144:147], a[196:199], a[224:227], a[144:147]
    ds_read_b128 a[248:251], v14 offset:16384
    v_mfma_f32_16x16x32_bf16 a[160:163], a[200:203], a[224:227], a[160:163]
    ds_read_b128 a[220:223], v21 offset:21504
    v_mfma_f32_16x16x32_bf16 a[164:167], a[200:203], a[228:231], a[164:167]
    ds_read_b128 a[252:255], v15 offset:16384
    v_mfma_f32_16x16x32_bf16 a[168:171], a[200:203], a[232:235], a[168:171]
    v_mfma_f32_16x16x32_bf16 a[172:175], a[200:203], a[236:239], a[172:175]
    v_mfma_f32_16x16x32_bf16 a[188:191], a[204:207], a[236:239], a[188:191]
    v_mfma_f32_16x16x32_bf16 a[184:187], a[204:207], a[232:235], a[184:187]
    v_mfma_f32_16x16x32_bf16 a[180:183], a[204:207], a[228:231], a[180:183]
    v_mfma_f32_16x16x32_bf16 a[176:179], a[204:207], a[224:227], a[176:179]
    s_waitcnt lgkmcnt(0)
    v_mfma_f32_16x16x32_bf16 a[128:131], a[208:211], a[240:243], a[128:131]
    ds_read_b128 a[192:195], v21 offset:32768
    v_mfma_f32_16x16x32_bf16 a[132:135], a[208:211], a[244:247], a[132:135]
    s_add_u32 m0, s88, 147456
    s_add_u32 s61, s61, 4096
    ds_read_b128 a[224:227], v12 offset:32768
    v_mfma_f32_16x16x32_bf16 a[136:139], a[208:211], a[248:251], a[136:139]
    buffer_load_dwordx4 v7, s[16:19], s61 offen offset:2048 sc1 lds
    v_mfma_f32_16x16x32_bf16 a[140:143], a[208:211], a[252:255], a[140:143]
    ds_read_b128 a[196:199], v21 offset:33792
    v_mfma_f32_16x16x32_bf16 a[156:159], a[212:215], a[252:255], a[156:159]
    ds_read_b128 a[228:231], v13 offset:32768
    v_mfma_f32_16x16x32_bf16 a[152:155], a[212:215], a[248:251], a[152:155]
    ds_read_b128 a[200:203], v21 offset:36864
    v_mfma_f32_16x16x32_bf16 a[148:151], a[212:215], a[244:247], a[148:151]
    buffer_load_dwordx4 v7, s[16:19], s61 offen offset:3072 sc1 lds
    v_mfma_f32_16x16x32_bf16 a[144:147], a[212:215], a[240:243], a[144:147]
    ds_read_b128 a[232:235], v14 offset:32768
    v_mfma_f32_16x16x32_bf16 a[160:163], a[216:219], a[240:243], a[160:163]
    ds_read_b128 a[204:207], v21 offset:37888
    v_mfma_f32_16x16x32_bf16 a[164:167], a[216:219], a[244:247], a[164:167]
    ds_read_b128 a[236:239], v15 offset:32768
    v_mfma_f32_16x16x32_bf16 a[168:171], a[216:219], a[248:251], a[168:171]
    v_mfma_f32_16x16x32_bf16 a[172:175], a[216:219], a[252:255], a[172:175]
    v_mfma_f32_16x16x32_bf16 a[188:191], a[220:223], a[252:255], a[188:191]
    v_mfma_f32_16x16x32_bf16 a[184:187], a[220:223], a[248:251], a[184:187]
    v_mfma_f32_16x16x32_bf16 a[180:183], a[220:223], a[244:247], a[180:183]
    v_mfma_f32_16x16x32_bf16 a[176:179], a[220:223], a[240:243], a[176:179]
    s_waitcnt vmcnt(16) lgkmcnt(0)
    s_barrier
    v_mfma_f32_16x16x32_bf16 a[128:131], a[192:195], a[224:227], a[128:131]
    ds_read_b128 a[208:211], v21 offset:49152
    buffer_load_dword v5, v4, s[28:31], 0 offen sc1
    v_mfma_f32_16x16x32_bf16 a[132:135], a[192:195], a[228:231], a[132:135]
    s_add_u32 m0, s88, 65536
    s_add_u32 s61, s61, 4096
    ds_read_b128 a[240:243], v12 offset:49152
    v_mfma_f32_16x16x32_bf16 a[136:139], a[192:195], a[232:235], a[136:139]
    buffer_load_dwordx4 v7, s[16:19], s61 offen offset:2048 sc1 lds
    v_mfma_f32_16x16x32_bf16 a[140:143], a[192:195], a[236:239], a[140:143]
    ds_read_b128 a[212:215], v21 offset:50176
    v_mfma_f32_16x16x32_bf16 a[156:159], a[196:199], a[236:239], a[156:159]
    ds_read_b128 a[244:247], v13 offset:49152
    v_mfma_f32_16x16x32_bf16 a[152:155], a[196:199], a[232:235], a[152:155]
    ds_read_b128 a[216:219], v21 offset:53248
    v_mfma_f32_16x16x32_bf16 a[148:151], a[196:199], a[228:231], a[148:151]
    buffer_load_dwordx4 v7, s[16:19], s61 offen offset:3072 sc1 lds
    v_mfma_f32_16x16x32_bf16 a[144:147], a[196:199], a[224:227], a[144:147]
    ds_read_b128 a[248:251], v14 offset:49152
    v_mfma_f32_16x16x32_bf16 a[160:163], a[200:203], a[224:227], a[160:163]
L_pad13:
    s_cbranch_execz L_warmret
    ds_read_b128 a[220:223], v21 offset:54272
    v_mfma_f32_16x16x32_bf16 a[164:167], a[200:203], a[228:231], a[164:167]
    ds_read_b128 a[252:255], v15 offset:49152
    v_mfma_f32_16x16x32_bf16 a[168:171], a[200:203], a[232:235], a[168:171]
    v_mfma_f32_16x16x32_bf16 a[172:175], a[200:203], a[236:239], a[172:175]
    v_mfma_f32_16x16x32_bf16 a[188:191], a[204:207], a[236:239], a[188:191]
    v_mfma_f32_16x16x32_bf16 a[184:187], a[204:207], a[232:235], a[184:187]
    v_mfma_f32_16x16x32_bf16 a[180:183], a[204:207], a[228:231], a[180:183]
    v_mfma_f32_16x16x32_bf16 a[176:179], a[204:207], a[224:227], a[176:179]
    s_waitcnt lgkmcnt(0)
    v_mfma_f32_16x16x32_bf16 a[128:131], a[208:211], a[240:243], a[128:131]
    ds_read_b128 a[192:195], v20 offset:0
    v_mfma_f32_16x16x32_bf16 a[132:135], a[208:211], a[244:247], a[132:135]
    s_add_u32 m0, s88, 81920
    s_add_u32 s61, s61, 4096
    ds_read_b128 a[224:227], v8 offset:0
    v_mfma_f32_16x16x32_bf16 a[136:139], a[208:211], a[248:251], a[136:139]
    buffer_load_dwordx4 v7, s[16:19], s61 offen offset:2048 sc1 lds
    v_mfma_f32_16x16x32_bf16 a[140:143], a[208:211], a[252:255], a[140:143]
    ds_read_b128 a[196:199], v20 offset:1024
    v_mfma_f32_16x16x32_bf16 a[156:159], a[212:215], a[252:255], a[156:159]
    ds_read_b128 a[228:231], v9 offset:0
    v_mfma_f32_16x16x32_bf16 a[152:155], a[212:215], a[248:251], a[152:155]
    ds_read_b128 a[200:203], v20 offset:4096
    v_mfma_f32_16x16x32_bf16 a[148:151], a[212:215], a[244:247], a[148:151]
    buffer_load_dwordx4 v7, s[16:19], s61 offen offset:3072 sc1 lds
    v_mfma_f32_16x16x32_bf16 a[144:147], a[212:215], a[240:243], a[144:147]
    ds_read_b128 a[232:235], v10 offset:0
    v_mfma_f32_16x16x32_bf16 a[160:163], a[216:219], a[240:243], a[160:163]
    ds_read_b128 a[204:207], v20 offset:5120
    v_mfma_f32_16x16x32_bf16 a[164:167], a[216:219], a[244:247], a[164:167]
    ds_read_b128 a[236:239], v11 offset:0
    v_mfma_f32_16x16x32_bf16 a[168:171], a[216:219], a[248:251], a[168:171]
    v_mfma_f32_16x16x32_bf16 a[172:175], a[216:219], a[252:255], a[172:175]
    v_mfma_f32_16x16x32_bf16 a[188:191], a[220:223], a[252:255], a[188:191]
    v_mfma_f32_16x16x32_bf16 a[184:187], a[220:223], a[248:251], a[184:187]
    v_mfma_f32_16x16x32_bf16 a[180:183], a[220:223], a[244:247], a[180:183]
    v_mfma_f32_16x16x32_bf16 a[176:179], a[220:223], a[240:243], a[176:179]
    s_waitcnt vmcnt(13) lgkmcnt(0)
    s_barrier
    s_lshl_b32 s3, s89, 2
    s_add_u32 s3, s3, s6
    s_mul_i32 s3, s3, 272384
    s_bfe_u32 s7, s2, 0x20001
    s_mul_i32 s7, s7, 32768
    s_add_u32 s3, s3, s7
    s_add_u32 s56, s3, 4294966272
    s_add_u32 s57, s56, 135168
    s_waitcnt vmcnt(4)
    v_cmp_ne_u32 vcc, v5, v6
    s_cbranch_vccnz L_po
L_po_ok:
    s_add_u32 m0, s88, 131072
    s_add_u32 s56, s56, 1024
    buffer_load_dwordx4 v7, s[16:19], s56 offen sc1 lds
    s_add_u32 s57, s57, 1024
    buffer_load_dwordx4 v7, s[16:19], s57 offen offset:1024 sc1 lds
    s_add_u32 m0, s88, 147456
    s_add_u32 s56, s56, 1024
    buffer_load_dwordx4 v7, s[16:19], s56 offen sc1 lds
    s_add_u32 s57, s57, 1024
    buffer_load_dwordx4 v7, s[16:19], s57 offen offset:1024 sc1 lds
    s_add_u32 m0, s88, 65536
    s_add_u32 s56, s56, 1024
    buffer_load_dwordx4 v7, s[16:19], s56 offen sc1 lds
    s_add_u32 s57, s57, 1024
    buffer_load_dwordx4 v7, s[16:19], s57 offen offset:1024 sc1 lds
    s_add_u32 m0, s88, 81920
    s_add_u32 s56, s56, 1024
    buffer_load_dwordx4 v7, s[16:19], s56 offen sc1 lds
    s_add_u32 s57, s57, 1024
    buffer_load_dwordx4 v7, s[16:19], s57 offen offset:1024 sc1 lds
    v_cmp_gt_u32 vcc, 4, v1
    s_bfe_u32 s7, s2, 0x20001
    v_cmp_eq_u32 s[98:99], s7, v1
    v_cndmask_b32 v6, 0, 1, vcc
    v_lshlrev_b32 v4, 7, v1
    v_mov_b32 v59, 0x10000
    v_cndmask_b32 v6, v6, 0, s[98:99]
    v_cndmask_b32 v4, v4, v59, s[98:99]
.p2align 3
    v_mfma_f32_16x16x32_bf16 a[128:131], a[192:195], a[224:227], a[128:131]
    ds_read_b128 a[208:211], v20 offset:16384
    v_mfma_f32_16x16x32_bf16 a[132:135], a[192:195], a[228:231], a[132:135]
    s_add_u32 m0, s88, 98304
    s_add_u32 s56, s56, 1024
    ds_read_b128 a[240:243], v8 offset:16384
    v_mfma_f32_16x16x32_bf16 a[136:139], a[192:195], a[232:235], a[136:139]
    buffer_load_dwordx4 v7, s[16:19], s56 offen sc1 lds
    v_mfma_f32_16x16x32_bf16 a[140:143], a[192:195], a[236:239], a[140:143]
    ds_read_b128 a[212:215], v20 offset:17408
    v_mfma_f32_16x16x32_bf16 a[156:159], a[196:199], a[236:239], a[156:159]
    ds_read_b128 a[244:247], v9 offset:16384
    v_mfma_f32_16x16x32_bf16 a[152:155], a[196:199], a[232:235], a[152:155]
    s_add_u32 s57, s57, 1024
    ds_read_b128 a[216:219], v20 offset:20480
    v_mfma_f32_16x16x32_bf16 a[148:151], a[196:199], a[228:231], a[148:151]
    buffer_load_dwordx4 v7, s[16:19], s57 offen offset:1024 sc1 lds
    v_mfma_f32_16x16x32_bf16 a[144:147], a[196:199], a[224:227], a[144:147]
    ds_read_b128 a[248:251], v10 offset:16384
    v_mfma_f32_16x16x32_bf16 a[160:163], a[200:203], a[224:227], a[160:163]
    ds_read_b128 a[220:223], v20 offset:21504
    v_mfma_f32_16x16x32_bf16 a[164:167], a[200:203], a[228:231], a[164:167]
    s_add_u32 s61, s61, 4096
    ds_read_b128 a[252:255], v11 offset:16384
    v_mfma_f32_16x16x32_bf16 a[168:171], a[200:203], a[232:235], a[168:171]
    buffer_load_dwordx4 v7, s[16:19], s61 offen offset:2048 sc1 lds
    v_mfma_f32_16x16x32_bf16 a[172:175], a[200:203], a[236:239], a[172:175]
    v_mfma_f32_16x16x32_bf16 a[188:191], a[204:207], a[236:239], a[188:191]
    v_mfma_f32_16x16x32_bf16 a[184:187], a[204:207], a[232:235], a[184:187]
    v_mfma_f32_16x16x32_bf16 a[180:183], a[204:207], a[228:231], a[180:183]
    buffer_load_dwordx4 v7, s[16:19], s61 offen offset:3072 sc1 lds
    v_mfma_f32_16x16x32_bf16 a[176:179], a[204:207], a[224:227], a[176:179]
    s_waitcnt lgkmcnt(0)
    v_mfma_f32_16x16x32_bf16 a[128:131], a[208:211], a[240:243], a[128:131]
    ds_read_b128 a[192:195], v20 offset:32768
    v_mfma_f32_16x16x32_bf16 a[132:135], a[208:211], a[244:247], a[132:135]
    s_add_u32 m0, s88, 114688
    s_add_u32 s56, s56, 1024
    ds_read_b128 a[224:227], v8 offset:32768
    v_mfma_f32_16x16x32_bf16 a[136:139], a[208:211], a[248:251], a[136:139]
    buffer_load_dwordx4 v7, s[16:19], s56 offen sc1 lds
    v_mfma_f32_16x16x32_bf16 a[140:143], a[208:211], a[252:255], a[140:143]
    ds_read_b128 a[196:199], v20 offset:33792
    v_mfma_f32_16x16x32_bf16 a[156:159], a[212:215], a[252:255], a[156:159]
    ds_read_b128 a[228:231], v9 offset:32768
    v_mfma_f32_16x16x32_bf16 a[152:155], a[212:215], a[248:251], a[152:155]
    s_add_u32 s57, s57, 1024
    ds_read_b128 a[200:203], v20 offset:36864
    v_mfma_f32_16x16x32_bf16 a[148:151], a[212:215], a[244:247], a[148:151]
    buffer_load_dwordx4 v7, s[16:19], s57 offen offset:1024 sc1 lds
    v_mfma_f32_16x16x32_bf16 a[144:147], a[212:215], a[240:243], a[144:147]
    ds_read_b128 a[232:235], v10 offset:32768
    v_mfma_f32_16x16x32_bf16 a[160:163], a[216:219], a[240:243], a[160:163]
    ds_read_b128 a[204:207], v20 offset:37888
    v_mfma_f32_16x16x32_bf16 a[164:167], a[216:219], a[244:247], a[164:167]
    s_add_u32 s61, s61, 4096
    ds_read_b128 a[236:239], v11 offset:32768
    v_mfma_f32_16x16x32_bf16 a[168:171], a[216:219], a[248:251], a[168:171]
    buffer_load_dwordx4 v7, s[16:19], s61 offen offset:2048 sc1 lds
    v_mfma_f32_16x16x32_bf16 a[172:175], a[216:219], a[252:255], a[172:175]
    v_mfma_f32_16x16x32_bf16 a[188:191], a[220:223], a[252:255], a[188:191]
    v_mfma_f32_16x16x32_bf16 a[184:187], a[220:223], a[248:251], a[184:187]
    v_mfma_f32_16x16x32_bf16 a[180:183], a[220:223], a[244:247], a[180:183]
    buffer_load_dwordx4 v7, s[16:19], s61 offen offset:3072 sc1 lds
    v_mfma_f32_16x16x32_bf16 a[176:179], a[220:223], a[240:243], a[176:179]
    s_waitcnt vmcnt(14) lgkmcnt(0)
    s_barrier
    v_mfma_f32_16x16x32_bf16 a[128:131], a[192:195], a[224:227], a[128:131]
    ds_read_b128 a[208:211], v20 offset:49152
    v_mfma_f32_16x16x32_bf16 a[132:135], a[192:195], a[228:231], a[132:135]
    s_add_u32 m0, s88, 0
    s_add_u32 s56, s56, 1024
    ds_read_b128 a[240:243], v8 offset:49152
    v_mfma_f32_16x16x32_bf16 a[136:139], a[192:195], a[232:235], a[136:139]
    buffer_load_dwordx4 v7, s[16:19], s56 offen sc1 lds
    v_mfma_f32_16x16x32_bf16 a[140:143], a[192:195], a[236:239], a[140:143]
    ds_read_b128 a[212:215], v20 offset:50176
    v_mfma_f32_16x16x32_bf16 a[156:159], a[196:199], a[236:239], a[156:159]
    ds_read_b128 a[244:247], v9 offset:49152
    v_mfma_f32_16x16x32_bf16 a[152:155], a[196:199], a[232:235], a[152:155]
    s_add_u32 s57, s57, 1024
    ds_read_b128 a[216:219], v20 offset:53248
    v_mfma_f32_16x16x32_bf16 a[148:151], a[196:199], a[228:231], a[148:151]
    buffer_load_dwordx4 v7, s[16:19], s57 offen offset:1024 sc1 lds
    v_mfma_f32_16x16x32_bf16 a[144:147], a[196:199], a[224:227], a[144:147]
    ds_read_b128 a[248:251], v10 offset:49152
    v_mfma_f32_16x16x32_bf16 a[160:163], a[200:203], a[224:227], a[160:163]
    ds_read_b128 a[220:223], v20 offset:54272
    v_mfma_f32_16x16x32_bf16 a[164:167], a[200:203], a[228:231], a[164:167]
    s_add_u32 s61, s61, 4096
    ds_read_b128 a[252:255], v11 offset:49152
    v_mfma_f32_16x16x32_bf16 a[168:171], a[200:203], a[232:235], a[168:171]
    buffer_load_dwordx4 v7, s[16:19], s61 offen offset:2048 sc1 lds
    v_mfma_f32_16x16x32_bf16 a[172:175], a[200:203], a[236:239], a[172:175]
    v_mfma_f32_16x16x32_bf16 a[188:191], a[204:207], a[236:239], a[188:191]
    v_mfma_f32_16x16x32_bf16 a[184:187], a[204:207], a[232:235], a[184:187]
    v_mfma_f32_16x16x32_bf16 a[180:183], a[204:207], a[228:231], a[180:183]
    buffer_load_dwordx4 v7, s[16:19], s61 offen offset:3072 sc1 lds
    v_mfma_f32_16x16x32_bf16 a[176:179], a[204:207], a[224:227], a[176:179]
    s_waitcnt lgkmcnt(0)
    v_mfma_f32_16x16x32_bf16 a[128:131], a[208:211], a[240:243], a[128:131]
    ds_read_b128 a[192:195], v22 offset:0
    v_mfma_f32_16x16x32_bf16 a[132:135], a[208:211], a[244:247], a[132:135]
    s_add_u32 m0, s88, 16384
    s_add_u32 s56, s56, 1024
    ds_read_b128 a[224:227], v16 offset:0
    v_mfma_f32_16x16x32_bf16 a[136:139], a[208:211], a[248:251], a[136:139]
    buffer_load_dwordx4 v7, s[16:19], s56 offen sc1 lds
    v_mfma_f32_16x16x32_bf16 a[140:143], a[208:211], a[252:255], a[140:143]
    ds_read_b128 a[196:199], v22 offset:1024
    v_mfma_f32_16x16x32_bf16 a[156:159], a[212:215], a[252:255], a[156:159]
    ds_read_b128 a[228:231], v17 offset:0
    v_mfma_f32_16x16x32_bf16 a[152:155], a[212:215], a[248:251], a[152:155]
    s_add_u32 s57, s57, 1024
    ds_read_b128 a[200:203], v22 offset:4096
    v_mfma_f32_16x16x32_bf16 a[148:151], a[212:215], a[244:247], a[148:151]
    buffer_load_dwordx4 v7, s[16:19], s57 offen offset:1024 sc1 lds
    v_mfma_f32_16x16x32_bf16 a[144:147], a[212:215], a[240:243], a[144:147]
    ds_read_b128 a[232:235], v18 offset:0
    v_mfma_f32_16x16x32_bf16 a[160:163], a[216:219], a[240:243], a[160:163]
    ds_read_b128 a[204:207], v22 offset:5120
    v_mfma_f32_16x16x32_bf16 a[164:167], a[216:219], a[244:247], a[164:167]
    s_add_u32 s61, s61, 4096
    ds_read_b128 a[236:239], v19 offset:0
    v_mfma_f32_16x16x32_bf16 a[168:171], a[216:219], a[248:251], a[168:171]
    buffer_load_dwordx4 v7, s[16:19], s61 offen offset:2048 sc1 lds
    v_mfma_f32_16x16x32_bf16 a[172:175], a[216:219], a[252:255], a[172:175]
    v_mfma_f32_16x16x32_bf16 a[188:191], a[220:223], a[252:255], a[188:191]
    v_mfma_f32_16x16x32_bf16 a[184:187], a[220:223], a[248:251], a[184:187]
    v_mfma_f32_16x16x32_bf16 a[180:183], a[220:223], a[244:247], a[180:183]
    buffer_load_dwordx4 v7, s[16:19], s61 offen offset:3072 sc1 lds
    v_mfma_f32_16x16x32_bf16 a[176:179], a[220:223], a[240:243], a[176:179]
    s_waitcnt vmcnt(18) lgkmcnt(0)
    s_barrier
    v_mfma_f32_16x16x32_bf16 a[64:67], a[192:195], a[224:227], 0
    ds_read_b128 a[208:211], v22 offset:16384
    v_mfma_f32_16x16x32_bf16 a[68:71], a[192:195], a[228:231], 0
    s_add_u32 m0, s88, 32768
    s_add_u32 s56, s56, 1024
    ds_read_b128 a[240:243], v16 offset:16384
    v_mfma_f32_16x16x32_bf16 a[72:75], a[192:195], a[232:235], 0
    buffer_load_dwordx4 v7, s[16:19], s56 offen sc1 lds
    v_mfma_f32_16x16x32_bf16 a[76:79], a[192:195], a[236:239], 0
    ds_read_b128 a[212:215], v22 offset:17408
    v_mfma_f32_16x16x32_bf16 a[92:95], a[196:199], a[236:239], 0
    ds_read_b128 a[244:247], v17 offset:16384
    v_mfma_f32_16x16x32_bf16 a[88:91], a[196:199], a[232:235], 0
    s_add_u32 s57, s57, 1024
    ds_read_b128 a[216:219], v22 offset:20480
    v_mfma_f32_16x16x32_bf16 a[84:87], a[196:199], a[228:231], 0
    buffer_load_dwordx4 v7, s[16:19], s57 offen offset:1024 sc1 lds
    v_mfma_f32_16x16x32_bf16 a[80:83], a[196:199], a[224:227], 0
    ds_read_b128 a[248:251], v18 offset:16384
    v_mfma_f32_16x16x32_bf16 a[96:99], a[200:203], a[224:227], 0
    ds_read_b128 a[220:223], v22 offset:21504
    v_mfma_f32_16x16x32_bf16 a[100:103], a[200:203], a[228:231], 0
    s_add_u32 s61, s61, 4096
    ds_read_b128 a[252:255], v19 offset:16384
    v_mfma_f32_16x16x32_bf16 a[104:107], a[200:203], a[232:235], 0
    buffer_load_dwordx4 v7, s[16:19], s61 offen offset:2048 sc1 lds
    v_mfma_f32_16x16x32_bf16 a[108:111], a[200:203], a[236:239], 0
    v_mfma_f32_16x16x32_bf16 a[124:127], a[204:207], a[236:239], 0
    v_mfma_f32_16x16x32_bf16 a[120:123], a[204:207], a[232:235], 0
    v_mfma_f32_16x16x32_bf16 a[116:119], a[204:207], a[228:231], 0
    buffer_load_dwordx4 v7, s[16:19], s61 offen offset:3072 sc1 lds
    v_mfma_f32_16x16x32_bf16 a[112:115], a[204:207], a[224:227], 0
    s_waitcnt lgkmcnt(0)
    v_mfma_f32_16x16x32_bf16 a[64:67], a[208:211], a[240:243], a[64:67]
    ds_read_b128 a[192:195], v21 offset:0
    v_accvgpr_read_b32 v160, a132
    v_accvgpr_read_b32 v161, a133
    v_mfma_f32_16x16x32_bf16 a[68:71], a[208:211], a[244:247], a[68:71]
    s_add_u32 m0, s88, 49152
    s_add_u32 s56, s56, 1024
    ds_read_b128 a[224:227], v12 offset:0
    v_accvgpr_read_b32 v162, a134
    v_accvgpr_read_b32 v163, a135
    v_mfma_f32_16x16x32_bf16 a[72:75], a[208:211], a[248:251], a[72:75]
    buffer_load_dwordx4 v7, s[16:19], s56 offen sc1 lds
    v_accvgpr_read_b32 v164, a148
    v_accvgpr_read_b32 v165, a149
    v_mfma_f32_16x16x32_bf16 a[76:79], a[208:211], a[252:255], a[76:79]
    ds_read_b128 a[196:199], v21 offset:1024
    v_accvgpr_read_b32 v166, a150
    v_accvgpr_read_b32 v167, a151
    v_mfma_f32_16x16x32_bf16 a[92:95], a[212:215], a[252:255], a[92:95]
    ds_read_b128 a[228:231], v13 offset:0
    v_accvgpr_read_b32 v168, a164
    v_accvgpr_read_b32 v169, a165
    v_mfma_f32_16x16x32_bf16 a[88:91], a[212:215], a[248:251], a[88:91]
    s_add_u32 s57, s57, 1024
    ds_read_b128 a[200:203], v21 offset:4096
    v_accvgpr_read_b32 v170, a166
    v_accvgpr_read_b32 v171, a167
    v_mfma_f32_16x16x32_bf16 a[84:87], a[212:215], a[244:247], a[84:87]
    buffer_load_dwordx4 v7, s[16:19], s57 offen offset:1024 sc1 lds
    v_accvgpr_read_b32 v172, a180
    v_accvgpr_read_b32 v173, a181
    v_mfma_f32_16x16x32_bf16 a[80:83], a[212:215], a[240:243], a[80:83]
    ds_read_b128 a[232:235], v14 offset:0
    v_accvgpr_read_b32 v174, a182
    v_accvgpr_read_b32 v175, a183
    v_mfma_f32_16x16x32_bf16 a[96:99], a[216:219], a[240:243], a[96:99]
    ds_read_b128 a[204:207], v21 offset:5120
    v_cvt_pk_bf16_f32 v176, v160, v161
    v_cvt_pk_bf16_f32 v177, v162, v163
    v_mfma_f32_16x16x32_bf16 a[100:103], a[216:219], a[244:247], a[100:103]
    s_add_u32 s61, s61, 4096
    ds_read_b128 a[236:239], v15 offset:0
    v_cvt_pk_bf16_f32 v178, v164, v165
    v_cvt_pk_bf16_f32 v179, v166, v167
    v_mfma_f32_16x16x32_bf16 a[104:107], a[216:219], a[248:251], a[104:107]
    buffer_load_dwordx4 v7, s[16:19], s61 offen offset:2048 sc1 lds
    v_cvt_pk_bf16_f32 v180, v168, v169
    v_cvt_pk_bf16_f32 v181, v170, v171
    v_mfma_f32_16x16x32_bf16 a[108:111], a[216:219], a[252:255], a[108:111]
    s_bfe_u32 s7, s2, 0x20001
    s_add_u32 s7, s7, 1
    s_and_b32 s7, s7, 3
    s_lshl_b32 s3, s54, 2
    s_add_u32 s3, s3, s7
    s_mul_i32 s3, s3, 12288
    s_add_u32 s58, s3, 35651584
    v_cvt_pk_bf16_f32 v182, v172, v173
    v_cvt_pk_bf16_f32 v183, v174, v175
    v_mfma_f32_16x16x32_bf16 a[124:127], a[220:223], a[252:255], a[124:127]
    v_mfma_f32_16x16x32_bf16 a[120:123], a[220:223], a[248:251], a[120:123]
    v_mfma_f32_16x16x32_bf16 a[116:119], a[220:223], a[244:247], a[116:119]
    buffer_load_dwordx4 v7, s[16:19], s61 offen offset:3072 sc1 lds
    v_mfma_f32_16x16x32_bf16 a[112:115], a[220:223], a[240:243], a[112:115]
    buffer_store_dwordx4 v[176:179], v7, s[16:19], s58 offen offset:0 sc1
    s_waitcnt vmcnt(21) lgkmcnt(0)
    s_barrier
    v_mfma_f32_16x16x32_bf16 a[64:67], a[192:195], a[224:227], a[64:67]
    ds_read_b128 a[208:211], v21 offset:16384
    v_mfma_f32_16x16x32_bf16 a[68:71], a[192:195], a[228:231], a[68:71]
    s_add_u32 m0, s88, 131072
    s_add_u32 s56, s56, 1024
    ds_read_b128 a[240:243], v12 offset:16384
    v_mfma_f32_16x16x32_bf16 a[72:75], a[192:195], a[232:235], a[72:75]
    buffer_load_dwordx4 v7, s[16:19], s56 offen sc1 lds
    v_mfma_f32_16x16x32_bf16 a[76:79], a[192:195], a[236:239], a[76:79]
    ds_read_b128 a[212:215], v21 offset:17408
    v_mfma_f32_16x16x32_bf16 a[92:95], a[196:199], a[236:239], a[92:95]
    ds_read_b128 a[244:247], v13 offset:16384
    v_mfma_f32_16x16x32_bf16 a[88:91], a[196:199], a[232:235], a[88:91]
    s_add_u32 s57, s57, 1024
    ds_read_b128 a[216:219], v21 offset:20480
    v_mfma_f32_16x16x32_bf16 a[84:87], a[196:199], a[228:231], a[84:87]
    buffer_load_dwordx4 v7, s[16:19], s57 offen offset:1024 sc1 lds
    v_mfma_f32_16x16x32_bf16 a[80:83], a[196:199], a[224:227], a[80:83]
    ds_read_b128 a[248:251], v14 offset:16384
    v_mfma_f32_16x16x32_bf16 a[96:99], a[200:203], a[224:227], a[96:99]
    ds_read_b128 a[220:223], v21 offset:21504
    v_mfma_f32_16x16x32_bf16 a[100:103], a[200:203], a[228:231], a[100:103]
    s_add_u32 s61, s61, 4096
    ds_read_b128 a[252:255], v15 offset:16384
    v_mfma_f32_16x16x32_bf16 a[104:107], a[200:203], a[232:235], a[104:107]
    buffer_load_dwordx4 v7, s[16:19], s61 offen offset:2048 sc1 lds
    v_mfma_f32_16x16x32_bf16 a[108:111], a[200:203], a[236:239], a[108:111]
    v_mfma_f32_16x16x32_bf16 a[124:127], a[204:207], a[236:239], a[124:127]
    v_mfma_f32_16x16x32_bf16 a[120:123], a[204:207], a[232:235], a[120:123]
    v_mfma_f32_16x16x32_bf16 a[116:119], a[204:207], a[228:231], a[116:119]
    buffer_load_dwordx4 v7, s[16:19], s61 offen offset:3072 sc1 lds
    v_mfma_f32_16x16x32_bf16 a[112:115], a[204:207], a[224:227], a[112:115]
    buffer_store_dwordx4 v[180:183], v7, s[16:19], s58 offen offset:1024 sc1
    s_waitcnt lgkmcnt(0)
    v_mfma_f32_16x16x32_bf16 a[64:67], a[208:211], a[240:243], a[64:67]
    ds_read_b128 a[192:195], v21 offset:32768
    v_accvgpr_read_b32 v160, a136
    v_accvgpr_read_b32 v161, a137
    v_mfma_f32_16x16x32_bf16 a[68:71], a[208:211], a[244:247], a[68:71]
    s_add_u32 m0, s88, 147456
    s_add_u32 s56, s56, 1024
    ds_read_b128 a[224:227], v12 offset:32768
    v_accvgpr_read_b32 v162, a138
    v_accvgpr_read_b32 v163, a139
    v_mfma_f32_16x16x32_bf16 a[72:75], a[208:211], a[248:251], a[72:75]
    buffer_load_dwordx4 v7, s[16:19], s56 offen sc1 lds
    v_accvgpr_read_b32 v164, a152
    v_accvgpr_read_b32 v165, a153
    v_mfma_f32_16x16x32_bf16 a[76:79], a[208:211], a[252:255], a[76:79]
    ds_read_b128 a[196:199], v21 offset:33792
    v_accvgpr_read_b32 v166, a154
    v_accvgpr_read_b32 v167, a155
    v_mfma_f32_16x16x32_bf16 a[92:95], a[212:215], a[252:255], a[92:95]
    ds_read_b128 a[228:231], v13 offset:32768
    v_accvgpr_read_b32 v168, a168
    v_accvgpr_read_b32 v169, a169
    v_mfma_f32_16x16x32_bf16 a[88:91], a[212:215], a[248:251], a[88:91]
    s_add_u32 s57, s57, 1024
    ds_read_b128 a[200:203], v21 offset:36864
    v_accvgpr_read_b32 v170, a170
    v_accvgpr_read_b32 v171, a171
    v_mfma_f32_16x16x32_bf16 a[84:87], a[212:215], a[244:247], a[84:87]
    buffer_load_dwordx4 v7, s[16:19], s57 offen offset:1024 sc1 lds
    v_accvgpr_read_b32 v172, a184
    v_accvgpr_read_b32 v173, a185
    v_mfma_f32_16x16x32_bf16 a[80:83], a[212:215], a[240:243], a[80:83]
    ds_read_b128 a[232:235], v14 offset:32768
    v_accvgpr_read_b32 v174, a186
    v_accvgpr_read_b32 v175, a187
    v_mfma_f32_16x16x32_bf16 a[96:99], a[216:219], a[240:243], a[96:99]
    ds_read_b128 a[204:207], v21 offset:37888
    v_cvt_pk_bf16_f32 v176, v160, v161
    v_cvt_pk_bf16_f32 v177, v162, v163
    v_mfma_f32_16x16x32_bf16 a[100:103], a[216:219], a[244:247], a[100:103]
    s_add_u32 s61, s61, 4096
    ds_read_b128 a[236:239], v15 offset:32768
    v_cvt_pk_bf16_f32 v178, v164, v165
    v_cvt_pk_bf16_f32 v179, v166, v167
    v_mfma_f32_16x16x32_bf16 a[104:107], a[216:219], a[248:251], a[104:107]
    buffer_load_dwordx4 v7, s[16:19], s61 offen offset:2048 sc1 lds
    v_cvt_pk_bf16_f32 v180, v168, v169
    v_cvt_pk_bf16_f32 v181, v170, v171
    v_mfma_f32_16x16x32_bf16 a[108:111], a[216:219], a[252:255], a[108:111]
    s_bfe_u32 s7, s2, 0x20001
    s_add_u32 s7, s7, 2
    s_and_b32 s7, s7, 3
    s_lshl_b32 s3, s54, 2
    s_add_u32 s3, s3, s7
    s_mul_i32 s3, s3, 12288
    s_add_u32 s58, s3, 35653632
    v_cvt_pk_bf16_f32 v182, v172, v173
    v_cvt_pk_bf16_f32 v183, v174, v175
    v_mfma_f32_16x16x32_bf16 a[124:127], a[220:223], a[252:255], a[124:127]
    v_mfma_f32_16x16x32_bf16 a[120:123], a[220:223], a[248:251], a[120:123]
    v_mfma_f32_16x16x32_bf16 a[116:119], a[220:223], a[244:247], a[116:119]
    buffer_load_dwordx4 v7, s[16:19], s61 offen offset:3072 sc1 lds
    v_mfma_f32_16x16x32_bf16 a[112:115], a[220:223], a[240:243], a[112:115]
    buffer_store_dwordx4 v[176:179], v7, s[16:19], s58 offen offset:0 sc1
    s_waitcnt vmcnt(23) lgkmcnt(0)
    s_barrier
    v_mfma_f32_16x16x32_bf16 a[64:67], a[192:195], a[224:227], a[64:67]
    ds_read_b128 a[208:211], v21 offset:49152
    v_mfma_f32_16x16x32_bf16 a[68:71], a[192:195], a[228:231], a[68:71]
    s_add_u32 m0, s88, 65536
    s_add_u32 s56, s56, 1024
    ds_read_b128 a[240:243], v12 offset:49152
    v_mfma_f32_16x16x32_bf16 a[72:75], a[192:195], a[232:235], a[72:75]
    buffer_load_dwordx4 v7, s[16:19], s56 offen sc1 lds
    v_mfma_f32_16x16x32_bf16 a[76:79], a[192:195], a[236:239], a[76:79]
    ds_read_b128 a[212:215], v21 offset:50176
    v_mfma_f32_16x16x32_bf16 a[92:95], a[196:199], a[236:239], a[92:95]
    ds_read_b128 a[244:247], v13 offset:49152
    v_mfma_f32_16x16x32_bf16 a[88:91], a[196:199], a[232:235], a[88:91]
    s_add_u32 s57, s57, 1024
    ds_read_b128 a[216:219], v21 offset:53248
    v_mfma_f32_16x16x32_bf16 a[84:87], a[196:199], a[228:231], a[84:87]
    buffer_load_dwordx4 v7, s[16:19], s57 offen offset:1024 sc1 lds
    v_mfma_f32_16x16x32_bf16 a[80:83], a[196:199], a[224:227], a[80:83]
    ds_read_b128 a[248:251], v14 offset:49152
    v_mfma_f32_16x16x32_bf16 a[96:99], a[200:203], a[224:227], a[96:99]
    ds_read_b128 a[220:223], v21 offset:54272
    v_mfma_f32_16x16x32_bf16 a[100:103], a[200:203], a[228:231], a[100:103]
    s_add_u32 s61, s61, 4096
    ds_read_b128 a[252:255], v15 offset:49152
    v_mfma_f32_16x16x32_bf16 a[104:107], a[200:203], a[232:235], a[104:107]
    buffer_load_dwordx4 v7, s[16:19], s61 offen offset:2048 sc1 lds
    v_mfma_f32_16x16x32_bf16 a[108:111], a[200:203], a[236:239], a[108:111]
    v_mfma_f32_16x16x32_bf16 a[124:127], a[204:207], a[236:239], a[124:127]
    v_mfma_f32_16x16x32_bf16 a[120:123], a[204:207], a[232:235], a[120:123]
    v_mfma_f32_16x16x32_bf16 a[116:119], a[204:207], a[228:231], a[116:119]
    buffer_load_dwordx4 v7, s[16:19], s61 offen offset:3072 sc1 lds
    v_mfma_f32_16x16x32_bf16 a[112:115], a[204:207], a[224:227], a[112:115]
    buffer_store_dwordx4 v[180:183], v7, s[16:19], s58 offen offset:1024 sc1
    s_waitcnt lgkmcnt(0)
    v_mfma_f32_16x16x32_bf16 a[64:67], a[208:211], a[240:243], a[64:67]
    ds_read_b128 a[192:195], v20 offset:0
    v_accvgpr_read_b32 v160, a140
    v_accvgpr_read_b32 v161, a141
    v_mfma_f32_16x16x32_bf16 a[68:71], a[208:211], a[244:247], a[68:71]
    s_add_u32 m0, s88, 81920
    s_add_u32 s56, s56, 1024
    ds_read_b128 a[224:227], v8 offset:0
    v_accvgpr_read_b32 v162, a142
    v_accvgpr_read_b32 v163, a143
    v_mfma_f32_16x16x32_bf16 a[72:75], a[208:211], a[248:251], a[72:75]
    buffer_load_dwordx4 v7, s[16:19], s56 offen sc1 lds
    v_accvgpr_read_b32 v164, a156
    v_accvgpr_read_b32 v165, a157
    v_mfma_f32_16x16x32_bf16 a[76:79], a[208:211], a[252:255], a[76:79]
    ds_read_b128 a[196:199], v20 offset:1024
    v_accvgpr_read_b32 v166, a158
    v_accvgpr_read_b32 v167, a159
    v_mfma_f32_16x16x32_bf16 a[92:95], a[212:215], a[252:255], a[92:95]
    ds_read_b128 a[228:231], v9 offset:0
    v_accvgpr_read_b32 v168, a172
    v_accvgpr_read_b32 v169, a173
    v_mfma_f32_16x16x32_bf16 a[88:91], a[212:215], a[248:251], a[88:91]
    s_add_u32 s57, s57, 1024
    ds_read_b128 a[200:203], v20 offset:4096
    v_accvgpr_read_b32 v170, a174
    v_accvgpr_read_b32 v171, a175
    v_mfma_f32_16x16x32_bf16 a[84:87], a[212:215], a[244:247], a[84:87]
    buffer_load_dwordx4 v7, s[16:19], s57 offen offset:1024 sc1 lds
    v_accvgpr_read_b32 v172, a188
    v_accvgpr_read_b32 v173, a189
    v_mfma_f32_16x16x32_bf16 a[80:83], a[212:215], a[240:243], a[80:83]
    ds_read_b128 a[232:235], v10 offset:0
    v_accvgpr_read_b32 v174, a190
    v_accvgpr_read_b32 v175, a191
    v_mfma_f32_16x16x32_bf16 a[96:99], a[216:219], a[240:243], a[96:99]
    ds_read_b128 a[204:207], v20 offset:5120
    v_cvt_pk_bf16_f32 v176, v160, v161
    v_cvt_pk_bf16_f32 v177, v162, v163
    v_mfma_f32_16x16x32_bf16 a[100:103], a[216:219], a[244:247], a[100:103]
    s_add_u32 s61, s61, 4096
    ds_read_b128 a[236:239], v11 offset:0
    v_cvt_pk_bf16_f32 v178, v164, v165
    v_cvt_pk_bf16_f32 v179, v166, v167
    v_mfma_f32_16x16x32_bf16 a[104:107], a[216:219], a[248:251], a[104:107]
    buffer_load_dwordx4 v7, s[16:19], s61 offen offset:2048 sc1 lds
    v_cvt_pk_bf16_f32 v180, v168, v169
    v_cvt_pk_bf16_f32 v181, v170, v171
    v_mfma_f32_16x16x32_bf16 a[108:111], a[216:219], a[252:255], a[108:111]
    s_bfe_u32 s7, s2, 0x20001
    s_add_u32 s7, s7, 3
    s_and_b32 s7, s7, 3
    s_lshl_b32 s3, s54, 2
    s_add_u32 s3, s3, s7
    s_mul_i32 s3, s3, 12288
    s_add_u32 s58, s3, 35655680
    v_cvt_pk_bf16_f32 v182, v172, v173
    v_cvt_pk_bf16_f32 v183, v174, v175
    v_mfma_f32_16x16x32_bf16 a[124:127], a[220:223], a[252:255], a[124:127]
    v_mfma_f32_16x16x32_bf16 a[120:123], a[220:223], a[248:251], a[120:123]
    v_mfma_f32_16x16x32_bf16 a[116:119], a[220:223], a[244:247], a[116:119]
    buffer_load_dwordx4 v7, s[16:19], s61 offen offset:3072 sc1 lds
    v_mfma_f32_16x16x32_bf16 a[112:115], a[220:223], a[240:243], a[112:115]
    buffer_store_dwordx4 v[176:179], v7, s[16:19], s58 offen offset:0 sc1
    s_waitcnt vmcnt(25) lgkmcnt(0)
    s_barrier
    v_mfma_f32_16x16x32_bf16 a[64:67], a[192:195], a[224:227], a[64:67]
    ds_read_b128 a[208:211], v20 offset:16384
    v_mfma_f32_16x16x32_bf16 a[68:71], a[192:195], a[228:231], a[68:71]
    s_add_u32 m0, s88, 98304
    s_add_u32 s56, s56, 1024
    ds_read_b128 a[240:243], v8 offset:16384
    v_mfma_f32_16x16x32_bf16 a[72:75], a[192:195], a[232:235], a[72:75]
    buffer_load_dwordx4 v7, s[16:19], s56 offen sc1 lds
    v_mfma_f32_16x16x32_bf16 a[76:79], a[192:195], a[236:239], a[76:79]
    ds_read_b128 a[212:215], v20 offset:17408
    v_mfma_f32_16x16x32_bf16 a[92:95], a[196:199], a[236:239], a[92:95]
    ds_read_b128 a[244:247], v9 offset:16384
    v_mfma_f32_16x16x32_bf16 a[88:91], a[196:199], a[232:235], a[88:91]
    s_add_u32 s57, s57, 1024
    ds_read_b128 a[216:219], v20 offset:20480
    v_mfma_f32_16x16x32_bf16 a[84:87], a[196:199], a[228:231], a[84:87]
    buffer_load_dwordx4 v7, s[16:19], s57 offen offset:1024 sc1 lds
    v_mfma_f32_16x16x32_bf16 a[80:83], a[196:199], a[224:227], a[80:83]
L_pad14:
    s_cbranch_execz L_warmret
    ds_read_b128 a[248:251], v10 offset:16384
    v_mfma_f32_16x16x32_bf16 a[96:99], a[200:203], a[224:227], a[96:99]
    ds_read_b128 a[220:223], v20 offset:21504
    v_mfma_f32_16x16x32_bf16 a[100:103], a[200:203], a[228:231], a[100:103]
    s_add_u32 s61, s61, 4096
    ds_read_b128 a[252:255], v11 offset:16384
    v_mfma_f32_16x16x32_bf16 a[104:107], a[200:203], a[232:235], a[104:107]
    buffer_load_dwordx4 v7, s[16:19], s61 offen offset:2048 sc1 lds
    v_mfma_f32_16x16x32_bf16 a[108:111], a[200:203], a[236:239], a[108:111]
    v_mfma_f32_16x16x32_bf16 a[124:127], a[204:207], a[236:239], a[124:127]
    v_mfma_f32_16x16x32_bf16 a[120:123], a[204:207], a[232:235], a[120:123]
    v_mfma_f32_16x16x32_bf16 a[116:119], a[204:207], a[228:231], a[116:119]
    buffer_load_dwordx4 v7, s[16:19], s61 offen offset:3072 sc1 lds
    v_mfma_f32_16x16x32_bf16 a[112:115], a[204:207], a[224:227], a[112:115]
    buffer_store_dwordx4 v[180:183], v7, s[16:19], s58 offen offset:1024 sc1
    s_waitcnt lgkmcnt(0)
    v_mfma_f32_16x16x32_bf16 a[64:67], a[208:211], a[240:243], a[64:67]
    ds_read_b128 a[192:195], v20 offset:32768
    v_mfma_f32_16x16x32_bf16 a[68:71], a[208:211], a[244:247], a[68:71]
    s_add_u32 m0, s88, 114688
    s_add_u32 s56, s56, 1024
    ds_read_b128 a[224:227], v8 offset:32768
    v_mfma_f32_16x16x32_bf16 a[72:75], a[208:211], a[248:251], a[72:75]
    buffer_load_dwordx4 v7, s[16:19], s56 offen sc1 lds
    v_mfma_f32_16x16x32_bf16 a[76:79], a[208:211], a[252:255], a[76:79]
    ds_read_b128 a[196:199], v20 offset:33792
    v_mfma_f32_16x16x32_bf16 a[92:95], a[212:215], a[252:255], a[92:95]
    ds_read_b128 a[228:231], v9 offset:32768
    v_mfma_f32_16x16x32_bf16 a[88:91], a[212:215], a[248:251], a[88:91]
    s_add_u32 s57, s57, 1024
    ds_read_b128 a[200:203], v20 offset:36864
    v_mfma_f32_16x16x32_bf16 a[84:87], a[212:215], a[244:247], a[84:87]
    buffer_load_dwordx4 v7, s[16:19], s57 offen offset:1024 sc1 lds
    v_mfma_f32_16x16x32_bf16 a[80:83], a[212:215], a[240:243], a[80:83]
    ds_read_b128 a[232:235], v10 offset:32768
    v_mfma_f32_16x16x32_bf16 a[96:99], a[216:219], a[240:243], a[96:99]
    ds_read_b128 a[204:207], v20 offset:37888
    v_mfma_f32_16x16x32_bf16 a[100:103], a[216:219], a[244:247], a[100:103]
    s_add_u32 s61, s61, 4096
    ds_read_b128 a[236:239], v11 offset:32768
    v_mfma_f32_16x16x32_bf16 a[104:107], a[216:219], a[248:251], a[104:107]
    buffer_load_dwordx4 v7, s[16:19], s61 offen offset:2048 sc1 lds
    v_mfma_f32_16x16x32_bf16 a[108:111], a[216:219], a[252:255], a[108:111]
    v_mfma_f32_16x16x32_bf16 a[124:127], a[220:223], a[252:255], a[124:127]
    v_mfma_f32_16x16x32_bf16 a[120:123], a[220:223], a[248:251], a[120:123]
    v_mfma_f32_16x16x32_bf16 a[116:119], a[220:223], a[244:247], a[116:119]
    buffer_load_dwordx4 v7, s[16:19], s61 offen offset:3072 sc1 lds
    v_mfma_f32_16x16x32_bf16 a[112:115], a[220:223], a[240:243], a[112:115]
    s_waitcnt vmcnt(25) lgkmcnt(0)
    s_barrier
    v_mfma_f32_16x16x32_bf16 a[64:67], a[192:195], a[224:227], a[64:67]
    ds_read_b128 a[208:211], v20 offset:49152
    v_mfma_f32_16x16x32_bf16 a[68:71], a[192:195], a[228:231], a[68:71]
    s_add_u32 m0, s88, 0
    s_add_u32 s56, s56, 1024
    ds_read_b128 a[240:243], v8 offset:49152
    v_mfma_f32_16x16x32_bf16 a[72:75], a[192:195], a[232:235], a[72:75]
    buffer_load_dwordx4 v7, s[16:19], s56 offen sc1 lds
    v_mfma_f32_16x16x32_bf16 a[76:79], a[192:195], a[236:239], a[76:79]
    ds_read_b128 a[212:215], v20 offset:50176
    v_mfma_f32_16x16x32_bf16 a[92:95], a[196:199], a[236:239], a[92:95]
    ds_read_b128 a[244:247], v9 offset:49152
    v_mfma_f32_16x16x32_bf16 a[88:91], a[196:199], a[232:235], a[88:91]
    s_add_u32 s57, s57, 1024
    ds_read_b128 a[216:219], v20 offset:53248
    v_mfma_f32_16x16x32_bf16 a[84:87], a[196:199], a[228:231], a[84:87]
    buffer_load_dwordx4 v7, s[16:19], s57 offen offset:1024 sc1 lds
    v_mfma_f32_16x16x32_bf16 a[80:83], a[196:199], a[224:227], a[80:83]
    ds_read_b128 a[248:251], v10 offset:49152
    v_mfma_f32_16x16x32_bf16 a[96:99], a[200:203], a[224:227], a[96:99]
    ds_read_b128 a[220:223], v20 offset:54272
    v_mfma_f32_16x16x32_bf16 a[100:103], a[200:203], a[228:231], a[100:103]
    s_add_u32 s61, s61, 4096
    ds_read_b128 a[252:255], v11 offset:49152
    v_mfma_f32_16x16x32_bf16 a[104:107], a[200:203], a[232:235], a[104:107]
    buffer_load_dwordx4 v7, s[16:19], s61 offen offset:2048 sc1 lds
    v_mfma_f32_16x16x32_bf16 a[108:111], a[200:203], a[236:239], a[108:111]
    v_mfma_f32_16x16x32_bf16 a[124:127], a[204:207], a[236:239], a[124:127]
    v_mfma_f32_16x16x32_bf16 a[120:123], a[204:207], a[232:235], a[120:123]
    v_mfma_f32_16x16x32_bf16 a[116:119], a[204:207], a[228:231], a[116:119]
    buffer_load_dwordx4 v7, s[16:19], s61 offen offset:3072 sc1 lds
    v_mfma_f32_16x16x32_bf16 a[112:115], a[204:207], a[224:227], a[112:115]
    s_waitcnt lgkmcnt(0)
    v_mfma_f32_16x16x32_bf16 a[64:67], a[208:211], a[240:243], a[64:67]
    ds_read_b128 a[192:195], v22 offset:0
    v_mfma_f32_16x16x32_bf16 a[68:71], a[208:211], a[244:247], a[68:71]
    s_add_u32 m0, s88, 16384
    s_add_u32 s56, s56, 1024
    ds_read_b128 a[224:227], v16 offset:0
    v_mfma_f32_16x16x32_bf16 a[72:75], a[208:211], a[248:251], a[72:75]
    buffer_load_dwordx4 v7, s[16:19], s56 offen sc1 lds
    v_mfma_f32_16x16x32_bf16 a[76:79], a[208:211], a[252:255], a[76:79]
    ds_read_b128 a[196:199], v22 offset:1024
    v_mfma_f32_16x16x32_bf16 a[92:95], a[212:215], a[252:255], a[92:95]
    ds_read_b128 a[228:231], v17 offset:0
    v_mfma_f32_16x16x32_bf16 a[88:91], a[212:215], a[248:251], a[88:91]
    s_add_u32 s57, s57, 1024
    ds_read_b128 a[200:203], v22 offset:4096
    v_mfma_f32_16x16x32_bf16 a[84:87], a[212:215], a[244:247], a[84:87]
    buffer_load_dwordx4 v7, s[16:19], s57 offen offset:1024 sc1 lds
    v_mfma_f32_16x16x32_bf16 a[80:83], a[212:215], a[240:243], a[80:83]
    ds_read_b128 a[232:235], v18 offset:0
    v_mfma_f32_16x16x32_bf16 a[96:99], a[216:219], a[240:243], a[96:99]
    ds_read_b128 a[204:207], v22 offset:5120
    v_mfma_f32_16x16x32_bf16 a[100:103], a[216:219], a[244:247], a[100:103]
    s_add_u32 s61, s61, 4096
    ds_read_b128 a[236:239], v19 offset:0
    v_mfma_f32_16x16x32_bf16 a[104:107], a[216:219], a[248:251], a[104:107]
    buffer_load_dwordx4 v7, s[16:19], s61 offen offset:2048 sc1 lds
    v_mfma_f32_16x16x32_bf16 a[108:111], a[216:219], a[252:255], a[108:111]
    v_mfma_f32_16x16x32_bf16 a[124:127], a[220:223], a[252:255], a[124:127]
    v_mfma_f32_16x16x32_bf16 a[120:123], a[220:223], a[248:251], a[120:123]
    v_mfma_f32_16x16x32_bf16 a[116:119], a[220:223], a[244:247], a[116:119]
    buffer_load_dwordx4 v7, s[16:19], s61 offen offset:3072 sc1 lds
    v_mfma_f32_16x16x32_bf16 a[112:115], a[220:223], a[240:243], a[112:115]
    s_waitcnt vmcnt(23) lgkmcnt(0)
    s_barrier
    v_mfma_f32_16x16x32_bf16 a[64:67], a[192:195], a[224:227], a[64:67]
    ds_read_b128 a[208:211], v22 offset:16384
    v_mfma_f32_16x16x32_bf16 a[68:71], a[192:195], a[228:231], a[68:71]
    s_add_u32 m0, s88, 32768
    s_add_u32 s56, s56, 1024
    ds_read_b128 a[240:243], v16 offset:16384
    v_mfma_f32_16x16x32_bf16 a[72:75], a[192:195], a[232:235], a[72:75]
    buffer_load_dwordx4 v7, s[16:19], s56 offen sc1 lds
    v_mfma_f32_16x16x32_bf16 a[76:79], a[192:195], a[236:239], a[76:79]
    ds_read_b128 a[212:215], v22 offset:17408
    v_mfma_f32_16x16x32_bf16 a[92:95], a[196:199], a[236:239], a[92:95]
    ds_read_b128 a[244:247], v17 offset:16384
    v_mfma_f32_16x16x32_bf16 a[88:91], a[196:199], a[232:235], a[88:91]
    s_add_u32 s57, s57, 1024
    ds_read_b128 a[216:219], v22 offset:20480
    v_mfma_f32_16x16x32_bf16 a[84:87], a[196:199], a[228:231], a[84:87]
    buffer_load_dwordx4 v7, s[16:19], s57 offen offset:1024 sc1 lds
    v_mfma_f32_16x16x32_bf16 a[80:83], a[196:199], a[224:227], a[80:83]
    ds_read_b128 a[248:251], v18 offset:16384
    v_mfma_f32_16x16x32_bf16 a[96:99], a[200:203], a[224:227], a[96:99]
    ds_read_b128 a[220:223], v22 offset:21504
    v_mfma_f32_16x16x32_bf16 a[100:103], a[200:203], a[228:231], a[100:103]
    s_add_u32 s61, s61, 4096
    ds_read_b128 a[252:255], v19 offset:16384
    v_mfma_f32_16x16x32_bf16 a[104:107], a[200:203], a[232:235], a[104:107]
    buffer_load_dwordx4 v7, s[16:19], s61 offen offset:2048 sc1 lds
    v_mfma_f32_16x16x32_bf16 a[108:111], a[200:203], a[236:239], a[108:111]
    v_mfma_f32_16x16x32_bf16 a[124:127], a[204:207], a[236:239], a[124:127]
    v_mfma_f32_16x16x32_bf16 a[120:123], a[204:207], a[232:235], a[120:123]
    v_mfma_f32_16x16x32_bf16 a[116:119], a[204:207], a[228:231], a[116:119]
    buffer_load_dwordx4 v7, s[16:19], s61 offen offset:3072 sc1 lds
    v_mfma_f32_16x16x32_bf16 a[112:115], a[204:207], a[224:227], a[112:115]
    s_waitcnt lgkmcnt(0)
    v_mfma_f32_16x16x32_bf16 a[64:67], a[208:211], a[240:243], a[64:67]
    ds_read_b128 a[192:195], v21 offset:0
    v_mfma_f32_16x16x32_bf16 a[68:71], a[208:211], a[244:247], a[68:71]
    s_add_u32 m0, s88, 49152
    s_add_u32 s56, s56, 1024
    ds_read_b128 a[224:227], v12 offset:0
    v_mfma_f32_16x16x32_bf16 a[72:75], a[208:211], a[248:251], a[72:75]
    buffer_load_dwordx4 v7, s[16:19], s56 offen sc1 lds
    v_mfma_f32_16x16x32_bf16 a[76:79], a[208:211], a[252:255], a[76:79]
    ds_read_b128 a[196:199], v21 offset:1024
    v_mfma_f32_16x16x32_bf16 a[92:95], a[212:215], a[252:255], a[92:95]
    ds_read_b128 a[228:231], v13 offset:0
    v_mfma_f32_16x16x32_bf16 a[88:91], a[212:215], a[248:251], a[88:91]
    s_add_u32 s57, s57, 1024
    ds_read_b128 a[200:203], v21 offset:4096
    v_mfma_f32_16x16x32_bf16 a[84:87], a[212:215], a[244:247], a[84:87]
    buffer_load_dwordx4 v7, s[16:19], s57 offen offset:1024 sc1 lds
    v_mfma_f32_16x16x32_bf16 a[80:83], a[212:215], a[240:243], a[80:83]
    ds_read_b128 a[232:235], v14 offset:0
    v_mfma_f32_16x16x32_bf16 a[96:99], a[216:219], a[240:243], a[96:99]
    ds_read_b128 a[204:207], v21 offset:5120
    v_mfma_f32_16x16x32_bf16 a[100:103], a[216:219], a[244:247], a[100:103]
    s_add_u32 s61, s61, 4096
    ds_read_b128 a[236:239], v15 offset:0
    v_mfma_f32_16x16x32_bf16 a[104:107], a[216:219], a[248:251], a[104:107]
    buffer_load_dwordx4 v7, s[16:19], s61 offen offset:2048 sc1 lds
    v_mfma_f32_16x16x32_bf16 a[108:111], a[216:219], a[252:255], a[108:111]
    v_mfma_f32_16x16x32_bf16 a[124:127], a[220:223], a[252:255], a[124:127]
    v_mfma_f32_16x16x32_bf16 a[120:123], a[220:223], a[248:251], a[120:123]
    v_mfma_f32_16x16x32_bf16 a[116:119], a[220:223], a[244:247], a[116:119]
    buffer_load_dwordx4 v7, s[16:19], s61 offen offset:3072 sc1 lds
    v_mfma_f32_16x16x32_bf16 a[112:115], a[220:223], a[240:243], a[112:115]
    s_waitcnt vmcnt(21) lgkmcnt(0)
    s_barrier
    v_mfma_f32_16x16x32_bf16 a[64:67], a[192:195], a[224:227], a[64:67]
    ds_read_b128 a[208:211], v21 offset:16384
    v_mfma_f32_16x16x32_bf16 a[68:71], a[192:195], a[228:231], a[68:71]
    s_add_u32 m0, s88, 131072
    s_add_u32 s56, s56, 1024
    ds_read_b128 a[240:243], v12 offset:16384
    v_mfma_f32_16x16x32_bf16 a[72:75], a[192:195], a[232:235], a[72:75]
    buffer_load_dwordx4 v7, s[16:19], s56 offen sc1 lds
    v_mfma_f32_16x16x32_bf16 a[76:79], a[192:195], a[236:239], a[76:79]
    ds_read_b128 a[212:215], v21 offset:17408
    v_mfma_f32_16x16x32_bf16 a[92:95], a[196:199], a[236:239], a[92:95]
    ds_read_b128 a[244:247], v13 offset:16384
    v_mfma_f32_16x16x32_bf16 a[88:91], a[196:199], a[232:235], a[88:91]
    s_add_u32 s57, s57, 1024
    ds_read_b128 a[216:219], v21 offset:20480
    v_mfma_f32_16x16x32_bf16 a[84:87], a[196:199], a[228:231], a[84:87]
    buffer_load_dwordx4 v7, s[16:19], s57 offen offset:1024 sc1 lds
    v_mfma_f32_16x16x32_bf16 a[80:83], a[196:199], a[224:227], a[80:83]
    ds_read_b128 a[248:251], v14 offset:16384
    v_mfma_f32_16x16x32_bf16 a[96:99], a[200:203], a[224:227], a[96:99]
    ds_read_b128 a[220:223], v21 offset:21504
    v_mfma_f32_16x16x32_bf16 a[100:103], a[200:203], a[228:231], a[100:103]
    s_add_u32 s61, s61, 4096
    ds_read_b128 a[252:255], v15 offset:16384
    v_mfma_f32_16x16x32_bf16 a[104:107], a[200:203], a[232:235], a[104:107]
    buffer_load_dwordx4 v7, s[16:19], s61 offen offset:2048 sc1 lds
    v_mfma_f32_16x16x32_bf16 a[108:111], a[200:203], a[236:239], a[108:111]
    v_mfma_f32_16x16x32_bf16 a[124:127], a[204:207], a[236:239], a[124:127]
    v_mfma_f32_16x16x32_bf16 a[120:123], a[204:207], a[232:235], a[120:123]
    v_mfma_f32_16x16x32_bf16 a[116:119], a[204:207], a[228:231], a[116:119]
    buffer_load_dwordx4 v7, s[16:19], s61 offen offset:3072 sc1 lds
    v_mfma_f32_16x16x32_bf16 a[112:115], a[204:207], a[224:227], a[112:115]
    s_waitcnt vmcnt(24)
    buffer_store_dword v223, v7, s[36:39], 0 offen sc1
    s_waitcnt lgkmcnt(0)
    v_mfma_f32_16x16x32_bf16 a[64:67], a[208:211], a[240:243], a[64:67]
    ds_read_b128 a[192:195], v21 offset:32768
    v_mfma_f32_16x16x32_bf16 a[68:71], a[208:211], a[244:247], a[68:71]
    s_add_u32 m0, s88, 147456
    s_add_u32 s56, s56, 1024
    ds_read_b128 a[224:227], v12 offset:32768
    v_mfma_f32_16x16x32_bf16 a[72:75], a[208:211], a[248:251], a[72:75]
    buffer_load_dwordx4 v7, s[16:19], s56 offen sc1 lds
    v_mfma_f32_16x16x32_bf16 a[76:79], a[208:211], a[252:255], a[76:79]
    ds_read_b128 a[196:199], v21 offset:33792
    v_mfma_f32_16x16x32_bf16 a[92:95], a[212:215], a[252:255], a[92:95]
    ds_read_b128 a[228:231], v13 offset:32768
    v_mfma_f32_16x16x32_bf16 a[88:91], a[212:215], a[248:251], a[88:91]
    s_add_u32 s57, s57, 1024
    ds_read_b128 a[200:203], v21 offset:36864
    v_mfma_f32_16x16x32_bf16 a[84:87], a[212:215], a[244:247], a[84:87]
    buffer_load_dwordx4 v7, s[16:19], s57 offen offset:1024 sc1 lds
    v_mfma_f32_16x16x32_bf16 a[80:83], a[212:215], a[240:243], a[80:83]
    ds_read_b128 a[232:235], v14 offset:32768
    v_mfma_f32_16x16x32_bf16 a[96:99], a[216:219], a[240:243], a[96:99]
    ds_read_b128 a[204:207], v21 offset:37888
    v_mfma_f32_16x16x32_bf16 a[100:103], a[216:219], a[244:247], a[100:103]
    s_add_u32 s61, s61, 4096
    ds_read_b128 a[236:239], v15 offset:32768
    v_mfma_f32_16x16x32_bf16 a[104:107], a[216:219], a[248:251], a[104:107]
    buffer_load_dwordx4 v7, s[16:19], s61 offen offset:2048 sc1 lds
    v_mfma_f32_16x16x32_bf16 a[108:111], a[216:219], a[252:255], a[108:111]
    v_mfma_f32_16x16x32_bf16 a[124:127], a[220:223], a[252:255], a[124:127]
    v_mfma_f32_16x16x32_bf16 a[120:123], a[220:223], a[248:251], a[120:123]
    v_mfma_f32_16x16x32_bf16 a[116:119], a[220:223], a[244:247], a[116:119]
    buffer_load_dwordx4 v7, s[16:19], s61 offen offset:3072 sc1 lds
    v_mfma_f32_16x16x32_bf16 a[112:115], a[220:223], a[240:243], a[112:115]
    s_waitcnt vmcnt(21) lgkmcnt(0)
    s_barrier
    v_mfma_f32_16x16x32_bf16 a[64:67], a[192:195], a[224:227], a[64:67]
    ds_read_b128 a[208:211], v21 offset:49152
    v_mfma_f32_16x16x32_bf16 a[68:71], a[192:195], a[228:231], a[68:71]
    s_add_u32 m0, s88, 65536
    s_add_u32 s56, s56, 1024
    ds_read_b128 a[240:243], v12 offset:49152
    v_mfma_f32_16x16x32_bf16 a[72:75], a[192:195], a[232:235], a[72:75]
    buffer_load_dwordx4 v7, s[16:19], s56 offen sc1 lds
    v_mfma_f32_16x16x32_bf16 a[76:79], a[192:195], a[236:239], a[76:79]
    ds_read_b128 a[212:215], v21 offset:50176
    v_mfma_f32_16x16x32_bf16 a[92:95], a[196:199], a[236:239], a[92:95]
    ds_read_b128 a[244:247], v13 offset:49152
    v_mfma_f32_16x16x32_bf16 a[88:91], a[196:199], a[232:235], a[88:91]
    s_add_u32 s57, s57, 1024
    ds_read_b128 a[216:219], v21 offset:53248
    v_mfma_f32_16x16x32_bf16 a[84:87], a[196:199], a[228:231], a[84:87]
    buffer_load_dwordx4 v7, s[16:19], s57 offen offset:1024 sc1 lds
    v_mfma_f32_16x16x32_bf16 a[80:83], a[196:199], a[224:227], a[80:83]
    ds_read_b128 a[248:251], v14 offset:49152
    v_mfma_f32_16x16x32_bf16 a[96:99], a[200:203], a[224:227], a[96:99]
    ds_read_b128 a[220:223], v21 offset:54272
    v_mfma_f32_16x16x32_bf16 a[100:103], a[200:203], a[228:231], a[100:103]
    s_add_u32 s61, s61, 4096
    ds_read_b128 a[252:255], v15 offset:49152
    v_mfma_f32_16x16x32_bf16 a[104:107], a[200:203], a[232:235], a[104:107]
    buffer_load_dwordx4 v7, s[16:19], s61 offen offset:2048 sc1 lds
    v_mfma_f32_16x16x32_bf16 a[108:111], a[200:203], a[236:239], a[108:111]
    v_mfma_f32_16x16x32_bf16 a[124:127], a[204:207], a[236:239], a[124:127]
    v_mfma_f32_16x16x32_bf16 a[120:123], a[204:207], a[232:235], a[120:123]
    v_mfma_f32_16x16x32_bf16 a[116:119], a[204:207], a[228:231], a[116:119]
    buffer_load_dwordx4 v7, s[16:19], s61 offen offset:3072 sc1 lds
    v_mfma_f32_16x16x32_bf16 a[112:115], a[204:207], a[224:227], a[112:115]
    s_waitcnt lgkmcnt(0)
    v_mfma_f32_16x16x32_bf16 a[64:67], a[208:211], a[240:243], a[64:67]
    ds_read_b128 a[192:195], v20 offset:0
    v_mfma_f32_16x16x32_bf16 a[68:71], a[208:211], a[244:247], a[68:71]
    s_add_u32 m0, s88, 81920
    s_add_u32 s56, s56, 1024
    ds_read_b128 a[224:227], v8 offset:0
    v_mfma_f32_16x16x32_bf16 a[72:75], a[208:211], a[248:251], a[72:75]
    buffer_load_dwordx4 v7, s[16:19], s56 offen sc1 lds
    v_mfma_f32_16x16x32_bf16 a[76:79], a[208:211], a[252:255], a[76:79]
    ds_read_b128 a[196:199], v20 offset:1024
    v_mfma_f32_16x16x32_bf16 a[92:95], a[212:215], a[252:255], a[92:95]
    ds_read_b128 a[228:231], v9 offset:0
    v_mfma_f32_16x16x32_bf16 a[88:91], a[212:215], a[248:251], a[88:91]
    s_add_u32 s57, s57, 1024
    ds_read_b128 a[200:203], v20 offset:4096
    v_mfma_f32_16x16x32_bf16 a[84:87], a[212:215], a[244:247], a[84:87]
    buffer_load_dwordx4 v7, s[16:19], s57 offen offset:1024 sc1 lds
    v_mfma_f32_16x16x32_bf16 a[80:83], a[212:215], a[240:243], a[80:83]
    ds_read_b128 a[232:235], v10 offset:0
    v_mfma_f32_16x16x32_bf16 a[96:99], a[216:219], a[240:243], a[96:99]
    ds_read_b128 a[204:207], v20 offset:5120
    v_mfma_f32_16x16x32_bf16 a[100:103], a[216:219], a[244:247], a[100:103]
    s_add_u32 s61, s61, 4096
    ds_read_b128 a[236:239], v11 offset:0
    v_mfma_f32_16x16x32_bf16 a[104:107], a[216:219], a[248:251], a[104:107]
    buffer_load_dwordx4 v7, s[16:19], s61 offen offset:2048 sc1 lds
    v_mfma_f32_16x16x32_bf16 a[108:111], a[216:219], a[252:255], a[108:111]
    v_mfma_f32_16x16x32_bf16 a[124:127], a[220:223], a[252:255], a[124:127]
    v_mfma_f32_16x16x32_bf16 a[120:123], a[220:223], a[248:251], a[120:123]
    v_mfma_f32_16x16x32_bf16 a[116:119], a[220:223], a[244:247], a[116:119]
    buffer_load_dwordx4 v7, s[16:19], s61 offen offset:3072 sc1 lds
    v_mfma_f32_16x16x32_bf16 a[112:115], a[220:223], a[240:243], a[112:115]
    s_waitcnt vmcnt(21) lgkmcnt(0)
    s_barrier
    v_mfma_f32_16x16x32_bf16 a[64:67], a[192:195], a[224:227], a[64:67]
    ds_read_b128 a[208:211], v20 offset:16384
    v_mfma_f32_16x16x32_bf16 a[68:71], a[192:195], a[228:231], a[68:71]
    s_add_u32 m0, s88, 98304
    s_add_u32 s56, s56, 1024
    ds_read_b128 a[240:243], v8 offset:16384
    v_mfma_f32_16x16x32_bf16 a[72:75], a[192:195], a[232:235], a[72:75]
    buffer_load_dwordx4 v7, s[16:19], s56 offen sc1 lds
    v_mfma_f32_16x16x32_bf16 a[76:79], a[192:195], a[236:239], a[76:79]
    ds_read_b128 a[212:215], v20 offset:17408
    v_mfma_f32_16x16x32_bf16 a[92:95], a[196:199], a[236:239], a[92:95]
    ds_read_b128 a[244:247], v9 offset:16384
    v_mfma_f32_16x16x32_bf16 a[88:91], a[196:199], a[232:235], a[88:91]
    s_add_u32 s57, s57, 1024
    ds_read_b128 a[216:219], v20 offset:20480
    v_mfma_f32_16x16x32_bf16 a[84:87], a[196:199], a[228:231], a[84:87]
    buffer_load_dwordx4 v7, s[16:19], s57 offen offset:1024 sc1 lds
    v_mfma_f32_16x16x32_bf16 a[80:83], a[196:199], a[224:227], a[80:83]
    ds_read_b128 a[248:251], v10 offset:16384
    v_mfma_f32_16x16x32_bf16 a[96:99], a[200:203], a[224:227], a[96:99]
    ds_read_b128 a[220:223], v20 offset:21504
    v_mfma_f32_16x16x32_bf16 a[100:103], a[200:203], a[228:231], a[100:103]
    s_add_u32 s61, s61, 4096
    ds_read_b128 a[252:255], v11 offset:16384
    v_mfma_f32_16x16x32_bf16 a[104:107], a[200:203], a[232:235], a[104:107]
    buffer_load_dwordx4 v7, s[16:19], s61 offen offset:2048 sc1 lds
    v_mfma_f32_16x16x32_bf16 a[108:111], a[200:203], a[236:239], a[108:111]
    v_mfma_f32_16x16x32_bf16 a[124:127], a[204:207], a[236:239], a[124:127]
    v_mfma_f32_16x16x32_bf16 a[120:123], a[204:207], a[232:235], a[120:123]
    v_mfma_f32_16x16x32_bf16 a[116:119], a[204:207], a[228:231], a[116:119]
    buffer_load_dwordx4 v7, s[16:19], s61 offen offset:3072 sc1 lds
    v_mfma_f32_16x16x32_bf16 a[112:115], a[204:207], a[224:227], a[112:115]
    s_waitcnt lgkmcnt(0)
    v_mfma_f32_16x16x32_bf16 a[64:67], a[208:211], a[240:243], a[64:67]
    ds_read_b128 a[192:195], v20 offset:32768
    v_mfma_f32_16x16x32_bf16 a[68:71], a[208:211], a[244:247], a[68:71]
    s_add_u32 m0, s88, 114688
    s_add_u32 s56, s56, 1024
    ds_read_b128 a[224:227], v8 offset:32768
    v_mfma_f32_16x16x32_bf16 a[72:75], a[208:211], a[248:251], a[72:75]
    buffer_load_dwordx4 v7, s[16:19], s56 offen sc1 lds
    v_mfma_f32_16x16x32_bf16 a[76:79], a[208:211], a[252:255], a[76:79]
    ds_read_b128 a[196:199], v20 offset:33792
    v_mfma_f32_16x16x32_bf16 a[92:95], a[212:215], a[252:255], a[92:95]
    ds_read_b128 a[228:231], v9 offset:32768
    v_mfma_f32_16x16x32_bf16 a[88:91], a[212:215], a[248:251], a[88:91]
    s_add_u32 s57, s57, 1024
    ds_read_b128 a[200:203], v20 offset:36864
    v_mfma_f32_16x16x32_bf16 a[84:87], a[212:215], a[244:247], a[84:87]
    buffer_load_dwordx4 v7, s[16:19], s57 offen offset:1024 sc1 lds
    v_mfma_f32_16x16x32_bf16 a[80:83], a[212:215], a[240:243], a[80:83]
    ds_read_b128 a[232:235], v10 offset:32768
    v_mfma_f32_16x16x32_bf16 a[96:99], a[216:219], a[240:243], a[96:99]
    ds_read_b128 a[204:207], v20 offset:37888
    v_mfma_f32_16x16x32_bf16 a[100:103], a[216:219], a[244:247], a[100:103]
    s_add_u32 s61, s61, 4096
    ds_read_b128 a[236:239], v11 offset:32768
    v_mfma_f32_16x16x32_bf16 a[104:107], a[216:219], a[248:251], a[104:107]
    buffer_load_dwordx4 v7, s[16:19], s61 offen offset:2048 sc1 lds
    v_mfma_f32_16x16x32_bf16 a[108:111], a[216:219], a[252:255], a[108:111]
    v_mfma_f32_16x16x32_bf16 a[124:127], a[220:223], a[252:255], a[124:127]
    v_mfma_f32_16x16x32_bf16 a[120:123], a[220:223], a[248:251], a[120:123]
    v_mfma_f32_16x16x32_bf16 a[116:119], a[220:223], a[244:247], a[116:119]
    buffer_load_dwordx4 v7, s[16:19], s61 offen offset:3072 sc1 lds
    v_mfma_f32_16x16x32_bf16 a[112:115], a[220:223], a[240:243], a[112:115]
    s_waitcnt vmcnt(21) lgkmcnt(0)
    s_barrier
    v_mfma_f32_16x16x32_bf16 a[64:67], a[192:195], a[224:227], a[64:67]
    ds_read_b128 a[208:211], v20 offset:49152
    v_mfma_f32_16x16x32_bf16 a[68:71], a[192:195], a[228:231], a[68:71]
    s_add_u32 m0, s88, 0
    s_add_u32 s56, s56, 1024
    ds_read_b128 a[240:243], v8 offset:49152
    v_mfma_f32_16x16x32_bf16 a[72:75], a[192:195], a[232:235], a[72:75]
    buffer_load_dwordx4 v7, s[16:19], s56 offen sc1 lds
    v_mfma_f32_16x16x32_bf16 a[76:79], a[192:195], a[236:239], a[76:79]
    ds_read_b128 a[212:215], v20 offset:50176
    v_mfma_f32_16x16x32_bf16 a[92:95], a[196:199], a[236:239], a[92:95]
    ds_read_b128 a[244:247], v9 offset:49152
    v_mfma_f32_16x16x32_bf16 a[88:91], a[196:199], a[232:235], a[88:91]
    s_add_u32 s57, s57, 1024
    ds_read_b128 a[216:219], v20 offset:53248
    v_mfma_f32_16x16x32_bf16 a[84:87], a[196:199], a[228:231], a[84:87]
    buffer_load_dwordx4 v7, s[16:19], s57 offen offset:1024 sc1 lds
    v_mfma_f32_16x16x32_bf16 a[80:83], a[196:199], a[224:227], a[80:83]
    ds_read_b128 a[248:251], v10 offset:49152
    v_mfma_f32_16x16x32_bf16 a[96:99], a[200:203], a[224:227], a[96:99]
    ds_read_b128 a[220:223], v20 offset:54272
    v_mfma_f32_16x16x32_bf16 a[100:103], a[200:203], a[228:231], a[100:103]
    s_add_u32 s61, s61, 4096
    ds_read_b128 a[252:255], v11 offset:49152
    v_mfma_f32_16x16x32_bf16 a[104:107], a[200:203], a[232:235], a[104:107]
    buffer_load_dwordx4 v7, s[16:19], s61 offen offset:2048 sc1 lds
    v_mfma_f32_16x16x32_bf16 a[108:111], a[200:203], a[236:239], a[108:111]
    v_mfma_f32_16x16x32_bf16 a[124:127], a[204:207], a[236:239], a[124:127]
    v_mfma_f32_16x16x32_bf16 a[120:123], a[204:207], a[232:235], a[120:123]
    v_mfma_f32_16x16x32_bf16 a[116:119], a[204:207], a[228:231], a[116:119]
    buffer_load_dwordx4 v7, s[16:19], s61 offen offset:3072 sc1 lds
    v_mfma_f32_16x16x32_bf16 a[112:115], a[204:207], a[224:227], a[112:115]
    s_waitcnt lgkmcnt(0)
    v_mfma_f32_16x16x32_bf16 a[64:67], a[208:211], a[240:243], a[64:67]
    ds_read_b128 a[192:195], v22 offset:0
    v_mfma_f32_16x16x32_bf16 a[68:71], a[208:211], a[244:247], a[68:71]
    s_add_u32 m0, s88, 16384
    s_add_u32 s56, s56, 1024
    ds_read_b128 a[224:227], v16 offset:0
    v_mfma_f32_16x16x32_bf16 a[72:75], a[208:211], a[248:251], a[72:75]
    buffer_load_dwordx4 v7, s[16:19], s56 offen sc1 lds
    v_mfma_f32_16x16x32_bf16 a[76:79], a[208:211], a[252:255], a[76:79]
    ds_read_b128 a[196:199], v22 offset:1024
    v_mfma_f32_16x16x32_bf16 a[92:95], a[212:215], a[252:255], a[92:95]
    ds_read_b128 a[228:231], v17 offset:0
    v_mfma_f32_16x16x32_bf16 a[88:91], a[212:215], a[248:251], a[88:91]
    s_add_u32 s57, s57, 1024
    ds_read_b128 a[200:203], v22 offset:4096
    v_mfma_f32_16x16x32_bf16 a[84:87], a[212:215], a[244:247], a[84:87]
    buffer_load_dwordx4 v7, s[16:19], s57 offen offset:1024 sc1 lds
    v_mfma_f32_16x16x32_bf16 a[80:83], a[212:215], a[240:243], a[80:83]
    ds_read_b128 a[232:235], v18 offset:0
    v_mfma_f32_16x16x32_bf16 a[96:99], a[216:219], a[240:243], a[96:99]
    ds_read_b128 a[204:207], v22 offset:5120
    v_mfma_f32_16x16x32_bf16 a[100:103], a[216:219], a[244:247], a[100:103]
    s_add_u32 s61, s61, 4096
    ds_read_b128 a[236:239], v19 offset:0
    v_mfma_f32_16x16x32_bf16 a[104:107], a[216:219], a[248:251], a[104:107]
    buffer_load_dwordx4 v7, s[16:19], s61 offen offset:2048 sc1 lds
    v_mfma_f32_16x16x32_bf16 a[108:111], a[216:219], a[252:255], a[108:111]
    v_mfma_f32_16x16x32_bf16 a[124:127], a[220:223], a[252:255], a[124:127]
    v_mfma_f32_16x16x32_bf16 a[120:123], a[220:223], a[248:251], a[120:123]
    v_mfma_f32_16x16x32_bf16 a[116:119], a[220:223], a[244:247], a[116:119]
    buffer_load_dwordx4 v7, s[16:19], s61 offen offset:3072 sc1 lds
    v_mfma_f32_16x16x32_bf16 a[112:115], a[220:223], a[240:243], a[112:115]
    s_waitcnt vmcnt(20) lgkmcnt(0)
    s_barrier
    v_mfma_f32_16x16x32_bf16 a[64:67], a[192:195], a[224:227], a[64:67]
    ds_read_b128 a[208:211], v22 offset:16384
    v_mfma_f32_16x16x32_bf16 a[68:71], a[192:195], a[228:231], a[68:71]
    s_add_u32 m0, s88, 32768
    s_add_u32 s56, s56, 1024
    ds_read_b128 a[240:243], v16 offset:16384
    v_mfma_f32_16x16x32_bf16 a[72:75], a[192:195], a[232:235], a[72:75]
    buffer_load_dwordx4 v7, s[16:19], s56 offen sc1 lds
    v_mfma_f32_16x16x32_bf16 a[76:79], a[192:195], a[236:239], a[76:79]
    ds_read_b128 a[212:215], v22 offset:17408
    v_mfma_f32_16x16x32_bf16 a[92:95], a[196:199], a[236:239], a[92:95]
    ds_read_b128 a[244:247], v17 offset:16384
    v_mfma_f32_16x16x32_bf16 a[88:91], a[196:199], a[232:235], a[88:91]
    s_add_u32 s57, s57, 1024
    ds_read_b128 a[216:219], v22 offset:20480
    v_mfma_f32_16x16x32_bf16 a[84:87], a[196:199], a[228:231], a[84:87]
    buffer_load_dwordx4 v7, s[16:19], s57 offen offset:1024 sc1 lds
    v_mfma_f32_16x16x32_bf16 a[80:83], a[196:199], a[224:227], a[80:83]
    ds_read_b128 a[248:251], v18 offset:16384
    v_mfma_f32_16x16x32_bf16 a[96:99], a[200:203], a[224:227], a[96:99]
    ds_read_b128 a[220:223], v22 offset:21504
    v_mfma_f32_16x16x32_bf16 a[100:103], a[200:203], a[228:231], a[100:103]
    s_add_u32 s61, s61, 4096
    ds_read_b128 a[252:255], v19 offset:16384
    v_mfma_f32_16x16x32_bf16 a[104:107], a[200:203], a[232:235], a[104:107]
    buffer_load_dwordx4 v7, s[16:19], s61 offen offset:2048 sc1 lds
    v_mfma_f32_16x16x32_bf16 a[108:111], a[200:203], a[236:239], a[108:111]
    v_mfma_f32_16x16x32_bf16 a[124:127], a[204:207], a[236:239], a[124:127]
    v_mfma_f32_16x16x32_bf16 a[120:123], a[204:207], a[232:235], a[120:123]
    v_mfma_f32_16x16x32_bf16 a[116:119], a[204:207], a[228:231], a[116:119]
    buffer_load_dwordx4 v7, s[16:19], s61 offen offset:3072 sc1 lds
    v_mfma_f32_16x16x32_bf16 a[112:115], a[204:207], a[224:227], a[112:115]
    buffer_load_dword v5, v4, s[40:43], 0 offen sc1
    s_waitcnt lgkmcnt(0)
    v_mfma_f32_16x16x32_bf16 a[64:67], a[208:211], a[240:243], a[64:67]
    ds_read_b128 a[192:195], v21 offset:0
    v_mfma_f32_16x16x32_bf16 a[68:71], a[208:211], a[244:247], a[68:71]
    s_add_u32 m0, s88, 49152
    s_add_u32 s56, s56, 1024
    ds_read_b128 a[224:227], v12 offset:0
    v_mfma_f32_16x16x32_bf16 a[72:75], a[208:211], a[248:251], a[72:75]
    buffer_load_dwordx4 v7, s[16:19], s56 offen sc1 lds
    v_mfma_f32_16x16x32_bf16 a[76:79], a[208:211], a[252:255], a[76:79]
    ds_read_b128 a[196:199], v21 offset:1024
    v_mfma_f32_16x16x32_bf16 a[92:95], a[212:215], a[252:255], a[92:95]
    ds_read_b128 a[228:231], v13 offset:0
    v_mfma_f32_16x16x32_bf16 a[88:91], a[212:215], a[248:251], a[88:91]
    s_add_u32 s57, s57, 1024
    ds_read_b128 a[200:203], v21 offset:4096
    v_mfma_f32_16x16x32_bf16 a[84:87], a[212:215], a[244:247], a[84:87]
    buffer_load_dwordx4 v7, s[16:19], s57 offen offset:1024 sc1 lds
    v_mfma_f32_16x16x32_bf16 a[80:83], a[212:215], a[240:243], a[80:83]
    ds_read_b128 a[232:235], v14 offset:0
    v_mfma_f32_16x16x32_bf16 a[96:99], a[216:219], a[240:243], a[96:99]
    ds_read_b128 a[204:207], v21 offset:5120
    v_mfma_f32_16x16x32_bf16 a[100:103], a[216:219], a[244:247], a[100:103]
    s_add_u32 s61, s61, 4096
    ds_read_b128 a[236:239], v15 offset:0
    v_mfma_f32_16x16x32_bf16 a[104:107], a[216:219], a[248:251], a[104:107]
    buffer_load_dwordx4 v7, s[16:19], s61 offen offset:2048 sc1 lds
    v_mfma_f32_16x16x32_bf16 a[108:111], a[216:219], a[252:255], a[108:111]
    v_mfma_f32_16x16x32_bf16 a[124:127], a[220:223], a[252:255], a[124:127]
    v_mfma_f32_16x16x32_bf16 a[120:123], a[220:223], a[248:251], a[120:123]
    v_mfma_f32_16x16x32_bf16 a[116:119], a[220:223], a[244:247], a[116:119]
    buffer_load_dwordx4 v7, s[16:19], s61 offen offset:3072 sc1 lds
    v_mfma_f32_16x16x32_bf16 a[112:115], a[220:223], a[240:243], a[112:115]
    s_waitcnt vmcnt(21) lgkmcnt(0)
    s_barrier
    v_mfma_f32_16x16x32_bf16 a[64:67], a[192:195], a[224:227], a[64:67]
    ds_read_b128 a[208:211], v21 offset:16384
    v_mfma_f32_16x16x32_bf16 a[68:71], a[192:195], a[228:231], a[68:71]
L_pad15:
    s_cbranch_execz L_warmret
    s_add_u32 m0, s88, 131072
    s_add_u32 s56, s56, 1024
    ds_read_b128 a[240:243], v12 offset:16384
    v_mfma_f32_16x16x32_bf16 a[72:75], a[192:195], a[232:235], a[72:75]
    buffer_load_dwordx4 v7, s[16:19], s56 offen sc1 lds
    v_mfma_f32_16x16x32_bf16 a[76:79], a[192:195], a[236:239], a[76:79]
    ds_read_b128 a[212:215], v21 offset:17408
    v_mfma_f32_16x16x32_bf16 a[92:95], a[196:199], a[236:239], a[92:95]
    ds_read_b128 a[244:247], v13 offset:16384
    v_mfma_f32_16x16x32_bf16 a[88:91], a[196:199], a[232:235], a[88:91]
    s_add_u32 s57, s57, 1024
    ds_read_b128 a[216:219], v21 offset:20480
    v_mfma_f32_16x16x32_bf16 a[84:87], a[196:199], a[228:231], a[84:87]
    buffer_load_dwordx4 v7, s[16:19], s57 offen offset:1024 sc1 lds
    v_mfma_f32_16x16x32_bf16 a[80:83], a[196:199], a[224:227], a[80:83]
    ds_read_b128 a[248:251], v14 offset:16384
    v_mfma_f32_16x16x32_bf16 a[96:99], a[200:203], a[224:227], a[96:99]
    ds_read_b128 a[220:223], v21 offset:21504
    v_mfma_f32_16x16x32_bf16 a[100:103], a[200:203], a[228:231], a[100:103]
    s_add_u32 s61, s61, 4096
    ds_read_b128 a[252:255], v15 offset:16384
    v_mfma_f32_16x16x32_bf16 a[104:107], a[200:203], a[232:235], a[104:107]
    buffer_load_dwordx4 v7, s[16:19], s61 offen offset:2048 sc1 lds
    v_mfma_f32_16x16x32_bf16 a[108:111], a[200:203], a[236:239], a[108:111]
    v_mfma_f32_16x16x32_bf16 a[124:127], a[204:207], a[236:239], a[124:127]
    v_mfma_f32_16x16x32_bf16 a[120:123], a[204:207], a[232:235], a[120:123]
    v_mfma_f32_16x16x32_bf16 a[116:119], a[204:207], a[228:231], a[116:119]
    buffer_load_dwordx4 v7, s[16:19], s61 offen offset:3072 sc1 lds
    v_mfma_f32_16x16x32_bf16 a[112:115], a[204:207], a[224:227], a[112:115]
    s_waitcnt lgkmcnt(0)
    v_mfma_f32_16x16x32_bf16 a[64:67], a[208:211], a[240:243], a[64:67]
    ds_read_b128 a[192:195], v21 offset:32768
    v_mfma_f32_16x16x32_bf16 a[68:71], a[208:211], a[244:247], a[68:71]
    s_add_u32 m0, s88, 147456
    s_add_u32 s56, s56, 1024
    ds_read_b128 a[224:227], v12 offset:32768
    v_mfma_f32_16x16x32_bf16 a[72:75], a[208:211], a[248:251], a[72:75]
    buffer_load_dwordx4 v7, s[16:19], s56 offen sc1 lds
    v_mfma_f32_16x16x32_bf16 a[76:79], a[208:211], a[252:255], a[76:79]
    ds_read_b128 a[196:199], v21 offset:33792
    v_mfma_f32_16x16x32_bf16 a[92:95], a[212:215], a[252:255], a[92:95]
    ds_read_b128 a[228:231], v13 offset:32768
    v_mfma_f32_16x16x32_bf16 a[88:91], a[212:215], a[248:251], a[88:91]
    s_add_u32 s57, s57, 1024
    ds_read_b128 a[200:203], v21 offset:36864
    v_mfma_f32_16x16x32_bf16 a[84:87], a[212:215], a[244:247], a[84:87]
    buffer_load_dwordx4 v7, s[16:19], s57 offen offset:1024 sc1 lds
    v_mfma_f32_16x16x32_bf16 a[80:83], a[212:215], a[240:243], a[80:83]
    ds_read_b128 a[232:235], v14 offset:32768
    v_mfma_f32_16x16x32_bf16 a[96:99], a[216:219], a[240:243], a[96:99]
    ds_read_b128 a[204:207], v21 offset:37888
    v_mfma_f32_16x16x32_bf16 a[100:103], a[216:219], a[244:247], a[100:103]
    s_add_u32 s61, s61, 4096
    ds_read_b128 a[236:239], v15 offset:32768
    v_mfma_f32_16x16x32_bf16 a[104:107], a[216:219], a[248:251], a[104:107]
    buffer_load_dwordx4 v7, s[16:19], s61 offen offset:2048 sc1 lds
    v_mfma_f32_16x16x32_bf16 a[108:111], a[216:219], a[252:255], a[108:111]
    v_mfma_f32_16x16x32_bf16 a[124:127], a[220:223], a[252:255], a[124:127]
    v_mfma_f32_16x16x32_bf16 a[120:123], a[220:223], a[248:251], a[120:123]
    v_mfma_f32_16x16x32_bf16 a[116:119], a[220:223], a[244:247], a[116:119]
    buffer_load_dwordx4 v7, s[16:19], s61 offen offset:3072 sc1 lds
    v_mfma_f32_16x16x32_bf16 a[112:115], a[220:223], a[240:243], a[112:115]
    s_waitcnt vmcnt(12)
    v_cmp_ne_u32 vcc, v5, v6
    s_cbranch_vccnz L_pf
L_pf_ok:
    s_waitcnt vmcnt(21) lgkmcnt(0)
    s_barrier
    v_mfma_f32_16x16x32_bf16 a[64:67], a[192:195], a[224:227], a[64:67]
    ds_read_b128 a[208:211], v21 offset:49152
    v_mfma_f32_16x16x32_bf16 a[68:71], a[192:195], a[228:231], a[68:71]
    ds_read_b128 a[240:243], v12 offset:49152
    buffer_load_dwordx4 v[32:35], v7, s[16:19], s92 offen offset:0 sc1
    v_mfma_f32_16x16x32_bf16 a[72:75], a[192:195], a[232:235], a[72:75]
    v_mfma_f32_16x16x32_bf16 a[76:79], a[192:195], a[236:239], a[76:79]
    ds_read_b128 a[212:215], v21 offset:50176
    buffer_load_dwordx4 v[36:39], v7, s[16:19], s92 offen offset:1024 sc1
    v_mfma_f32_16x16x32_bf16 a[92:95], a[196:199], a[236:239], a[92:95]
    ds_read_b128 a[244:247], v13 offset:49152
    v_mfma_f32_16x16x32_bf16 a[88:91], a[196:199], a[232:235], a[88:91]
    ds_read_b128 a[216:219], v21 offset:53248
    buffer_load_dwordx4 v[40:43], v7, s[16:19], s92 offen offset:2048 sc1
    v_mfma_f32_16x16x32_bf16 a[84:87], a[196:199], a[228:231], a[84:87]
    v_mfma_f32_16x16x32_bf16 a[80:83], a[196:199], a[224:227], a[80:83]
    ds_read_b128 a[248:251], v14 offset:49152
    buffer_load_dwordx4 v[44:47], v7, s[16:19], s92 offen offset:3072 sc1
    v_mfma_f32_16x16x32_bf16 a[96:99], a[200:203], a[224:227], a[96:99]
    ds_read_b128 a[220:223], v21 offset:54272
    v_mfma_f32_16x16x32_bf16 a[100:103], a[200:203], a[228:231], a[100:103]
    ds_read_b128 a[252:255], v15 offset:49152
    buffer_load_dwordx4 v[48:51], v7, s[16:19], s93 offen offset:0 sc1
    v_mfma_f32_16x16x32_bf16 a[104:107], a[200:203], a[232:235], a[104:107]
    v_mfma_f32_16x16x32_bf16 a[108:111], a[200:203], a[236:239], a[108:111]
    buffer_load_dwordx4 v[52:55], v7, s[16:19], s93 offen offset:1024 sc1
    v_mfma_f32_16x16x32_bf16 a[124:127], a[204:207], a[236:239], a[124:127]
    v_mfma_f32_16x16x32_bf16 a[120:123], a[204:207], a[232:235], a[120:123]
    v_mfma_f32_16x16x32_bf16 a[116:119], a[204:207], a[228:231], a[116:119]
    v_mfma_f32_16x16x32_bf16 a[112:115], a[204:207], a[224:227], a[112:115]
    s_waitcnt lgkmcnt(0)
    v_mfma_f32_16x16x32_bf16 a[64:67], a[208:211], a[240:243], a[64:67]
    ds_read_b128 a[192:195], v20 offset:0
    v_mfma_f32_16x16x32_bf16 a[68:71], a[208:211], a[244:247], a[68:71]
    ds_read_b128 a[224:227], v8 offset:0
    v_mfma_f32_16x16x32_bf16 a[72:75], a[208:211], a[248:251], a[72:75]
    v_mfma_f32_16x16x32_bf16 a[76:79], a[208:211], a[252:255], a[76:79]
    ds_read_b128 a[196:199], v20 offset:1024
    v_mfma_f32_16x16x32_bf16 a[92:95], a[212:215], a[252:255], a[92:95]
    ds_read_b128 a[228:231], v9 offset:0
    v_mfma_f32_16x16x32_bf16 a[88:91], a[212:215], a[248:251], a[88:91]
    ds_read_b128 a[200:203], v20 offset:4096
    v_mfma_f32_16x16x32_bf16 a[84:87], a[212:215], a[244:247], a[84:87]
    v_mfma_f32_16x16x32_bf16 a[80:83], a[212:215], a[240:243], a[80:83]
    ds_read_b128 a[232:235], v10 offset:0
    v_mfma_f32_16x16x32_bf16 a[96:99], a[216:219], a[240:243], a[96:99]
    ds_read_b128 a[204:207], v20 offset:5120
    v_mfma_f32_16x16x32_bf16 a[100:103], a[216:219], a[244:247], a[100:103]
    ds_read_b128 a[236:239], v11 offset:0
    v_mfma_f32_16x16x32_bf16 a[104:107], a[216:219], a[248:251], a[104:107]
    v_mfma_f32_16x16x32_bf16 a[108:111], a[216:219], a[252:255], a[108:111]
    v_mfma_f32_16x16x32_bf16 a[124:127], a[220:223], a[252:255], a[124:127]
    v_mfma_f32_16x16x32_bf16 a[120:123], a[220:223], a[248:251], a[120:123]
    v_mfma_f32_16x16x32_bf16 a[116:119], a[220:223], a[244:247], a[116:119]
    v_mfma_f32_16x16x32_bf16 a[112:115], a[220:223], a[240:243], a[112:115]
    s_waitcnt vmcnt(19) lgkmcnt(0)
    s_barrier
    v_mfma_f32_16x16x32_bf16 a[64:67], a[192:195], a[224:227], a[64:67]
    ds_read_b128 a[208:211], v20 offset:16384
    v_mfma_f32_16x16x32_bf16 a[68:71], a[192:195], a[228:231], a[68:71]
    ds_read_b128 a[240:243], v8 offset:16384
    v_mfma_f32_16x16x32_bf16 a[72:75], a[192:195], a[232:235], a[72:75]
    v_mfma_f32_16x16x32_bf16 a[76:79], a[192:195], a[236:239], a[76:79]
    ds_read_b128 a[212:215], v20 offset:17408
    v_mfma_f32_16x16x32_bf16 a[92:95], a[196:199], a[236:239], a[92:95]
    ds_read_b128 a[244:247], v9 offset:16384
    buffer_load_dwordx4 v[24:27], v23, s[20:23], s53 offen offset:0
    v_mfma_f32_16x16x32_bf16 a[88:91], a[196:199], a[232:235], a[88:91]
    ds_read_b128 a[216:219], v20 offset:20480
    v_mfma_f32_16x16x32_bf16 a[84:87], a[196:199], a[228:231], a[84:87]
    v_mfma_f32_16x16x32_bf16 a[80:83], a[196:199], a[224:227], a[80:83]
    ds_read_b128 a[248:251], v10 offset:16384
    v_mfma_f32_16x16x32_bf16 a[96:99], a[200:203], a[224:227], a[96:99]
    ds_read_b128 a[220:223], v20 offset:21504
    v_mfma_f32_16x16x32_bf16 a[100:103], a[200:203], a[228:231], a[100:103]
    ds_read_b128 a[252:255], v11 offset:16384
    v_mfma_f32_16x16x32_bf16 a[104:107], a[200:203], a[232:235], a[104:107]
    buffer_load_dwordx4 v[28:31], v23, s[20:23], s53 offen offset:16
    v_mfma_f32_16x16x32_bf16 a[108:111], a[200:203], a[236:239], a[108:111]
    v_mfma_f32_16x16x32_bf16 a[124:127], a[204:207], a[236:239], a[124:127]
    v_mfma_f32_16x16x32_bf16 a[120:123], a[204:207], a[232:235], a[120:123]
    v_mfma_f32_16x16x32_bf16 a[116:119], a[204:207], a[228:231], a[116:119]
    v_mfma_f32_16x16x32_bf16 a[112:115], a[204:207], a[224:227], a[112:115]
    s_waitcnt lgkmcnt(0)
    v_mfma_f32_16x16x32_bf16 a[64:67], a[208:211], a[240:243], a[64:67]
    ds_read_b128 a[192:195], v20 offset:32768
    v_mfma_f32_16x16x32_bf16 a[68:71], a[208:211], a[244:247], a[68:71]
    ds_read_b128 a[224:227], v8 offset:32768
    v_mfma_f32_16x16x32_bf16 a[72:75], a[208:211], a[248:251], a[72:75]
    v_mfma_f32_16x16x32_bf16 a[76:79], a[208:211], a[252:255], a[76:79]
    ds_read_b128 a[196:199], v20 offset:33792
    v_mfma_f32_16x16x32_bf16 a[92:95], a[212:215], a[252:255], a[92:95]
    s_add_u32 s40, s40, 512
    s_addc_u32 s41, s41, 0
    ds_read_b128 a[228:231], v9 offset:32768
    v_mfma_f32_16x16x32_bf16 a[88:91], a[212:215], a[248:251], a[88:91]
    ds_read_b128 a[200:203], v20 offset:36864
    v_mfma_f32_16x16x32_bf16 a[84:87], a[212:215], a[244:247], a[84:87]
    v_mfma_f32_16x16x32_bf16 a[80:83], a[212:215], a[240:243], a[80:83]
    ds_read_b128 a[232:235], v10 offset:32768
    v_mfma_f32_16x16x32_bf16 a[96:99], a[216:219], a[240:243], a[96:99]
    ds_read_b128 a[204:207], v20 offset:37888
    v_mfma_f32_16x16x32_bf16 a[100:103], a[216:219], a[244:247], a[100:103]
    ds_read_b128 a[236:239], v11 offset:32768
    v_mfma_f32_16x16x32_bf16 a[104:107], a[216:219], a[248:251], a[104:107]
    v_mfma_f32_16x16x32_bf16 a[108:111], a[216:219], a[252:255], a[108:111]
    v_mfma_f32_16x16x32_bf16 a[124:127], a[220:223], a[252:255], a[124:127]
    v_mfma_f32_16x16x32_bf16 a[120:123], a[220:223], a[248:251], a[120:123]
    v_mfma_f32_16x16x32_bf16 a[116:119], a[220:223], a[244:247], a[116:119]
    v_mfma_f32_16x16x32_bf16 a[112:115], a[220:223], a[240:243], a[112:115]
    s_waitcnt vmcnt(12) lgkmcnt(0)
    s_barrier
    v_mfma_f32_16x16x32_bf16 a[64:67], a[192:195], a[224:227], a[64:67]
    ds_read_b128 a[208:211], v20 offset:49152
    v_mfma_f32_16x16x32_bf16 a[68:71], a[192:195], a[228:231], a[68:71]
    ds_read_b128 a[240:243], v8 offset:49152
    v_mfma_f32_16x16x32_bf16 a[72:75], a[192:195], a[232:235], a[72:75]
    v_mfma_f32_16x16x32_bf16 a[76:79], a[192:195], a[236:239], a[76:79]
    ds_read_b128 a[212:215], v20 offset:50176
    v_mfma_f32_16x16x32_bf16 a[92:95], a[196:199], a[236:239], a[92:95]
    s_add_u32 s36, s36, 512
    s_addc_u32 s37, s37, 0
    ds_read_b128 a[244:247], v9 offset:49152
    v_mfma_f32_16x16x32_bf16 a[88:91], a[196:199], a[232:235], a[88:91]
    ds_read_b128 a[216:219], v20 offset:53248
    v_mfma_f32_16x16x32_bf16 a[84:87], a[196:199], a[228:231], a[84:87]
    v_mfma_f32_16x16x32_bf16 a[80:83], a[196:199], a[224:227], a[80:83]
    ds_read_b128 a[248:251], v10 offset:49152
    v_mfma_f32_16x16x32_bf16 a[96:99], a[200:203], a[224:227], a[96:99]
    ds_read_b128 a[220:223], v20 offset:54272
    v_mfma_f32_16x16x32_bf16 a[100:103], a[200:203], a[228:231], a[100:103]
    ds_read_b128 a[252:255], v11 offset:49152
    v_mfma_f32_16x16x32_bf16 a[104:107], a[200:203], a[232:235], a[104:107]
    v_mfma_f32_16x16x32_bf16 a[108:111], a[200:203], a[236:239], a[108:111]
    v_mfma_f32_16x16x32_bf16 a[124:127], a[204:207], a[236:239], a[124:127]
    v_mfma_f32_16x16x32_bf16 a[120:123], a[204:207], a[232:235], a[120:123]
    v_mfma_f32_16x16x32_bf16 a[116:119], a[204:207], a[228:231], a[116:119]
    v_mfma_f32_16x16x32_bf16 a[112:115], a[204:207], a[224:227], a[112:115]
    s_waitcnt vmcnt(2)
    s_waitcnt lgkmcnt(0)
    v_mfma_f32_16x16x32_bf16 a[128:131], v[82:85], v[32:35], a[128:131]
    v_mfma_f32_16x16x32_bf16 a[144:147], v[80:83], v[32:35], a[144:147]
    v_mfma_f32_16x16x32_bf16 a[160:163], v[82:85], v[36:39], a[160:163]
    v_mfma_f32_16x16x32_bf16 a[176:179], v[80:83], v[36:39], a[176:179]
    v_mfma_f32_16x16x32_bf16 a[128:131], v[82:85], v[40:43], a[128:131]
    v_mfma_f32_16x16x32_bf16 a[144:147], v[80:83], v[40:43], a[144:147]
    v_mfma_f32_16x16x32_bf16 a[160:163], v[82:85], v[44:47], a[160:163]
    v_mfma_f32_16x16x32_bf16 a[176:179], v[80:83], v[44:47], a[176:179]
    v_mfma_f32_16x16x32_bf16 a[128:131], v[82:85], v[48:51], a[128:131]
    v_mfma_f32_16x16x32_bf16 a[144:147], v[80:83], v[48:51], a[144:147]
    v_mfma_f32_16x16x32_bf16 a[160:163], v[82:85], v[52:55], a[160:163]
    v_mfma_f32_16x16x32_bf16 a[176:179], v[80:83], v[52:55], a[176:179]
    v_mfma_f32_16x16x32_bf16 a[64:67], a[208:211], a[240:243], a[64:67]
    ds_read_b128 a[192:195], v22 offset:0
    v_mfma_f32_16x16x32_bf16 a[68:71], a[208:211], a[244:247], a[68:71]
    ds_read_b128 a[224:227], v16 offset:0
    v_mfma_f32_16x16x32_bf16 a[72:75], a[208:211], a[248:251], a[72:75]
    v_mfma_f32_16x16x32_bf16 a[76:79], a[208:211], a[252:255], a[76:79]
    ds_read_b128 a[196:199], v22 offset:1024
    v_mfma_f32_16x16x32_bf16 a[92:95], a[212:215], a[252:255], a[92:95]
    ds_read_b128 a[228:231], v17 offset:0
    v_mfma_f32_16x16x32_bf16 a[88:91], a[212:215], a[248:251], a[88:91]
    ds_read_b128 a[200:203], v22 offset:4096
    v_mfma_f32_16x16x32_bf16 a[84:87], a[212:215], a[244:247], a[84:87]
    v_mfma_f32_16x16x32_bf16 a[80:83], a[212:215], a[240:243], a[80:83]
    ds_read_b128 a[232:235], v18 offset:0
    v_mfma_f32_16x16x32_bf16 a[96:99], a[216:219], a[240:243], a[96:99]
    ds_read_b128 a[204:207], v22 offset:5120
    v_mfma_f32_16x16x32_bf16 a[100:103], a[216:219], a[244:247], a[100:103]
    ds_read_b128 a[236:239], v19 offset:0
    v_mfma_f32_16x16x32_bf16 a[104:107], a[216:219], a[248:251], a[104:107]
    v_mfma_f32_16x16x32_bf16 a[108:111], a[216:219], a[252:255], a[108:111]
    v_mfma_f32_16x16x32_bf16 a[124:127], a[220:223], a[252:255], a[124:127]
    v_mfma_f32_16x16x32_bf16 a[120:123], a[220:223], a[248:251], a[120:123]
    v_mfma_f32_16x16x32_bf16 a[116:119], a[220:223], a[244:247], a[116:119]
    v_mfma_f32_16x16x32_bf16 a[112:115], a[220:223], a[240:243], a[112:115]
    s_waitcnt vmcnt(8) lgkmcnt(0)
    s_barrier
    v_mfma_f32_16x16x32_bf16 a[64:67], a[192:195], a[224:227], a[64:67]
    ds_read_b128 a[208:211], v22 offset:16384
    v_accvgpr_read_b32 v240, a128
    v_mfma_f32_16x16x32_bf16 a[68:71], a[192:195], a[228:231], a[68:71]
    ds_read_b128 a[240:243], v16 offset:16384
    v_accvgpr_read_b32 v241, a129
    v_mfma_f32_16x16x32_bf16 a[72:75], a[192:195], a[232:235], a[72:75]
    v_accvgpr_read_b32 v242, a130
    v_mfma_f32_16x16x32_bf16 a[76:79], a[192:195], a[236:239], a[76:79]
    ds_read_b128 a[212:215], v22 offset:17408
    v_accvgpr_read_b32 v243, a131
    v_mfma_f32_16x16x32_bf16 a[92:95], a[196:199], a[236:239], a[92:95]
    s_bfe_u32 s7, s2, 0x20001
    s_add_u32 s7, s7, 1
    s_and_b32 s7, s7, 3
    s_lshl_b32 s3, s54, 2
    s_add_u32 s3, s3, s7
    s_mul_i32 s3, s3, 12288
    s_add_u32 s56, s3, 35657728
    ds_read_b128 a[244:247], v17 offset:16384
    v_accvgpr_read_b32 v244, a144
    v_mfma_f32_16x16x32_bf16 a[88:91], a[196:199], a[232:235], a[88:91]
    ds_read_b128 a[216:219], v22 offset:20480
    v_accvgpr_read_b32 v245, a145
    v_mfma_f32_16x16x32_bf16 a[84:87], a[196:199], a[228:231], a[84:87]
    v_accvgpr_read_b32 v246, a146
    v_mfma_f32_16x16x32_bf16 a[80:83], a[196:199], a[224:227], a[80:83]
    ds_read_b128 a[248:251], v18 offset:16384
    v_accvgpr_read_b32 v247, a147
    v_mfma_f32_16x16x32_bf16 a[96:99], a[200:203], a[224:227], a[96:99]
    s_bfe_u32 s7, s2, 0x20001
    s_add_u32 s7, s7, 2
    s_and_b32 s7, s7, 3
    s_lshl_b32 s3, s54, 2
    s_add_u32 s3, s3, s7
    s_mul_i32 s3, s3, 12288
    s_add_u32 s57, s3, 35659776
    ds_read_b128 a[220:223], v22 offset:21504
    v_accvgpr_read_b32 v248, a160
    v_mfma_f32_16x16x32_bf16 a[100:103], a[200:203], a[228:231], a[100:103]
    ds_read_b128 a[252:255], v19 offset:16384
    v_accvgpr_read_b32 v249, a161
    v_mfma_f32_16x16x32_bf16 a[104:107], a[200:203], a[232:235], a[104:107]
    v_accvgpr_read_b32 v250, a162
    v_mfma_f32_16x16x32_bf16 a[108:111], a[200:203], a[236:239], a[108:111]
    v_accvgpr_read_b32 v251, a163
    v_mfma_f32_16x16x32_bf16 a[124:127], a[204:207], a[236:239], a[124:127]
    s_bfe_u32 s7, s2, 0x20001
    s_add_u32 s7, s7, 3
    s_and_b32 s7, s7, 3
    s_lshl_b32 s3, s54, 2
    s_add_u32 s3, s3, s7
    s_mul_i32 s3, s3, 12288
    s_add_u32 s58, s3, 35661824
    v_accvgpr_read_b32 v252, a176
    v_mfma_f32_16x16x32_bf16 a[120:123], a[204:207], a[232:235], a[120:123]
    v_accvgpr_read_b32 v253, a177
    v_mfma_f32_16x16x32_bf16 a[116:119], a[204:207], a[228:231], a[116:119]
    v_accvgpr_read_b32 v254, a178
    v_mfma_f32_16x16x32_bf16 a[112:115], a[204:207], a[224:227], a[112:115]
    v_accvgpr_read_b32 v255, a179
    s_waitcnt lgkmcnt(0)
    v_mfma_f32_16x16x32_bf16 a[68:71], a[208:211], a[244:247], a[68:71]
    v_mfma_f32_16x16x32_bf16 a[84:87], a[212:215], a[244:247], a[84:87]
    v_mfma_f32_16x16x32_bf16 a[100:103], a[216:219], a[244:247], a[100:103]
    v_mfma_f32_16x16x32_bf16 a[116:119], a[220:223], a[244:247], a[116:119]
    v_mfma_f32_16x16x32_bf16 a[72:75], a[208:211], a[248:251], a[72:75]
    v_mfma_f32_16x16x32_bf16 a[88:91], a[212:215], a[248:251], a[88:91]
    v_mfma_f32_16x16x32_bf16 a[104:107], a[216:219], a[248:251], a[104:107]
    v_mfma_f32_16x16x32_bf16 a[120:123], a[220:223], a[248:251], a[120:123]
    v_mfma_f32_16x16x32_bf16 a[76:79], a[208:211], a[252:255], a[76:79]
    v_mfma_f32_16x16x32_bf16 a[92:95], a[212:215], a[252:255], a[92:95]
    v_mfma_f32_16x16x32_bf16 a[108:111], a[216:219], a[252:255], a[108:111]
    v_mfma_f32_16x16x32_bf16 a[124:127], a[220:223], a[252:255], a[124:127]
    v_mfma_f32_16x16x32_bf16 a[64:67], a[208:211], a[240:243], a[64:67]
    v_mfma_f32_16x16x32_bf16 a[80:83], a[212:215], a[240:243], a[80:83]
    v_mfma_f32_16x16x32_bf16 a[96:99], a[216:219], a[240:243], a[96:99]
    v_mfma_f32_16x16x32_bf16 a[112:115], a[220:223], a[240:243], a[112:115]
    v_accvgpr_read_b32 v160, a68
    v_accvgpr_read_b32 v161, a69
    v_accvgpr_read_b32 v162, a70
    v_accvgpr_read_b32 v163, a71
    v_accvgpr_read_b32 v164, a84
    v_accvgpr_read_b32 v165, a85
    v_accvgpr_read_b32 v166, a86
    v_accvgpr_read_b32 v167, a87
    v_accvgpr_read_b32 v168, a100
    v_accvgpr_read_b32 v169, a101
    v_accvgpr_read_b32 v170, a102
    v_accvgpr_read_b32 v171, a103
    v_accvgpr_read_b32 v172, a116
    v_accvgpr_read_b32 v173, a117
    v_accvgpr_read_b32 v174, a118
    v_accvgpr_read_b32 v175, a119
    v_cvt_pk_bf16_f32 v176, v160, v161
    v_cvt_pk_bf16_f32 v177, v162, v163
    v_cvt_pk_bf16_f32 v178, v164, v165
    v_cvt_pk_bf16_f32 v179, v166, v167
    v_cvt_pk_bf16_f32 v180, v168, v169
    v_cvt_pk_bf16_f32 v181, v170, v171
    v_cvt_pk_bf16_f32 v182, v172, v173
    v_cvt_pk_bf16_f32 v183, v174, v175
    buffer_store_dwordx4 v[176:179], v7, s[16:19], s56 offen offset:0 sc1
    buffer_store_dwordx4 v[180:183], v7, s[16:19], s56 offen offset:1024 sc1
    v_accvgpr_read_b32 v160, a72
    v_accvgpr_read_b32 v161, a73
    v_accvgpr_read_b32 v162, a74
    v_accvgpr_read_b32 v163, a75
    v_accvgpr_read_b32 v164, a88
    v_accvgpr_read_b32 v165, a89
    v_accvgpr_read_b32 v166, a90
    v_accvgpr_read_b32 v167, a91
    v_accvgpr_read_b32 v168, a104
    v_accvgpr_read_b32 v169, a105
    v_accvgpr_read_b32 v170, a106
    v_accvgpr_read_b32 v171, a107
    v_accvgpr_read_b32 v172, a120
    v_accvgpr_read_b32 v173, a121
    v_accvgpr_read_b32 v174, a122
    v_accvgpr_read_b32 v175, a123
    v_cvt_pk_bf16_f32 v184, v160, v161
    v_cvt_pk_bf16_f32 v185, v162, v163
    v_cvt_pk_bf16_f32 v186, v164, v165
    v_cvt_pk_bf16_f32 v187, v166, v167
    v_cvt_pk_bf16_f32 v188, v168, v169
    v_cvt_pk_bf16_f32 v189, v170, v171
    v_cvt_pk_bf16_f32 v190, v172, v173
    v_cvt_pk_bf16_f32 v191, v174, v175
    buffer_store_dwordx4 v[184:187], v7, s[16:19], s57 offen offset:0 sc1
    buffer_store_dwordx4 v[188:191], v7, s[16:19], s57 offen offset:1024 sc1
    v_accvgpr_read_b32 v160, a76
    v_accvgpr_read_b32 v161, a77
    v_accvgpr_read_b32 v162, a78
    v_accvgpr_read_b32 v163, a79
    v_accvgpr_read_b32 v164, a92
    v_accvgpr_read_b32 v165, a93
    v_accvgpr_read_b32 v166, a94
    v_accvgpr_read_b32 v167, a95
    v_accvgpr_read_b32 v168, a108
    v_accvgpr_read_b32 v169, a109
    v_accvgpr_read_b32 v170, a110
    v_accvgpr_read_b32 v171, a111
    v_accvgpr_read_b32 v172, a124
    v_accvgpr_read_b32 v173, a125
    v_accvgpr_read_b32 v174, a126
    v_accvgpr_read_b32 v175, a127
    v_cvt_pk_bf16_f32 v192, v160, v161
    v_cvt_pk_bf16_f32 v193, v162, v163
    v_cvt_pk_bf16_f32 v194, v164, v165
    v_cvt_pk_bf16_f32 v195, v166, v167
    v_cvt_pk_bf16_f32 v196, v168, v169
    v_cvt_pk_bf16_f32 v197, v170, v171
    v_cvt_pk_bf16_f32 v198, v172, v173
    v_cvt_pk_bf16_f32 v199, v174, v175
    buffer_store_dwordx4 v[192:195], v7, s[16:19], s58 offen offset:0 sc1
    buffer_store_dwordx4 v[196:199], v7, s[16:19], s58 offen offset:1024 sc1
    s_waitcnt vmcnt(6)
    v_lshlrev_b32 v64, 16, v24
    v_and_b32 v65, 0xffff0000, v24
    v_lshlrev_b32 v66, 16, v25
    v_and_b32 v67, 0xffff0000, v25
    v_lshlrev_b32 v68, 16, v26
    v_and_b32 v69, 0xffff0000, v26
    v_lshlrev_b32 v70, 16, v27
    v_and_b32 v71, 0xffff0000, v27
    v_lshlrev_b32 v72, 16, v28
    v_and_b32 v73, 0xffff0000, v28
    v_lshlrev_b32 v74, 16, v29
    v_and_b32 v75, 0xffff0000, v29
    v_lshlrev_b32 v76, 16, v30
    v_and_b32 v77, 0xffff0000, v30
    v_lshlrev_b32 v78, 16, v31
    v_and_b32 v79, 0xffff0000, v31
    v_mul_f32 v144, 0xbfb8aa3b, v240
    v_mul_f32 v145, 0xbfb8aa3b, v241
    v_mul_f32 v146, 0xbfb8aa3b, v242
    v_mul_f32 v147, 0xbfb8aa3b, v243
    v_mul_f32 v148, 0xbfb8aa3b, v244
    v_mul_f32 v149, 0xbfb8aa3b, v245
    v_mul_f32 v150, 0xbfb8aa3b, v246
    v_mul_f32 v151, 0xbfb8aa3b, v247
    v_mul_f32 v152, 0xbfb8aa3b, v248
    v_mul_f32 v153, 0xbfb8aa3b, v249
    v_mul_f32 v154, 0xbfb8aa3b, v250
    v_mul_f32 v155, 0xbfb8aa3b, v251
    v_mul_f32 v156, 0xbfb8aa3b, v252
    v_mul_f32 v157, 0xbfb8aa3b, v253
    v_mul_f32 v158, 0xbfb8aa3b, v254
    v_mul_f32 v159, 0xbfb8aa3b, v255
    v_exp_f32 v144, v144
    v_exp_f32 v145, v145
    v_exp_f32 v146, v146
    v_exp_f32 v147, v147
    v_exp_f32 v148, v148
    v_exp_f32 v149, v149
    v_exp_f32 v150, v150
    v_exp_f32 v151, v151
    v_exp_f32 v152, v152
    v_exp_f32 v153, v153
    v_exp_f32 v154, v154
    v_exp_f32 v155, v155
    v_exp_f32 v156, v156
    v_exp_f32 v157, v157
    v_exp_f32 v158, v158
    v_exp_f32 v159, v159
    v_add_f32 v112, 1.0, v144
    v_add_f32 v113, 1.0, v145
    v_add_f32 v114, 1.0, v146
    v_add_f32 v115, 1.0, v147
    v_add_f32 v116, 1.0, v148
    v_add_f32 v117, 1.0, v149
    v_add_f32 v118, 1.0, v150
    v_add_f32 v119, 1.0, v151
    v_add_f32 v120, 1.0, v152
    v_add_f32 v121, 1.0, v153
    v_add_f32 v122, 1.0, v154
    v_add_f32 v123, 1.0, v155
    v_add_f32 v124, 1.0, v156
    v_add_f32 v125, 1.0, v157
    v_add_f32 v126, 1.0, v158
    v_add_f32 v127, 1.0, v159
    v_rcp_f32 v112, v112
    v_rcp_f32 v113, v113
    v_rcp_f32 v114, v114
    v_rcp_f32 v115, v115
    v_rcp_f32 v116, v116
    v_rcp_f32 v117, v117
    v_rcp_f32 v118, v118
    v_rcp_f32 v119, v119
    v_rcp_f32 v120, v120
    v_rcp_f32 v121, v121
    v_rcp_f32 v122, v122
    v_rcp_f32 v123, v123
    v_rcp_f32 v124, v124
    v_rcp_f32 v125, v125
    v_rcp_f32 v126, v126
    v_rcp_f32 v127, v127
    v_pk_mul_f32 v[240:241], v[240:241], v[112:113]
    v_pk_mul_f32 v[242:243], v[242:243], v[114:115]
    v_pk_mul_f32 v[244:245], v[244:245], v[116:117]
    v_pk_mul_f32 v[246:247], v[246:247], v[118:119]
    v_pk_mul_f32 v[248:249], v[248:249], v[120:121]
    v_pk_mul_f32 v[250:251], v[250:251], v[122:123]
    v_pk_mul_f32 v[252:253], v[252:253], v[124:125]
    v_pk_mul_f32 v[254:255], v[254:255], v[126:127]
    s_waitcnt vmcnt(0)
    buffer_store_dword v223, v7, s[36:39], 0 offen sc1
    buffer_load_dword v5, v4, s[40:43], 0 offen sc1
    s_waitcnt vmcnt(0)
    v_cmp_ne_u32 vcc, v5, v6
    s_cbranch_vccnz L_ps
L_ps_ok:
    buffer_load_dwordx4 v[32:35], v7, s[16:19], s93 offen offset:2048 sc1
    buffer_load_dwordx4 v[36:39], v7, s[16:19], s93 offen offset:3072 sc1
    buffer_load_dwordx4 v[40:43], v7, s[16:19], s62 offen offset:0 sc1
    buffer_load_dwordx4 v[44:47], v7, s[16:19], s62 offen offset:1024 sc1
    buffer_load_dwordx4 v[48:51], v7, s[16:19], s62 offen offset:2048 sc1
    buffer_load_dwordx4 v[52:55], v7, s[16:19], s62 offen offset:3072 sc1
    s_waitcnt vmcnt(4)
    v_mfma_f32_16x16x32_bf16 a[64:67], v[82:85], v[32:35], a[64:67]
    v_mfma_f32_16x16x32_bf16 a[80:83], v[80:83], v[32:35], a[80:83]
    v_mfma_f32_16x16x32_bf16 a[96:99], v[82:85], v[36:39], a[96:99]
    v_mfma_f32_16x16x32_bf16 a[112:115], v[80:83], v[36:39], a[112:115]
    s_waitcnt vmcnt(2)
    v_mfma_f32_16x16x32_bf16 a[64:67], v[82:85], v[40:43], a[64:67]
    v_mfma_f32_16x16x32_bf16 a[80:83], v[80:83], v[40:43], a[80:83]
    v_mfma_f32_16x16x32_bf16 a[96:99], v[82:85], v[44:47], a[96:99]
    v_mfma_f32_16x16x32_bf16 a[112:115], v[80:83], v[44:47], a[112:115]
    s_waitcnt vmcnt(0)
    v_mfma_f32_16x16x32_bf16 a[64:67], v[82:85], v[48:51], a[64:67]
    v_mfma_f32_16x16x32_bf16 a[80:83], v[80:83], v[48:51], a[80:83]
    v_mfma_f32_16x16x32_bf16 a[96:99], v[82:85], v[52:55], a[96:99]
    v_mfma_f32_16x16x32_bf16 a[112:115], v[80:83], v[52:55], a[112:115]
    s_nop 4
    v_accvgpr_read_b32 v224, a64
    v_accvgpr_read_b32 v225, a65
    v_accvgpr_read_b32 v226, a66
    v_accvgpr_read_b32 v227, a67
    v_accvgpr_read_b32 v228, a80
    v_accvgpr_read_b32 v229, a81
    v_accvgpr_read_b32 v230, a82
    v_accvgpr_read_b32 v231, a83
    v_accvgpr_read_b32 v232, a96
    v_accvgpr_read_b32 v233, a97
    v_accvgpr_read_b32 v234, a98
    v_accvgpr_read_b32 v235, a99
    v_accvgpr_read_b32 v236, a112
    v_accvgpr_read_b32 v237, a113
    v_accvgpr_read_b32 v238, a114
    v_accvgpr_read_b32 v239, a115
    v_pk_fma_f32 v[224:225], v[224:225], v[240:241], v[64:65]
    v_pk_fma_f32 v[226:227], v[226:227], v[242:243], v[66:67]
    v_pk_fma_f32 v[228:229], v[228:229], v[244:245], v[68:69]
    v_pk_fma_f32 v[230:231], v[230:231], v[246:247], v[70:71]
    v_pk_fma_f32 v[232:233], v[232:233], v[248:249], v[72:73]
    v_pk_fma_f32 v[234:235], v[234:235], v[250:251], v[74:75]
    v_pk_fma_f32 v[236:237], v[236:237], v[252:253], v[76:77]
    v_pk_fma_f32 v[238:239], v[238:239], v[254:255], v[78:79]
    v_cvt_pk_bf16_f32 v24, v224, v225
    v_cvt_pk_bf16_f32 v25, v226, v227
    v_cvt_pk_bf16_f32 v26, v228, v229
    v_cvt_pk_bf16_f32 v27, v230, v231
    v_cvt_pk_bf16_f32 v28, v232, v233
    v_cvt_pk_bf16_f32 v29, v234, v235
    v_cvt_pk_bf16_f32 v30, v236, v237
    v_cvt_pk_bf16_f32 v31, v238, v239
    buffer_store_dwordx4 v[24:27], v23, s[44:47], s53 offen offset:0
    buffer_store_dwordx4 v[28:31], v23, s[44:47], s53 offen offset:16
L_end:
    s_endpgm
L_cnt:
    buffer_atomic_add v223, v7, s[32:35], 0 offen sc1
    s_branch L_cnt_ok
L_pollall:
    s_mov_b32 s63, 0x20000
L_pollall_l:
    s_sub_u32 s63, s63, 1
    s_cbranch_scc1 L_pollall_ok
    s_sleep 8
    buffer_load_dword v6, off, s[48:51], 0 sc1
    s_waitcnt vmcnt(0)
    v_cmp_gt_u32 vcc, 0x100, v6
    s_cbranch_vccnz L_pollall_l
    s_branch L_pollall_ok
L_po:
    s_mov_b32 s63, 0x20000
L_po_l:
    s_sub_u32 s63, s63, 1
    s_cbranch_scc1 L_po_ok
    s_sleep 8
    buffer_load_dword v5, v4, s[28:31], 0 offen sc1
    s_waitcnt vmcnt(0)
    v_cmp_ne_u32 vcc, v5, v6
    s_cbranch_vccnz L_po_l
    s_branch L_po_ok
L_pf:
    s_mov_b32 s63, 0x20000
L_pf_l:
    s_sub_u32 s63, s63, 1
    s_cbranch_scc1 L_pf_ok
    s_sleep 8
    buffer_load_dword v5, v4, s[40:43], 0 offen sc1
    s_waitcnt vmcnt(0)
    v_cmp_ne_u32 vcc, v5, v6
    s_cbranch_vccnz L_pf_l
    s_branch L_pf_ok
L_ps:
    s_mov_b32 s63, 0x20000
L_ps_l:
    s_sub_u32 s63, s63, 1
    s_cbranch_scc1 L_ps_ok
    s_sleep 2
    buffer_load_dword v5, v4, s[40:43], 0 offen sc1
    s_waitcnt vmcnt(0)
    v_cmp_ne_u32 vcc, v5, v6
    s_cbranch_vccnz L_ps_l
    s_branch L_ps_ok
L_slow0_f0:
    s_call_b64 s[98:99], L_slowfn0_0_0
    s_branch L_back0_f0
L_slow1_f0:
    s_call_b64 s[98:99], L_slowfn1_0_0
    s_branch L_back1_f0
L_slow0_f1:
    s_call_b64 s[98:99], L_slowfn0_1_0
    s_branch L_back0_f1
L_slow1_f1:
    s_call_b64 s[98:99], L_slowfn1_1_0
    s_branch L_back1_f1
L_slow0_f2:
    s_call_b64 s[98:99], L_slowfn0_0_0
    s_branch L_back0_f2
L_slow1_f2:
    s_call_b64 s[98:99], L_slowfn1_0_0
    s_branch L_back1_f2
L_slow0_f3:
    s_call_b64 s[98:99], L_slowfn0_1_0
    s_branch L_back0_f3
L_slow1_f3:
    s_call_b64 s[98:99], L_slowfn1_1_0
    s_branch L_back1_f3
L_slow0_f4:
    s_call_b64 s[98:99], L_slowfn0_0_0
    s_branch L_back0_f4
L_slow1_f4:
    s_call_b64 s[98:99], L_slowfn1_0_0
    s_branch L_back1_f4
L_slow0_f5:
    s_call_b64 s[98:99], L_slowfn0_1_0
    s_branch L_back0_f5
L_slow1_f5:
    s_call_b64 s[98:99], L_slowfn1_1_0
    s_branch L_back1_f5
L_slow0_f6:
    s_call_b64 s[98:99], L_slowfn0_0_0
    s_branch L_back0_f6
L_slow1_f6:
    s_call_b64 s[98:99], L_slowfn1_0_0
    s_branch L_back1_f6
L_slow0_f7:
    s_call_b64 s[98:99], L_slowfn0_1_0
    s_branch L_back0_f7
L_slow1_f7:
    s_call_b64 s[98:99], L_slowfn1_1_0
    s_branch L_back1_f7
L_slow0_f8:
    s_call_b64 s[98:99], L_slowfn0_0_0
    s_branch L_back0_f8
L_slow1_f8:
    s_call_b64 s[98:99], L_slowfn1_0_0
    s_branch L_back1_f8
L_slow0_f9:
    s_call_b64 s[98:99], L_slowfn0_1_0
    s_branch L_back0_f9
L_slow1_f9:
    s_call_b64 s[98:99], L_slowfn1_1_0
    s_branch L_back1_f9
L_slow0_f10:
    s_call_b64 s[98:99], L_slowfn0_0_0
    s_branch L_back0_f10
L_slow1_f10:
    s_call_b64 s[98:99], L_slowfn1_0_0
    s_branch L_back1_f10
L_slow0_f11:
    s_call_b64 s[98:99], L_slowfn0_1_0
    s_branch L_back0_f11
L_slow1_f11:
    s_call_b64 s[98:99], L_slowfn1_1_0
    s_branch L_back1_f11
L_slow0_f12:
    s_call_b64 s[98:99], L_slowfn0_0_0
    s_branch L_back0_f12
L_slow1_f12:
    s_call_b64 s[98:99], L_slowfn1_0_0
    s_branch L_back1_f12
L_slow0_f13:
    s_call_b64 s[98:99], L_slowfn0_1_0
    s_branch L_back0_f13
L_slow1_f13:
    s_call_b64 s[98:99], L_slowfn1_1_0
    s_branch L_back1_f13
L_slow0_f14:
    s_call_b64 s[98:99], L_slowfn0_0_0
    s_branch L_back0_f14
L_slow1_f14:
    s_call_b64 s[98:99], L_slowfn1_0_0
    s_branch L_back1_f14
L_slow0_f15:
    s_call_b64 s[98:99], L_slowfn0_1_0
    s_branch L_back0_f15
L_slow1_f15:
    s_call_b64 s[98:99], L_slowfn1_1_0
    s_branch L_back1_f15
L_slow0_s0:
    s_call_b64 s[98:99], L_slowfn0_0_0
    s_branch L_back0_s0
L_slow1_s0:
    s_call_b64 s[98:99], L_slowfn1_0_0
    s_branch L_back1_s0
L_slow0_s1:
    s_call_b64 s[98:99], L_slowfn0_1_0
    s_branch L_back0_s1
L_slow1_s1:
    s_call_b64 s[98:99], L_slowfn1_1_0
    s_branch L_back1_s1
L_slow0_s2:
    s_call_b64 s[98:99], L_slowfn0_0_0
    s_branch L_back0_s2
L_slow1_s2:
    s_call_b64 s[98:99], L_slowfn1_0_0
    s_branch L_back1_s2
L_slow0_s3:
    s_call_b64 s[98:99], L_slowfn0_1_0
    s_branch L_back0_s3
L_slow1_s3:
    s_call_b64 s[98:99], L_slowfn1_1_0
    s_branch L_back1_s3
L_slow0_s4:
    s_call_b64 s[98:99], L_slowfn0_0_0
    s_branch L_back0_s4
L_slow1_s4:
    s_call_b64 s[98:99], L_slowfn1_0_0
    s_branch L_back1_s4
L_slow0_s5:
    s_call_b64 s[98:99], L_slowfn0_1_0
    s_branch L_back0_s5
L_slow1_s5:
    s_call_b64 s[98:99], L_slowfn1_1_0
    s_branch L_back1_s5
L_slow0_s6:
    s_call_b64 s[98:99], L_slowfn0_0_0
    s_branch L_back0_s6
L_slow1_s6:
    s_call_b64 s[98:99], L_slowfn1_0_0
    s_branch L_back1_s6
L_slow0_s7:
    s_call_b64 s[98:99], L_slowfn0_1_0
    s_branch L_back0_s7
L_slow1_s7:
    s_call_b64 s[98:99], L_slowfn1_1_0
    s_branch L_back1_s7
L_slow0_t0:
    s_call_b64 s[98:99], L_slowfn0_0_0
    s_branch L_back0_t0
L_slow1_t0:
    s_call_b64 s[98:99], L_slowfn1_0_0
    s_branch L_back1_t0
L_slow0_t1:
    s_call_b64 s[98:99], L_slowfn0_1_0
    s_branch L_back0_t1
L_slow1_t1:
    s_call_b64 s[98:99], L_slowfn1_1_0
    s_branch L_back1_t1
L_slow0_t2:
    s_call_b64 s[98:99], L_slowfn0_0_0
    s_branch L_back0_t2
L_slow1_t2:
    s_call_b64 s[98:99], L_slowfn1_0_0
    s_branch L_back1_t2
L_slow0_t3:
    s_call_b64 s[98:99], L_slowfn0_1_0
    s_branch L_back0_t3
L_slow1_t3:
    s_call_b64 s[98:99], L_slowfn1_1_0
    s_branch L_back1_t3
L_slow0_t4:
    s_call_b64 s[98:99], L_slowfn0_0_0
    s_branch L_back0_t4
L_slow1_t4:
    s_call_b64 s[98:99], L_slowfn1_0_0
    s_branch L_back1_t4
L_slow0_t5:
    s_call_b64 s[98:99], L_slowfn0_1_0
    s_branch L_back0_t5
L_slow1_t5:
    s_call_b64 s[98:99], L_slowfn1_1_0
    s_branch L_back1_t5
L_slow0_t6:
    s_call_b64 s[98:99], L_slowfn0_0_0
    s_branch L_back0_t6
L_slow1_t6:
    s_call_b64 s[98:99], L_slowfn1_0_0
    s_branch L_back1_t6
L_slow0_t7:
    s_call_b64 s[98:99], L_slowfn0_1_1
    s_branch L_back0_t7
L_slow1_t7:
    s_call_b64 s[98:99], L_slowfn1_1_1
    s_branch L_back1_t7
L_slowfn0_0_0:
    s_nop 15
    v_mov_b32 v220, v233
    v_mov_b32 v221, v233
    s_nop 1
    v_permlane16_swap_b32 v220, v221
    v_add_f32 v220, v220, v221
    v_max3_f32 v216, v112, v113, v114
    v_max3_f32 v216, v216, v115, v116
    v_max3_f32 v216, v216, v117, v118
    v_max_f32 v216, v216, v119
    v_mov_b32 v213, v216
    s_nop 1
    v_permlane32_swap_b32 v216, v213
    v_max_f32 v216, v216, v213
    v_mov_b32 v213, v216
    s_nop 1
    v_permlane16_swap_b32 v216, v213
    v_max_f32 v216, v216, v213
    v_max_f32 v216, 0, v216
    v_mov_b32 v212, v220
    v_mov_b32 v213, v220
    s_nop 1
    v_permlane32_swap_b32 v212, v213
    v_log_f32 v212, v212
    s_nop 0
    v_max_f32 v216, v216, v212
    v_sub_f32 v218, 0, v216
    v_exp_f32 v218, v218
    v_sub_f32 v112, v112, v216
    v_sub_f32 v113, v113, v216
    v_sub_f32 v114, v114, v216
    v_sub_f32 v115, v115, v216
    v_sub_f32 v116, v116, v216
    v_sub_f32 v117, v117, v216
    v_sub_f32 v118, v118, v216
    v_sub_f32 v119, v119, v216
    v_sub_f32 v144, v144, v216
    v_sub_f32 v145, v145, v216
    v_sub_f32 v146, v146, v216
    v_sub_f32 v147, v147, v216
    v_sub_f32 v148, v148, v216
    v_sub_f32 v149, v149, v216
    v_sub_f32 v150, v150, v216
    v_sub_f32 v151, v151, v216
    v_sub_f32 v168, v168, v216
    v_sub_f32 v169, v169, v216
    v_sub_f32 v170, v170, v216
    v_sub_f32 v171, v171, v216
    v_accvgpr_read_b32 v214, a64
    v_mul_f32 v214, v214, v218
    v_accvgpr_write_b32 a64, v214
    v_accvgpr_read_b32 v214, a65
    v_mul_f32 v214, v214, v218
    v_accvgpr_write_b32 a65, v214
    v_accvgpr_read_b32 v214, a66
    v_mul_f32 v214, v214, v218
    v_accvgpr_write_b32 a66, v214
    v_accvgpr_read_b32 v214, a67
    v_mul_f32 v214, v214, v218
    v_accvgpr_write_b32 a67, v214
    v_accvgpr_read_b32 v214, a68
    v_mul_f32 v214, v214, v218
    v_accvgpr_write_b32 a68, v214
    v_accvgpr_read_b32 v214, a69
    v_mul_f32 v214, v214, v218
    v_accvgpr_write_b32 a69, v214
    v_accvgpr_read_b32 v214, a70
    v_mul_f32 v214, v214, v218
    v_accvgpr_write_b32 a70, v214
    v_accvgpr_read_b32 v214, a71
    v_mul_f32 v214, v214, v218
    v_accvgpr_write_b32 a71, v214
    v_accvgpr_read_b32 v214, a72
    v_mul_f32 v214, v214, v218
    v_accvgpr_write_b32 a72, v214
    v_accvgpr_read_b32 v214, a73
    v_mul_f32 v214, v214, v218
    v_accvgpr_write_b32 a73, v214
    v_accvgpr_read_b32 v214, a74
    v_mul_f32 v214, v214, v218
    v_accvgpr_write_b32 a74, v214
    v_accvgpr_read_b32 v214, a75
    v_mul_f32 v214, v214, v218
    v_accvgpr_write_b32 a75, v214
    v_accvgpr_read_b32 v214, a76
    v_mul_f32 v214, v214, v218
    v_accvgpr_write_b32 a76, v214
    v_accvgpr_read_b32 v214, a77
    v_mul_f32 v214, v214, v218
    v_accvgpr_write_b32 a77, v214
    v_accvgpr_read_b32 v214, a78
    v_mul_f32 v214, v214, v218
    v_accvgpr_write_b32 a78, v214
    v_accvgpr_read_b32 v214, a79
    v_mul_f32 v214, v214, v218
    v_accvgpr_write_b32 a79, v214
    v_accvgpr_read_b32 v214, a80
    v_mul_f32 v214, v214, v218
    v_accvgpr_write_b32 a80, v214
    v_accvgpr_read_b32 v214, a81
    v_mul_f32 v214, v214, v218
    v_accvgpr_write_b32 a81, v214
    v_accvgpr_read_b32 v214, a82
    v_mul_f32 v214, v214, v218
    v_accvgpr_write_b32 a82, v214
    v_accvgpr_read_b32 v214, a83
    v_mul_f32 v214, v214, v218
    v_accvgpr_write_b32 a83, v214
    v_accvgpr_read_b32 v214, a84
    v_mul_f32 v214, v214, v218
    v_accvgpr_write_b32 a84, v214
    v_accvgpr_read_b32 v214, a85
    v_mul_f32 v214, v214, v218
    v_accvgpr_write_b32 a85, v214
    v_accvgpr_read_b32 v214, a86
    v_mul_f32 v214, v214, v218
    v_accvgpr_write_b32 a86, v214
    v_accvgpr_read_b32 v214, a87
    v_mul_f32 v214, v214, v218
    v_accvgpr_write_b32 a87, v214
    v_accvgpr_read_b32 v214, a88
    v_mul_f32 v214, v214, v218
    v_accvgpr_write_b32 a88, v214
    v_accvgpr_read_b32 v214, a89
    v_mul_f32 v214, v214, v218
    v_accvgpr_write_b32 a89, v214
    v_accvgpr_read_b32 v214, a90
    v_mul_f32 v214, v214, v218
    v_accvgpr_write_b32 a90, v214
    v_accvgpr_read_b32 v214, a91
    v_mul_f32 v214, v214, v218
    v_accvgpr_write_b32 a91, v214
    v_accvgpr_read_b32 v214, a92
    v_mul_f32 v214, v214, v218
    v_accvgpr_write_b32 a92, v214
    v_accvgpr_read_b32 v214, a93
    v_mul_f32 v214, v214, v218
    v_accvgpr_write_b32 a93, v214
    v_accvgpr_read_b32 v214, a94
    v_mul_f32 v214, v214, v218
    v_accvgpr_write_b32 a94, v214
    v_accvgpr_read_b32 v214, a95
    v_mul_f32 v214, v214, v218
    v_accvgpr_write_b32 a95, v214
    v_exp_f32 v214, v112
    v_exp_f32 v215, v113
    s_nop 0
    v_cvt_pk_bf16_f32 v192, v214, v215
    v_exp_f32 v214, v114
    v_exp_f32 v215, v115
    s_nop 0
    v_cvt_pk_bf16_f32 v193, v214, v215
    v_exp_f32 v214, v116
    v_exp_f32 v215, v117
    s_nop 0
    v_cvt_pk_bf16_f32 v194, v214, v215
    v_exp_f32 v214, v118
    v_exp_f32 v215, v119
    s_nop 0
    v_cvt_pk_bf16_f32 v195, v214, v215
    v_lshlrev_b32 v214, 16, v200
    v_and_b32 v215, 0xffff0000, v200
    v_mul_f32 v214, v214, v218
    v_mul_f32 v215, v215, v218
    v_cvt_pk_bf16_f32 v200, v214, v215
    v_lshlrev_b32 v214, 16, v201
    v_and_b32 v215, 0xffff0000, v201
    v_mul_f32 v214, v214, v218
    v_mul_f32 v215, v215, v218
    v_cvt_pk_bf16_f32 v201, v214, v215
    v_lshlrev_b32 v214, 16, v202
    v_and_b32 v215, 0xffff0000, v202
    v_mul_f32 v214, v214, v218
    v_mul_f32 v215, v215, v218
    v_cvt_pk_bf16_f32 v202, v214, v215
    v_lshlrev_b32 v214, 16, v203
    v_and_b32 v215, 0xffff0000, v203
    v_mul_f32 v214, v214, v218
    v_mul_f32 v215, v215, v218
    v_cvt_pk_bf16_f32 v203, v214, v215
    v_max3_f32 v217, v120, v121, v122
    v_max3_f32 v217, v217, v123, v124
    v_max3_f32 v217, v217, v125, v126
    v_max_f32 v217, v217, v127
    v_mov_b32 v213, v217
    s_nop 1
    v_permlane32_swap_b32 v217, v213
    v_max_f32 v217, v217, v213
    v_mov_b32 v213, v217
    s_nop 1
    v_permlane16_swap_b32 v217, v213
    v_max_f32 v217, v217, v213
    v_max_f32 v217, 0, v217
    v_mov_b32 v212, v220
    v_mov_b32 v213, v220
    s_nop 1
    v_permlane32_swap_b32 v212, v213
    v_log_f32 v212, v213
    s_nop 0
    v_max_f32 v217, v217, v212
    v_sub_f32 v219, 0, v217
    v_exp_f32 v219, v219
    v_sub_f32 v120, v120, v217
    v_sub_f32 v121, v121, v217
    v_sub_f32 v122, v122, v217
    v_sub_f32 v123, v123, v217
    v_sub_f32 v124, v124, v217
    v_sub_f32 v125, v125, v217
    v_sub_f32 v126, v126, v217
    v_sub_f32 v127, v127, v217
    v_sub_f32 v152, v152, v217
    v_sub_f32 v153, v153, v217
    v_sub_f32 v154, v154, v217
    v_sub_f32 v155, v155, v217
    v_sub_f32 v156, v156, v217
    v_sub_f32 v157, v157, v217
    v_sub_f32 v158, v158, v217
    v_sub_f32 v159, v159, v217
    v_sub_f32 v172, v172, v217
    v_sub_f32 v173, v173, v217
    v_sub_f32 v174, v174, v217
    v_sub_f32 v175, v175, v217
    v_accvgpr_read_b32 v214, a96
    v_mul_f32 v214, v214, v219
    v_accvgpr_write_b32 a96, v214
    v_accvgpr_read_b32 v214, a97
    v_mul_f32 v214, v214, v219
    v_accvgpr_write_b32 a97, v214
    v_accvgpr_read_b32 v214, a98
    v_mul_f32 v214, v214, v219
    v_accvgpr_write_b32 a98, v214
    v_accvgpr_read_b32 v214, a99
    v_mul_f32 v214, v214, v219
    v_accvgpr_write_b32 a99, v214
    v_accvgpr_read_b32 v214, a100
    v_mul_f32 v214, v214, v219
    v_accvgpr_write_b32 a100, v214
    v_accvgpr_read_b32 v214, a101
    v_mul_f32 v214, v214, v219
    v_accvgpr_write_b32 a101, v214
    v_accvgpr_read_b32 v214, a102
    v_mul_f32 v214, v214, v219
    v_accvgpr_write_b32 a102, v214
    v_accvgpr_read_b32 v214, a103
    v_mul_f32 v214, v214, v219
    v_accvgpr_write_b32 a103, v214
    v_accvgpr_read_b32 v214, a104
    v_mul_f32 v214, v214, v219
    v_accvgpr_write_b32 a104, v214
    v_accvgpr_read_b32 v214, a105
    v_mul_f32 v214, v214, v219
    v_accvgpr_write_b32 a105, v214
    v_accvgpr_read_b32 v214, a106
    v_mul_f32 v214, v214, v219
    v_accvgpr_write_b32 a106, v214
    v_accvgpr_read_b32 v214, a107
    v_mul_f32 v214, v214, v219
    v_accvgpr_write_b32 a107, v214
    v_accvgpr_read_b32 v214, a108
    v_mul_f32 v214, v214, v219
    v_accvgpr_write_b32 a108, v214
    v_accvgpr_read_b32 v214, a109
    v_mul_f32 v214, v214, v219
    v_accvgpr_write_b32 a109, v214
    v_accvgpr_read_b32 v214, a110
    v_mul_f32 v214, v214, v219
    v_accvgpr_write_b32 a110, v214
    v_accvgpr_read_b32 v214, a111
    v_mul_f32 v214, v214, v219
    v_accvgpr_write_b32 a111, v214
    v_accvgpr_read_b32 v214, a112
    v_mul_f32 v214, v214, v219
    v_accvgpr_write_b32 a112, v214
    v_accvgpr_read_b32 v214, a113
    v_mul_f32 v214, v214, v219
    v_accvgpr_write_b32 a113, v214
    v_accvgpr_read_b32 v214, a114
    v_mul_f32 v214, v214, v219
    v_accvgpr_write_b32 a114, v214
    v_accvgpr_read_b32 v214, a115
    v_mul_f32 v214, v214, v219
    v_accvgpr_write_b32 a115, v214
    v_accvgpr_read_b32 v214, a116
    v_mul_f32 v214, v214, v219
    v_accvgpr_write_b32 a116, v214
    v_accvgpr_read_b32 v214, a117
    v_mul_f32 v214, v214, v219
    v_accvgpr_write_b32 a117, v214
    v_accvgpr_read_b32 v214, a118
    v_mul_f32 v214, v214, v219
    v_accvgpr_write_b32 a118, v214
    v_accvgpr_read_b32 v214, a119
    v_mul_f32 v214, v214, v219
    v_accvgpr_write_b32 a119, v214
    v_accvgpr_read_b32 v214, a120
    v_mul_f32 v214, v214, v219
    v_accvgpr_write_b32 a120, v214
    v_accvgpr_read_b32 v214, a121
    v_mul_f32 v214, v214, v219
    v_accvgpr_write_b32 a121, v214
    v_accvgpr_read_b32 v214, a122
    v_mul_f32 v214, v214, v219
    v_accvgpr_write_b32 a122, v214
    v_accvgpr_read_b32 v214, a123
    v_mul_f32 v214, v214, v219
    v_accvgpr_write_b32 a123, v214
    v_accvgpr_read_b32 v214, a124
    v_mul_f32 v214, v214, v219
    v_accvgpr_write_b32 a124, v214
    v_accvgpr_read_b32 v214, a125
    v_mul_f32 v214, v214, v219
    v_accvgpr_write_b32 a125, v214
    v_accvgpr_read_b32 v214, a126
    v_mul_f32 v214, v214, v219
    v_accvgpr_write_b32 a126, v214
    v_accvgpr_read_b32 v214, a127
    v_mul_f32 v214, v214, v219
    v_accvgpr_write_b32 a127, v214
    v_exp_f32 v214, v120
    v_exp_f32 v215, v121
    s_nop 0
    v_cvt_pk_bf16_f32 v196, v214, v215
    v_exp_f32 v214, v122
    v_exp_f32 v215, v123
    s_nop 0
    v_cvt_pk_bf16_f32 v197, v214, v215
    v_exp_f32 v214, v124
    v_exp_f32 v215, v125
    s_nop 0
    v_cvt_pk_bf16_f32 v198, v214, v215
    v_exp_f32 v214, v126
    v_exp_f32 v215, v127
    s_nop 0
    v_cvt_pk_bf16_f32 v199, v214, v215
    v_lshlrev_b32 v214, 16, v204
    v_and_b32 v215, 0xffff0000, v204
    v_mul_f32 v214, v214, v219
    v_mul_f32 v215, v215, v219
    v_cvt_pk_bf16_f32 v204, v214, v215
    v_lshlrev_b32 v214, 16, v205
    v_and_b32 v215, 0xffff0000, v205
    v_mul_f32 v214, v214, v219
    v_mul_f32 v215, v215, v219
    v_cvt_pk_bf16_f32 v205, v214, v215
    v_lshlrev_b32 v214, 16, v206
    v_and_b32 v215, 0xffff0000, v206
    v_mul_f32 v214, v214, v219
    v_mul_f32 v215, v215, v219
    v_cvt_pk_bf16_f32 v206, v214, v215
    v_lshlrev_b32 v214, 16, v207
    v_and_b32 v215, 0xffff0000, v207
    v_mul_f32 v214, v214, v219
    v_mul_f32 v215, v215, v219
    v_cvt_pk_bf16_f32 v207, v214, v215
    v_cmp_gt_u32 vcc, 32, v1
    s_nop 1
    v_cndmask_b32 v212, v219, v218, vcc
    v_mul_f32 v228, v233, v212
    s_nop 1
    v_smfmac_f32_16x16x64_bf16 v[228:231], v[24:27], v[192:199], v235
    s_nop 7
    s_setpc_b64 s[98:99]
L_slowfn1_0_0:
    s_nop 15
    v_mov_b32 v220, v232
    v_mov_b32 v221, v232
    s_nop 1
    v_permlane16_swap_b32 v220, v221
    v_add_f32 v220, v220, v221
    v_max3_f32 v216, v96, v97, v98
    v_max3_f32 v216, v216, v99, v100
    v_max3_f32 v216, v216, v101, v102
    v_max_f32 v216, v216, v103
    v_mov_b32 v213, v216
    s_nop 1
    v_permlane32_swap_b32 v216, v213
    v_max_f32 v216, v216, v213
    v_mov_b32 v213, v216
    s_nop 1
    v_permlane16_swap_b32 v216, v213
    v_max_f32 v216, v216, v213
    v_max_f32 v216, 0, v216
    v_mov_b32 v212, v220
    v_mov_b32 v213, v220
    s_nop 1
    v_permlane32_swap_b32 v212, v213
    v_log_f32 v212, v212
    s_nop 0
    v_max_f32 v216, v216, v212
    v_sub_f32 v218, 0, v216
    v_exp_f32 v218, v218
    v_sub_f32 v96, v96, v216
    v_sub_f32 v97, v97, v216
    v_sub_f32 v98, v98, v216
    v_sub_f32 v99, v99, v216
    v_sub_f32 v100, v100, v216
    v_sub_f32 v101, v101, v216
    v_sub_f32 v102, v102, v216
    v_sub_f32 v103, v103, v216
    v_sub_f32 v128, v128, v216
    v_sub_f32 v129, v129, v216
    v_sub_f32 v130, v130, v216
    v_sub_f32 v131, v131, v216
    v_sub_f32 v132, v132, v216
    v_sub_f32 v133, v133, v216
    v_sub_f32 v134, v134, v216
    v_sub_f32 v135, v135, v216
    v_sub_f32 v160, v160, v216
    v_sub_f32 v161, v161, v216
    v_sub_f32 v162, v162, v216
    v_sub_f32 v163, v163, v216
    v_accvgpr_read_b32 v214, a0
    v_mul_f32 v214, v214, v218
    v_accvgpr_write_b32 a0, v214
    v_accvgpr_read_b32 v214, a1
    v_mul_f32 v214, v214, v218
    v_accvgpr_write_b32 a1, v214
    v_accvgpr_read_b32 v214, a2
    v_mul_f32 v214, v214, v218
    v_accvgpr_write_b32 a2, v214
    v_accvgpr_read_b32 v214, a3
    v_mul_f32 v214, v214, v218
    v_accvgpr_write_b32 a3, v214
    v_accvgpr_read_b32 v214, a4
    v_mul_f32 v214, v214, v218
    v_accvgpr_write_b32 a4, v214
    v_accvgpr_read_b32 v214, a5
    v_mul_f32 v214, v214, v218
    v_accvgpr_write_b32 a5, v214
    v_accvgpr_read_b32 v214, a6
    v_mul_f32 v214, v214, v218
    v_accvgpr_write_b32 a6, v214
    v_accvgpr_read_b32 v214, a7
    v_mul_f32 v214, v214, v218
    v_accvgpr_write_b32 a7, v214
    v_accvgpr_read_b32 v214, a8
    v_mul_f32 v214, v214, v218
    v_accvgpr_write_b32 a8, v214
    v_accvgpr_read_b32 v214, a9
    v_mul_f32 v214, v214, v218
    v_accvgpr_write_b32 a9, v214
    v_accvgpr_read_b32 v214, a10
    v_mul_f32 v214, v214, v218
    v_accvgpr_write_b32 a10, v214
    v_accvgpr_read_b32 v214, a11
    v_mul_f32 v214, v214, v218
    v_accvgpr_write_b32 a11, v214
    v_accvgpr_read_b32 v214, a12
    v_mul_f32 v214, v214, v218
    v_accvgpr_write_b32 a12, v214
    v_accvgpr_read_b32 v214, a13
    v_mul_f32 v214, v214, v218
    v_accvgpr_write_b32 a13, v214
    v_accvgpr_read_b32 v214, a14
    v_mul_f32 v214, v214, v218
    v_accvgpr_write_b32 a14, v214
    v_accvgpr_read_b32 v214, a15
    v_mul_f32 v214, v214, v218
    v_accvgpr_write_b32 a15, v214
    v_accvgpr_read_b32 v214, a16
    v_mul_f32 v214, v214, v218
    v_accvgpr_write_b32 a16, v214
    v_accvgpr_read_b32 v214, a17
    v_mul_f32 v214, v214, v218
    v_accvgpr_write_b32 a17, v214
    v_accvgpr_read_b32 v214, a18
    v_mul_f32 v214, v214, v218
    v_accvgpr_write_b32 a18, v214
    v_accvgpr_read_b32 v214, a19
    v_mul_f32 v214, v214, v218
    v_accvgpr_write_b32 a19, v214
    v_accvgpr_read_b32 v214, a20
    v_mul_f32 v214, v214, v218
    v_accvgpr_write_b32 a20, v214
    v_accvgpr_read_b32 v214, a21
    v_mul_f32 v214, v214, v218
    v_accvgpr_write_b32 a21, v214
    v_accvgpr_read_b32 v214, a22
    v_mul_f32 v214, v214, v218
    v_accvgpr_write_b32 a22, v214
    v_accvgpr_read_b32 v214, a23
    v_mul_f32 v214, v214, v218
    v_accvgpr_write_b32 a23, v214
    v_accvgpr_read_b32 v214, a24
    v_mul_f32 v214, v214, v218
    v_accvgpr_write_b32 a24, v214
    v_accvgpr_read_b32 v214, a25
    v_mul_f32 v214, v214, v218
    v_accvgpr_write_b32 a25, v214
    v_accvgpr_read_b32 v214, a26
    v_mul_f32 v214, v214, v218
    v_accvgpr_write_b32 a26, v214
    v_accvgpr_read_b32 v214, a27
    v_mul_f32 v214, v214, v218
    v_accvgpr_write_b32 a27, v214
    v_accvgpr_read_b32 v214, a28
    v_mul_f32 v214, v214, v218
    v_accvgpr_write_b32 a28, v214
    v_accvgpr_read_b32 v214, a29
    v_mul_f32 v214, v214, v218
    v_accvgpr_write_b32 a29, v214
    v_accvgpr_read_b32 v214, a30
    v_mul_f32 v214, v214, v218
    v_accvgpr_write_b32 a30, v214
    v_accvgpr_read_b32 v214, a31
    v_mul_f32 v214, v214, v218
    v_accvgpr_write_b32 a31, v214
    v_exp_f32 v214, v96
    v_exp_f32 v215, v97
    s_nop 0
    v_cvt_pk_bf16_f32 v176, v214, v215
    v_exp_f32 v214, v98
    v_exp_f32 v215, v99
    s_nop 0
    v_cvt_pk_bf16_f32 v177, v214, v215
    v_exp_f32 v214, v100
    v_exp_f32 v215, v101
    s_nop 0
    v_cvt_pk_bf16_f32 v178, v214, v215
    v_exp_f32 v214, v102
    v_exp_f32 v215, v103
    s_nop 0
    v_cvt_pk_bf16_f32 v179, v214, v215
    v_exp_f32 v214, v128
    v_exp_f32 v215, v129
    s_nop 0
    v_cvt_pk_bf16_f32 v184, v214, v215
    v_exp_f32 v214, v130
    v_exp_f32 v215, v131
    s_nop 0
    v_cvt_pk_bf16_f32 v185, v214, v215
    v_exp_f32 v214, v132
    v_exp_f32 v215, v133
    s_nop 0
    v_cvt_pk_bf16_f32 v186, v214, v215
    v_max3_f32 v217, v104, v105, v106
    v_max3_f32 v217, v217, v107, v108
    v_max3_f32 v217, v217, v109, v110
    v_max_f32 v217, v217, v111
    v_mov_b32 v213, v217
    s_nop 1
    v_permlane32_swap_b32 v217, v213
    v_max_f32 v217, v217, v213
    v_mov_b32 v213, v217
    s_nop 1
    v_permlane16_swap_b32 v217, v213
    v_max_f32 v217, v217, v213
    v_max_f32 v217, 0, v217
    v_mov_b32 v212, v220
    v_mov_b32 v213, v220
    s_nop 1
    v_permlane32_swap_b32 v212, v213
    v_log_f32 v212, v213
    s_nop 0
    v_max_f32 v217, v217, v212
    v_sub_f32 v219, 0, v217
    v_exp_f32 v219, v219
    v_sub_f32 v104, v104, v217
    v_sub_f32 v105, v105, v217
    v_sub_f32 v106, v106, v217
    v_sub_f32 v107, v107, v217
    v_sub_f32 v108, v108, v217
    v_sub_f32 v109, v109, v217
    v_sub_f32 v110, v110, v217
    v_sub_f32 v111, v111, v217
    v_sub_f32 v136, v136, v217
    v_sub_f32 v137, v137, v217
    v_sub_f32 v138, v138, v217
    v_sub_f32 v139, v139, v217
    v_sub_f32 v140, v140, v217
    v_sub_f32 v141, v141, v217
    v_sub_f32 v142, v142, v217
    v_sub_f32 v143, v143, v217
    v_sub_f32 v164, v164, v217
    v_sub_f32 v165, v165, v217
    v_sub_f32 v166, v166, v217
    v_sub_f32 v167, v167, v217
    v_accvgpr_read_b32 v214, a32
    v_mul_f32 v214, v214, v219
    v_accvgpr_write_b32 a32, v214
    v_accvgpr_read_b32 v214, a33
    v_mul_f32 v214, v214, v219
    v_accvgpr_write_b32 a33, v214
    v_accvgpr_read_b32 v214, a34
    v_mul_f32 v214, v214, v219
    v_accvgpr_write_b32 a34, v214
    v_accvgpr_read_b32 v214, a35
    v_mul_f32 v214, v214, v219
    v_accvgpr_write_b32 a35, v214
    v_accvgpr_read_b32 v214, a36
    v_mul_f32 v214, v214, v219
    v_accvgpr_write_b32 a36, v214
    v_accvgpr_read_b32 v214, a37
    v_mul_f32 v214, v214, v219
    v_accvgpr_write_b32 a37, v214
    v_accvgpr_read_b32 v214, a38
    v_mul_f32 v214, v214, v219
    v_accvgpr_write_b32 a38, v214
    v_accvgpr_read_b32 v214, a39
    v_mul_f32 v214, v214, v219
    v_accvgpr_write_b32 a39, v214
    v_accvgpr_read_b32 v214, a40
    v_mul_f32 v214, v214, v219
    v_accvgpr_write_b32 a40, v214
    v_accvgpr_read_b32 v214, a41
    v_mul_f32 v214, v214, v219
    v_accvgpr_write_b32 a41, v214
    v_accvgpr_read_b32 v214, a42
    v_mul_f32 v214, v214, v219
    v_accvgpr_write_b32 a42, v214
    v_accvgpr_read_b32 v214, a43
    v_mul_f32 v214, v214, v219
    v_accvgpr_write_b32 a43, v214
    v_accvgpr_read_b32 v214, a44
    v_mul_f32 v214, v214, v219
    v_accvgpr_write_b32 a44, v214
    v_accvgpr_read_b32 v214, a45
    v_mul_f32 v214, v214, v219
    v_accvgpr_write_b32 a45, v214
    v_accvgpr_read_b32 v214, a46
    v_mul_f32 v214, v214, v219
    v_accvgpr_write_b32 a46, v214
    v_accvgpr_read_b32 v214, a47
    v_mul_f32 v214, v214, v219
    v_accvgpr_write_b32 a47, v214
    v_accvgpr_read_b32 v214, a48
    v_mul_f32 v214, v214, v219
    v_accvgpr_write_b32 a48, v214
    v_accvgpr_read_b32 v214, a49
    v_mul_f32 v214, v214, v219
    v_accvgpr_write_b32 a49, v214
    v_accvgpr_read_b32 v214, a50
    v_mul_f32 v214, v214, v219
    v_accvgpr_write_b32 a50, v214
    v_accvgpr_read_b32 v214, a51
    v_mul_f32 v214, v214, v219
    v_accvgpr_write_b32 a51, v214
    v_accvgpr_read_b32 v214, a52
    v_mul_f32 v214, v214, v219
    v_accvgpr_write_b32 a52, v214
    v_accvgpr_read_b32 v214, a53
    v_mul_f32 v214, v214, v219
    v_accvgpr_write_b32 a53, v214
    v_accvgpr_read_b32 v214, a54
    v_mul_f32 v214, v214, v219
    v_accvgpr_write_b32 a54, v214
    v_accvgpr_read_b32 v214, a55
    v_mul_f32 v214, v214, v219
    v_accvgpr_write_b32 a55, v214
    v_accvgpr_read_b32 v214, a56
    v_mul_f32 v214, v214, v219
    v_accvgpr_write_b32 a56, v214
    v_accvgpr_read_b32 v214, a57
    v_mul_f32 v214, v214, v219
    v_accvgpr_write_b32 a57, v214
    v_accvgpr_read_b32 v214, a58
    v_mul_f32 v214, v214, v219
    v_accvgpr_write_b32 a58, v214
    v_accvgpr_read_b32 v214, a59
    v_mul_f32 v214, v214, v219
    v_accvgpr_write_b32 a59, v214
    v_accvgpr_read_b32 v214, a60
    v_mul_f32 v214, v214, v219
    v_accvgpr_write_b32 a60, v214
    v_accvgpr_read_b32 v214, a61
    v_mul_f32 v214, v214, v219
    v_accvgpr_write_b32 a61, v214
    v_accvgpr_read_b32 v214, a62
    v_mul_f32 v214, v214, v219
    v_accvgpr_write_b32 a62, v214
    v_accvgpr_read_b32 v214, a63
    v_mul_f32 v214, v214, v219
    v_accvgpr_write_b32 a63, v214
    v_exp_f32 v214, v104
    v_exp_f32 v215, v105
    s_nop 0
    v_cvt_pk_bf16_f32 v180, v214, v215
    v_exp_f32 v214, v106
    v_exp_f32 v215, v107
    s_nop 0
    v_cvt_pk_bf16_f32 v181, v214, v215
    v_exp_f32 v214, v108
    v_exp_f32 v215, v109
    s_nop 0
    v_cvt_pk_bf16_f32 v182, v214, v215
    v_exp_f32 v214, v110
    v_exp_f32 v215, v111
    s_nop 0
    v_cvt_pk_bf16_f32 v183, v214, v215
    v_cmp_gt_u32 vcc, 32, v1
    s_nop 1
    v_cndmask_b32 v212, v219, v218, vcc
    v_mul_f32 v224, v232, v212
    s_nop 1
    v_smfmac_f32_16x16x64_bf16 v[224:227], v[24:27], v[176:183], v235
    s_nop 7
    s_setpc_b64 s[98:99]
L_slowfn0_1_0:
    s_nop 15
    v_mov_b32 v220, v232
    v_mov_b32 v221, v232
    s_nop 1
    v_permlane16_swap_b32 v220, v221
    v_add_f32 v220, v220, v221
    v_max3_f32 v216, v128, v129, v130
    v_max3_f32 v216, v216, v131, v132
    v_max3_f32 v216, v216, v133, v134
    v_max_f32 v216, v216, v135
    v_mov_b32 v213, v216
    s_nop 1
    v_permlane32_swap_b32 v216, v213
    v_max_f32 v216, v216, v213
    v_mov_b32 v213, v216
    s_nop 1
    v_permlane16_swap_b32 v216, v213
    v_max_f32 v216, v216, v213
    v_max_f32 v216, 0, v216
    v_mov_b32 v212, v220
    v_mov_b32 v213, v220
    s_nop 1
    v_permlane32_swap_b32 v212, v213
    v_log_f32 v212, v212
    s_nop 0
    v_max_f32 v216, v216, v212
    v_sub_f32 v218, 0, v216
    v_exp_f32 v218, v218
    v_sub_f32 v128, v128, v216
    v_sub_f32 v129, v129, v216
    v_sub_f32 v130, v130, v216
    v_sub_f32 v131, v131, v216
    v_sub_f32 v132, v132, v216
    v_sub_f32 v133, v133, v216
    v_sub_f32 v134, v134, v216
    v_sub_f32 v135, v135, v216
    v_sub_f32 v96, v96, v216
    v_sub_f32 v97, v97, v216
    v_sub_f32 v98, v98, v216
    v_sub_f32 v99, v99, v216
    v_sub_f32 v100, v100, v216
    v_sub_f32 v101, v101, v216
    v_sub_f32 v102, v102, v216
    v_sub_f32 v103, v103, v216
    v_sub_f32 v160, v160, v216
    v_sub_f32 v161, v161, v216
    v_sub_f32 v162, v162, v216
    v_sub_f32 v163, v163, v216
    v_accvgpr_read_b32 v214, a0
    v_mul_f32 v214, v214, v218
    v_accvgpr_write_b32 a0, v214
    v_accvgpr_read_b32 v214, a1
    v_mul_f32 v214, v214, v218
    v_accvgpr_write_b32 a1, v214
    v_accvgpr_read_b32 v214, a2
    v_mul_f32 v214, v214, v218
    v_accvgpr_write_b32 a2, v214
    v_accvgpr_read_b32 v214, a3
    v_mul_f32 v214, v214, v218
    v_accvgpr_write_b32 a3, v214
    v_accvgpr_read_b32 v214, a4
    v_mul_f32 v214, v214, v218
    v_accvgpr_write_b32 a4, v214
    v_accvgpr_read_b32 v214, a5
    v_mul_f32 v214, v214, v218
    v_accvgpr_write_b32 a5, v214
    v_accvgpr_read_b32 v214, a6
    v_mul_f32 v214, v214, v218
    v_accvgpr_write_b32 a6, v214
    v_accvgpr_read_b32 v214, a7
    v_mul_f32 v214, v214, v218
    v_accvgpr_write_b32 a7, v214
    v_accvgpr_read_b32 v214, a8
    v_mul_f32 v214, v214, v218
    v_accvgpr_write_b32 a8, v214
    v_accvgpr_read_b32 v214, a9
    v_mul_f32 v214, v214, v218
    v_accvgpr_write_b32 a9, v214
    v_accvgpr_read_b32 v214, a10
    v_mul_f32 v214, v214, v218
    v_accvgpr_write_b32 a10, v214
    v_accvgpr_read_b32 v214, a11
    v_mul_f32 v214, v214, v218
    v_accvgpr_write_b32 a11, v214
    v_accvgpr_read_b32 v214, a12
    v_mul_f32 v214, v214, v218
    v_accvgpr_write_b32 a12, v214
    v_accvgpr_read_b32 v214, a13
    v_mul_f32 v214, v214, v218
    v_accvgpr_write_b32 a13, v214
    v_accvgpr_read_b32 v214, a14
    v_mul_f32 v214, v214, v218
    v_accvgpr_write_b32 a14, v214
    v_accvgpr_read_b32 v214, a15
    v_mul_f32 v214, v214, v218
    v_accvgpr_write_b32 a15, v214
    v_accvgpr_read_b32 v214, a16
    v_mul_f32 v214, v214, v218
    v_accvgpr_write_b32 a16, v214
    v_accvgpr_read_b32 v214, a17
    v_mul_f32 v214, v214, v218
    v_accvgpr_write_b32 a17, v214
    v_accvgpr_read_b32 v214, a18
    v_mul_f32 v214, v214, v218
    v_accvgpr_write_b32 a18, v214
    v_accvgpr_read_b32 v214, a19
    v_mul_f32 v214, v214, v218
    v_accvgpr_write_b32 a19, v214
    v_accvgpr_read_b32 v214, a20
    v_mul_f32 v214, v214, v218
    v_accvgpr_write_b32 a20, v214
    v_accvgpr_read_b32 v214, a21
    v_mul_f32 v214, v214, v218
    v_accvgpr_write_b32 a21, v214
    v_accvgpr_read_b32 v214, a22
    v_mul_f32 v214, v214, v218
    v_accvgpr_write_b32 a22, v214
    v_accvgpr_read_b32 v214, a23
    v_mul_f32 v214, v214, v218
    v_accvgpr_write_b32 a23, v214
    v_accvgpr_read_b32 v214, a24
    v_mul_f32 v214, v214, v218
    v_accvgpr_write_b32 a24, v214
    v_accvgpr_read_b32 v214, a25
    v_mul_f32 v214, v214, v218
    v_accvgpr_write_b32 a25, v214
    v_accvgpr_read_b32 v214, a26
    v_mul_f32 v214, v214, v218
    v_accvgpr_write_b32 a26, v214
    v_accvgpr_read_b32 v214, a27
    v_mul_f32 v214, v214, v218
    v_accvgpr_write_b32 a27, v214
    v_accvgpr_read_b32 v214, a28
    v_mul_f32 v214, v214, v218
    v_accvgpr_write_b32 a28, v214
    v_accvgpr_read_b32 v214, a29
    v_mul_f32 v214, v214, v218
    v_accvgpr_write_b32 a29, v214
    v_accvgpr_read_b32 v214, a30
    v_mul_f32 v214, v214, v218
    v_accvgpr_write_b32 a30, v214
    v_accvgpr_read_b32 v214, a31
    v_mul_f32 v214, v214, v218
    v_accvgpr_write_b32 a31, v214
    v_exp_f32 v214, v128
    v_exp_f32 v215, v129
    s_nop 0
    v_cvt_pk_bf16_f32 v184, v214, v215
    v_exp_f32 v214, v130
    v_exp_f32 v215, v131
    s_nop 0
    v_cvt_pk_bf16_f32 v185, v214, v215
    v_exp_f32 v214, v132
    v_exp_f32 v215, v133
    s_nop 0
    v_cvt_pk_bf16_f32 v186, v214, v215
    v_exp_f32 v214, v134
    v_exp_f32 v215, v135
    s_nop 0
    v_cvt_pk_bf16_f32 v187, v214, v215
    v_lshlrev_b32 v214, 16, v176
    v_and_b32 v215, 0xffff0000, v176
    v_mul_f32 v214, v214, v218
    v_mul_f32 v215, v215, v218
    v_cvt_pk_bf16_f32 v176, v214, v215
    v_lshlrev_b32 v214, 16, v177
    v_and_b32 v215, 0xffff0000, v177
    v_mul_f32 v214, v214, v218
    v_mul_f32 v215, v215, v218
    v_cvt_pk_bf16_f32 v177, v214, v215
    v_lshlrev_b32 v214, 16, v178
    v_and_b32 v215, 0xffff0000, v178
    v_mul_f32 v214, v214, v218
    v_mul_f32 v215, v215, v218
    v_cvt_pk_bf16_f32 v178, v214, v215
    v_lshlrev_b32 v214, 16, v179
    v_and_b32 v215, 0xffff0000, v179
    v_mul_f32 v214, v214, v218
    v_mul_f32 v215, v215, v218
    v_cvt_pk_bf16_f32 v179, v214, v215
    v_max3_f32 v217, v136, v137, v138
    v_max3_f32 v217, v217, v139, v140
    v_max3_f32 v217, v217, v141, v142
    v_max_f32 v217, v217, v143
    v_mov_b32 v213, v217
    s_nop 1
    v_permlane32_swap_b32 v217, v213
    v_max_f32 v217, v217, v213
    v_mov_b32 v213, v217
    s_nop 1
    v_permlane16_swap_b32 v217, v213
    v_max_f32 v217, v217, v213
    v_max_f32 v217, 0, v217
    v_mov_b32 v212, v220
    v_mov_b32 v213, v220
    s_nop 1
    v_permlane32_swap_b32 v212, v213
    v_log_f32 v212, v213
    s_nop 0
    v_max_f32 v217, v217, v212
    v_sub_f32 v219, 0, v217
    v_exp_f32 v219, v219
    v_sub_f32 v136, v136, v217
    v_sub_f32 v137, v137, v217
    v_sub_f32 v138, v138, v217
    v_sub_f32 v139, v139, v217
    v_sub_f32 v140, v140, v217
    v_sub_f32 v141, v141, v217
    v_sub_f32 v142, v142, v217
    v_sub_f32 v143, v143, v217
    v_sub_f32 v104, v104, v217
    v_sub_f32 v105, v105, v217
    v_sub_f32 v106, v106, v217
    v_sub_f32 v107, v107, v217
    v_sub_f32 v108, v108, v217
    v_sub_f32 v109, v109, v217
    v_sub_f32 v110, v110, v217
    v_sub_f32 v111, v111, v217
    v_sub_f32 v164, v164, v217
    v_sub_f32 v165, v165, v217
    v_sub_f32 v166, v166, v217
    v_sub_f32 v167, v167, v217
    v_accvgpr_read_b32 v214, a32
    v_mul_f32 v214, v214, v219
    v_accvgpr_write_b32 a32, v214
    v_accvgpr_read_b32 v214, a33
    v_mul_f32 v214, v214, v219
    v_accvgpr_write_b32 a33, v214
    v_accvgpr_read_b32 v214, a34
    v_mul_f32 v214, v214, v219
    v_accvgpr_write_b32 a34, v214
    v_accvgpr_read_b32 v214, a35
    v_mul_f32 v214, v214, v219
    v_accvgpr_write_b32 a35, v214
    v_accvgpr_read_b32 v214, a36
    v_mul_f32 v214, v214, v219
    v_accvgpr_write_b32 a36, v214
    v_accvgpr_read_b32 v214, a37
    v_mul_f32 v214, v214, v219
    v_accvgpr_write_b32 a37, v214
    v_accvgpr_read_b32 v214, a38
    v_mul_f32 v214, v214, v219
    v_accvgpr_write_b32 a38, v214
    v_accvgpr_read_b32 v214, a39
    v_mul_f32 v214, v214, v219
    v_accvgpr_write_b32 a39, v214
    v_accvgpr_read_b32 v214, a40
    v_mul_f32 v214, v214, v219
    v_accvgpr_write_b32 a40, v214
    v_accvgpr_read_b32 v214, a41
    v_mul_f32 v214, v214, v219
    v_accvgpr_write_b32 a41, v214
    v_accvgpr_read_b32 v214, a42
    v_mul_f32 v214, v214, v219
    v_accvgpr_write_b32 a42, v214
    v_accvgpr_read_b32 v214, a43
    v_mul_f32 v214, v214, v219
    v_accvgpr_write_b32 a43, v214
    v_accvgpr_read_b32 v214, a44
    v_mul_f32 v214, v214, v219
    v_accvgpr_write_b32 a44, v214
    v_accvgpr_read_b32 v214, a45
    v_mul_f32 v214, v214, v219
    v_accvgpr_write_b32 a45, v214
    v_accvgpr_read_b32 v214, a46
    v_mul_f32 v214, v214, v219
    v_accvgpr_write_b32 a46, v214
    v_accvgpr_read_b32 v214, a47
    v_mul_f32 v214, v214, v219
    v_accvgpr_write_b32 a47, v214
    v_accvgpr_read_b32 v214, a48
    v_mul_f32 v214, v214, v219
    v_accvgpr_write_b32 a48, v214
    v_accvgpr_read_b32 v214, a49
    v_mul_f32 v214, v214, v219
    v_accvgpr_write_b32 a49, v214
    v_accvgpr_read_b32 v214, a50
    v_mul_f32 v214, v214, v219
    v_accvgpr_write_b32 a50, v214
    v_accvgpr_read_b32 v214, a51
    v_mul_f32 v214, v214, v219
    v_accvgpr_write_b32 a51, v214
    v_accvgpr_read_b32 v214, a52
    v_mul_f32 v214, v214, v219
    v_accvgpr_write_b32 a52, v214
    v_accvgpr_read_b32 v214, a53
    v_mul_f32 v214, v214, v219
    v_accvgpr_write_b32 a53, v214
    v_accvgpr_read_b32 v214, a54
    v_mul_f32 v214, v214, v219
    v_accvgpr_write_b32 a54, v214
    v_accvgpr_read_b32 v214, a55
    v_mul_f32 v214, v214, v219
    v_accvgpr_write_b32 a55, v214
    v_accvgpr_read_b32 v214, a56
    v_mul_f32 v214, v214, v219
    v_accvgpr_write_b32 a56, v214
    v_accvgpr_read_b32 v214, a57
    v_mul_f32 v214, v214, v219
    v_accvgpr_write_b32 a57, v214
    v_accvgpr_read_b32 v214, a58
    v_mul_f32 v214, v214, v219
    v_accvgpr_write_b32 a58, v214
    v_accvgpr_read_b32 v214, a59
    v_mul_f32 v214, v214, v219
    v_accvgpr_write_b32 a59, v214
    v_accvgpr_read_b32 v214, a60
    v_mul_f32 v214, v214, v219
    v_accvgpr_write_b32 a60, v214
    v_accvgpr_read_b32 v214, a61
    v_mul_f32 v214, v214, v219
    v_accvgpr_write_b32 a61, v214
    v_accvgpr_read_b32 v214, a62
    v_mul_f32 v214, v214, v219
    v_accvgpr_write_b32 a62, v214
    v_accvgpr_read_b32 v214, a63
    v_mul_f32 v214, v214, v219
    v_accvgpr_write_b32 a63, v214
    v_exp_f32 v214, v136
    v_exp_f32 v215, v137
    s_nop 0
    v_cvt_pk_bf16_f32 v188, v214, v215
    v_exp_f32 v214, v138
    v_exp_f32 v215, v139
    s_nop 0
    v_cvt_pk_bf16_f32 v189, v214, v215
    v_exp_f32 v214, v140
    v_exp_f32 v215, v141
    s_nop 0
    v_cvt_pk_bf16_f32 v190, v214, v215
    v_exp_f32 v214, v142
    v_exp_f32 v215, v143
    s_nop 0
    v_cvt_pk_bf16_f32 v191, v214, v215
    v_lshlrev_b32 v214, 16, v180
    v_and_b32 v215, 0xffff0000, v180
    v_mul_f32 v214, v214, v219
    v_mul_f32 v215, v215, v219
    v_cvt_pk_bf16_f32 v180, v214, v215
    v_lshlrev_b32 v214, 16, v181
    v_and_b32 v215, 0xffff0000, v181
    v_mul_f32 v214, v214, v219
    v_mul_f32 v215, v215, v219
    v_cvt_pk_bf16_f32 v181, v214, v215
    v_lshlrev_b32 v214, 16, v182
    v_and_b32 v215, 0xffff0000, v182
    v_mul_f32 v214, v214, v219
    v_mul_f32 v215, v215, v219
    v_cvt_pk_bf16_f32 v182, v214, v215
    v_lshlrev_b32 v214, 16, v183
    v_and_b32 v215, 0xffff0000, v183
    v_mul_f32 v214, v214, v219
    v_mul_f32 v215, v215, v219
    v_cvt_pk_bf16_f32 v183, v214, v215
    v_cmp_gt_u32 vcc, 32, v1
    s_nop 1
    v_cndmask_b32 v212, v219, v218, vcc
    v_mul_f32 v224, v232, v212
    s_nop 1
    v_smfmac_f32_16x16x64_bf16 v[224:227], v[24:27], v[184:191], v235
    s_nop 7
    s_setpc_b64 s[98:99]
L_slowfn1_1_0:
    s_nop 15
    v_mov_b32 v220, v233
    v_mov_b32 v221, v233
    s_nop 1
    v_permlane16_swap_b32 v220, v221
    v_add_f32 v220, v220, v221
    v_max3_f32 v216, v144, v145, v146
    v_max3_f32 v216, v216, v147, v148
    v_max3_f32 v216, v216, v149, v150
    v_max_f32 v216, v216, v151
    v_mov_b32 v213, v216
    s_nop 1
    v_permlane32_swap_b32 v216, v213
    v_max_f32 v216, v216, v213
    v_mov_b32 v213, v216
    s_nop 1
    v_permlane16_swap_b32 v216, v213
    v_max_f32 v216, v216, v213
    v_max_f32 v216, 0, v216
    v_mov_b32 v212, v220
    v_mov_b32 v213, v220
    s_nop 1
    v_permlane32_swap_b32 v212, v213
    v_log_f32 v212, v212
    s_nop 0
    v_max_f32 v216, v216, v212
    v_sub_f32 v218, 0, v216
    v_exp_f32 v218, v218
    v_sub_f32 v144, v144, v216
    v_sub_f32 v145, v145, v216
    v_sub_f32 v146, v146, v216
    v_sub_f32 v147, v147, v216
    v_sub_f32 v148, v148, v216
    v_sub_f32 v149, v149, v216
    v_sub_f32 v150, v150, v216
    v_sub_f32 v151, v151, v216
    v_sub_f32 v112, v112, v216
    v_sub_f32 v113, v113, v216
    v_sub_f32 v114, v114, v216
    v_sub_f32 v115, v115, v216
    v_sub_f32 v116, v116, v216
    v_sub_f32 v117, v117, v216
    v_sub_f32 v118, v118, v216
    v_sub_f32 v119, v119, v216
    v_sub_f32 v168, v168, v216
    v_sub_f32 v169, v169, v216
    v_sub_f32 v170, v170, v216
    v_sub_f32 v171, v171, v216
    v_accvgpr_read_b32 v214, a64
    v_mul_f32 v214, v214, v218
    v_accvgpr_write_b32 a64, v214
    v_accvgpr_read_b32 v214, a65
    v_mul_f32 v214, v214, v218
    v_accvgpr_write_b32 a65, v214
    v_accvgpr_read_b32 v214, a66
    v_mul_f32 v214, v214, v218
    v_accvgpr_write_b32 a66, v214
    v_accvgpr_read_b32 v214, a67
    v_mul_f32 v214, v214, v218
    v_accvgpr_write_b32 a67, v214
    v_accvgpr_read_b32 v214, a68
    v_mul_f32 v214, v214, v218
    v_accvgpr_write_b32 a68, v214
    v_accvgpr_read_b32 v214, a69
    v_mul_f32 v214, v214, v218
    v_accvgpr_write_b32 a69, v214
    v_accvgpr_read_b32 v214, a70
    v_mul_f32 v214, v214, v218
    v_accvgpr_write_b32 a70, v214
    v_accvgpr_read_b32 v214, a71
    v_mul_f32 v214, v214, v218
    v_accvgpr_write_b32 a71, v214
    v_accvgpr_read_b32 v214, a72
    v_mul_f32 v214, v214, v218
    v_accvgpr_write_b32 a72, v214
    v_accvgpr_read_b32 v214, a73
    v_mul_f32 v214, v214, v218
    v_accvgpr_write_b32 a73, v214
    v_accvgpr_read_b32 v214, a74
    v_mul_f32 v214, v214, v218
    v_accvgpr_write_b32 a74, v214
    v_accvgpr_read_b32 v214, a75
    v_mul_f32 v214, v214, v218
    v_accvgpr_write_b32 a75, v214
    v_accvgpr_read_b32 v214, a76
    v_mul_f32 v214, v214, v218
    v_accvgpr_write_b32 a76, v214
    v_accvgpr_read_b32 v214, a77
    v_mul_f32 v214, v214, v218
    v_accvgpr_write_b32 a77, v214
    v_accvgpr_read_b32 v214, a78
    v_mul_f32 v214, v214, v218
    v_accvgpr_write_b32 a78, v214
    v_accvgpr_read_b32 v214, a79
    v_mul_f32 v214, v214, v218
    v_accvgpr_write_b32 a79, v214
    v_accvgpr_read_b32 v214, a80
    v_mul_f32 v214, v214, v218
    v_accvgpr_write_b32 a80, v214
    v_accvgpr_read_b32 v214, a81
    v_mul_f32 v214, v214, v218
    v_accvgpr_write_b32 a81, v214
    v_accvgpr_read_b32 v214, a82
    v_mul_f32 v214, v214, v218
    v_accvgpr_write_b32 a82, v214
    v_accvgpr_read_b32 v214, a83
    v_mul_f32 v214, v214, v218
    v_accvgpr_write_b32 a83, v214
    v_accvgpr_read_b32 v214, a84
    v_mul_f32 v214, v214, v218
    v_accvgpr_write_b32 a84, v214
    v_accvgpr_read_b32 v214, a85
    v_mul_f32 v214, v214, v218
    v_accvgpr_write_b32 a85, v214
    v_accvgpr_read_b32 v214, a86
    v_mul_f32 v214, v214, v218
    v_accvgpr_write_b32 a86, v214
    v_accvgpr_read_b32 v214, a87
    v_mul_f32 v214, v214, v218
    v_accvgpr_write_b32 a87, v214
    v_accvgpr_read_b32 v214, a88
    v_mul_f32 v214, v214, v218
    v_accvgpr_write_b32 a88, v214
    v_accvgpr_read_b32 v214, a89
    v_mul_f32 v214, v214, v218
    v_accvgpr_write_b32 a89, v214
    v_accvgpr_read_b32 v214, a90
    v_mul_f32 v214, v214, v218
    v_accvgpr_write_b32 a90, v214
    v_accvgpr_read_b32 v214, a91
    v_mul_f32 v214, v214, v218
    v_accvgpr_write_b32 a91, v214
    v_accvgpr_read_b32 v214, a92
    v_mul_f32 v214, v214, v218
    v_accvgpr_write_b32 a92, v214
    v_accvgpr_read_b32 v214, a93
    v_mul_f32 v214, v214, v218
    v_accvgpr_write_b32 a93, v214
    v_accvgpr_read_b32 v214, a94
    v_mul_f32 v214, v214, v218
    v_accvgpr_write_b32 a94, v214
    v_accvgpr_read_b32 v214, a95
    v_mul_f32 v214, v214, v218
    v_accvgpr_write_b32 a95, v214
    v_exp_f32 v214, v144
    v_exp_f32 v215, v145
    s_nop 0
    v_cvt_pk_bf16_f32 v200, v214, v215
    v_exp_f32 v214, v146
    v_exp_f32 v215, v147
    s_nop 0
    v_cvt_pk_bf16_f32 v201, v214, v215
    v_exp_f32 v214, v148
    v_exp_f32 v215, v149
    s_nop 0
    v_cvt_pk_bf16_f32 v202, v214, v215
    v_exp_f32 v214, v150
    v_exp_f32 v215, v151
    s_nop 0
    v_cvt_pk_bf16_f32 v203, v214, v215
    v_exp_f32 v214, v112
    v_exp_f32 v215, v113
    s_nop 0
    v_cvt_pk_bf16_f32 v192, v214, v215
    v_exp_f32 v214, v114
    v_exp_f32 v215, v115
    s_nop 0
    v_cvt_pk_bf16_f32 v193, v214, v215
    v_exp_f32 v214, v116
    v_exp_f32 v215, v117
    s_nop 0
    v_cvt_pk_bf16_f32 v194, v214, v215
    v_max3_f32 v217, v152, v153, v154
    v_max3_f32 v217, v217, v155, v156
    v_max3_f32 v217, v217, v157, v158
    v_max_f32 v217, v217, v159
    v_mov_b32 v213, v217
    s_nop 1
    v_permlane32_swap_b32 v217, v213
    v_max_f32 v217, v217, v213
    v_mov_b32 v213, v217
    s_nop 1
    v_permlane16_swap_b32 v217, v213
    v_max_f32 v217, v217, v213
    v_max_f32 v217, 0, v217
    v_mov_b32 v212, v220
    v_mov_b32 v213, v220
    s_nop 1
    v_permlane32_swap_b32 v212, v213
    v_log_f32 v212, v213
    s_nop 0
    v_max_f32 v217, v217, v212
    v_sub_f32 v219, 0, v217
    v_exp_f32 v219, v219
    v_sub_f32 v152, v152, v217
    v_sub_f32 v153, v153, v217
    v_sub_f32 v154, v154, v217
    v_sub_f32 v155, v155, v217
    v_sub_f32 v156, v156, v217
    v_sub_f32 v157, v157, v217
    v_sub_f32 v158, v158, v217
    v_sub_f32 v159, v159, v217
    v_sub_f32 v120, v120, v217
    v_sub_f32 v121, v121, v217
    v_sub_f32 v122, v122, v217
    v_sub_f32 v123, v123, v217
    v_sub_f32 v124, v124, v217
    v_sub_f32 v125, v125, v217
    v_sub_f32 v126, v126, v217
    v_sub_f32 v127, v127, v217
    v_sub_f32 v172, v172, v217
    v_sub_f32 v173, v173, v217
    v_sub_f32 v174, v174, v217
    v_sub_f32 v175, v175, v217
    v_accvgpr_read_b32 v214, a96
    v_mul_f32 v214, v214, v219
    v_accvgpr_write_b32 a96, v214
    v_accvgpr_read_b32 v214, a97
    v_mul_f32 v214, v214, v219
    v_accvgpr_write_b32 a97, v214
    v_accvgpr_read_b32 v214, a98
    v_mul_f32 v214, v214, v219
    v_accvgpr_write_b32 a98, v214
    v_accvgpr_read_b32 v214, a99
    v_mul_f32 v214, v214, v219
    v_accvgpr_write_b32 a99, v214
    v_accvgpr_read_b32 v214, a100
    v_mul_f32 v214, v214, v219
    v_accvgpr_write_b32 a100, v214
    v_accvgpr_read_b32 v214, a101
    v_mul_f32 v214, v214, v219
    v_accvgpr_write_b32 a101, v214
    v_accvgpr_read_b32 v214, a102
    v_mul_f32 v214, v214, v219
    v_accvgpr_write_b32 a102, v214
    v_accvgpr_read_b32 v214, a103
    v_mul_f32 v214, v214, v219
    v_accvgpr_write_b32 a103, v214
    v_accvgpr_read_b32 v214, a104
    v_mul_f32 v214, v214, v219
    v_accvgpr_write_b32 a104, v214
    v_accvgpr_read_b32 v214, a105
    v_mul_f32 v214, v214, v219
    v_accvgpr_write_b32 a105, v214
    v_accvgpr_read_b32 v214, a106
    v_mul_f32 v214, v214, v219
    v_accvgpr_write_b32 a106, v214
    v_accvgpr_read_b32 v214, a107
    v_mul_f32 v214, v214, v219
    v_accvgpr_write_b32 a107, v214
    v_accvgpr_read_b32 v214, a108
    v_mul_f32 v214, v214, v219
    v_accvgpr_write_b32 a108, v214
    v_accvgpr_read_b32 v214, a109
    v_mul_f32 v214, v214, v219
    v_accvgpr_write_b32 a109, v214
    v_accvgpr_read_b32 v214, a110
    v_mul_f32 v214, v214, v219
    v_accvgpr_write_b32 a110, v214
    v_accvgpr_read_b32 v214, a111
    v_mul_f32 v214, v214, v219
    v_accvgpr_write_b32 a111, v214
    v_accvgpr_read_b32 v214, a112
    v_mul_f32 v214, v214, v219
    v_accvgpr_write_b32 a112, v214
    v_accvgpr_read_b32 v214, a113
    v_mul_f32 v214, v214, v219
    v_accvgpr_write_b32 a113, v214
    v_accvgpr_read_b32 v214, a114
    v_mul_f32 v214, v214, v219
    v_accvgpr_write_b32 a114, v214
    v_accvgpr_read_b32 v214, a115
    v_mul_f32 v214, v214, v219
    v_accvgpr_write_b32 a115, v214
    v_accvgpr_read_b32 v214, a116
    v_mul_f32 v214, v214, v219
    v_accvgpr_write_b32 a116, v214
    v_accvgpr_read_b32 v214, a117
    v_mul_f32 v214, v214, v219
    v_accvgpr_write_b32 a117, v214
    v_accvgpr_read_b32 v214, a118
    v_mul_f32 v214, v214, v219
    v_accvgpr_write_b32 a118, v214
    v_accvgpr_read_b32 v214, a119
    v_mul_f32 v214, v214, v219
    v_accvgpr_write_b32 a119, v214
    v_accvgpr_read_b32 v214, a120
    v_mul_f32 v214, v214, v219
    v_accvgpr_write_b32 a120, v214
    v_accvgpr_read_b32 v214, a121
    v_mul_f32 v214, v214, v219
    v_accvgpr_write_b32 a121, v214
    v_accvgpr_read_b32 v214, a122
    v_mul_f32 v214, v214, v219
    v_accvgpr_write_b32 a122, v214
    v_accvgpr_read_b32 v214, a123
    v_mul_f32 v214, v214, v219
    v_accvgpr_write_b32 a123, v214
    v_accvgpr_read_b32 v214, a124
    v_mul_f32 v214, v214, v219
    v_accvgpr_write_b32 a124, v214
    v_accvgpr_read_b32 v214, a125
    v_mul_f32 v214, v214, v219
    v_accvgpr_write_b32 a125, v214
    v_accvgpr_read_b32 v214, a126
    v_mul_f32 v214, v214, v219
    v_accvgpr_write_b32 a126, v214
    v_accvgpr_read_b32 v214, a127
    v_mul_f32 v214, v214, v219
    v_accvgpr_write_b32 a127, v214
    v_exp_f32 v214, v152
    v_exp_f32 v215, v153
    s_nop 0
    v_cvt_pk_bf16_f32 v204, v214, v215
    v_exp_f32 v214, v154
    v_exp_f32 v215, v155
    s_nop 0
    v_cvt_pk_bf16_f32 v205, v214, v215
    v_exp_f32 v214, v156
    v_exp_f32 v215, v157
    s_nop 0
    v_cvt_pk_bf16_f32 v206, v214, v215
    v_exp_f32 v214, v158
    v_exp_f32 v215, v159
    s_nop 0
    v_cvt_pk_bf16_f32 v207, v214, v215
    v_cmp_gt_u32 vcc, 32, v1
    s_nop 1
    v_cndmask_b32 v212, v219, v218, vcc
    v_mul_f32 v228, v233, v212
    s_nop 1
    v_smfmac_f32_16x16x64_bf16 v[228:231], v[24:27], v[200:207], v235
    s_nop 7
    s_setpc_b64 s[98:99]
L_slowfn0_1_1:
    s_nop 15
    v_mov_b32 v220, v232
    v_mov_b32 v221, v232
    s_nop 1
    v_permlane16_swap_b32 v220, v221
    v_add_f32 v220, v220, v221
    v_max3_f32 v216, v128, v129, v130
    v_max3_f32 v216, v216, v131, v132
    v_max3_f32 v216, v216, v133, v134
    v_max_f32 v216, v216, v135
    v_mov_b32 v213, v216
    s_nop 1
    v_permlane32_swap_b32 v216, v213
    v_max_f32 v216, v216, v213
    v_mov_b32 v213, v216
    s_nop 1
    v_permlane16_swap_b32 v216, v213
    v_max_f32 v216, v216, v213
    v_max_f32 v216, 0, v216
    v_mov_b32 v212, v220
    v_mov_b32 v213, v220
    s_nop 1
    v_permlane32_swap_b32 v212, v213
    v_log_f32 v212, v212
    s_nop 0
    v_max_f32 v216, v216, v212
    v_sub_f32 v218, 0, v216
    v_exp_f32 v218, v218
    v_sub_f32 v128, v128, v216
    v_sub_f32 v129, v129, v216
    v_sub_f32 v130, v130, v216
    v_sub_f32 v131, v131, v216
    v_sub_f32 v132, v132, v216
    v_sub_f32 v133, v133, v216
    v_sub_f32 v134, v134, v216
    v_sub_f32 v135, v135, v216
    v_sub_f32 v160, v160, v216
    v_sub_f32 v161, v161, v216
    v_sub_f32 v162, v162, v216
    v_sub_f32 v163, v163, v216
    v_accvgpr_read_b32 v214, a0
    v_mul_f32 v214, v214, v218
    v_accvgpr_write_b32 a0, v214
    v_accvgpr_read_b32 v214, a1
    v_mul_f32 v214, v214, v218
    v_accvgpr_write_b32 a1, v214
    v_accvgpr_read_b32 v214, a2
    v_mul_f32 v214, v214, v218
    v_accvgpr_write_b32 a2, v214
    v_accvgpr_read_b32 v214, a3
    v_mul_f32 v214, v214, v218
    v_accvgpr_write_b32 a3, v214
    v_accvgpr_read_b32 v214, a4
    v_mul_f32 v214, v214, v218
    v_accvgpr_write_b32 a4, v214
    v_accvgpr_read_b32 v214, a5
    v_mul_f32 v214, v214, v218
    v_accvgpr_write_b32 a5, v214
    v_accvgpr_read_b32 v214, a6
    v_mul_f32 v214, v214, v218
    v_accvgpr_write_b32 a6, v214
    v_accvgpr_read_b32 v214, a7
    v_mul_f32 v214, v214, v218
    v_accvgpr_write_b32 a7, v214
    v_accvgpr_read_b32 v214, a8
    v_mul_f32 v214, v214, v218
    v_accvgpr_write_b32 a8, v214
    v_accvgpr_read_b32 v214, a9
    v_mul_f32 v214, v214, v218
    v_accvgpr_write_b32 a9, v214
    v_accvgpr_read_b32 v214, a10
    v_mul_f32 v214, v214, v218
    v_accvgpr_write_b32 a10, v214
    v_accvgpr_read_b32 v214, a11
    v_mul_f32 v214, v214, v218
    v_accvgpr_write_b32 a11, v214
    v_accvgpr_read_b32 v214, a12
    v_mul_f32 v214, v214, v218
    v_accvgpr_write_b32 a12, v214
    v_accvgpr_read_b32 v214, a13
    v_mul_f32 v214, v214, v218
    v_accvgpr_write_b32 a13, v214
    v_accvgpr_read_b32 v214, a14
    v_mul_f32 v214, v214, v218
    v_accvgpr_write_b32 a14, v214
    v_accvgpr_read_b32 v214, a15
    v_mul_f32 v214, v214, v218
    v_accvgpr_write_b32 a15, v214
    v_accvgpr_read_b32 v214, a16
    v_mul_f32 v214, v214, v218
    v_accvgpr_write_b32 a16, v214
    v_accvgpr_read_b32 v214, a17
    v_mul_f32 v214, v214, v218
    v_accvgpr_write_b32 a17, v214
    v_accvgpr_read_b32 v214, a18
    v_mul_f32 v214, v214, v218
    v_accvgpr_write_b32 a18, v214
    v_accvgpr_read_b32 v214, a19
    v_mul_f32 v214, v214, v218
    v_accvgpr_write_b32 a19, v214
    v_accvgpr_read_b32 v214, a20
    v_mul_f32 v214, v214, v218
    v_accvgpr_write_b32 a20, v214
    v_accvgpr_read_b32 v214, a21
    v_mul_f32 v214, v214, v218
    v_accvgpr_write_b32 a21, v214
    v_accvgpr_read_b32 v214, a22
    v_mul_f32 v214, v214, v218
    v_accvgpr_write_b32 a22, v214
    v_accvgpr_read_b32 v214, a23
    v_mul_f32 v214, v214, v218
    v_accvgpr_write_b32 a23, v214
    v_accvgpr_read_b32 v214, a24
    v_mul_f32 v214, v214, v218
    v_accvgpr_write_b32 a24, v214
    v_accvgpr_read_b32 v214, a25
    v_mul_f32 v214, v214, v218
    v_accvgpr_write_b32 a25, v214
    v_accvgpr_read_b32 v214, a26
    v_mul_f32 v214, v214, v218
    v_accvgpr_write_b32 a26, v214
    v_accvgpr_read_b32 v214, a27
    v_mul_f32 v214, v214, v218
    v_accvgpr_write_b32 a27, v214
    v_accvgpr_read_b32 v214, a28
    v_mul_f32 v214, v214, v218
    v_accvgpr_write_b32 a28, v214
    v_accvgpr_read_b32 v214, a29
    v_mul_f32 v214, v214, v218
    v_accvgpr_write_b32 a29, v214
    v_accvgpr_read_b32 v214, a30
    v_mul_f32 v214, v214, v218
    v_accvgpr_write_b32 a30, v214
    v_accvgpr_read_b32 v214, a31
    v_mul_f32 v214, v214, v218
    v_accvgpr_write_b32 a31, v214
    v_exp_f32 v214, v128
    v_exp_f32 v215, v129
    s_nop 0
    v_cvt_pk_bf16_f32 v184, v214, v215
    v_exp_f32 v214, v130
    v_exp_f32 v215, v131
    s_nop 0
    v_cvt_pk_bf16_f32 v185, v214, v215
    v_exp_f32 v214, v132
    v_exp_f32 v215, v133
    s_nop 0
    v_cvt_pk_bf16_f32 v186, v214, v215
    v_exp_f32 v214, v134
    v_exp_f32 v215, v135
    s_nop 0
    v_cvt_pk_bf16_f32 v187, v214, v215
    v_max3_f32 v217, v136, v137, v138
    v_max3_f32 v217, v217, v139, v140
    v_max3_f32 v217, v217, v141, v142
    v_max_f32 v217, v217, v143
    v_mov_b32 v213, v217
    s_nop 1
    v_permlane32_swap_b32 v217, v213
    v_max_f32 v217, v217, v213
    v_mov_b32 v213, v217
    s_nop 1
    v_permlane16_swap_b32 v217, v213
    v_max_f32 v217, v217, v213
    v_max_f32 v217, 0, v217
    v_mov_b32 v212, v220
    v_mov_b32 v213, v220
    s_nop 1
    v_permlane32_swap_b32 v212, v213
    v_log_f32 v212, v213
    s_nop 0
    v_max_f32 v217, v217, v212
    v_sub_f32 v219, 0, v217
    v_exp_f32 v219, v219
    v_sub_f32 v136, v136, v217
    v_sub_f32 v137, v137, v217
    v_sub_f32 v138, v138, v217
    v_sub_f32 v139, v139, v217
    v_sub_f32 v140, v140, v217
    v_sub_f32 v141, v141, v217
    v_sub_f32 v142, v142, v217
    v_sub_f32 v143, v143, v217
    v_sub_f32 v164, v164, v217
    v_sub_f32 v165, v165, v217
    v_sub_f32 v166, v166, v217
    v_sub_f32 v167, v167, v217
    v_accvgpr_read_b32 v214, a32
    v_mul_f32 v214, v214, v219
    v_accvgpr_write_b32 a32, v214
    v_accvgpr_read_b32 v214, a33
    v_mul_f32 v214, v214, v219
    v_accvgpr_write_b32 a33, v214
    v_accvgpr_read_b32 v214, a34
    v_mul_f32 v214, v214, v219
    v_accvgpr_write_b32 a34, v214
    v_accvgpr_read_b32 v214, a35
    v_mul_f32 v214, v214, v219
    v_accvgpr_write_b32 a35, v214
    v_accvgpr_read_b32 v214, a36
    v_mul_f32 v214, v214, v219
    v_accvgpr_write_b32 a36, v214
    v_accvgpr_read_b32 v214, a37
    v_mul_f32 v214, v214, v219
    v_accvgpr_write_b32 a37, v214
    v_accvgpr_read_b32 v214, a38
    v_mul_f32 v214, v214, v219
    v_accvgpr_write_b32 a38, v214
    v_accvgpr_read_b32 v214, a39
    v_mul_f32 v214, v214, v219
    v_accvgpr_write_b32 a39, v214
    v_accvgpr_read_b32 v214, a40
    v_mul_f32 v214, v214, v219
    v_accvgpr_write_b32 a40, v214
    v_accvgpr_read_b32 v214, a41
    v_mul_f32 v214, v214, v219
    v_accvgpr_write_b32 a41, v214
    v_accvgpr_read_b32 v214, a42
    v_mul_f32 v214, v214, v219
    v_accvgpr_write_b32 a42, v214
    v_accvgpr_read_b32 v214, a43
    v_mul_f32 v214, v214, v219
    v_accvgpr_write_b32 a43, v214
    v_accvgpr_read_b32 v214, a44
    v_mul_f32 v214, v214, v219
    v_accvgpr_write_b32 a44, v214
    v_accvgpr_read_b32 v214, a45
    v_mul_f32 v214, v214, v219
    v_accvgpr_write_b32 a45, v214
    v_accvgpr_read_b32 v214, a46
    v_mul_f32 v214, v214, v219
    v_accvgpr_write_b32 a46, v214
    v_accvgpr_read_b32 v214, a47
    v_mul_f32 v214, v214, v219
    v_accvgpr_write_b32 a47, v214
    v_accvgpr_read_b32 v214, a48
    v_mul_f32 v214, v214, v219
    v_accvgpr_write_b32 a48, v214
    v_accvgpr_read_b32 v214, a49
    v_mul_f32 v214, v214, v219
    v_accvgpr_write_b32 a49, v214
    v_accvgpr_read_b32 v214, a50
    v_mul_f32 v214, v214, v219
    v_accvgpr_write_b32 a50, v214
    v_accvgpr_read_b32 v214, a51
    v_mul_f32 v214, v214, v219
    v_accvgpr_write_b32 a51, v214
    v_accvgpr_read_b32 v214, a52
    v_mul_f32 v214, v214, v219
    v_accvgpr_write_b32 a52, v214
    v_accvgpr_read_b32 v214, a53
    v_mul_f32 v214, v214, v219
    v_accvgpr_write_b32 a53, v214
    v_accvgpr_read_b32 v214, a54
    v_mul_f32 v214, v214, v219
    v_accvgpr_write_b32 a54, v214
    v_accvgpr_read_b32 v214, a55
    v_mul_f32 v214, v214, v219
    v_accvgpr_write_b32 a55, v214
    v_accvgpr_read_b32 v214, a56
    v_mul_f32 v214, v214, v219
    v_accvgpr_write_b32 a56, v214
    v_accvgpr_read_b32 v214, a57
    v_mul_f32 v214, v214, v219
    v_accvgpr_write_b32 a57, v214
    v_accvgpr_read_b32 v214, a58
    v_mul_f32 v214, v214, v219
    v_accvgpr_write_b32 a58, v214
    v_accvgpr_read_b32 v214, a59
    v_mul_f32 v214, v214, v219
    v_accvgpr_write_b32 a59, v214
    v_accvgpr_read_b32 v214, a60
    v_mul_f32 v214, v214, v219
    v_accvgpr_write_b32 a60, v214
    v_accvgpr_read_b32 v214, a61
    v_mul_f32 v214, v214, v219
    v_accvgpr_write_b32 a61, v214
    v_accvgpr_read_b32 v214, a62
    v_mul_f32 v214, v214, v219
    v_accvgpr_write_b32 a62, v214
    v_accvgpr_read_b32 v214, a63
    v_mul_f32 v214, v214, v219
    v_accvgpr_write_b32 a63, v214
    v_exp_f32 v214, v136
    v_exp_f32 v215, v137
    s_nop 0
    v_cvt_pk_bf16_f32 v188, v214, v215
    v_exp_f32 v214, v138
    v_exp_f32 v215, v139
    s_nop 0
    v_cvt_pk_bf16_f32 v189, v214, v215
    v_exp_f32 v214, v140
    v_exp_f32 v215, v141
    s_nop 0
    v_cvt_pk_bf16_f32 v190, v214, v215
    v_exp_f32 v214, v142
    v_exp_f32 v215, v143
    s_nop 0
    v_cvt_pk_bf16_f32 v191, v214, v215
    v_cmp_gt_u32 vcc, 32, v1
    s_nop 1
    v_cndmask_b32 v212, v219, v218, vcc
    v_mul_f32 v224, v232, v212
    s_nop 1
    v_smfmac_f32_16x16x64_bf16 v[224:227], v[24:27], v[184:191], v235
    s_nop 7
    s_setpc_b64 s[98:99]
L_slowfn1_1_1:
    s_nop 15
    v_mov_b32 v220, v233
    v_mov_b32 v221, v233
    s_nop 1
    v_permlane16_swap_b32 v220, v221
    v_add_f32 v220, v220, v221
    v_max3_f32 v216, v144, v145, v146
    v_max3_f32 v216, v216, v147, v148
    v_max3_f32 v216, v216, v149, v150
    v_max_f32 v216, v216, v151
    v_mov_b32 v213, v216
    s_nop 1
    v_permlane32_swap_b32 v216, v213
    v_max_f32 v216, v216, v213
    v_mov_b32 v213, v216
    s_nop 1
    v_permlane16_swap_b32 v216, v213
    v_max_f32 v216, v216, v213
    v_max_f32 v216, 0, v216
    v_mov_b32 v212, v220
    v_mov_b32 v213, v220
    s_nop 1
    v_permlane32_swap_b32 v212, v213
    v_log_f32 v212, v212
    s_nop 0
    v_max_f32 v216, v216, v212
    v_sub_f32 v218, 0, v216
    v_exp_f32 v218, v218
    v_sub_f32 v144, v144, v216
    v_sub_f32 v145, v145, v216
    v_sub_f32 v146, v146, v216
    v_sub_f32 v147, v147, v216
    v_sub_f32 v148, v148, v216
    v_sub_f32 v149, v149, v216
    v_sub_f32 v150, v150, v216
    v_sub_f32 v151, v151, v216
    v_sub_f32 v168, v168, v216
    v_sub_f32 v169, v169, v216
    v_sub_f32 v170, v170, v216
    v_sub_f32 v171, v171, v216
    v_accvgpr_read_b32 v214, a64
    v_mul_f32 v214, v214, v218
    v_accvgpr_write_b32 a64, v214
    v_accvgpr_read_b32 v214, a65
    v_mul_f32 v214, v214, v218
    v_accvgpr_write_b32 a65, v214
    v_accvgpr_read_b32 v214, a66
    v_mul_f32 v214, v214, v218
    v_accvgpr_write_b32 a66, v214
    v_accvgpr_read_b32 v214, a67
    v_mul_f32 v214, v214, v218
    v_accvgpr_write_b32 a67, v214
    v_accvgpr_read_b32 v214, a68
    v_mul_f32 v214, v214, v218
    v_accvgpr_write_b32 a68, v214
    v_accvgpr_read_b32 v214, a69
    v_mul_f32 v214, v214, v218
    v_accvgpr_write_b32 a69, v214
    v_accvgpr_read_b32 v214, a70
    v_mul_f32 v214, v214, v218
    v_accvgpr_write_b32 a70, v214
    v_accvgpr_read_b32 v214, a71
    v_mul_f32 v214, v214, v218
    v_accvgpr_write_b32 a71, v214
    v_accvgpr_read_b32 v214, a72
    v_mul_f32 v214, v214, v218
    v_accvgpr_write_b32 a72, v214
    v_accvgpr_read_b32 v214, a73
    v_mul_f32 v214, v214, v218
    v_accvgpr_write_b32 a73, v214
    v_accvgpr_read_b32 v214, a74
    v_mul_f32 v214, v214, v218
    v_accvgpr_write_b32 a74, v214
    v_accvgpr_read_b32 v214, a75
    v_mul_f32 v214, v214, v218
    v_accvgpr_write_b32 a75, v214
    v_accvgpr_read_b32 v214, a76
    v_mul_f32 v214, v214, v218
    v_accvgpr_write_b32 a76, v214
    v_accvgpr_read_b32 v214, a77
    v_mul_f32 v214, v214, v218
    v_accvgpr_write_b32 a77, v214
    v_accvgpr_read_b32 v214, a78
    v_mul_f32 v214, v214, v218
    v_accvgpr_write_b32 a78, v214
    v_accvgpr_read_b32 v214, a79
    v_mul_f32 v214, v214, v218
    v_accvgpr_write_b32 a79, v214
    v_accvgpr_read_b32 v214, a80
    v_mul_f32 v214, v214, v218
    v_accvgpr_write_b32 a80, v214
    v_accvgpr_read_b32 v214, a81
    v_mul_f32 v214, v214, v218
    v_accvgpr_write_b32 a81, v214
    v_accvgpr_read_b32 v214, a82
    v_mul_f32 v214, v214, v218
    v_accvgpr_write_b32 a82, v214
    v_accvgpr_read_b32 v214, a83
    v_mul_f32 v214, v214, v218
    v_accvgpr_write_b32 a83, v214
    v_accvgpr_read_b32 v214, a84
    v_mul_f32 v214, v214, v218
    v_accvgpr_write_b32 a84, v214
    v_accvgpr_read_b32 v214, a85
    v_mul_f32 v214, v214, v218
    v_accvgpr_write_b32 a85, v214
    v_accvgpr_read_b32 v214, a86
    v_mul_f32 v214, v214, v218
    v_accvgpr_write_b32 a86, v214
    v_accvgpr_read_b32 v214, a87
    v_mul_f32 v214, v214, v218
    v_accvgpr_write_b32 a87, v214
    v_accvgpr_read_b32 v214, a88
    v_mul_f32 v214, v214, v218
    v_accvgpr_write_b32 a88, v214
    v_accvgpr_read_b32 v214, a89
    v_mul_f32 v214, v214, v218
    v_accvgpr_write_b32 a89, v214
    v_accvgpr_read_b32 v214, a90
    v_mul_f32 v214, v214, v218
    v_accvgpr_write_b32 a90, v214
    v_accvgpr_read_b32 v214, a91
    v_mul_f32 v214, v214, v218
    v_accvgpr_write_b32 a91, v214
    v_accvgpr_read_b32 v214, a92
    v_mul_f32 v214, v214, v218
    v_accvgpr_write_b32 a92, v214
    v_accvgpr_read_b32 v214, a93
    v_mul_f32 v214, v214, v218
    v_accvgpr_write_b32 a93, v214
    v_accvgpr_read_b32 v214, a94
    v_mul_f32 v214, v214, v218
    v_accvgpr_write_b32 a94, v214
    v_accvgpr_read_b32 v214, a95
    v_mul_f32 v214, v214, v218
    v_accvgpr_write_b32 a95, v214
    v_exp_f32 v214, v144
    v_exp_f32 v215, v145
    s_nop 0
    v_cvt_pk_bf16_f32 v200, v214, v215
    v_exp_f32 v214, v146
    v_exp_f32 v215, v147
    s_nop 0
    v_cvt_pk_bf16_f32 v201, v214, v215
    v_exp_f32 v214, v148
    v_exp_f32 v215, v149
    s_nop 0
    v_cvt_pk_bf16_f32 v202, v214, v215
    v_exp_f32 v214, v150
    v_exp_f32 v215, v151
    s_nop 0
    v_cvt_pk_bf16_f32 v203, v214, v215
    v_max3_f32 v217, v152, v153, v154
    v_max3_f32 v217, v217, v155, v156
    v_max3_f32 v217, v217, v157, v158
    v_max_f32 v217, v217, v159
    v_mov_b32 v213, v217
    s_nop 1
    v_permlane32_swap_b32 v217, v213
    v_max_f32 v217, v217, v213
    v_mov_b32 v213, v217
    s_nop 1
    v_permlane16_swap_b32 v217, v213
    v_max_f32 v217, v217, v213
    v_max_f32 v217, 0, v217
    v_mov_b32 v212, v220
    v_mov_b32 v213, v220
    s_nop 1
    v_permlane32_swap_b32 v212, v213
    v_log_f32 v212, v213
    s_nop 0
    v_max_f32 v217, v217, v212
    v_sub_f32 v219, 0, v217
    v_exp_f32 v219, v219
    v_sub_f32 v152, v152, v217
    v_sub_f32 v153, v153, v217
    v_sub_f32 v154, v154, v217
    v_sub_f32 v155, v155, v217
    v_sub_f32 v156, v156, v217
    v_sub_f32 v157, v157, v217
    v_sub_f32 v158, v158, v217
    v_sub_f32 v159, v159, v217
    v_sub_f32 v172, v172, v217
    v_sub_f32 v173, v173, v217
    v_sub_f32 v174, v174, v217
    v_sub_f32 v175, v175, v217
    v_accvgpr_read_b32 v214, a96
    v_mul_f32 v214, v214, v219
    v_accvgpr_write_b32 a96, v214
    v_accvgpr_read_b32 v214, a97
    v_mul_f32 v214, v214, v219
    v_accvgpr_write_b32 a97, v214
    v_accvgpr_read_b32 v214, a98
    v_mul_f32 v214, v214, v219
    v_accvgpr_write_b32 a98, v214
    v_accvgpr_read_b32 v214, a99
    v_mul_f32 v214, v214, v219
    v_accvgpr_write_b32 a99, v214
    v_accvgpr_read_b32 v214, a100
    v_mul_f32 v214, v214, v219
    v_accvgpr_write_b32 a100, v214
    v_accvgpr_read_b32 v214, a101
    v_mul_f32 v214, v214, v219
    v_accvgpr_write_b32 a101, v214
    v_accvgpr_read_b32 v214, a102
    v_mul_f32 v214, v214, v219
    v_accvgpr_write_b32 a102, v214
    v_accvgpr_read_b32 v214, a103
    v_mul_f32 v214, v214, v219
    v_accvgpr_write_b32 a103, v214
    v_accvgpr_read_b32 v214, a104
    v_mul_f32 v214, v214, v219
    v_accvgpr_write_b32 a104, v214
    v_accvgpr_read_b32 v214, a105
    v_mul_f32 v214, v214, v219
    v_accvgpr_write_b32 a105, v214
    v_accvgpr_read_b32 v214, a106
    v_mul_f32 v214, v214, v219
    v_accvgpr_write_b32 a106, v214
    v_accvgpr_read_b32 v214, a107
    v_mul_f32 v214, v214, v219
    v_accvgpr_write_b32 a107, v214
    v_accvgpr_read_b32 v214, a108
    v_mul_f32 v214, v214, v219
    v_accvgpr_write_b32 a108, v214
    v_accvgpr_read_b32 v214, a109
    v_mul_f32 v214, v214, v219
    v_accvgpr_write_b32 a109, v214
    v_accvgpr_read_b32 v214, a110
    v_mul_f32 v214, v214, v219
    v_accvgpr_write_b32 a110, v214
    v_accvgpr_read_b32 v214, a111
    v_mul_f32 v214, v214, v219
    v_accvgpr_write_b32 a111, v214
    v_accvgpr_read_b32 v214, a112
    v_mul_f32 v214, v214, v219
    v_accvgpr_write_b32 a112, v214
    v_accvgpr_read_b32 v214, a113
    v_mul_f32 v214, v214, v219
    v_accvgpr_write_b32 a113, v214
    v_accvgpr_read_b32 v214, a114
    v_mul_f32 v214, v214, v219
    v_accvgpr_write_b32 a114, v214
    v_accvgpr_read_b32 v214, a115
    v_mul_f32 v214, v214, v219
    v_accvgpr_write_b32 a115, v214
    v_accvgpr_read_b32 v214, a116
    v_mul_f32 v214, v214, v219
    v_accvgpr_write_b32 a116, v214
    v_accvgpr_read_b32 v214, a117
    v_mul_f32 v214, v214, v219
    v_accvgpr_write_b32 a117, v214
    v_accvgpr_read_b32 v214, a118
    v_mul_f32 v214, v214, v219
    v_accvgpr_write_b32 a118, v214
    v_accvgpr_read_b32 v214, a119
    v_mul_f32 v214, v214, v219
    v_accvgpr_write_b32 a119, v214
    v_accvgpr_read_b32 v214, a120
    v_mul_f32 v214, v214, v219
    v_accvgpr_write_b32 a120, v214
    v_accvgpr_read_b32 v214, a121
    v_mul_f32 v214, v214, v219
    v_accvgpr_write_b32 a121, v214
    v_accvgpr_read_b32 v214, a122
    v_mul_f32 v214, v214, v219
    v_accvgpr_write_b32 a122, v214
    v_accvgpr_read_b32 v214, a123
    v_mul_f32 v214, v214, v219
    v_accvgpr_write_b32 a123, v214
    v_accvgpr_read_b32 v214, a124
    v_mul_f32 v214, v214, v219
    v_accvgpr_write_b32 a124, v214
    v_accvgpr_read_b32 v214, a125
    v_mul_f32 v214, v214, v219
    v_accvgpr_write_b32 a125, v214
    v_accvgpr_read_b32 v214, a126
    v_mul_f32 v214, v214, v219
    v_accvgpr_write_b32 a126, v214
    v_accvgpr_read_b32 v214, a127
    v_mul_f32 v214, v214, v219
    v_accvgpr_write_b32 a127, v214
    v_exp_f32 v214, v152
    v_exp_f32 v215, v153
    s_nop 0
    v_cvt_pk_bf16_f32 v204, v214, v215
    v_exp_f32 v214, v154
    v_exp_f32 v215, v155
    s_nop 0
    v_cvt_pk_bf16_f32 v205, v214, v215
    v_exp_f32 v214, v156
    v_exp_f32 v215, v157
    s_nop 0
    v_cvt_pk_bf16_f32 v206, v214, v215
    v_exp_f32 v214, v158
    v_exp_f32 v215, v159
    s_nop 0
    v_cvt_pk_bf16_f32 v207, v214, v215
    v_cmp_gt_u32 vcc, 32, v1
    s_nop 1
    v_cndmask_b32 v212, v219, v218, vcc
    v_mul_f32 v228, v233, v212
    s_nop 1
    v_smfmac_f32_16x16x64_bf16 v[228:231], v[24:27], v[200:207], v235
    s_nop 7
    s_setpc_b64 s[98:99]
L_codeend:
    s_endpgm
.section .rodata,"a"
.p2align 6
.amdhsa_kernel recurrent_scan__mha_block_cached__glu_gated_bilinear__prompt_kernel
  .amdhsa_next_free_vgpr 512
  .amdhsa_next_free_sgpr 102
  .amdhsa_accum_offset 256
  .amdhsa_group_segment_fixed_size 0
  .amdhsa_kernarg_size 96
  .amdhsa_user_sgpr_count 2
  .amdhsa_user_sgpr_kernarg_segment_ptr 1
  .amdhsa_system_sgpr_workgroup_id_x 1
.end_amdhsa_kernel
```
